```python
import torch

def _softmax(x, axis=-1):
    return torch.softmax(x, dim=axis)
def _gelu(x):
    return torch.nn.functional.gelu(x, approximate="tanh")
def _silu(x):
    return torch.nn.functional.silu(x)
def _sigmoid(x):
    return torch.sigmoid(x)
def _layernorm(x, axis=-1, eps=1e-5):
    m = x.mean(dim=axis, keepdim=True)
    v = x.var(dim=axis, keepdim=True, unbiased=False)
    return (x - m) / torch.sqrt(v + eps)
def _scatter_add(tgt, idx, src, axis=0):
    return tgt.clone().index_add_(axis, idx, src)
def _segment_sum(src, seg, n):
    out = torch.zeros((n,) + src.shape[1:], dtype=src.dtype)
    return out.index_add_(0, seg, src)
def _pad(x, pw):
    flat = tuple(v for pair in reversed(pw) for v in pair)
    return torch.nn.functional.pad(x, flat)

kernel_name = 'interleave_layers__ssm_conv_h3__dense_activation_mish__prompt'

def setup_inputs():

    _w = (lambda a: (lambda t: t.to(torch.bfloat16) if t.is_floating_point() else t)(torch.as_tensor(a)))
    def _A_setup():
        B, S, D = 1, 2048, 640
        ks = 4
        return {
            "q": _w((lambda *s: torch.randn(*s, dtype=torch.bfloat16) * 0.05)(B, S, D)),
            "k": _w((lambda *s: torch.randn(*s, dtype=torch.bfloat16) * 0.2)(B, S, D)),
            "v": _w((lambda *s: torch.randn(*s, dtype=torch.bfloat16) * 0.2)(B, S, D)),
            "shift_k": _w((lambda *s: torch.randn(*s, dtype=torch.bfloat16) * 0.2)(D, ks) * 0.5),
            "ssm_k": _w((lambda *s: torch.randn(*s, dtype=torch.bfloat16) * 0.4)(D, S) * (1.0 / S ** 0.5)),
            "ssm_D": _w((lambda *s: torch.randn(*s, dtype=torch.bfloat16) * 0.2)(D)),
        }
    _A_in = _A_setup()

    def _B_setup():
        B, S, D, F = 1, 2048, 640, 1728
        return {
            "x": _w((lambda *s: torch.randn(*s, dtype=torch.bfloat16) * 0.05)(B, S, D)),
            "w1": _w((lambda *s: torch.randn(*s, dtype=torch.bfloat16) * 0.8)(D, F) * (D ** -0.5)),
            "b1": _w((lambda *s: torch.randn(*s, dtype=torch.bfloat16) * 0.2)(F)),
            "w2": _w((lambda *s: torch.randn(*s, dtype=torch.bfloat16) * 0.1)(F, D) * (F ** -0.5)),
        }
    _B_in = _B_setup()

    return {
        "A_q": _A_in["q"],
        "A_k": _A_in["k"],
        "A_v": _A_in["v"],
        "A_shift_k": _A_in["shift_k"],
        "A_ssm_k": _A_in["ssm_k"],
        "A_ssm_D": _A_in["ssm_D"],
        "B_x": _B_in["x"],
        "B_w1": _B_in["w1"],
        "B_b1": _B_in["b1"],
        "B_w2": _B_in["w2"],
    }

def reference(A_q, A_k, A_v, A_shift_k, A_ssm_k, A_ssm_D, B_x, B_w1, B_b1, B_w2):
    def _A_ref(q, k, v, shift_k, ssm_k, ssm_D):
        B, S, D = q.shape
        ks = shift_k.shape[-1]
        k_pad = _pad(k, ((0, 0), (ks - 1, 0), (0, 0)))
        k_shift = torch.zeros_like(k)
        for t in range(ks):
            k_shift = k_shift + k_pad[:, t:t + S, :] * shift_k[:, ks - 1 - t][None, None, :]
        kv = k_shift * v
        L = 2 * S
        kv_pad = _pad(kv, ((0, 0), (0, S), (0, 0)))
        kf_pad = _pad(ssm_k, ((0, 0), (0, S)))
        kv_f = (lambda x, axes=(-2,-1): torch.fft.rfft2(x.float(), dim=axes))(kv_pad[:, None, :, :], axes=(1, 2))
        kf_f = (lambda x, axes=(-2,-1): torch.fft.rfft2(x.float(), dim=axes))(kf_pad[:, None, :], axes=(1, 2))
        kf_f = (lambda x, *d: x.permute(*d))(kf_f, 1, 2, 0)
        y_f = kv_f * kf_f[None, :, :, :]
        y = (lambda x, s, axes=(-2,-1): torch.fft.irfft2(x, s=s, dim=axes).to(torch.bfloat16))(y_f, (1, L), axes=(1, 2))[:, 0, :S, :]
        y = y + kv * ssm_D[None, None, :]
        return q * y

    def _B_ref(x, w1, b1, w2):
        h = torch.einsum("bsd,df->bsf", x, w1) + b1
        sp = torch.log1p(torch.exp(-torch.abs(h))) + torch.where(h > 0, h, torch.zeros_like(h))
        act = h * torch.tanh(sp)
        return torch.einsum("bsf,fd->bsd", act, w2)

    x = A_q
    x = x + _A_ref(_layernorm(x, axis=-1), A_k, A_v, A_shift_k, A_ssm_k, A_ssm_D)
    x = x + _B_ref(_layernorm(x, axis=-1), B_w1, B_b1, B_w2)
    x = x + _A_ref(_layernorm(x, axis=-1), A_k, A_v, A_shift_k, A_ssm_k, A_ssm_D)
    x = x + _B_ref(_layernorm(x, axis=-1), B_w1, B_b1, B_w2)
    return x
```

```asm
; @launch grid=(256,1,1) block=(256,1,1) lds=163840
.amdgcn_target "amdgcn-amd-amdhsa--gfx950"
.text
.globl interleave_layers__ssm_conv_h3__dense_activation_mish__prompt_kernel
.p2align 8
.type interleave_layers__ssm_conv_h3__dense_activation_mish__prompt_kernel,@function
interleave_layers__ssm_conv_h3__dense_activation_mish__prompt_kernel:
    s_cmp_ge_u32 s2, 256
    s_cbranch_scc1 END
    s_load_dwordx16 s[4:19], s[0:1], 0
    s_load_dwordx8 s[20:27], s[0:1], 64
    s_load_dwordx2 s[28:29], s[0:1], 96
    s_getpc_b64 s[70:71]
    s_lshr_b32 s53, s2, 3
    s_lshl_b32 s64, s53, 11
    v_lshl_add_u32 v30, v0, 3, s64
    global_load_dword v27, v30, s[70:71]
    v_lshrrev_b32 v30, 6, v0
    v_and_b32 v0, 63, v0
    v_readfirstlane_b32 s54, v30
    s_and_b32 s52, s2, 7
    v_lshlrev_b32 v4, 3, v0
    v_and_b32 v2, 15, v0
    v_lshrrev_b32 v3, 4, v0
    v_lshlrev_b32 v1, 4, v0
    s_mov_b32 s51, 0x20000
    s_mov_b64 s[48:49], s[0:1]
    s_mov_b32 s50, 0
    v_mul_u32_u24 v30, 205, v0
    v_lshrrev_b32 v30, 11, v30
    v_mul_u32_u24 v38, 1120, v30
    v_lshl_add_u32 v38, v0, 4, v38
    s_lshl_b32 s68, s52, 9
    s_add_u32 s68, s68, 4096
    v_add_u32 v35, s68, v4
    s_lshl_b32 s69, s2, 2
    s_add_u32 s69, s69, s54
    s_lshl_b32 s70, s69, 7
    s_add_u32 s70, s70, 262144
    v_writelane_b32 v35, s70, 4
    s_add_u32 s70, s70, 131072
    v_writelane_b32 v35, s70, 8
    s_lshl_b32 s69, s69, 8
    v_writelane_b32 v35, s69, 2
    s_add_u32 s69, s69, 128
    v_writelane_b32 v35, s69, 3
    s_add_u32 s70, s68, 61440
    v_writelane_b32 v35, s70, 5
    s_add_u32 s70, s70, 128
    v_writelane_b32 v35, s70, 6
    s_add_u32 s70, s70, 128
    v_writelane_b32 v35, s70, 7
    s_lshl_b32 s64, s53, 2
    s_add_u32 s64, s64, s54
    s_mul_i32 s65, s64, 20480
    s_mul_i32 s66, s52, 160
    s_add_u32 s65, s65, s66
    v_add_u32 v38, s65, v38
    v_subrev_u32 v39, 5120, v38
    s_mov_b32 s38, 2621440
    s_mov_b32 s39, 0x20000
    s_mov_b32 s42, 2621440
    s_mov_b32 s43, 0x20000
    s_mul_i32 s66, s52, 640
    v_lshl_add_u32 v30, v2, 3, s66
    s_mul_i32 s3, s52, 20
    s_min_u32 s65, s53, 19
    s_add_u32 s3, s3, s65
    s_lshl_b32 s67, s3, 2
    s_add_u32 s67, s67, s54
    s_lshl_b32 s65, s67, 1
    s_and_b32 s66, s65, 0xfffc
    s_waitcnt lgkmcnt(0)
    s_load_dword s60, s[28:29], 0
    s_load_dword s61, s[14:15], s66
    global_load_dword v27, v35, s[28:29] sc1
    global_load_dwordx2 v[40:41], v30, s[10:11] offset:0
    global_load_dwordx2 v[42:43], v30, s[10:11] offset:128
    global_load_dwordx2 v[44:45], v30, s[10:11] offset:256
    global_load_dwordx2 v[46:47], v30, s[10:11] offset:384
    global_load_dwordx2 v[48:49], v30, s[10:11] offset:512
    s_mov_b32 s36, s6
    s_mov_b32 s37, s7
    s_mov_b32 s40, s8
    s_mov_b32 s41, s9
    s_mul_i32 m0, s54, 6400
    s_mov_b32 exec_hi, 0x3ffff
    buffer_load_dwordx4 v39, s[36:39], 0 offen nt lds
    s_add_u32 m0, m0, 800
    v_add_u32 v39, 6400, v39
    buffer_load_dwordx4 v39, s[36:39], 0 offen nt lds
    s_add_u32 m0, m0, 800
    v_add_u32 v39, 6400, v39
    buffer_load_dwordx4 v39, s[36:39], 0 offen nt lds
    s_add_u32 m0, m0, 800
    v_add_u32 v39, 6400, v39
    buffer_load_dwordx4 v39, s[36:39], 0 offen nt lds
    s_add_u32 m0, m0, 800
    s_nop 0
    buffer_load_dwordx4 v38, s[40:43], 0 offen nt lds
    s_add_u32 m0, m0, 800
    v_add_u32 v38, 6400, v38
    buffer_load_dwordx4 v38, s[40:43], 0 offen nt lds
    s_add_u32 m0, m0, 800
    v_add_u32 v38, 6400, v38
    buffer_load_dwordx4 v38, s[40:43], 0 offen nt lds
    s_add_u32 m0, m0, 800
    v_add_u32 v38, 6400, v38
    s_mov_b32 exec_hi, 0
    s_mov_b32 exec_lo, 0x3ff
    buffer_load_dwordx4 v38, s[40:43], 0 offen nt lds
    s_mov_b64 exec, -1
    s_mov_b32 s34, 0x10000000
    s_mov_b32 s35, 0x20000
    s_mov_b32 s46, 2621440
    s_mov_b32 s47, 0x20000
    s_lshl_b32 s67, s67, 12
    s_sub_u32 s67, s67, 32
    s_cmp_lt_u32 s53, 20
    s_cselect_b32 s67, s67, 0x70000000
    v_add_u32 v35, s67, v1
    s_mov_b32 s44, s12
    s_mov_b32 s45, s13
    s_mov_b32 s32, s28
    s_mov_b32 s33, s29
    s_lshr_b32 s64, s53, 3
    s_lshl_b32 s55, s52, 2
    s_add_u32 s55, s55, s64
    s_and_b32 s56, s53, 7
    s_lshr_b32 s57, s55, 1
    s_and_b32 s58, s53, 15
    s_getreg_b32 s62, hwreg(HW_REG_XCC_ID)
    s_lshl_b32 s62, s62, 28
    s_lshl_b32 s64, s52, 5
    s_add_u32 s64, s64, s53
    s_lshl_b32 s64, s64, 5
    s_add_u32 s64, s64, 221184
    v_mov_b32 v30, 0
    s_waitcnt lgkmcnt(0)
    s_mul_i32 s59, s60, 0x9E3779B1
    s_add_u32 s59, s59, 0x7F4A7C15
    s_xor_b32 s97, s59, 0x5bd1e995
    s_xor_b32 s62, s62, s59
    v_mov_b32 v31, s62
    s_cmp_eq_u32 s54, 0
    s_cselect_b32 s64, s64, 0x70000000
    buffer_store_dword v31, v30, s[32:35], s64 offen sc1
    s_and_b32 s64, s54, 1
    s_lshr_b32 s65, s54, 1
    s_lshl_b32 s89, s65, 3
    s_lshl_b32 s66, s55, 2
    s_add_u32 s66, s66, s64
    s_lshl_b32 s67, s57, 3
    s_add_u32 s67, s67, s64
    s_lshl_b32 s68, s65, 2
    s_add_u32 s67, s67, s68
    s_lshl_b32 s68, s56, 1
    s_add_u32 s68, s68, s65
    s_mul_i32 s76, s67, 20480
    s_add_u32 s76, s76, 11534336
    s_mul_i32 s69, s66, 20480
    s_add_u32 s69, s69, 11534336
    s_lshl_b32 s77, s68, 10
    s_add_u32 s77, s77, s69
    s_lshr_b32 s78, s68, 2
    s_lshl_b32 s78, s78, 10
    s_and_b32 s70, s68, 3
    s_lshl_b32 s70, s70, 2
    s_add_u32 s78, s78, s70
    s_add_u32 s78, s78, s69
    s_add_u32 s78, s78, 16384
    s_mul_i32 s69, s67, 55296
    s_add_u32 s69, s69, 16777216
    s_mul_i32 s79, s58, 3072
    s_add_u32 s79, s79, s69
    s_lshl_b32 s80, s58, 9
    s_add_u32 s80, s80, s69
    s_add_u32 s80, s80, 49152
    s_mul_i32 s81, s66, 55296
    s_mul_i32 s69, s54, 12288
    s_add_u32 s81, s81, s69
    s_add_u32 s81, s81, 16777216
    s_lshl_b32 s82, s67, 6
    s_add_u32 s82, s82, 16384
    s_lshl_b32 s83, s66, 4
    s_add_u32 s83, s83, s68
    s_lshl_b32 s83, s83, 2
    s_add_u32 s83, s83, 16384
    s_lshl_b32 s84, s57, 8
    s_lshl_b32 s69, s54, 6
    s_add_u32 s84, s84, s69
    s_and_b32 s69, s55, 1
    s_lshl_b32 s69, s69, 3
    s_add_u32 s84, s84, s69
    s_add_u32 s84, s84, 32768
    s_lshl_b32 s85, s57, 4
    s_add_u32 s85, s85, s58
    s_lshl_b32 s85, s85, 2
    s_add_u32 s85, s85, s54
    s_lshl_b32 s85, s85, 2
    s_add_u32 s85, s85, 32768
    s_lshl_b32 s87, s66, 12
    s_add_u32 s87, s87, 1048576
    s_lshl_b32 s86, s68, 8
    s_add_u32 s86, s86, s87
    s_lshl_b32 s88, s67, 12
    s_add_u32 s88, s88, 1048576
    s_mul_i32 s64, s56, 54
    s_mul_i32 s69, s54, 12
    s_add_u32 s69, s69, s64
    s_mul_i32 s90, s69, 5120
    s_add_u32 s90, s90, 34603008
    s_lshl_b32 s69, s54, 1
    s_min_u32 s69, s69, 4
    s_add_u32 s69, s69, s64
    s_add_u32 s69, s69, 48
    s_mul_i32 s91, s69, 5120
    s_add_u32 s91, s91, 34603008
    s_cmp_eq_u32 s54, 3
    s_cselect_b32 s91, 0x70000000, s91
    v_add_u32 v28, 57344, v1
    v_add_u32 v29, 114688, v1
    s_waitcnt vmcnt(13)
    v_alignbit_b32 v92, v40, v40, 16
    v_alignbit_b32 v93, v41, v41, 16
    v_and_b32 v94, 0xffff, v40
    v_and_b32 v96, 0xffff0000, v41
    v_and_b32 v95, 0xffff0000, v40
    v_and_b32 v41, 0xffff, v41
    v_or_b32 v95, v95, v41
    s_waitcnt vmcnt(12)
    v_alignbit_b32 v97, v42, v42, 16
    v_alignbit_b32 v98, v43, v43, 16
    v_and_b32 v99, 0xffff, v42
    v_and_b32 v101, 0xffff0000, v43
    v_and_b32 v100, 0xffff0000, v42
    v_and_b32 v43, 0xffff, v43
    v_or_b32 v100, v100, v43
    s_waitcnt vmcnt(11)
    v_alignbit_b32 v102, v44, v44, 16
    v_alignbit_b32 v103, v45, v45, 16
    v_and_b32 v104, 0xffff, v44
    v_and_b32 v106, 0xffff0000, v45
    v_and_b32 v105, 0xffff0000, v44
    v_and_b32 v45, 0xffff, v45
    v_or_b32 v105, v105, v45
    s_waitcnt vmcnt(10)
    v_alignbit_b32 v107, v46, v46, 16
    v_alignbit_b32 v108, v47, v47, 16
    v_and_b32 v109, 0xffff, v46
    v_and_b32 v111, 0xffff0000, v47
    v_and_b32 v110, 0xffff0000, v46
    v_and_b32 v47, 0xffff, v47
    v_or_b32 v110, v110, v47
    s_waitcnt vmcnt(9)
    v_alignbit_b32 v112, v48, v48, 16
    v_alignbit_b32 v113, v49, v49, 16
    v_and_b32 v114, 0xffff, v48
    v_and_b32 v116, 0xffff0000, v49
    v_and_b32 v115, 0xffff0000, v48
    v_and_b32 v49, 0xffff, v49
    v_or_b32 v115, v115, v49
    s_cmp_ge_u32 s53, 20
    s_cbranch_scc1 PREP_W
    s_mul_i32 s67, s54, 21312
    s_add_u32 s67, s67, 78592
    v_mov_b32 v30, 0
    v_mov_b32 v31, 0
    v_add_u32 v32, s67, v4
    ds_write_b64 v32, v[30:31] offset:20736
    v_add_u32 v32, 1, v2
    v_and_b32 v33, 3, v32
    v_sub_u32 v32, v32, v33
    v_lshlrev_b32 v32, 1, v32
    v_mul_u32_u24 v33, 4160, v33
    v_add3_u32 v36, v32, v33, s67
    v_lshl_add_u32 v36, v3, 4, v36
    v_lshlrev_b32 v32, 5, v2
    v_sub_u32 v32, 17120, v32
    v_lshl_add_u32 v32, v3, 4, v32
    v_add_u32 v37, s67, v32
    s_lshl_b32 s65, s61, 16
    s_bitcmp1_b32 s54, 0
    s_cselect_b32 s65, s61, s65
    s_and_b32 s65, s65, 0xffff0000
    s_lshr_b32 s66, s65, 16
    v_lshlrev_b32 v32, 3, v3
    v_add_u32 v32, v32, v2
    v_sub_u32 v32, 15, v32
    v_mov_b32 v33, s65
    v_mov_b32 v34, s66
    v_cmp_eq_u32 vcc, 0, v32
    s_nop 1
    v_cndmask_b32 v252, 0, v34, vcc
    v_cmp_eq_u32 vcc, 1, v32
    s_nop 1
    v_cndmask_b32 v252, v252, v33, vcc
    v_cmp_eq_u32 vcc, 2, v32
    s_nop 1
    v_cndmask_b32 v253, 0, v34, vcc
    v_cmp_eq_u32 vcc, 3, v32
    s_nop 1
    v_cndmask_b32 v253, v253, v33, vcc
    v_cmp_eq_u32 vcc, 4, v32
    s_nop 1
    v_cndmask_b32 v254, 0, v34, vcc
    v_cmp_eq_u32 vcc, 5, v32
    s_nop 1
    v_cndmask_b32 v254, v254, v33, vcc
    v_cmp_eq_u32 vcc, 6, v32
    s_nop 1
    v_cndmask_b32 v255, 0, v34, vcc
    v_cmp_eq_u32 vcc, 7, v32
    s_nop 1
    v_cndmask_b32 v255, v255, v33, vcc
    s_sub_u32 s64, s53, -12
    s_lshl_b32 s64, s64, 2
    s_add_u32 s64, s64, s54
    s_mov_b32 s50, 2211840
    v_mov_b32 v32, 0
    s_cmp_ge_u32 s64, 40
    s_cbranch_scc1 WU2_5
    s_mul_i32 s65, s52, 40
    s_add_u32 s64, s64, s65
    s_and_b32 s71, s64, 15
    s_lshr_b32 s70, s64, 4
    s_mul_i32 s64, s71, 20
    s_add_u32 s64, s64, s70
    s_mul_i32 s98, s64, 7168
    s_add_u32 s98, s98, 31457280
    s_mul_i32 s101, s64, 448
    s_add_u32 s101, s101, 73728
    s_lshr_b32 s65, s70, 1
    s_mul_i32 s65, s65, 80
    s_and_b32 s66, s70, 1
    s_lshl_b32 s66, s66, 1
    s_add_u32 s65, s65, s66
    s_add_u32 s66, s65, 32
    s_sub_u32 s67, s70, 16
    s_mul_i32 s67, s67, 160
    s_add_u32 s68, s67, 64
    s_add_u32 s67, s67, 144
    s_cmp_ge_u32 s70, 16
    s_cselect_b32 s65, s68, s65
    s_cselect_b32 s66, s67, s66
    s_cselect_b32 s67, 0, 14
    v_mov_b32 v32, s67
    s_mul_i32 s65, s65, 3456
    s_mul_i32 s66, s66, 3456
    s_lshl_b32 s70, s64, 7
    s_add_u32 s99, s70, 393216
    s_mul_i32 s67, s71, 7
    s_mul_i32 s68, s71, 6
    s_add_u32 s68, s68, 12
    s_cmp_ge_u32 s71, 12
    s_cselect_b32 s67, s68, s67
    s_lshl_b32 s67, s67, 5
    s_add_u32 s65, s65, s67
    s_add_u32 s66, s66, s67
    s_mov_b32 s67, 3456
    s_mov_b32 s68, 14
    s_branch WUE_6
WU2_5:
    s_sub_u32 s64, s64, 40
    s_mov_b32 s101, s64
    s_min_u32 s64, s64, 53
    s_mul_i32 s65, s52, 54
    s_add_u32 s64, s64, s65
    s_and_b32 s71, s64, 7
    s_lshr_b32 s70, s64, 3
    s_mul_i32 s64, s71, 54
    s_add_u32 s64, s64, s70
    s_mul_i32 s98, s64, 5120
    s_add_u32 s98, s98, 34603008
    s_mul_i32 s65, s70, 21846
    s_lshr_b32 s65, s65, 16
    s_mul_i32 s66, s65, 3
    s_sub_u32 s66, s70, s66
    s_mul_i32 s67, s65, 7
    s_mul_i32 s68, s65, 6
    s_add_u32 s68, s68, 12
    s_cmp_ge_u32 s65, 12
    s_cselect_b32 s65, s68, s67
    s_lshl_b32 s66, s66, 1
    s_add_u32 s65, s65, s66
    s_add_u32 s66, s65, 1
    s_sub_u32 s67, s70, 48
    s_mul_i32 s67, s67, 14
    s_add_u32 s68, s67, 6
    s_add_u32 s67, s67, 13
    s_cmp_ge_u32 s70, 48
    s_cselect_b32 s65, s68, s65
    s_cselect_b32 s66, s67, s66
    s_mul_i32 s65, s65, 20480
    s_mul_i32 s66, s66, 20480
    s_lshl_b32 s70, s64, 7
    s_add_u32 s99, s70, 434176
    s_mul_i32 s67, s71, 160
    s_add_u32 s65, s65, s67
    s_add_u32 s66, s66, s67
    s_mov_b32 s67, 1280
    s_mov_b32 s68, 10
    s_cmp_ge_u32 s101, 54
    s_cselect_b32 s65, 0x70000000, s65
    s_cselect_b32 s66, 0x70000000, s66
    s_cselect_b32 s98, 0x70000000, s98
    s_cselect_b32 s99, 0x70000000, s99
WUE_6:
    s_lshl_b32 s100, s68, 4
    v_cvt_f32_u32 v30, v0
    v_cvt_f32_u32 v31, s68
    v_add_f32 v30, 0.5, v30
    v_rcp_f32 v31, v31
    s_nop 0
    v_mul_f32 v30, v30, v31
    v_cvt_u32_f32 v30, v30
    v_mul_lo_u32 v31, v30, s68
    v_sub_u32 v31, v0, v31
    v_lshlrev_b32 v31, 4, v31
    v_cmp_gt_u32 vcc, 4, v30
    v_lshrrev_b32 v33, 1, v30
    v_mad_u32_u24 v30, v33, v32, v30
    v_mul_lo_u32 v30, v30, s67
    v_add_u32 v84, v31, v30
    s_mov_b32 s30, s65
    s_mov_b32 s31, s66
    s_lshl_b32 s74, s67, 2
    s_mov_b32 s75, vcc_hi
    v_lshrrev_b32 v32, 2, v0
    v_mul_lo_u32 v32, v32, s100
    v_and_b32 v33, 3, v0
    v_lshl_add_u32 v32, v33, 3, v32
    s_mul_i32 s64, s54, 19456
    s_add_u32 s64, s64, 9216
    v_add_u32 v85, s64, v32
    s_lshl_b32 s65, s100, 4
    v_add_u32 v86, s65, v85
PREP_DONE:
    v_lshrrev_b32 v30, 2, v0
    v_mul_u32_u24 v30, 160, v30
    v_and_b32 v31, 3, v0
    v_lshl_add_u32 v30, v31, 3, v30
    s_mul_i32 s67, s54, 6400
    v_add_u32 v56, s67, v30
    s_lshl_b32 s66, s54, 5
    s_sub_u32 s66, 25720, s66
    v_mul_u32_u24 v57, 144, v2
    v_lshlrev_b32 v32, 3, v3
    v_sub_u32 v57, v57, v32
    v_add_u32 v57, s66, v57
    s_mul_i32 s64, s52, 327680
    s_lshl_b32 s66, s53, 7
    s_sub_u32 s64, s64, s66
    s_lshl_b32 s66, s54, 15
    s_add_u32 s64, s64, s66
    s_add_u32 s64, s64, 3149696
    v_lshrrev_b32 v60, 3, v0
    v_and_b32 v61, 7, v0
    v_lshlrev_b32 v61, 4, v61
    v_lshl_add_u32 v62, v60, 12, v61
    v_mul_u32_u24 v60, 144, v60
    s_mul_i32 s66, s54, 1152
    s_add_u32 s66, s66, 25600
    v_add3_u32 v60, v60, v61, s66
    s_lshl_b32 s69, s52, 5
    s_add_u32 s69, s69, s53
    s_lshl_b32 s69, s69, 2
    s_add_u32 s69, s69, s54
    s_lshl_b32 s69, s69, 2
    s_add_u32 s69, s69, 4096
    s_add_u32 s65, s64, 131072
    s_add_u32 s66, s64, 262144
    s_cmp_lt_u32 s54, 2
    s_cselect_b32 s66, s66, 0x70000000
    s_waitcnt vmcnt(1)
    ds_read_b64_tr_b16 v[120:121], v56 offset:0
    ds_read_b64_tr_b16 v[122:123], v56 offset:640
    ds_read_b64_tr_b16 v[124:125], v56 offset:3200
    ds_read_b64_tr_b16 v[126:127], v56 offset:32
    ds_read_b64_tr_b16 v[128:129], v56 offset:672
    ds_read_b64_tr_b16 v[130:131], v56 offset:3232
    ds_read_b64_tr_b16 v[132:133], v56 offset:64
    ds_read_b64_tr_b16 v[134:135], v56 offset:704
    ds_read_b64_tr_b16 v[136:137], v56 offset:3264
    ds_read_b64_tr_b16 v[138:139], v56 offset:96
    ds_read_b64_tr_b16 v[140:141], v56 offset:736
    ds_read_b64_tr_b16 v[142:143], v56 offset:3296
    ds_read_b64_tr_b16 v[144:145], v56 offset:128
    ds_read_b64_tr_b16 v[146:147], v56 offset:768
    ds_read_b64_tr_b16 v[148:149], v56 offset:3328
    s_cmp_ge_u32 s53, 20
    s_cbranch_scc1 ROLE_W
    buffer_load_dwordx4 v[170:173], v35, s[44:47], 0 offen nt
    v_add_u32 v35, 1024, v35
    buffer_load_dwordx4 v[176:179], v35, s[44:47], 0 offen nt
    v_add_u32 v35, 1024, v35
    buffer_load_dwordx4 v[182:185], v35, s[44:47], 0 offen nt
    v_add_u32 v35, 1024, v35
    buffer_load_dwordx4 v[188:191], v35, s[44:47], 0 offen nt
    v_add_u32 v35, 1024, v35
    s_mov_b64 exec, 15
    buffer_load_dwordx4 v[194:197], v35, s[44:47], 0 offen nt
    s_mov_b64 exec, -1
ROLE_DONE:
    s_waitcnt lgkmcnt(14)
    v_dot2_f32_bf16 v150, v120, v96, 0
    v_dot2_f32_bf16 v151, v121, v93, 0
    v_dot2_f32_bf16 v152, v121, v96, 0
    s_waitcnt lgkmcnt(13)
    v_dot2_f32_bf16 v153, v122, v93, 0
    s_waitcnt lgkmcnt(12)
    v_lshlrev_b32 v154, 16, v124
    v_and_b32 v155, 0xffff0000, v124
    v_dot2_f32_bf16 v150, v121, v95, v150
    v_dot2_f32_bf16 v151, v122, v92, v151
    v_dot2_f32_bf16 v152, v122, v95, v152
    v_dot2_f32_bf16 v153, v123, v92, v153
    v_dot2_f32_bf16 v150, v122, v94, v150
    v_dot2_f32_bf16 v152, v123, v94, v152
    v_lshlrev_b32 v156, 16, v125
    v_and_b32 v157, 0xffff0000, v125
    s_nop 0
    v_pk_mul_f32 v[150:151], v[150:151], v[154:155]
    v_pk_mul_f32 v[152:153], v[152:153], v[156:157]
    v_cvt_pk_bf16_f32 v159, v151, v150
    v_cvt_pk_bf16_f32 v158, v153, v152
    ds_write_b64 v57, v[158:159] offset:0
    s_waitcnt lgkmcnt(12)
    v_dot2_f32_bf16 v150, v126, v101, 0
    v_dot2_f32_bf16 v151, v127, v98, 0
    v_dot2_f32_bf16 v152, v127, v101, 0
    s_waitcnt lgkmcnt(11)
    v_dot2_f32_bf16 v153, v128, v98, 0
    s_waitcnt lgkmcnt(10)
    v_lshlrev_b32 v154, 16, v130
    v_and_b32 v155, 0xffff0000, v130
    v_dot2_f32_bf16 v150, v127, v100, v150
    v_dot2_f32_bf16 v151, v128, v97, v151
    v_dot2_f32_bf16 v152, v128, v100, v152
    v_dot2_f32_bf16 v153, v129, v97, v153
    v_dot2_f32_bf16 v150, v128, v99, v150
    v_dot2_f32_bf16 v152, v129, v99, v152
    v_lshlrev_b32 v156, 16, v131
    v_and_b32 v157, 0xffff0000, v131
    s_nop 0
    v_pk_mul_f32 v[150:151], v[150:151], v[154:155]
    v_pk_mul_f32 v[152:153], v[152:153], v[156:157]
    v_cvt_pk_bf16_f32 v161, v151, v150
    v_cvt_pk_bf16_f32 v160, v153, v152
    ds_write_b64 v57, v[160:161] offset:2304
    s_waitcnt lgkmcnt(10)
    v_dot2_f32_bf16 v150, v132, v106, 0
    v_dot2_f32_bf16 v151, v133, v103, 0
    v_dot2_f32_bf16 v152, v133, v106, 0
    s_waitcnt lgkmcnt(9)
    v_dot2_f32_bf16 v153, v134, v103, 0
    s_waitcnt lgkmcnt(8)
    v_lshlrev_b32 v154, 16, v136
    v_and_b32 v155, 0xffff0000, v136
    v_dot2_f32_bf16 v150, v133, v105, v150
    v_dot2_f32_bf16 v151, v134, v102, v151
    v_dot2_f32_bf16 v152, v134, v105, v152
    v_dot2_f32_bf16 v153, v135, v102, v153
    v_dot2_f32_bf16 v150, v134, v104, v150
    v_dot2_f32_bf16 v152, v135, v104, v152
    v_lshlrev_b32 v156, 16, v137
    v_and_b32 v157, 0xffff0000, v137
    s_nop 0
    v_pk_mul_f32 v[150:151], v[150:151], v[154:155]
    v_pk_mul_f32 v[152:153], v[152:153], v[156:157]
    v_cvt_pk_bf16_f32 v159, v151, v150
    v_cvt_pk_bf16_f32 v158, v153, v152
    ds_write_b64 v57, v[158:159] offset:4608
    s_waitcnt lgkmcnt(8)
    v_dot2_f32_bf16 v150, v138, v111, 0
    v_dot2_f32_bf16 v151, v139, v108, 0
    v_dot2_f32_bf16 v152, v139, v111, 0
    s_waitcnt lgkmcnt(7)
    v_dot2_f32_bf16 v153, v140, v108, 0
    s_waitcnt lgkmcnt(6)
    v_lshlrev_b32 v154, 16, v142
    v_and_b32 v155, 0xffff0000, v142
    v_dot2_f32_bf16 v150, v139, v110, v150
    v_dot2_f32_bf16 v151, v140, v107, v151
    v_dot2_f32_bf16 v152, v140, v110, v152
    v_dot2_f32_bf16 v153, v141, v107, v153
    v_dot2_f32_bf16 v150, v140, v109, v150
    v_dot2_f32_bf16 v152, v141, v109, v152
    v_lshlrev_b32 v156, 16, v143
    v_and_b32 v157, 0xffff0000, v143
    s_nop 0
    v_pk_mul_f32 v[150:151], v[150:151], v[154:155]
    v_pk_mul_f32 v[152:153], v[152:153], v[156:157]
    v_cvt_pk_bf16_f32 v161, v151, v150
    v_cvt_pk_bf16_f32 v160, v153, v152
    ds_write_b64 v57, v[160:161] offset:6912
    s_waitcnt lgkmcnt(6)
    v_dot2_f32_bf16 v150, v144, v116, 0
    v_dot2_f32_bf16 v151, v145, v113, 0
    v_dot2_f32_bf16 v152, v145, v116, 0
    s_waitcnt lgkmcnt(5)
    v_dot2_f32_bf16 v153, v146, v113, 0
    s_waitcnt lgkmcnt(4)
    v_lshlrev_b32 v154, 16, v148
    v_and_b32 v155, 0xffff0000, v148
    v_dot2_f32_bf16 v150, v145, v115, v150
    v_dot2_f32_bf16 v151, v146, v112, v151
    v_dot2_f32_bf16 v152, v146, v115, v152
    v_dot2_f32_bf16 v153, v147, v112, v153
    v_dot2_f32_bf16 v150, v146, v114, v150
    v_dot2_f32_bf16 v152, v147, v114, v152
    v_lshlrev_b32 v156, 16, v149
    v_and_b32 v157, 0xffff0000, v149
    s_nop 0
    v_pk_mul_f32 v[150:151], v[150:151], v[154:155]
    v_pk_mul_f32 v[152:153], v[152:153], v[156:157]
    v_cvt_pk_bf16_f32 v159, v151, v150
    v_cvt_pk_bf16_f32 v158, v153, v152
    ds_write_b64 v57, v[158:159] offset:9216
    s_waitcnt lgkmcnt(0)
    s_barrier
    ds_read_b128 v[92:95], v60 offset:0
    ds_read_b128 v[96:99], v60 offset:4608
    ds_read_b128 v[100:103], v60 offset:9216
    s_waitcnt lgkmcnt(2)
    buffer_store_dwordx4 v[92:95], v62, s[32:35], s64 offen sc1
    s_waitcnt lgkmcnt(1)
    buffer_store_dwordx4 v[96:99], v62, s[32:35], s65 offen sc1
    s_waitcnt lgkmcnt(0)
    buffer_store_dwordx4 v[100:103], v62, s[32:35], s66 offen sc1
    s_mul_i32 s67, s54, 21312
    s_add_u32 s67, s67, 78592
    v_add_u32 v33, s67, v1
    s_cmp_ge_u32 s53, 20
    s_cbranch_scc1 HB1
    v_cmp_lt_u32 vcc, 1, v0
    s_waitcnt vmcnt(7)
    s_nop 0
    v_cndmask_b32 v170, 0, v170, vcc
    v_cndmask_b32 v171, 0, v171, vcc
    v_cndmask_b32 v172, 0, v172, vcc
    v_cndmask_b32 v173, 0, v173, vcc
    v_mov_b32_dpp v174, v170 wave_shl:1 row_mask:0xf bank_mask:0xf
    v_mov_b32_dpp v175, v171 wave_shl:1 row_mask:0xf bank_mask:0xf
    s_waitcnt vmcnt(6)
    v_readfirstlane_b32 s70, v176
    v_readfirstlane_b32 s71, v177
    s_nop 0
    v_writelane_b32 v174, s70, 63
    v_writelane_b32 v175, s71, 63
    v_mov_b32_dpp v180, v176 wave_shl:1 row_mask:0xf bank_mask:0xf
    v_mov_b32_dpp v181, v177 wave_shl:1 row_mask:0xf bank_mask:0xf
    s_waitcnt vmcnt(5)
    v_readfirstlane_b32 s70, v182
    v_readfirstlane_b32 s71, v183
    s_nop 0
    v_writelane_b32 v180, s70, 63
    v_writelane_b32 v181, s71, 63
    v_mov_b32_dpp v186, v182 wave_shl:1 row_mask:0xf bank_mask:0xf
    v_mov_b32_dpp v187, v183 wave_shl:1 row_mask:0xf bank_mask:0xf
    s_waitcnt vmcnt(4)
    v_readfirstlane_b32 s70, v188
    v_readfirstlane_b32 s71, v189
    s_nop 0
    v_writelane_b32 v186, s70, 63
    v_writelane_b32 v187, s71, 63
    v_mov_b32_dpp v192, v188 wave_shl:1 row_mask:0xf bank_mask:0xf
    v_mov_b32_dpp v193, v189 wave_shl:1 row_mask:0xf bank_mask:0xf
    s_waitcnt vmcnt(3)
    v_readfirstlane_b32 s70, v194
    v_readfirstlane_b32 s71, v195
    s_nop 0
    v_writelane_b32 v192, s70, 63
    v_writelane_b32 v193, s71, 63
    v_mov_b32_dpp v198, v194 wave_shl:1 row_mask:0xf bank_mask:0xf
    v_mov_b32_dpp v199, v195 wave_shl:1 row_mask:0xf bank_mask:0xf
    ds_write_b128 v33, v[170:173] offset:0
    v_alignbit_b32 v200, v171, v170, 16
    v_alignbit_b32 v201, v172, v171, 16
    v_alignbit_b32 v202, v173, v172, 16
    v_alignbit_b32 v203, v174, v173, 16
    ds_write_b128 v33, v[200:203] offset:4160
    v_mov_b32 v204, v171
    v_mov_b32 v205, v172
    v_mov_b32 v206, v173
    v_mov_b32 v207, v174
    ds_write_b128 v33, v[204:207] offset:8320
    v_alignbit_b32 v208, v172, v171, 16
    v_alignbit_b32 v209, v173, v172, 16
    v_alignbit_b32 v210, v174, v173, 16
    v_alignbit_b32 v211, v175, v174, 16
    ds_write_b128 v33, v[208:211] offset:12480
    ds_write_b128 v33, v[176:179] offset:1024
    v_alignbit_b32 v212, v177, v176, 16
    v_alignbit_b32 v213, v178, v177, 16
    v_alignbit_b32 v214, v179, v178, 16
    v_alignbit_b32 v215, v180, v179, 16
    ds_write_b128 v33, v[212:215] offset:5184
    v_mov_b32 v216, v177
    v_mov_b32 v217, v178
    v_mov_b32 v218, v179
    v_mov_b32 v219, v180
    ds_write_b128 v33, v[216:219] offset:9344
    v_alignbit_b32 v220, v178, v177, 16
    v_alignbit_b32 v221, v179, v178, 16
    v_alignbit_b32 v222, v180, v179, 16
    v_alignbit_b32 v223, v181, v180, 16
    ds_write_b128 v33, v[220:223] offset:13504
    s_mov_b64 exec, -1
HB1:
    v_mov_b32 v30, s59
    v_mov_b32 v31, 0
    s_waitcnt vmcnt(0)
    buffer_store_dword v30, v31, s[32:35], s69 offen
    s_lshl_b32 s68, s52, 10
    s_add_u32 s68, s68, 221184
    v_and_b32 v63, 31, v0
    v_lshlrev_b32 v63, 5, v63
    buffer_load_dword v62, v63, s[32:35], s68 offen sc1
    s_cmp_ge_u32 s53, 20
    s_cbranch_scc1 MID_W
    ds_write_b128 v33, v[182:185] offset:2048
    v_alignbit_b32 v200, v183, v182, 16
    v_alignbit_b32 v201, v184, v183, 16
    v_alignbit_b32 v202, v185, v184, 16
    v_alignbit_b32 v203, v186, v185, 16
    ds_write_b128 v33, v[200:203] offset:6208
    v_mov_b32 v204, v183
    v_mov_b32 v205, v184
    v_mov_b32 v206, v185
    v_mov_b32 v207, v186
    ds_write_b128 v33, v[204:207] offset:10368
    v_alignbit_b32 v208, v184, v183, 16
    v_alignbit_b32 v209, v185, v184, 16
    v_alignbit_b32 v210, v186, v185, 16
    v_alignbit_b32 v211, v187, v186, 16
    ds_write_b128 v33, v[208:211] offset:14528
    ds_write_b128 v33, v[188:191] offset:3072
    v_alignbit_b32 v212, v189, v188, 16
    v_alignbit_b32 v213, v190, v189, 16
    v_alignbit_b32 v214, v191, v190, 16
    v_alignbit_b32 v215, v192, v191, 16
    ds_write_b128 v33, v[212:215] offset:7232
    v_mov_b32 v216, v189
    v_mov_b32 v217, v190
    v_mov_b32 v218, v191
    v_mov_b32 v219, v192
    ds_write_b128 v33, v[216:219] offset:11392
    v_alignbit_b32 v220, v190, v189, 16
    v_alignbit_b32 v221, v191, v190, 16
    v_alignbit_b32 v222, v192, v191, 16
    v_alignbit_b32 v223, v193, v192, 16
    ds_write_b128 v33, v[220:223] offset:15552
    s_mov_b64 exec, 7
    ds_write_b128 v33, v[194:197] offset:4096
    v_alignbit_b32 v200, v195, v194, 16
    v_alignbit_b32 v201, v196, v195, 16
    v_alignbit_b32 v202, v197, v196, 16
    v_alignbit_b32 v203, v198, v197, 16
    ds_write_b128 v33, v[200:203] offset:8256
    v_mov_b32 v204, v195
    v_mov_b32 v205, v196
    v_mov_b32 v206, v197
    v_mov_b32 v207, v198
    ds_write_b128 v33, v[204:207] offset:12416
    v_alignbit_b32 v208, v196, v195, 16
    v_alignbit_b32 v209, v197, v196, 16
    v_alignbit_b32 v210, v198, v197, 16
    v_alignbit_b32 v211, v199, v198, 16
    ds_write_b128 v33, v[208:211] offset:16576
    s_mov_b64 exec, -1
CHECK:
    s_mov_b32 s63, 0
    s_branch VER2
VER:
    s_sleep 1
    s_add_u32 s63, s63, 1
    s_cmp_gt_u32 s63, 400000
    s_cbranch_scc1 SLOW
    buffer_load_dword v62, v63, s[32:35], s68 offen sc1
VER2:
    s_waitcnt vmcnt(0)
    v_xor_b32 v62, s62, v62
    v_cmp_ne_u32 vcc, 0, v62
    s_cbranch_vccz FAST
    v_and_b32 v62, 0x0fffffff, v62
    v_cmp_ne_u32 vcc, 0, v62
    s_cbranch_vccnz VER
    s_branch SLOW
FAST:
    s_cmp_ge_u32 s53, 20
    s_cbranch_scc1 F_W_PHASE
    s_lshl_b32 s64, s52, 9
    s_add_u32 s64, s64, 4096
    ds_read_b64 v[92:93], v36 offset:0
    ds_read_b64 v[94:95], v36 offset:8
    ds_read_b64 v[96:97], v36 offset:512
    ds_read_b64 v[98:99], v36 offset:520
    ds_read_b64 v[100:101], v36 offset:1024
    ds_read_b64 v[102:103], v36 offset:1032
    ds_read_b64 v[104:105], v36 offset:1536
    ds_read_b64 v[106:107], v36 offset:1544
    ds_read_b64 v[108:109], v36 offset:2048
    ds_read_b64 v[110:111], v36 offset:2056
    ds_read_b64 v[112:113], v36 offset:2560
    ds_read_b64 v[114:115], v36 offset:2568
    ds_read_b64 v[116:117], v36 offset:3072
    ds_read_b64 v[118:119], v36 offset:3080
    ds_read_b64 v[120:121], v36 offset:3584
    ds_read_b64 v[122:123], v36 offset:3592
    v_and_b32 v33, 31, v0
    s_mul_i32 s65, s54, 12
    v_add_u32 v90, s65, v33
    s_lshl_b32 s66, s54, 1
    s_add_u32 s66, s66, 36
    v_add_u32 v91, s66, v33
    v_cmp_gt_u32 vcc, 12, v33
    s_nop 1
    v_cndmask_b32 v90, v91, v90, vcc
    s_add_u32 s66, s66, 13
    s_min_u32 s66, s66, 53
    v_min_u32 v90, s66, v90
    s_mul_i32 s65, s56, 6912
    s_add_u32 s65, s65, 434176
    v_lshl_add_u32 v90, v90, 7, s65
    v_min_u32 v91, 19, v0
    s_mul_i32 s65, s58, 2560
    s_add_u32 s65, s65, 393216
    v_lshl_add_u32 v91, v91, 7, s65
    s_lshr_b32 s65, s89, 2
    v_xor_b32 v35, s65, v0
    v_lshlrev_b32 v35, 4, v35
    s_mul_i32 s92, s58, 143360
    s_add_u32 s92, s92, 31457280
    s_mov_b32 s63, 0
    s_branch POLLB_9
POLL_8:
    s_sleep 1
    s_add_u32 s63, s63, 1
    s_cmp_gt_u32 s63, 400000
    s_cbranch_scc1 POLLX_10
POLLB_9:
    buffer_load_dwordx2 v[30:31], v4, s[32:35], s64 offen sc1
    s_waitcnt vmcnt(0)
    v_cmp_ne_u32 vcc, s59, v30
    s_cbranch_vccnz POLL_8
    v_cmp_ne_u32 vcc, s59, v31
    s_cbranch_vccnz POLL_8
POLLX_10:
    s_lshl_b32 s64, s3, 2
    s_add_u32 s64, s64, s54
    s_lshl_b32 s64, s64, 12
    s_add_u32 s64, s64, 3145728
    s_add_u32 m0, s67, 16640
    s_nop 0
    buffer_load_dwordx4 v1, s[32:35], s64 offen offset:0 sc1 lds
    buffer_load_dwordx4 v1, s[32:35], s64 offen offset:1024 sc1 lds
    buffer_load_dwordx4 v1, s[32:35], s64 offen offset:2048 sc1 lds
    buffer_load_dwordx4 v1, s[32:35], s64 offen offset:3072 sc1 lds
    s_waitcnt vmcnt(0)
    ds_read_b128 v[156:159], v37 offset:3584
    ds_read_b128 v[160:163], v37 offset:3072
    ds_read_b128 v[164:167], v37 offset:2560
    ds_read_b128 v[168:171], v37 offset:2048
    ds_read_b128 v[172:175], v37 offset:1536
    ds_read_b128 v[176:179], v37 offset:1024
    ds_read_b128 v[180:183], v37 offset:512
    ds_read_b128 v[184:187], v37 offset:0
    s_waitcnt lgkmcnt(7)
    v_mfma_f32_16x16x32_bf16 v[220:223], v[252:255], v[156:159], 0
    s_mov_b32 s48, s22
    s_mov_b32 s49, s23
    s_waitcnt lgkmcnt(6)
    v_mfma_f32_16x16x32_bf16 v[224:227], v[252:255], v[160:163], 0
    s_mul_i32 s69, s54, 19456
    s_add_u32 m0, s69, 9216
    s_add_u32 s66, s30, 0
    s_mov_b32 exec_hi, 255
    buffer_load_dwordx4 v84, s[48:51], s66 offen nt lds
    s_mov_b64 exec, -1
    s_waitcnt lgkmcnt(5)
    v_mfma_f32_16x16x32_bf16 v[228:231], v[252:255], v[164:167], 0
    s_waitcnt lgkmcnt(4)
    v_mfma_f32_16x16x32_bf16 v[232:235], v[252:255], v[168:171], 0
    s_waitcnt lgkmcnt(3)
    v_mfma_f32_16x16x32_bf16 v[236:239], v[252:255], v[172:175], 0
    s_waitcnt lgkmcnt(2)
    v_mfma_f32_16x16x32_bf16 v[240:243], v[252:255], v[176:179], 0
    s_waitcnt lgkmcnt(1)
    v_mfma_f32_16x16x32_bf16 v[244:247], v[252:255], v[180:183], 0
    s_add_u32 m0, s69, 9856
    s_add_u32 s66, s30, 5120
    s_mov_b32 exec_hi, 255
    buffer_load_dwordx4 v84, s[48:51], s66 offen nt lds
    s_mov_b64 exec, -1
    s_waitcnt lgkmcnt(0)
    v_mfma_f32_16x16x32_bf16 v[248:251], v[252:255], v[184:187], 0
    v_mfma_f32_16x16x32_bf16 v[220:223], v[92:95], v[156:159], v[220:223]
    v_mfma_f32_16x16x32_bf16 v[224:227], v[92:95], v[160:163], v[224:227]
    v_mfma_f32_16x16x32_bf16 v[224:227], v[96:99], v[156:159], v[224:227]
    s_add_u32 m0, s69, 10496
    s_add_u32 s66, s30, 10240
    s_mov_b32 exec_hi, 255
    buffer_load_dwordx4 v84, s[48:51], s66 offen nt lds
    s_mov_b64 exec, -1
    v_mfma_f32_16x16x32_bf16 v[228:231], v[96:99], v[160:163], v[228:231]
    v_mfma_f32_16x16x32_bf16 v[228:231], v[92:95], v[164:167], v[228:231]
    v_mfma_f32_16x16x32_bf16 v[228:231], v[100:103], v[156:159], v[228:231]
    v_mfma_f32_16x16x32_bf16 v[232:235], v[96:99], v[164:167], v[232:235]
    s_add_u32 m0, s69, 11136
    s_add_u32 s66, s30, 15360
    s_mov_b32 exec_hi, 255
    buffer_load_dwordx4 v84, s[48:51], s66 offen nt lds
    s_mov_b64 exec, -1
    v_mfma_f32_16x16x32_bf16 v[232:235], v[100:103], v[160:163], v[232:235]
    v_mfma_f32_16x16x32_bf16 v[236:239], v[100:103], v[164:167], v[236:239]
    ds_read_b128 v[188:191], v37 offset:3648
    v_mfma_f32_16x16x32_bf16 v[232:235], v[92:95], v[168:171], v[232:235]
    ds_read_b64 v[124:125], v36 offset:64
    v_mfma_f32_16x16x32_bf16 v[232:235], v[104:107], v[156:159], v[232:235]
    ds_read_b64 v[126:127], v36 offset:72
    v_mfma_f32_16x16x32_bf16 v[236:239], v[96:99], v[168:171], v[236:239]
    ds_read_b128 v[192:195], v37 offset:3136
    s_add_u32 m0, s69, 11776
    s_add_u32 s66, s31, 0
    s_mov_b32 exec_hi, 255
    buffer_load_dwordx4 v84, s[48:51], s66 offen nt lds
    s_mov_b64 exec, -1
    v_mfma_f32_16x16x32_bf16 v[236:239], v[104:107], v[160:163], v[236:239]
    ds_read_b64 v[128:129], v36 offset:576
    v_mfma_f32_16x16x32_bf16 v[240:243], v[100:103], v[168:171], v[240:243]
    ds_read_b64 v[130:131], v36 offset:584
    v_mfma_f32_16x16x32_bf16 v[240:243], v[104:107], v[164:167], v[240:243]
    ds_read_b128 v[196:199], v37 offset:2624
    v_mfma_f32_16x16x32_bf16 v[244:247], v[104:107], v[168:171], v[244:247]
    ds_read_b64 v[132:133], v36 offset:1088
    v_mfma_f32_16x16x32_bf16 v[236:239], v[92:95], v[172:175], v[236:239]
    ds_read_b64 v[134:135], v36 offset:1096
    v_mfma_f32_16x16x32_bf16 v[236:239], v[108:111], v[156:159], v[236:239]
    ds_read_b128 v[200:203], v37 offset:2112
    v_mfma_f32_16x16x32_bf16 v[240:243], v[96:99], v[172:175], v[240:243]
    ds_read_b64 v[136:137], v36 offset:1600
    s_add_u32 m0, s69, 12416
    s_add_u32 s66, s31, 5120
    s_mov_b32 exec_hi, 255
    buffer_load_dwordx4 v84, s[48:51], s66 offen nt lds
    s_mov_b64 exec, -1
    v_mfma_f32_16x16x32_bf16 v[240:243], v[108:111], v[160:163], v[240:243]
    ds_read_b64 v[138:139], v36 offset:1608
    v_mfma_f32_16x16x32_bf16 v[244:247], v[100:103], v[172:175], v[244:247]
    ds_read_b128 v[204:207], v37 offset:1600
    v_mfma_f32_16x16x32_bf16 v[244:247], v[108:111], v[164:167], v[244:247]
    ds_read_b64 v[140:141], v36 offset:2112
    v_mfma_f32_16x16x32_bf16 v[248:251], v[104:107], v[172:175], v[248:251]
    ds_read_b64 v[142:143], v36 offset:2120
    v_mfma_f32_16x16x32_bf16 v[248:251], v[108:111], v[168:171], v[248:251]
    ds_read_b128 v[208:211], v37 offset:1088
    v_mfma_f32_16x16x32_bf16 v[240:243], v[92:95], v[176:179], v[240:243]
    ds_read_b64 v[144:145], v36 offset:2624
    v_mfma_f32_16x16x32_bf16 v[240:243], v[112:115], v[156:159], v[240:243]
    ds_read_b64 v[146:147], v36 offset:2632
    s_add_u32 m0, s69, 13056
    s_add_u32 s66, s31, 10240
    s_mov_b32 exec_hi, 255
    buffer_load_dwordx4 v84, s[48:51], s66 offen nt lds
    s_mov_b64 exec, -1
    v_mfma_f32_16x16x32_bf16 v[244:247], v[96:99], v[176:179], v[244:247]
    ds_read_b128 v[212:215], v37 offset:576
    v_mfma_f32_16x16x32_bf16 v[244:247], v[112:115], v[160:163], v[244:247]
    ds_read_b64 v[148:149], v36 offset:3136
    v_mfma_f32_16x16x32_bf16 v[248:251], v[100:103], v[176:179], v[248:251]
    ds_read_b64 v[150:151], v36 offset:3144
    v_mfma_f32_16x16x32_bf16 v[248:251], v[112:115], v[164:167], v[248:251]
    ds_read_b128 v[216:219], v37 offset:64
    v_mfma_f32_16x16x32_bf16 v[244:247], v[92:95], v[180:183], v[244:247]
    ds_read_b64 v[152:153], v36 offset:3648
    v_mfma_f32_16x16x32_bf16 v[244:247], v[116:119], v[156:159], v[244:247]
    ds_read_b64 v[154:155], v36 offset:3656
    v_mfma_f32_16x16x32_bf16 v[248:251], v[96:99], v[180:183], v[248:251]
    s_add_u32 m0, s69, 13696
    s_add_u32 s66, s31, 15360
    s_mov_b32 exec_hi, 255
    buffer_load_dwordx4 v84, s[48:51], s66 offen nt lds
    s_mov_b64 exec, -1
    v_mfma_f32_16x16x32_bf16 v[248:251], v[116:119], v[160:163], v[248:251]
    v_mfma_f32_16x16x32_bf16 v[248:251], v[92:95], v[184:187], v[248:251]
    v_mfma_f32_16x16x32_bf16 v[248:251], v[120:123], v[156:159], v[248:251]
    s_waitcnt lgkmcnt(15)
    v_mfma_f32_16x16x32_bf16 v[220:223], v[124:127], v[188:191], v[220:223]
    v_mul_u32_u24 v30, 205, v0
    v_lshrrev_b32 v30, 11, v30
    v_mul_u32_u24 v83, 1120, v30
    v_lshl_add_u32 v83, v0, 4, v83
    s_lshl_b32 s64, s55, 2
    s_and_b32 s65, s54, 1
    s_add_u32 s64, s64, s65
    s_mul_i32 s64, s64, 20480
    s_mul_i32 s65, s56, 160
    s_add_u32 s70, s64, s65
    s_mov_b32 s44, s4
    s_mov_b32 s45, s5
    s_mul_i32 s71, s54, 19456
    v_mfma_f32_16x16x32_bf16 v[224:227], v[124:127], v[192:195], v[224:227]
    v_mfma_f32_16x16x32_bf16 v[224:227], v[128:131], v[188:191], v[224:227]
    v_mfma_f32_16x16x32_bf16 v[228:231], v[128:131], v[192:195], v[228:231]
    v_mfma_f32_16x16x32_bf16 v[228:231], v[124:127], v[196:199], v[228:231]
    v_mfma_f32_16x16x32_bf16 v[228:231], v[132:135], v[188:191], v[228:231]
    v_mfma_f32_16x16x32_bf16 v[232:235], v[128:131], v[196:199], v[232:235]
    v_mfma_f32_16x16x32_bf16 v[232:235], v[132:135], v[192:195], v[232:235]
    s_add_u32 m0, s71, 14336
    s_add_u32 s66, s70, 0
    s_mov_b32 exec_hi, 262143
    buffer_load_dwordx4 v83, s[44:47], s66 offen nt lds
    s_mov_b64 exec, -1
    v_mfma_f32_16x16x32_bf16 v[236:239], v[132:135], v[196:199], v[236:239]
    ds_read_b128 v[156:159], v37 offset:3712
    s_waitcnt lgkmcnt(15)
    v_mfma_f32_16x16x32_bf16 v[232:235], v[124:127], v[200:203], v[232:235]
    ds_read_b64 v[92:93], v36 offset:128
    s_waitcnt lgkmcnt(14)
    v_mfma_f32_16x16x32_bf16 v[232:235], v[136:139], v[188:191], v[232:235]
    ds_read_b64 v[94:95], v36 offset:136
    v_mfma_f32_16x16x32_bf16 v[236:239], v[128:131], v[200:203], v[236:239]
    ds_read_b128 v[160:163], v37 offset:3200
    v_mfma_f32_16x16x32_bf16 v[236:239], v[136:139], v[192:195], v[236:239]
    ds_read_b64 v[96:97], v36 offset:640
    v_mfma_f32_16x16x32_bf16 v[240:243], v[132:135], v[200:203], v[240:243]
    ds_read_b64 v[98:99], v36 offset:648
    v_mfma_f32_16x16x32_bf16 v[240:243], v[136:139], v[196:199], v[240:243]
    ds_read_b128 v[164:167], v37 offset:2688
    s_add_u32 m0, s71, 15136
    s_add_u32 s66, s70, 6400
    s_mov_b32 exec_hi, 262143
    buffer_load_dwordx4 v83, s[44:47], s66 offen nt lds
    s_mov_b64 exec, -1
    v_mfma_f32_16x16x32_bf16 v[244:247], v[136:139], v[200:203], v[244:247]
    ds_read_b64 v[100:101], v36 offset:1152
    s_waitcnt lgkmcnt(15)
    v_mfma_f32_16x16x32_bf16 v[236:239], v[124:127], v[204:207], v[236:239]
    ds_read_b64 v[102:103], v36 offset:1160
    v_mfma_f32_16x16x32_bf16 v[236:239], v[140:143], v[188:191], v[236:239]
    ds_read_b128 v[168:171], v37 offset:2176
    v_mfma_f32_16x16x32_bf16 v[240:243], v[128:131], v[204:207], v[240:243]
    ds_read_b64 v[104:105], v36 offset:1664
    v_mfma_f32_16x16x32_bf16 v[240:243], v[140:143], v[192:195], v[240:243]
    ds_read_b64 v[106:107], v36 offset:1672
    v_mfma_f32_16x16x32_bf16 v[244:247], v[132:135], v[204:207], v[244:247]
    ds_read_b128 v[172:175], v37 offset:1664
    v_mfma_f32_16x16x32_bf16 v[244:247], v[140:143], v[196:199], v[244:247]
    ds_read_b64 v[108:109], v36 offset:2176
    s_add_u32 m0, s71, 15936
    s_add_u32 s66, s70, 12800
    s_mov_b32 exec_hi, 262143
    buffer_load_dwordx4 v83, s[44:47], s66 offen nt lds
    s_mov_b64 exec, -1
    v_mfma_f32_16x16x32_bf16 v[248:251], v[136:139], v[204:207], v[248:251]
    ds_read_b64 v[110:111], v36 offset:2184
    v_mfma_f32_16x16x32_bf16 v[248:251], v[140:143], v[200:203], v[248:251]
    ds_read_b128 v[176:179], v37 offset:1152
    v_mfma_f32_16x16x32_bf16 v[240:243], v[124:127], v[208:211], v[240:243]
    ds_read_b64 v[112:113], v36 offset:2688
    s_waitcnt lgkmcnt(15)
    v_mfma_f32_16x16x32_bf16 v[240:243], v[144:147], v[188:191], v[240:243]
    ds_read_b64 v[114:115], v36 offset:2696
    v_mfma_f32_16x16x32_bf16 v[244:247], v[128:131], v[208:211], v[244:247]
    ds_read_b128 v[180:183], v37 offset:640
    v_mfma_f32_16x16x32_bf16 v[244:247], v[144:147], v[192:195], v[244:247]
    ds_read_b64 v[116:117], v36 offset:3200
    v_mfma_f32_16x16x32_bf16 v[248:251], v[132:135], v[208:211], v[248:251]
    ds_read_b64 v[118:119], v36 offset:3208
    s_add_u32 m0, s71, 16736
    s_add_u32 s66, s70, 19200
    s_mov_b32 exec_hi, 0
    s_mov_b32 exec_lo, 1023
    buffer_load_dwordx4 v83, s[44:47], s66 offen nt lds
    s_mov_b64 exec, -1
    v_mfma_f32_16x16x32_bf16 v[248:251], v[144:147], v[196:199], v[248:251]
    ds_read_b128 v[184:187], v37 offset:128
    v_mfma_f32_16x16x32_bf16 v[244:247], v[124:127], v[212:215], v[244:247]
    ds_read_b64 v[120:121], v36 offset:3712
    v_mfma_f32_16x16x32_bf16 v[244:247], v[148:151], v[188:191], v[244:247]
    ds_read_b64 v[122:123], v36 offset:3720
    v_mfma_f32_16x16x32_bf16 v[248:251], v[128:131], v[212:215], v[248:251]
    v_mfma_f32_16x16x32_bf16 v[248:251], v[148:151], v[192:195], v[248:251]
    v_mfma_f32_16x16x32_bf16 v[248:251], v[124:127], v[216:219], v[248:251]
    s_add_u32 m0, s71, 16896
    s_add_u32 s66, s70, 40960
    s_mov_b32 exec_hi, 262143
    buffer_load_dwordx4 v83, s[44:47], s66 offen nt lds
    s_mov_b64 exec, -1
    v_mfma_f32_16x16x32_bf16 v[248:251], v[152:155], v[188:191], v[248:251]
    s_waitcnt lgkmcnt(15)
    v_mfma_f32_16x16x32_bf16 v[220:223], v[92:95], v[156:159], v[220:223]
    v_mfma_f32_16x16x32_bf16 v[224:227], v[92:95], v[160:163], v[224:227]
    v_mfma_f32_16x16x32_bf16 v[224:227], v[96:99], v[156:159], v[224:227]
    s_add_u32 m0, s71, 17696
    s_add_u32 s66, s70, 47360
    s_mov_b32 exec_hi, 262143
    buffer_load_dwordx4 v83, s[44:47], s66 offen nt lds
    s_mov_b64 exec, -1
    v_mfma_f32_16x16x32_bf16 v[228:231], v[96:99], v[160:163], v[228:231]
    v_mfma_f32_16x16x32_bf16 v[228:231], v[92:95], v[164:167], v[228:231]
    v_mfma_f32_16x16x32_bf16 v[228:231], v[100:103], v[156:159], v[228:231]
    v_mfma_f32_16x16x32_bf16 v[232:235], v[96:99], v[164:167], v[232:235]
    s_add_u32 m0, s71, 18496
    s_add_u32 s66, s70, 53760
    s_mov_b32 exec_hi, 262143
    buffer_load_dwordx4 v83, s[44:47], s66 offen nt lds
    s_mov_b64 exec, -1
    v_mfma_f32_16x16x32_bf16 v[232:235], v[100:103], v[160:163], v[232:235]
    v_mfma_f32_16x16x32_bf16 v[236:239], v[100:103], v[164:167], v[236:239]
    ds_read_b128 v[188:191], v37 offset:3776
    s_waitcnt lgkmcnt(15)
    v_mfma_f32_16x16x32_bf16 v[232:235], v[92:95], v[168:171], v[232:235]
    ds_read_b64 v[124:125], v36 offset:192
    s_waitcnt lgkmcnt(14)
    v_mfma_f32_16x16x32_bf16 v[232:235], v[104:107], v[156:159], v[232:235]
    ds_read_b64 v[126:127], v36 offset:200
    v_mfma_f32_16x16x32_bf16 v[236:239], v[96:99], v[168:171], v[236:239]
    ds_read_b128 v[192:195], v37 offset:3264
    s_add_u32 m0, s71, 19296
    s_add_u32 s66, s70, 60160
    s_mov_b32 exec_hi, 0
    s_mov_b32 exec_lo, 1023
    buffer_load_dwordx4 v83, s[44:47], s66 offen nt lds
    s_mov_b64 exec, -1
    v_mfma_f32_16x16x32_bf16 v[236:239], v[104:107], v[160:163], v[236:239]
    ds_read_b64 v[128:129], v36 offset:704
    v_mfma_f32_16x16x32_bf16 v[240:243], v[100:103], v[168:171], v[240:243]
    ds_read_b64 v[130:131], v36 offset:712
    v_mfma_f32_16x16x32_bf16 v[240:243], v[104:107], v[164:167], v[240:243]
    ds_read_b128 v[196:199], v37 offset:2752
    v_mfma_f32_16x16x32_bf16 v[244:247], v[104:107], v[168:171], v[244:247]
    ds_read_b64 v[132:133], v36 offset:1216
    s_waitcnt lgkmcnt(15)
    v_mfma_f32_16x16x32_bf16 v[236:239], v[92:95], v[172:175], v[236:239]
    ds_read_b64 v[134:135], v36 offset:1224
    v_mfma_f32_16x16x32_bf16 v[236:239], v[108:111], v[156:159], v[236:239]
    ds_read_b128 v[200:203], v37 offset:2240
    v_mfma_f32_16x16x32_bf16 v[240:243], v[96:99], v[172:175], v[240:243]
    ds_read_b64 v[136:137], v36 offset:1728
    v_and_b32 v30, 1, v0
    v_mfma_f32_16x16x32_bf16 v[240:243], v[108:111], v[160:163], v[240:243]
    ds_read_b64 v[138:139], v36 offset:1736
    v_lshlrev_b32 v31, 7, v30
    v_mfma_f32_16x16x32_bf16 v[244:247], v[100:103], v[172:175], v[244:247]
    ds_read_b128 v[204:207], v37 offset:1728
    v_add_u32 v31, s83, v31
    v_mfma_f32_16x16x32_bf16 v[244:247], v[108:111], v[164:167], v[244:247]
    ds_read_b64 v[140:141], v36 offset:2240
    v_lshlrev_b32 v30, 12, v30
    v_mfma_f32_16x16x32_bf16 v[248:251], v[104:107], v[172:175], v[248:251]
    ds_read_b64 v[142:143], v36 offset:2248
    v_add_u32 v30, s85, v30
    v_mfma_f32_16x16x32_bf16 v[248:251], v[108:111], v[168:171], v[248:251]
    ds_read_b128 v[208:211], v37 offset:1216
    v_cmp_gt_u32 vcc, 2, v0
    v_mfma_f32_16x16x32_bf16 v[240:243], v[92:95], v[176:179], v[240:243]
    ds_read_b64 v[144:145], v36 offset:2752
    v_cndmask_b32 v30, v30, v31, vcc
    s_waitcnt lgkmcnt(15)
    v_mfma_f32_16x16x32_bf16 v[240:243], v[112:115], v[156:159], v[240:243]
    ds_read_b64 v[146:147], v36 offset:2760
    v_and_b32 v31, 7, v0
    v_mfma_f32_16x16x32_bf16 v[244:247], v[96:99], v[176:179], v[244:247]
    ds_read_b128 v[212:215], v37 offset:704
    v_lshlrev_b32 v31, 7, v31
    v_mfma_f32_16x16x32_bf16 v[244:247], v[112:115], v[160:163], v[244:247]
    ds_read_b64 v[148:149], v36 offset:3264
    v_bfe_u32 v32, v0, 3, 1
    v_mfma_f32_16x16x32_bf16 v[248:251], v[100:103], v[176:179], v[248:251]
    ds_read_b64 v[150:151], v36 offset:3272
    v_mul_u32_u24 v32, 40960, v32
    v_mfma_f32_16x16x32_bf16 v[248:251], v[112:115], v[164:167], v[248:251]
    ds_read_b128 v[216:219], v37 offset:192
    v_add3_u32 v31, v31, v32, s78
    v_mfma_f32_16x16x32_bf16 v[244:247], v[92:95], v[180:183], v[244:247]
    ds_read_b64 v[152:153], v36 offset:3776
    v_cmp_gt_u32 vcc, 32, v0
    v_mfma_f32_16x16x32_bf16 v[244:247], v[116:119], v[156:159], v[244:247]
    ds_read_b64 v[154:155], v36 offset:3784
    v_cndmask_b32 v30, v31, v30, vcc
    v_mfma_f32_16x16x32_bf16 v[248:251], v[96:99], v[180:183], v[248:251]
    s_sub_u32 s64, s77, s78
    v_add_u32 v31, s64, v31
    v_mfma_f32_16x16x32_bf16 v[248:251], v[116:119], v[160:163], v[248:251]
    v_cmp_gt_u32 vcc, 48, v0
    s_nop 1
    v_cndmask_b32 v30, v31, v30, vcc
    v_mfma_f32_16x16x32_bf16 v[248:251], v[92:95], v[184:187], v[248:251]
    v_and_b32 v31, 1, v0
    v_lshlrev_b32 v31, 7, v31
    v_mfma_f32_16x16x32_bf16 v[248:251], v[120:123], v[156:159], v[248:251]
    v_bfe_u32 v32, v0, 1, 1
    v_lshl_add_u32 v31, v32, 13, v31
    s_waitcnt lgkmcnt(15)
    v_mfma_f32_16x16x32_bf16 v[220:223], v[124:127], v[188:191], v[220:223]
    s_add_u32 s64, s86, 524288
    v_add_u32 v31, s64, v31
    v_mfma_f32_16x16x32_bf16 v[224:227], v[124:127], v[192:195], v[224:227]
    v_bfe_u32 v32, v0, 2, 4
    v_cmp_eq_u32 vcc, 1, v32
    v_mfma_f32_16x16x32_bf16 v[224:227], v[128:131], v[188:191], v[224:227]
    s_nop 0
    v_cndmask_b32 v30, v30, v31, vcc
    v_subrev_u32 v31, 524288, v31
    v_mfma_f32_16x16x32_bf16 v[228:231], v[128:131], v[192:195], v[228:231]
    v_cmp_eq_u32 vcc, 2, v32
    s_nop 1
    v_cndmask_b32 v30, v30, v31, vcc
    v_mfma_f32_16x16x32_bf16 v[228:231], v[124:127], v[196:199], v[228:231]
    buffer_load_dword v27, v30, s[32:35], 0 offen sc1
    v_mov_b32 v26, v85
    v_mfma_f32_16x16x32_bf16 v[228:231], v[132:135], v[188:191], v[228:231]
    v_mfma_f32_16x16x32_bf16 v[232:235], v[128:131], v[196:199], v[232:235]
    v_mfma_f32_16x16x32_bf16 v[232:235], v[132:135], v[192:195], v[232:235]
    v_mfma_f32_16x16x32_bf16 v[236:239], v[132:135], v[196:199], v[236:239]
    ds_read_b128 v[156:159], v37 offset:3840
    s_waitcnt lgkmcnt(15)
    v_mfma_f32_16x16x32_bf16 v[232:235], v[124:127], v[200:203], v[232:235]
    ds_read_b64 v[92:93], v36 offset:256
    s_waitcnt lgkmcnt(14)
    v_mfma_f32_16x16x32_bf16 v[232:235], v[136:139], v[188:191], v[232:235]
    ds_read_b64 v[94:95], v36 offset:264
    v_mfma_f32_16x16x32_bf16 v[236:239], v[128:131], v[200:203], v[236:239]
    ds_read_b128 v[160:163], v37 offset:3328
    v_mfma_f32_16x16x32_bf16 v[236:239], v[136:139], v[192:195], v[236:239]
    ds_read_b64 v[96:97], v36 offset:768
    v_mfma_f32_16x16x32_bf16 v[240:243], v[132:135], v[200:203], v[240:243]
    ds_read_b64 v[98:99], v36 offset:776
    v_mfma_f32_16x16x32_bf16 v[240:243], v[136:139], v[196:199], v[240:243]
    ds_read_b128 v[164:167], v37 offset:2816
    v_mfma_f32_16x16x32_bf16 v[244:247], v[136:139], v[200:203], v[244:247]
    ds_read_b64 v[100:101], v36 offset:1280
    s_waitcnt lgkmcnt(15)
    v_mfma_f32_16x16x32_bf16 v[236:239], v[124:127], v[204:207], v[236:239]
    ds_read_b64 v[102:103], v36 offset:1288
    v_mfma_f32_16x16x32_bf16 v[236:239], v[140:143], v[188:191], v[236:239]
    ds_read_b128 v[168:171], v37 offset:2304
    v_mfma_f32_16x16x32_bf16 v[240:243], v[128:131], v[204:207], v[240:243]
    ds_read_b64 v[104:105], v36 offset:1792
    v_mfma_f32_16x16x32_bf16 v[240:243], v[140:143], v[192:195], v[240:243]
    ds_read_b64 v[106:107], v36 offset:1800
    v_mfma_f32_16x16x32_bf16 v[244:247], v[132:135], v[204:207], v[244:247]
    ds_read_b128 v[172:175], v37 offset:1792
    v_mfma_f32_16x16x32_bf16 v[244:247], v[140:143], v[196:199], v[244:247]
    ds_read_b64 v[108:109], v36 offset:2304
    v_mfma_f32_16x16x32_bf16 v[248:251], v[136:139], v[204:207], v[248:251]
    ds_read_b64 v[110:111], v36 offset:2312
    v_mfma_f32_16x16x32_bf16 v[248:251], v[140:143], v[200:203], v[248:251]
    ds_read_b128 v[176:179], v37 offset:1280
    v_mfma_f32_16x16x32_bf16 v[240:243], v[124:127], v[208:211], v[240:243]
    ds_read_b64 v[112:113], v36 offset:2816
    s_waitcnt lgkmcnt(15)
    v_mfma_f32_16x16x32_bf16 v[240:243], v[144:147], v[188:191], v[240:243]
    ds_read_b64 v[114:115], v36 offset:2824
    v_mfma_f32_16x16x32_bf16 v[244:247], v[128:131], v[208:211], v[244:247]
    ds_read_b128 v[180:183], v37 offset:768
    v_mfma_f32_16x16x32_bf16 v[244:247], v[144:147], v[192:195], v[244:247]
    ds_read_b64 v[116:117], v36 offset:3328
    v_mfma_f32_16x16x32_bf16 v[248:251], v[132:135], v[208:211], v[248:251]
    ds_read_b64 v[118:119], v36 offset:3336
    v_mfma_f32_16x16x32_bf16 v[248:251], v[144:147], v[196:199], v[248:251]
    ds_read_b128 v[184:187], v37 offset:256
    v_mfma_f32_16x16x32_bf16 v[244:247], v[124:127], v[212:215], v[244:247]
    ds_read_b64 v[120:121], v36 offset:3840
    v_mfma_f32_16x16x32_bf16 v[244:247], v[148:151], v[188:191], v[244:247]
    ds_read_b64 v[122:123], v36 offset:3848
    v_mfma_f32_16x16x32_bf16 v[248:251], v[128:131], v[212:215], v[248:251]
    v_mfma_f32_16x16x32_bf16 v[248:251], v[148:151], v[192:195], v[248:251]
    v_mfma_f32_16x16x32_bf16 v[248:251], v[124:127], v[216:219], v[248:251]
    v_mfma_f32_16x16x32_bf16 v[248:251], v[152:155], v[188:191], v[248:251]
    s_waitcnt lgkmcnt(15)
    v_mfma_f32_16x16x32_bf16 v[220:223], v[92:95], v[156:159], v[220:223]
    v_mfma_f32_16x16x32_bf16 v[224:227], v[92:95], v[160:163], v[224:227]
    v_mfma_f32_16x16x32_bf16 v[224:227], v[96:99], v[156:159], v[224:227]
    v_mfma_f32_16x16x32_bf16 v[228:231], v[96:99], v[160:163], v[228:231]
    v_mfma_f32_16x16x32_bf16 v[228:231], v[92:95], v[164:167], v[228:231]
    v_mfma_f32_16x16x32_bf16 v[228:231], v[100:103], v[156:159], v[228:231]
    v_mfma_f32_16x16x32_bf16 v[232:235], v[96:99], v[164:167], v[232:235]
    v_mfma_f32_16x16x32_bf16 v[232:235], v[100:103], v[160:163], v[232:235]
    v_mfma_f32_16x16x32_bf16 v[236:239], v[100:103], v[164:167], v[236:239]
    ds_read_b128 v[188:191], v37 offset:3904
    s_waitcnt lgkmcnt(15)
    v_mfma_f32_16x16x32_bf16 v[232:235], v[92:95], v[168:171], v[232:235]
    ds_read_b64 v[124:125], v36 offset:320
    s_waitcnt lgkmcnt(14)
    v_mfma_f32_16x16x32_bf16 v[232:235], v[104:107], v[156:159], v[232:235]
    ds_read_b64 v[126:127], v36 offset:328
    v_mfma_f32_16x16x32_bf16 v[236:239], v[96:99], v[168:171], v[236:239]
    ds_read_b128 v[192:195], v37 offset:3392
    v_mfma_f32_16x16x32_bf16 v[236:239], v[104:107], v[160:163], v[236:239]
    ds_read_b64 v[128:129], v36 offset:832
    v_mfma_f32_16x16x32_bf16 v[240:243], v[100:103], v[168:171], v[240:243]
    ds_read_b64 v[130:131], v36 offset:840
    v_mfma_f32_16x16x32_bf16 v[240:243], v[104:107], v[164:167], v[240:243]
    ds_read_b128 v[196:199], v37 offset:2880
    v_mfma_f32_16x16x32_bf16 v[244:247], v[104:107], v[168:171], v[244:247]
    ds_read_b64 v[132:133], v36 offset:1344
    s_waitcnt lgkmcnt(15)
    v_mfma_f32_16x16x32_bf16 v[236:239], v[92:95], v[172:175], v[236:239]
    ds_read_b64 v[134:135], v36 offset:1352
    v_mfma_f32_16x16x32_bf16 v[236:239], v[108:111], v[156:159], v[236:239]
    ds_read_b128 v[200:203], v37 offset:2368
    v_mfma_f32_16x16x32_bf16 v[240:243], v[96:99], v[172:175], v[240:243]
    ds_read_b64 v[136:137], v36 offset:1856
    v_mfma_f32_16x16x32_bf16 v[240:243], v[108:111], v[160:163], v[240:243]
    ds_read_b64 v[138:139], v36 offset:1864
    v_mfma_f32_16x16x32_bf16 v[244:247], v[100:103], v[172:175], v[244:247]
    ds_read_b128 v[204:207], v37 offset:1856
    v_mfma_f32_16x16x32_bf16 v[244:247], v[108:111], v[164:167], v[244:247]
    ds_read_b64 v[140:141], v36 offset:2368
    v_mfma_f32_16x16x32_bf16 v[248:251], v[104:107], v[172:175], v[248:251]
    ds_read_b64 v[142:143], v36 offset:2376
    v_mfma_f32_16x16x32_bf16 v[248:251], v[108:111], v[168:171], v[248:251]
    ds_read_b128 v[208:211], v37 offset:1344
    v_mfma_f32_16x16x32_bf16 v[240:243], v[92:95], v[176:179], v[240:243]
    ds_read_b64 v[144:145], v36 offset:2880
    s_waitcnt lgkmcnt(15)
    v_mfma_f32_16x16x32_bf16 v[240:243], v[112:115], v[156:159], v[240:243]
    ds_read_b64 v[146:147], v36 offset:2888
    v_mfma_f32_16x16x32_bf16 v[244:247], v[96:99], v[176:179], v[244:247]
    ds_read_b128 v[212:215], v37 offset:832
    v_mfma_f32_16x16x32_bf16 v[244:247], v[112:115], v[160:163], v[244:247]
    ds_read_b64 v[148:149], v36 offset:3392
    v_mfma_f32_16x16x32_bf16 v[248:251], v[100:103], v[176:179], v[248:251]
    ds_read_b64 v[150:151], v36 offset:3400
    v_mfma_f32_16x16x32_bf16 v[248:251], v[112:115], v[164:167], v[248:251]
    ds_read_b128 v[216:219], v37 offset:320
    v_mfma_f32_16x16x32_bf16 v[244:247], v[92:95], v[180:183], v[244:247]
    ds_read_b64 v[152:153], v36 offset:3904
    v_mfma_f32_16x16x32_bf16 v[244:247], v[116:119], v[156:159], v[244:247]
    ds_read_b64 v[154:155], v36 offset:3912
    v_mfma_f32_16x16x32_bf16 v[248:251], v[96:99], v[180:183], v[248:251]
    v_mfma_f32_16x16x32_bf16 v[248:251], v[116:119], v[160:163], v[248:251]
    v_mfma_f32_16x16x32_bf16 v[248:251], v[92:95], v[184:187], v[248:251]
    v_mfma_f32_16x16x32_bf16 v[248:251], v[120:123], v[156:159], v[248:251]
    s_waitcnt lgkmcnt(15)
    v_mfma_f32_16x16x32_bf16 v[220:223], v[124:127], v[188:191], v[220:223]
    v_mfma_f32_16x16x32_bf16 v[224:227], v[124:127], v[192:195], v[224:227]
    v_mfma_f32_16x16x32_bf16 v[224:227], v[128:131], v[188:191], v[224:227]
    v_mfma_f32_16x16x32_bf16 v[228:231], v[128:131], v[192:195], v[228:231]
    v_mfma_f32_16x16x32_bf16 v[228:231], v[124:127], v[196:199], v[228:231]
    v_mfma_f32_16x16x32_bf16 v[228:231], v[132:135], v[188:191], v[228:231]
    v_mfma_f32_16x16x32_bf16 v[232:235], v[128:131], v[196:199], v[232:235]
    v_mfma_f32_16x16x32_bf16 v[232:235], v[132:135], v[192:195], v[232:235]
    v_mfma_f32_16x16x32_bf16 v[236:239], v[132:135], v[196:199], v[236:239]
    ds_read_b128 v[156:159], v37 offset:3968
    s_waitcnt lgkmcnt(15)
    v_mfma_f32_16x16x32_bf16 v[232:235], v[124:127], v[200:203], v[232:235]
    ds_read_b64 v[92:93], v36 offset:384
    s_waitcnt lgkmcnt(14)
    v_mfma_f32_16x16x32_bf16 v[232:235], v[136:139], v[188:191], v[232:235]
    ds_read_b64 v[94:95], v36 offset:392
    v_mfma_f32_16x16x32_bf16 v[236:239], v[128:131], v[200:203], v[236:239]
    ds_read_b128 v[160:163], v37 offset:3456
    v_mfma_f32_16x16x32_bf16 v[236:239], v[136:139], v[192:195], v[236:239]
    ds_read_b64 v[96:97], v36 offset:896
    v_mfma_f32_16x16x32_bf16 v[240:243], v[132:135], v[200:203], v[240:243]
    ds_read_b64 v[98:99], v36 offset:904
    v_mfma_f32_16x16x32_bf16 v[240:243], v[136:139], v[196:199], v[240:243]
    ds_read_b128 v[164:167], v37 offset:2944
    v_mfma_f32_16x16x32_bf16 v[244:247], v[136:139], v[200:203], v[244:247]
    ds_read_b64 v[100:101], v36 offset:1408
    s_waitcnt lgkmcnt(15)
    v_mfma_f32_16x16x32_bf16 v[236:239], v[124:127], v[204:207], v[236:239]
    ds_read_b64 v[102:103], v36 offset:1416
    v_mfma_f32_16x16x32_bf16 v[236:239], v[140:143], v[188:191], v[236:239]
    ds_read_b128 v[168:171], v37 offset:2432
    s_mul_i32 s64, s54, 19456
    v_mfma_f32_16x16x32_bf16 v[240:243], v[128:131], v[204:207], v[240:243]
    ds_read_b64 v[104:105], v36 offset:1920
    s_lshr_b32 s65, s89, 1
    v_mfma_f32_16x16x32_bf16 v[240:243], v[140:143], v[192:195], v[240:243]
    ds_read_b64 v[106:107], v36 offset:1928
    s_add_u32 s64, s64, s65
    v_mfma_f32_16x16x32_bf16 v[244:247], v[132:135], v[204:207], v[244:247]
    ds_read_b128 v[172:175], v37 offset:1920
    s_add_u32 s64, s64, 14336
    v_mfma_f32_16x16x32_bf16 v[244:247], v[140:143], v[196:199], v[244:247]
    ds_read_b64 v[108:109], v36 offset:2432
    v_mul_u32_u24 v30, 160, v2
    v_mfma_f32_16x16x32_bf16 v[248:251], v[136:139], v[204:207], v[248:251]
    ds_read_b64 v[110:111], v36 offset:2440
    v_lshl_add_u32 v30, v3, 3, v30
    v_mfma_f32_16x16x32_bf16 v[248:251], v[140:143], v[200:203], v[248:251]
    ds_read_b128 v[176:179], v37 offset:1408
    v_add_u32 v30, s64, v30
    v_mfma_f32_16x16x32_bf16 v[240:243], v[124:127], v[208:211], v[240:243]
    ds_read_b64 v[112:113], v36 offset:2944
    s_waitcnt vmcnt(1)
    s_waitcnt lgkmcnt(15)
    v_mfma_f32_16x16x32_bf16 v[240:243], v[144:147], v[188:191], v[240:243]
    ds_read_b64 v[114:115], v36 offset:2952
    ds_read_b32 v6, v30 offset:0
    v_mfma_f32_16x16x32_bf16 v[244:247], v[128:131], v[208:211], v[244:247]
    ds_read_b128 v[180:183], v37 offset:896
    ds_read_b32 v7, v30 offset:32
    v_mfma_f32_16x16x32_bf16 v[244:247], v[144:147], v[192:195], v[244:247]
    ds_read_b64 v[116:117], v36 offset:3456
    ds_read_b32 v8, v30 offset:64
    v_mfma_f32_16x16x32_bf16 v[248:251], v[132:135], v[208:211], v[248:251]
    ds_read_b64 v[118:119], v36 offset:3464
    ds_read_b32 v9, v30 offset:96
    v_mfma_f32_16x16x32_bf16 v[248:251], v[144:147], v[196:199], v[248:251]
    ds_read_b128 v[184:187], v37 offset:384
    ds_read_b32 v10, v30 offset:128
    v_mfma_f32_16x16x32_bf16 v[244:247], v[124:127], v[212:215], v[244:247]
    ds_read_b64 v[120:121], v36 offset:3968
    ds_read_b32 v12, v30 offset:2560
    v_mfma_f32_16x16x32_bf16 v[244:247], v[148:151], v[188:191], v[244:247]
    ds_read_b64 v[122:123], v36 offset:3976
    ds_read_b32 v13, v30 offset:2592
    v_mfma_f32_16x16x32_bf16 v[248:251], v[128:131], v[212:215], v[248:251]
    ds_read_b32 v14, v30 offset:2624
    ds_read_b32 v15, v30 offset:2656
    v_mfma_f32_16x16x32_bf16 v[248:251], v[148:151], v[192:195], v[248:251]
    ds_read_b32 v16, v30 offset:2688
    v_mfma_f32_16x16x32_bf16 v[248:251], v[124:127], v[216:219], v[248:251]
    v_mfma_f32_16x16x32_bf16 v[248:251], v[152:155], v[188:191], v[248:251]
    s_waitcnt lgkmcnt(15)
    v_mfma_f32_16x16x32_bf16 v[220:223], v[92:95], v[156:159], v[220:223]
    v_mfma_f32_16x16x32_bf16 v[224:227], v[92:95], v[160:163], v[224:227]
    v_mfma_f32_16x16x32_bf16 v[224:227], v[96:99], v[156:159], v[224:227]
    v_mfma_f32_16x16x32_bf16 v[228:231], v[96:99], v[160:163], v[228:231]
    v_mfma_f32_16x16x32_bf16 v[228:231], v[92:95], v[164:167], v[228:231]
    v_lshlrev_b32 v38, 16, v6
    v_and_b32 v39, 0xffff0000, v6
    v_mfma_f32_16x16x32_bf16 v[228:231], v[100:103], v[156:159], v[228:231]
    s_waitcnt lgkmcnt(13)
    v_lshlrev_b32 v40, 16, v7
    v_and_b32 v41, 0xffff0000, v7
    v_mfma_f32_16x16x32_bf16 v[232:235], v[96:99], v[164:167], v[232:235]
    s_waitcnt lgkmcnt(11)
    v_lshlrev_b32 v42, 16, v8
    v_and_b32 v43, 0xffff0000, v8
    v_mfma_f32_16x16x32_bf16 v[232:235], v[100:103], v[160:163], v[232:235]
    s_waitcnt lgkmcnt(9)
    v_lshlrev_b32 v44, 16, v9
    v_and_b32 v45, 0xffff0000, v9
    v_mfma_f32_16x16x32_bf16 v[236:239], v[100:103], v[164:167], v[236:239]
    ds_read_b128 v[188:191], v37 offset:4032
    s_waitcnt lgkmcnt(8)
    v_lshlrev_b32 v46, 16, v10
    v_mfma_f32_16x16x32_bf16 v[232:235], v[92:95], v[168:171], v[232:235]
    ds_read_b64 v[124:125], v36 offset:448
    v_and_b32 v47, 0xffff0000, v10
    v_mfma_f32_16x16x32_bf16 v[232:235], v[104:107], v[156:159], v[232:235]
    ds_read_b64 v[126:127], v36 offset:456
    s_add_u32 s64, s86, 0
    v_mfma_f32_16x16x32_bf16 v[236:239], v[96:99], v[168:171], v[236:239]
    ds_read_b128 v[192:195], v37 offset:3520
    v_add_f32 v58, v38, v39
    v_mfma_f32_16x16x32_bf16 v[236:239], v[104:107], v[160:163], v[236:239]
    ds_read_b64 v[128:129], v36 offset:960
    v_mul_f32 v59, v38, v38
    v_mfma_f32_16x16x32_bf16 v[240:243], v[100:103], v[168:171], v[240:243]
    ds_read_b64 v[130:131], v36 offset:968
    v_mul_f32 v61, v39, v39
    v_mfma_f32_16x16x32_bf16 v[240:243], v[104:107], v[164:167], v[240:243]
    ds_read_b128 v[196:199], v37 offset:3008
    v_add_f32 v60, v40, v41
    v_mfma_f32_16x16x32_bf16 v[244:247], v[104:107], v[168:171], v[244:247]
    ds_read_b64 v[132:133], v36 offset:1472
    v_fmac_f32 v59, v40, v40
    v_mfma_f32_16x16x32_bf16 v[236:239], v[92:95], v[172:175], v[236:239]
    ds_read_b64 v[134:135], v36 offset:1480
    v_fmac_f32 v61, v41, v41
    v_mfma_f32_16x16x32_bf16 v[236:239], v[108:111], v[156:159], v[236:239]
    ds_read_b128 v[200:203], v37 offset:2496
    v_fmac_f32 v59, v42, v42
    v_mfma_f32_16x16x32_bf16 v[240:243], v[96:99], v[172:175], v[240:243]
    ds_read_b64 v[136:137], v36 offset:1984
    v_fmac_f32 v61, v43, v43
    v_mfma_f32_16x16x32_bf16 v[240:243], v[108:111], v[160:163], v[240:243]
    ds_read_b64 v[138:139], v36 offset:1992
    v_add_f32 v58, v58, v42
    v_mfma_f32_16x16x32_bf16 v[244:247], v[100:103], v[172:175], v[244:247]
    ds_read_b128 v[204:207], v37 offset:1984
    v_add_f32 v60, v60, v43
    v_mfma_f32_16x16x32_bf16 v[244:247], v[108:111], v[164:167], v[244:247]
    ds_read_b64 v[140:141], v36 offset:2496
    v_fmac_f32 v59, v44, v44
    v_mfma_f32_16x16x32_bf16 v[248:251], v[104:107], v[172:175], v[248:251]
    ds_read_b64 v[142:143], v36 offset:2504
    v_fmac_f32 v61, v45, v45
    v_mfma_f32_16x16x32_bf16 v[248:251], v[108:111], v[168:171], v[248:251]
    ds_read_b128 v[208:211], v37 offset:1472
    v_add_f32 v58, v58, v44
    v_mfma_f32_16x16x32_bf16 v[240:243], v[92:95], v[176:179], v[240:243]
    ds_read_b64 v[144:145], v36 offset:3008
    v_add_f32 v60, v60, v45
    v_mfma_f32_16x16x32_bf16 v[240:243], v[112:115], v[156:159], v[240:243]
    ds_read_b64 v[146:147], v36 offset:3016
    v_fmac_f32 v59, v46, v46
    v_mfma_f32_16x16x32_bf16 v[244:247], v[96:99], v[176:179], v[244:247]
    ds_read_b128 v[212:215], v37 offset:960
    v_fmac_f32 v61, v47, v47
    v_mfma_f32_16x16x32_bf16 v[244:247], v[112:115], v[160:163], v[244:247]
    ds_read_b64 v[148:149], v36 offset:3520
    v_add_f32 v58, v58, v46
    v_mfma_f32_16x16x32_bf16 v[248:251], v[100:103], v[176:179], v[248:251]
    ds_read_b64 v[150:151], v36 offset:3528
    v_add_f32 v60, v60, v47
    v_mfma_f32_16x16x32_bf16 v[248:251], v[112:115], v[164:167], v[248:251]
    ds_read_b128 v[216:219], v37 offset:448
    v_add_f32 v58, v58, v60
    v_mfma_f32_16x16x32_bf16 v[244:247], v[92:95], v[180:183], v[244:247]
    ds_read_b64 v[152:153], v36 offset:4032
    v_add_f32 v59, v59, v61
    v_mfma_f32_16x16x32_bf16 v[244:247], v[116:119], v[156:159], v[244:247]
    ds_read_b64 v[154:155], v36 offset:4040
    v_lshlrev_b32 v61, 4, v2
    v_mfma_f32_16x16x32_bf16 v[248:251], v[96:99], v[180:183], v[248:251]
    v_mov_b32 v60, s59
    v_permlane16_swap_b32 v58, v59
    v_mfma_f32_16x16x32_bf16 v[248:251], v[116:119], v[160:163], v[248:251]
    v_add_f32 v58, v58, v59
    v_mov_b32 v59, v58
    v_mfma_f32_16x16x32_bf16 v[248:251], v[92:95], v[184:187], v[248:251]
    s_nop 0
    v_permlane32_swap_b32 v58, v59
    v_add_f32 v58, v58, v59
    s_waitcnt lgkmcnt(15)
    v_mfma_f32_16x16x32_bf16 v[248:251], v[120:123], v[156:159], v[248:251]
    v_mov_b32 v59, v58
    s_nop 1
    v_permlane16_swap_b32 v58, v59
    v_mfma_f32_16x16x32_bf16 v[220:223], v[124:127], v[188:191], v[220:223]
    buffer_store_dwordx3 v[58:60], v61, s[32:35], s64 offen offset:0
    v_lshlrev_b32 v48, 16, v12
    v_mfma_f32_16x16x32_bf16 v[224:227], v[124:127], v[192:195], v[224:227]
    v_and_b32 v49, 0xffff0000, v12
    v_lshlrev_b32 v50, 16, v13
    v_mfma_f32_16x16x32_bf16 v[224:227], v[128:131], v[188:191], v[224:227]
    v_and_b32 v51, 0xffff0000, v13
    v_lshlrev_b32 v52, 16, v14
    v_mfma_f32_16x16x32_bf16 v[228:231], v[128:131], v[192:195], v[228:231]
    v_and_b32 v53, 0xffff0000, v14
    v_lshlrev_b32 v54, 16, v15
    v_mfma_f32_16x16x32_bf16 v[228:231], v[124:127], v[196:199], v[228:231]
    v_and_b32 v55, 0xffff0000, v15
    v_lshlrev_b32 v56, 16, v16
    v_mfma_f32_16x16x32_bf16 v[228:231], v[132:135], v[188:191], v[228:231]
    v_and_b32 v57, 0xffff0000, v16
    s_add_u32 s64, s86, 8192
    v_add_f32 v58, v48, v49
    v_mul_f32 v59, v48, v48
    v_mul_f32 v61, v49, v49
    v_add_f32 v60, v50, v51
    v_fmac_f32 v59, v50, v50
    v_fmac_f32 v61, v51, v51
    v_fmac_f32 v59, v52, v52
    v_fmac_f32 v61, v53, v53
    v_add_f32 v58, v58, v52
    v_add_f32 v60, v60, v53
    v_fmac_f32 v59, v54, v54
    v_fmac_f32 v61, v55, v55
    v_add_f32 v58, v58, v54
    v_add_f32 v60, v60, v55
    v_fmac_f32 v59, v56, v56
    v_fmac_f32 v61, v57, v57
    v_add_f32 v58, v58, v56
    v_add_f32 v60, v60, v57
    v_add_f32 v58, v58, v60
    v_add_f32 v59, v59, v61
    v_lshlrev_b32 v61, 4, v2
    v_mov_b32 v60, s59
    v_permlane16_swap_b32 v58, v59
    v_add_f32 v58, v58, v59
    v_mov_b32 v59, v58
    s_nop 1
    v_permlane32_swap_b32 v58, v59
    v_add_f32 v58, v58, v59
    v_mov_b32 v59, v58
    s_nop 1
    v_permlane16_swap_b32 v58, v59
    buffer_store_dwordx3 v[58:60], v61, s[32:35], s64 offen offset:0
    buffer_load_dword v34, v91, s[32:35], 0 offen sc1
    v_mfma_f32_16x16x32_bf16 v[232:235], v[128:131], v[196:199], v[232:235]
    s_mul_i32 s67, s54, 21312
    s_add_u32 s67, s67, 78592
    v_mfma_f32_16x16x32_bf16 v[232:235], v[132:135], v[192:195], v[232:235]
    v_lshlrev_b32 v108, 5, v2
    v_lshl_add_u32 v108, v3, 3, v108
    v_mfma_f32_16x16x32_bf16 v[236:239], v[132:135], v[196:199], v[236:239]
    v_add_u32 v108, s67, v108
    v_bfe_u32 v109, v0, 2, 2
    s_waitcnt lgkmcnt(14)
    v_mfma_f32_16x16x32_bf16 v[232:235], v[124:127], v[200:203], v[232:235]
    v_mul_u32_u24 v109, 21312, v109
    v_and_b32 v110, 3, v0
    s_waitcnt lgkmcnt(12)
    v_mfma_f32_16x16x32_bf16 v[232:235], v[136:139], v[188:191], v[232:235]
    v_lshl_add_u32 v109, v110, 3, v109
    v_lshl_add_u32 v109, v3, 5, v109
    v_mfma_f32_16x16x32_bf16 v[236:239], v[128:131], v[200:203], v[236:239]
    s_lshl_b32 s64, s54, 10
    s_add_u32 s64, s64, 78592
    v_mfma_f32_16x16x32_bf16 v[236:239], v[136:139], v[192:195], v[236:239]
    v_add_u32 v109, s64, v109
    v_mul_u32_u24 v110, 20480, v3
    v_mfma_f32_16x16x32_bf16 v[240:243], v[132:135], v[200:203], v[240:243]
    v_lshl_add_u32 v110, v2, 3, v110
    s_mul_i32 s68, s54, 655360
    v_mfma_f32_16x16x32_bf16 v[240:243], v[136:139], v[196:199], v[240:243]
    s_lshl_b32 s65, s3, 7
    s_add_u32 s68, s68, s65
    v_mfma_f32_16x16x32_bf16 v[244:247], v[136:139], v[200:203], v[244:247]
    s_add_u32 s68, s68, 6291456
    s_lshl_b32 s64, s3, 9
    s_waitcnt lgkmcnt(11)
    v_mfma_f32_16x16x32_bf16 v[236:239], v[124:127], v[204:207], v[236:239]
    s_lshl_b32 s65, s54, 7
    s_add_u32 s64, s64, s65
    s_waitcnt lgkmcnt(9)
    v_mfma_f32_16x16x32_bf16 v[236:239], v[140:143], v[188:191], v[236:239]
    s_add_u32 s64, s64, 262144
    v_mov_b32 v111, s64
    v_mfma_f32_16x16x32_bf16 v[240:243], v[128:131], v[204:207], v[240:243]
    s_lshl_b32 s64, s52, 5
    s_add_u32 s64, s64, s53
    v_mfma_f32_16x16x32_bf16 v[240:243], v[140:143], v[192:195], v[240:243]
    s_lshl_b32 s64, s64, 4
    s_lshr_b32 s65, s65, 5
    v_mfma_f32_16x16x32_bf16 v[244:247], v[132:135], v[204:207], v[244:247]
    s_add_u32 s64, s64, s65
    s_add_u32 s64, s64, 65536
    v_mfma_f32_16x16x32_bf16 v[244:247], v[140:143], v[196:199], v[244:247]
    v_mov_b32 v112, s64
    v_mov_b32 v113, s59
    v_mfma_f32_16x16x32_bf16 v[248:251], v[136:139], v[204:207], v[248:251]
    v_mfma_f32_16x16x32_bf16 v[248:251], v[140:143], v[200:203], v[248:251]
    s_waitcnt lgkmcnt(8)
    v_mfma_f32_16x16x32_bf16 v[240:243], v[124:127], v[208:211], v[240:243]
    s_waitcnt lgkmcnt(6)
    v_mfma_f32_16x16x32_bf16 v[240:243], v[144:147], v[188:191], v[240:243]
    v_mfma_f32_16x16x32_bf16 v[244:247], v[128:131], v[208:211], v[244:247]
    v_mfma_f32_16x16x32_bf16 v[244:247], v[144:147], v[192:195], v[244:247]
    v_mfma_f32_16x16x32_bf16 v[248:251], v[132:135], v[208:211], v[248:251]
    v_mfma_f32_16x16x32_bf16 v[248:251], v[144:147], v[196:199], v[248:251]
    s_waitcnt lgkmcnt(5)
    v_mfma_f32_16x16x32_bf16 v[244:247], v[124:127], v[212:215], v[244:247]
    s_waitcnt lgkmcnt(3)
    v_mfma_f32_16x16x32_bf16 v[244:247], v[148:151], v[188:191], v[244:247]
    v_mfma_f32_16x16x32_bf16 v[248:251], v[128:131], v[212:215], v[248:251]
    v_mfma_f32_16x16x32_bf16 v[248:251], v[148:151], v[192:195], v[248:251]
    s_waitcnt lgkmcnt(2)
    v_mfma_f32_16x16x32_bf16 v[248:251], v[124:127], v[216:219], v[248:251]
    s_waitcnt lgkmcnt(0)
    v_mfma_f32_16x16x32_bf16 v[248:251], v[152:155], v[188:191], v[248:251]
    v_cvt_pk_bf16_f32 v92, v220, v221
    v_cvt_pk_bf16_f32 v93, v222, v223
    ds_write_b64 v108, v[92:93] offset:0
    v_cvt_pk_bf16_f32 v94, v224, v225
    v_cvt_pk_bf16_f32 v95, v226, v227
    ds_write_b64 v108, v[94:95] offset:512
    v_cvt_pk_bf16_f32 v96, v228, v229
    v_cvt_pk_bf16_f32 v97, v230, v231
    ds_write_b64 v108, v[96:97] offset:1024
    v_cvt_pk_bf16_f32 v98, v232, v233
    v_cvt_pk_bf16_f32 v99, v234, v235
    ds_write_b64 v108, v[98:99] offset:1536
    v_cvt_pk_bf16_f32 v100, v236, v237
    v_cvt_pk_bf16_f32 v101, v238, v239
    ds_write_b64 v108, v[100:101] offset:2048
    v_cvt_pk_bf16_f32 v102, v240, v241
    v_cvt_pk_bf16_f32 v103, v242, v243
    ds_write_b64 v108, v[102:103] offset:2560
    v_cvt_pk_bf16_f32 v104, v244, v245
    v_cvt_pk_bf16_f32 v105, v246, v247
    ds_write_b64 v108, v[104:105] offset:3072
    v_cvt_pk_bf16_f32 v106, v248, v249
    v_cvt_pk_bf16_f32 v107, v250, v251
    ds_write_b64 v108, v[106:107] offset:3584
    s_waitcnt lgkmcnt(0)
    s_barrier
    ds_read_b64_tr_b16 v[156:157], v109 offset:0
    ds_read_b64_tr_b16 v[158:159], v109 offset:128
    ds_read_b64_tr_b16 v[160:161], v109 offset:256
    ds_read_b64_tr_b16 v[162:163], v109 offset:384
    ds_read_b64_tr_b16 v[164:165], v109 offset:512
    ds_read_b64_tr_b16 v[166:167], v109 offset:640
    ds_read_b64_tr_b16 v[168:169], v109 offset:768
    ds_read_b64_tr_b16 v[170:171], v109 offset:896
    s_waitcnt lgkmcnt(7)
    buffer_store_dwordx2 v[156:157], v110, s[32:35], s68 offen sc1
    s_add_u32 s68, s68, 81920
    s_waitcnt lgkmcnt(6)
    buffer_store_dwordx2 v[158:159], v110, s[32:35], s68 offen sc1
    s_add_u32 s68, s68, 81920
    s_waitcnt lgkmcnt(5)
    buffer_store_dwordx2 v[160:161], v110, s[32:35], s68 offen sc1
    s_add_u32 s68, s68, 81920
    s_waitcnt lgkmcnt(4)
    buffer_store_dwordx2 v[162:163], v110, s[32:35], s68 offen sc1
    s_add_u32 s68, s68, 81920
    s_waitcnt lgkmcnt(3)
    buffer_store_dwordx2 v[164:165], v110, s[32:35], s68 offen sc1
    s_add_u32 s68, s68, 81920
    s_waitcnt lgkmcnt(2)
    buffer_store_dwordx2 v[166:167], v110, s[32:35], s68 offen sc1
    s_add_u32 s68, s68, 81920
    s_waitcnt lgkmcnt(1)
    buffer_store_dwordx2 v[168:169], v110, s[32:35], s68 offen sc1
    s_add_u32 s68, s68, 81920
    s_waitcnt lgkmcnt(0)
    buffer_store_dwordx2 v[170:171], v110, s[32:35], s68 offen sc1
    buffer_store_dword v113, v112, s[32:35], 0 offen
    s_mov_b32 s67, s87
    s_add_u32 s68, s87, 8192
    buffer_load_dwordx3 v[58:60], v1, s[32:35], s67 offen offset:0 sc1
    buffer_load_dwordx3 v[62:64], v1, s[32:35], s67 offen offset:1024 sc1
    buffer_load_dwordx3 v[66:68], v1, s[32:35], s67 offen offset:2048 sc1
    buffer_load_dwordx3 v[70:72], v1, s[32:35], s67 offen offset:3072 sc1
    buffer_load_dwordx3 v[74:76], v1, s[32:35], s68 offen offset:0 sc1
    buffer_load_dwordx3 v[78:80], v1, s[32:35], s68 offen offset:1024 sc1
    buffer_load_dwordx3 v[82:84], v1, s[32:35], s68 offen offset:2048 sc1
    buffer_load_dwordx3 v[86:88], v1, s[32:35], s68 offen offset:3072 sc1
    ds_read_b64_tr_b16 v[192:193], v26 offset:0
    ds_read_b64_tr_b16 v[194:195], v26 offset:2560
    ds_read_b64_tr_b16 v[196:197], v26 offset:32
    ds_read_b64_tr_b16 v[198:199], v26 offset:2592
    ds_read_b64_tr_b16 v[200:201], v26 offset:64
    ds_read_b64_tr_b16 v[202:203], v26 offset:2624
    ds_read_b64_tr_b16 v[204:205], v26 offset:96
    ds_read_b64_tr_b16 v[206:207], v26 offset:2656
    ds_read_b64_tr_b16 v[208:209], v26 offset:128
    ds_read_b64_tr_b16 v[210:211], v26 offset:2688
    s_waitcnt vmcnt(9)
    buffer_store_dword v113, v111, s[32:35], 0 offen sc1
    s_waitcnt lgkmcnt(8)
    buffer_store_dwordx4 v[192:195], v1, s[32:35], s98 offen offset:0 sc1
    s_waitcnt lgkmcnt(6)
    buffer_store_dwordx4 v[196:199], v1, s[32:35], s98 offen offset:1024 sc1
    s_waitcnt lgkmcnt(4)
    buffer_store_dwordx4 v[200:203], v1, s[32:35], s98 offen offset:2048 sc1
    s_waitcnt lgkmcnt(2)
    buffer_store_dwordx4 v[204:207], v1, s[32:35], s98 offen offset:3072 sc1
    s_add_u32 s98, s98, 4096
    s_waitcnt lgkmcnt(0)
    buffer_store_dwordx4 v[208:211], v1, s[32:35], s98 offen offset:0 sc1
    v_cmp_ne_u32 vcc, s59, v34
    s_cbranch_vccnz SPIN_15
BACK_16:
    s_mul_i32 s69, s54, 19456
    s_add_u32 m0, s69, 0
    s_add_u32 s66, s92, m0
    buffer_load_dwordx4 v1, s[32:35], s66 offen sc1 lds
    s_add_u32 m0, s69, 1024
    s_add_u32 s66, s92, m0
    buffer_load_dwordx4 v1, s[32:35], s66 offen sc1 lds
    s_add_u32 m0, s69, 2048
    s_add_u32 s66, s92, m0
    buffer_load_dwordx4 v1, s[32:35], s66 offen sc1 lds
    s_add_u32 m0, s69, 3072
    s_add_u32 s66, s92, m0
    buffer_load_dwordx4 v1, s[32:35], s66 offen sc1 lds
    s_add_u32 m0, s69, 4096
    s_add_u32 s66, s92, m0
    buffer_load_dwordx4 v1, s[32:35], s66 offen sc1 lds
    s_add_u32 m0, s69, 5120
    s_add_u32 s66, s92, m0
    buffer_load_dwordx4 v1, s[32:35], s66 offen sc1 lds
    s_add_u32 m0, s69, 6144
    s_add_u32 s66, s92, m0
    buffer_load_dwordx4 v1, s[32:35], s66 offen sc1 lds
    s_add_u32 m0, s69, 7168
    s_add_u32 s66, s92, m0
    buffer_load_dwordx4 v1, s[32:35], s66 offen sc1 lds
    s_add_u32 m0, s69, 8192
    s_add_u32 s66, s92, m0
    buffer_load_dwordx4 v1, s[32:35], s66 offen sc1 lds
    s_add_u32 m0, s69, 9216
    s_add_u32 s66, s92, m0
    buffer_load_dwordx4 v1, s[32:35], s66 offen sc1 lds
    s_add_u32 m0, s69, 10240
    s_add_u32 s66, s92, m0
    buffer_load_dwordx4 v1, s[32:35], s66 offen sc1 lds
    s_add_u32 m0, s69, 11264
    s_add_u32 s66, s92, m0
    buffer_load_dwordx4 v1, s[32:35], s66 offen sc1 lds
    s_waitcnt vmcnt(24)
    v_xor_b32 v60, v60, v64
    s_waitcnt vmcnt(22)
    v_xor_b32 v68, v68, v72
    v_xor_b32 v64, v64, v72
    v_xor_b32 v72, s59, v72
    v_or3_b32 v60, v60, v64, v68
    v_or_b32 v60, v60, v72
    v_cmp_ne_u32 vcc, 0, v60
    s_cbranch_vccnz SPIN_17
BACK_18:
    v_add_f32 v58, v58, v62
    v_add_f32 v59, v59, v63
    v_add_f32 v66, v66, v70
    v_add_f32 v67, v67, v71
    v_add_f32 v58, v58, v66
    v_add_f32 v59, v59, v67
    s_nop 1
    v_permlane16_swap_b32 v58, v59
    v_add_f32 v58, v58, v59
    v_mov_b32 v59, v58
    s_nop 1
    v_permlane32_swap_b32 v58, v59
    v_add_f32 v58, v58, v59
    v_mul_f32 v30, 0x3acccccd, v58
    v_mul_f32 v31, 0x3acccccd, v58
    s_nop 1
    v_permlane16_swap_b32 v30, v31
    v_fma_f32 v31, -v30, v30, v31
    v_max_f32 v31, 0, v31
    v_cvt_pk_bf16_f32 v31, v31, v30
    v_and_b32 v30, 0xffff0000, v31
    v_lshlrev_b32 v31, 16, v31
    v_add_f32 v31, 0x3727c5ac, v31
    v_cvt_pk_bf16_f32 v31, v31, v31
    v_lshlrev_b32 v31, 16, v31
    v_sqrt_f32 v31, v31
    s_nop 0
    v_cvt_pk_bf16_f32 v31, v31, v31
    v_lshlrev_b32 v31, 16, v31
    v_rcp_f32 v31, v31
    s_nop 0
    v_mul_f32 v32, -v30, v31
    v_fma_f32 v58, v38, v31, v32
    v_fma_f32 v59, v39, v31, v32
    v_fma_f32 v60, v40, v31, v32
    v_fma_f32 v61, v41, v31, v32
    v_fma_f32 v62, v42, v31, v32
    v_fma_f32 v63, v43, v31, v32
    v_fma_f32 v64, v44, v31, v32
    v_fma_f32 v65, v45, v31, v32
    v_fma_f32 v66, v46, v31, v32
    v_fma_f32 v67, v47, v31, v32
    s_waitcnt vmcnt(20)
    v_xor_b32 v76, v76, v80
    s_waitcnt vmcnt(18)
    v_xor_b32 v84, v84, v88
    v_xor_b32 v80, v80, v88
    v_xor_b32 v88, s59, v88
    v_or3_b32 v76, v76, v80, v84
    v_or_b32 v76, v76, v88
    v_cmp_ne_u32 vcc, 0, v76
    s_cbranch_vccnz SPIN_19
BACK_20:
    v_add_f32 v74, v74, v78
    v_add_f32 v75, v75, v79
    v_add_f32 v82, v82, v86
    v_add_f32 v83, v83, v87
    v_add_f32 v74, v74, v82
    v_add_f32 v75, v75, v83
    s_nop 1
    v_permlane16_swap_b32 v74, v75
    v_add_f32 v74, v74, v75
    v_mov_b32 v75, v74
    s_nop 1
    v_permlane32_swap_b32 v74, v75
    v_add_f32 v74, v74, v75
    v_mul_f32 v30, 0x3acccccd, v74
    v_mul_f32 v31, 0x3acccccd, v74
    s_nop 1
    v_permlane16_swap_b32 v30, v31
    v_fma_f32 v31, -v30, v30, v31
    v_max_f32 v31, 0, v31
    v_cvt_pk_bf16_f32 v31, v31, v30
    v_and_b32 v30, 0xffff0000, v31
    v_lshlrev_b32 v31, 16, v31
    v_add_f32 v31, 0x3727c5ac, v31
    v_cvt_pk_bf16_f32 v31, v31, v31
    v_lshlrev_b32 v31, 16, v31
    v_sqrt_f32 v31, v31
    s_nop 0
    v_cvt_pk_bf16_f32 v31, v31, v31
    v_lshlrev_b32 v31, 16, v31
    v_rcp_f32 v31, v31
    s_nop 0
    v_mul_f32 v32, -v30, v31
    v_fma_f32 v74, v48, v31, v32
    v_fma_f32 v75, v49, v31, v32
    v_fma_f32 v76, v50, v31, v32
    v_fma_f32 v77, v51, v31, v32
    v_fma_f32 v78, v52, v31, v32
    v_fma_f32 v79, v53, v31, v32
    v_fma_f32 v80, v54, v31, v32
    v_fma_f32 v81, v55, v31, v32
    v_fma_f32 v82, v56, v31, v32
    v_fma_f32 v83, v57, v31, v32
    s_branch F_W1DONE
F_W_PHASE:
    v_and_b32 v33, 31, v0
    s_mul_i32 s65, s54, 12
    v_add_u32 v90, s65, v33
    s_lshl_b32 s66, s54, 1
    s_add_u32 s66, s66, 36
    v_add_u32 v91, s66, v33
    v_cmp_gt_u32 vcc, 12, v33
    s_nop 1
    v_cndmask_b32 v90, v91, v90, vcc
    s_add_u32 s66, s66, 13
    s_min_u32 s66, s66, 53
    v_min_u32 v90, s66, v90
    s_mul_i32 s65, s56, 6912
    s_add_u32 s65, s65, 434176
    v_lshl_add_u32 v90, v90, 7, s65
    v_min_u32 v91, 19, v0
    s_mul_i32 s65, s58, 2560
    s_add_u32 s65, s65, 393216
    v_lshl_add_u32 v91, v91, 7, s65
    s_lshr_b32 s65, s89, 2
    v_xor_b32 v35, s65, v0
    v_lshlrev_b32 v35, 4, v35
    s_mul_i32 s92, s58, 143360
    s_add_u32 s92, s92, 31457280
    v_mul_u32_u24 v30, 205, v0
    v_lshrrev_b32 v30, 11, v30
    v_mul_u32_u24 v83, 1120, v30
    v_lshl_add_u32 v83, v0, 4, v83
    s_lshl_b32 s64, s55, 2
    s_and_b32 s65, s54, 1
    s_add_u32 s64, s64, s65
    s_mul_i32 s64, s64, 20480
    s_mul_i32 s65, s56, 160
    s_add_u32 s70, s64, s65
    s_mov_b32 s44, s4
    s_mov_b32 s45, s5
    s_mul_i32 s71, s54, 5120
    s_add_u32 m0, s71, 143360
    s_add_u32 s66, s70, 0
    s_mov_b32 exec_hi, 262143
    buffer_load_dwordx4 v83, s[44:47], s66 offen nt lds
    s_mov_b64 exec, -1
    s_add_u32 m0, s71, 144160
    s_add_u32 s66, s70, 6400
    s_mov_b32 exec_hi, 262143
    buffer_load_dwordx4 v83, s[44:47], s66 offen nt lds
    s_mov_b64 exec, -1
    s_add_u32 m0, s71, 144960
    s_add_u32 s66, s70, 12800
    s_mov_b32 exec_hi, 262143
    buffer_load_dwordx4 v83, s[44:47], s66 offen nt lds
    s_mov_b64 exec, -1
    s_add_u32 m0, s71, 145760
    s_add_u32 s66, s70, 19200
    s_mov_b32 exec_hi, 0
    s_mov_b32 exec_lo, 1023
    buffer_load_dwordx4 v83, s[44:47], s66 offen nt lds
    s_mov_b64 exec, -1
    s_add_u32 m0, s71, 145920
    s_add_u32 s66, s70, 40960
    s_mov_b32 exec_hi, 262143
    buffer_load_dwordx4 v83, s[44:47], s66 offen nt lds
    s_mov_b64 exec, -1
    s_add_u32 m0, s71, 146720
    s_add_u32 s66, s70, 47360
    s_mov_b32 exec_hi, 262143
    buffer_load_dwordx4 v83, s[44:47], s66 offen nt lds
    s_mov_b64 exec, -1
    s_add_u32 m0, s71, 147520
    s_add_u32 s66, s70, 53760
    s_mov_b32 exec_hi, 262143
    buffer_load_dwordx4 v83, s[44:47], s66 offen nt lds
    s_mov_b64 exec, -1
    s_add_u32 m0, s71, 148320
    s_add_u32 s66, s70, 60160
    s_mov_b32 exec_hi, 0
    s_mov_b32 exec_lo, 1023
    buffer_load_dwordx4 v83, s[44:47], s66 offen nt lds
    s_mov_b64 exec, -1
    v_and_b32 v30, 1, v0
    v_lshlrev_b32 v31, 7, v30
    v_add_u32 v31, s83, v31
    v_lshlrev_b32 v30, 12, v30
    v_add_u32 v30, s85, v30
    v_cmp_gt_u32 vcc, 2, v0
    s_nop 1
    v_cndmask_b32 v30, v30, v31, vcc
    v_and_b32 v31, 7, v0
    v_lshlrev_b32 v31, 7, v31
    v_bfe_u32 v32, v0, 3, 1
    v_mul_u32_u24 v32, 40960, v32
    v_add3_u32 v31, v31, v32, s78
    v_cmp_gt_u32 vcc, 32, v0
    s_nop 1
    v_cndmask_b32 v30, v31, v30, vcc
    s_sub_u32 s64, s77, s78
    v_add_u32 v31, s64, v31
    v_cmp_gt_u32 vcc, 48, v0
    s_nop 1
    v_cndmask_b32 v30, v31, v30, vcc
    v_and_b32 v31, 1, v0
    v_lshlrev_b32 v31, 7, v31
    v_bfe_u32 v32, v0, 1, 1
    v_lshl_add_u32 v31, v32, 13, v31
    s_add_u32 s64, s86, 524288
    v_add_u32 v31, s64, v31
    v_bfe_u32 v32, v0, 2, 4
    v_cmp_eq_u32 vcc, 1, v32
    s_nop 1
    v_cndmask_b32 v30, v30, v31, vcc
    v_subrev_u32 v31, 524288, v31
    v_cmp_eq_u32 vcc, 2, v32
    s_nop 1
    v_cndmask_b32 v30, v30, v31, vcc
    buffer_load_dword v27, v30, s[32:35], 0 offen sc1
    s_cmp_lg_u32 s54, 0
    s_cbranch_scc1 F_NOWP
    s_mov_b32 s63, 0
    s_branch POLLB_23
POLL_22:
    s_sleep 6
    s_add_u32 s63, s63, 1
    s_cmp_gt_u32 s63, 400000
    s_cbranch_scc1 POLLX_24
POLLB_23:
    buffer_load_dword v34, v91, s[32:35], 0 offen sc1
    s_waitcnt vmcnt(0)
    v_cmp_ne_u32 vcc, s59, v34
    s_cbranch_vccnz POLL_22
POLLX_24:
F_NOWP:
    s_barrier
    s_mul_i32 s64, s54, 5120
    s_lshr_b32 s65, s89, 1
    s_add_u32 s64, s64, s65
    s_add_u32 s64, s64, 143360
    v_mul_u32_u24 v30, 160, v2
    v_lshl_add_u32 v30, v3, 3, v30
    v_add_u32 v30, s64, v30
    s_waitcnt vmcnt(1)
    ds_read_b32 v6, v30 offset:0
    ds_read_b32 v7, v30 offset:32
    ds_read_b32 v8, v30 offset:64
    ds_read_b32 v9, v30 offset:96
    ds_read_b32 v10, v30 offset:128
    ds_read_b32 v12, v30 offset:2560
    ds_read_b32 v13, v30 offset:2592
    ds_read_b32 v14, v30 offset:2624
    ds_read_b32 v15, v30 offset:2656
    ds_read_b32 v16, v30 offset:2688
    s_waitcnt lgkmcnt(9)
    v_lshlrev_b32 v38, 16, v6
    v_and_b32 v39, 0xffff0000, v6
    s_waitcnt lgkmcnt(8)
    v_lshlrev_b32 v40, 16, v7
    v_and_b32 v41, 0xffff0000, v7
    s_waitcnt lgkmcnt(7)
    v_lshlrev_b32 v42, 16, v8
    v_and_b32 v43, 0xffff0000, v8
    s_waitcnt lgkmcnt(6)
    v_lshlrev_b32 v44, 16, v9
    v_and_b32 v45, 0xffff0000, v9
    s_waitcnt lgkmcnt(5)
    v_lshlrev_b32 v46, 16, v10
    v_and_b32 v47, 0xffff0000, v10
    s_add_u32 s64, s86, 0
    v_add_f32 v58, v38, v39
    v_mul_f32 v59, v38, v38
    v_mul_f32 v61, v39, v39
    v_add_f32 v60, v40, v41
    v_fmac_f32 v59, v40, v40
    v_fmac_f32 v61, v41, v41
    v_fmac_f32 v59, v42, v42
    v_fmac_f32 v61, v43, v43
    v_add_f32 v58, v58, v42
    v_add_f32 v60, v60, v43
    v_fmac_f32 v59, v44, v44
    v_fmac_f32 v61, v45, v45
    v_add_f32 v58, v58, v44
    v_add_f32 v60, v60, v45
    v_fmac_f32 v59, v46, v46
    v_fmac_f32 v61, v47, v47
    v_add_f32 v58, v58, v46
    v_add_f32 v60, v60, v47
    v_add_f32 v58, v58, v60
    v_add_f32 v59, v59, v61
    v_lshlrev_b32 v61, 4, v2
    v_mov_b32 v60, s59
    v_permlane16_swap_b32 v58, v59
    v_add_f32 v58, v58, v59
    v_mov_b32 v59, v58
    s_nop 1
    v_permlane32_swap_b32 v58, v59
    v_add_f32 v58, v58, v59
    v_mov_b32 v59, v58
    s_nop 1
    v_permlane16_swap_b32 v58, v59
    buffer_store_dwordx3 v[58:60], v61, s[32:35], s64 offen offset:0
    s_waitcnt lgkmcnt(4)
    v_lshlrev_b32 v48, 16, v12
    v_and_b32 v49, 0xffff0000, v12
    s_waitcnt lgkmcnt(3)
    v_lshlrev_b32 v50, 16, v13
    v_and_b32 v51, 0xffff0000, v13
    s_waitcnt lgkmcnt(2)
    v_lshlrev_b32 v52, 16, v14
    v_and_b32 v53, 0xffff0000, v14
    s_waitcnt lgkmcnt(1)
    v_lshlrev_b32 v54, 16, v15
    v_and_b32 v55, 0xffff0000, v15
    s_waitcnt lgkmcnt(0)
    v_lshlrev_b32 v56, 16, v16
    v_and_b32 v57, 0xffff0000, v16
    s_add_u32 s64, s86, 8192
    v_add_f32 v58, v48, v49
    v_mul_f32 v59, v48, v48
    v_mul_f32 v61, v49, v49
    v_add_f32 v60, v50, v51
    v_fmac_f32 v59, v50, v50
    v_fmac_f32 v61, v51, v51
    v_fmac_f32 v59, v52, v52
    v_fmac_f32 v61, v53, v53
    v_add_f32 v58, v58, v52
    v_add_f32 v60, v60, v53
    v_fmac_f32 v59, v54, v54
    v_fmac_f32 v61, v55, v55
    v_add_f32 v58, v58, v54
    v_add_f32 v60, v60, v55
    v_fmac_f32 v59, v56, v56
    v_fmac_f32 v61, v57, v57
    v_add_f32 v58, v58, v56
    v_add_f32 v60, v60, v57
    v_add_f32 v58, v58, v60
    v_add_f32 v59, v59, v61
    v_lshlrev_b32 v61, 4, v2
    v_mov_b32 v60, s59
    v_permlane16_swap_b32 v58, v59
    v_add_f32 v58, v58, v59
    v_mov_b32 v59, v58
    s_nop 1
    v_permlane32_swap_b32 v58, v59
    v_add_f32 v58, v58, v59
    v_mov_b32 v59, v58
    s_nop 1
    v_permlane16_swap_b32 v58, v59
    buffer_store_dwordx3 v[58:60], v61, s[32:35], s64 offen offset:0
    s_mul_i32 s69, s54, 19456
    s_add_u32 m0, s69, 0
    s_add_u32 s66, s92, m0
    buffer_load_dwordx4 v1, s[32:35], s66 offen sc1 lds
    s_add_u32 m0, s69, 1024
    s_add_u32 s66, s92, m0
    buffer_load_dwordx4 v1, s[32:35], s66 offen sc1 lds
    s_add_u32 m0, s69, 2048
    s_add_u32 s66, s92, m0
    buffer_load_dwordx4 v1, s[32:35], s66 offen sc1 lds
    s_add_u32 m0, s69, 3072
    s_add_u32 s66, s92, m0
    buffer_load_dwordx4 v1, s[32:35], s66 offen sc1 lds
    s_add_u32 m0, s69, 4096
    s_add_u32 s66, s92, m0
    buffer_load_dwordx4 v1, s[32:35], s66 offen sc1 lds
    s_add_u32 m0, s69, 5120
    s_add_u32 s66, s92, m0
    buffer_load_dwordx4 v1, s[32:35], s66 offen sc1 lds
    s_add_u32 m0, s69, 6144
    s_add_u32 s66, s92, m0
    buffer_load_dwordx4 v1, s[32:35], s66 offen sc1 lds
    s_add_u32 m0, s69, 7168
    s_add_u32 s66, s92, m0
    buffer_load_dwordx4 v1, s[32:35], s66 offen sc1 lds
    s_add_u32 m0, s69, 8192
    s_add_u32 s66, s92, m0
    buffer_load_dwordx4 v1, s[32:35], s66 offen sc1 lds
    s_add_u32 m0, s69, 9216
    s_add_u32 s66, s92, m0
    buffer_load_dwordx4 v1, s[32:35], s66 offen sc1 lds
    s_add_u32 m0, s69, 10240
    s_add_u32 s66, s92, m0
    buffer_load_dwordx4 v1, s[32:35], s66 offen sc1 lds
    s_add_u32 m0, s69, 11264
    s_add_u32 s66, s92, m0
    buffer_load_dwordx4 v1, s[32:35], s66 offen sc1 lds
    s_sub_u32 s64, s53, 20
    s_lshl_b32 s64, s64, 2
    s_add_u32 s64, s64, s54
    s_mul_i32 s64, s64, 16384
    s_add_u32 s64, s64, 31457280
    s_cmp_lt_u32 s64, 32030720
    s_cselect_b32 s64, s64, 0x70000000
    s_add_u32 s65, s64, 8192
    v_lshlrev_b32 v30, 7, v0
    v_min_u32 v31, 79, v0
    v_lshlrev_b32 v31, 7, v31
    s_mov_b32 s66, 393216
    s_waitcnt vmcnt(8)
    buffer_load_dword v27, v30, s[32:35], s64 offen sc1
    buffer_load_dword v27, v30, s[32:35], s65 offen sc1
    s_cmp_lg_u32 s53, 31
    s_cbranch_scc1 F_NOCB
    s_cmp_gt_u32 s54, 1
    s_cbranch_scc1 F_NOCB
    s_lshl_b32 s69, s52, 1
    s_add_u32 s69, s69, s54
    v_min_u32 v30, 19, v0
    s_mul_i32 s65, s69, 2560
    v_lshl_add_u32 v30, v30, 7, s65
    s_mov_b32 s64, 393216
    s_mul_i32 s66, s69, 7
    s_mul_i32 s67, s69, 6
    s_add_u32 s67, s67, 12
    s_cmp_ge_u32 s69, 12
    s_cselect_b32 s66, s67, s66
    s_lshl_b32 s66, s66, 5
    v_min_u32 v32, 27, v0
    v_lshl_add_u32 v33, v32, 3, s66
    v_min_u32 v33, 3448, v33
    global_load_dwordx2 v[92:93], v33, s[20:21]
    v_lshlrev_b32 v32, 4, v32
    s_mov_b32 s63, 0
    s_branch POLLB_26
POLL_25:
    s_sleep 6
    s_add_u32 s63, s63, 1
    s_cmp_gt_u32 s63, 400000
    s_cbranch_scc1 POLLX_27
POLLB_26:
    buffer_load_dword v31, v30, s[32:35], s64 offen sc1
    s_waitcnt vmcnt(0)
    v_cmp_ne_u32 vcc, s59, v31
    s_cbranch_vccnz POLL_25
POLLX_27:
    s_mul_i32 s64, s69, 8960
    s_add_u32 s64, s64, 73728
    buffer_load_dwordx4 v[100:103], v32, s[32:35], s64 offen offset:0 sc1
    buffer_load_dwordx4 v[104:107], v32, s[32:35], s64 offen offset:448 sc1
    buffer_load_dwordx4 v[108:111], v32, s[32:35], s64 offen offset:896 sc1
    buffer_load_dwordx4 v[112:115], v32, s[32:35], s64 offen offset:1344 sc1
    buffer_load_dwordx4 v[116:119], v32, s[32:35], s64 offen offset:1792 sc1
    buffer_load_dwordx4 v[120:123], v32, s[32:35], s64 offen offset:2240 sc1
    buffer_load_dwordx4 v[124:127], v32, s[32:35], s64 offen offset:2688 sc1
    buffer_load_dwordx4 v[128:131], v32, s[32:35], s64 offen offset:3136 sc1
    buffer_load_dwordx4 v[132:135], v32, s[32:35], s64 offen offset:3584 sc1
    s_add_u32 s64, s64, 4032
    buffer_load_dwordx4 v[136:139], v32, s[32:35], s64 offen offset:0 sc1
    buffer_load_dwordx4 v[140:143], v32, s[32:35], s64 offen offset:448 sc1
    buffer_load_dwordx4 v[144:147], v32, s[32:35], s64 offen offset:896 sc1
    buffer_load_dwordx4 v[148:151], v32, s[32:35], s64 offen offset:1344 sc1
    buffer_load_dwordx4 v[152:155], v32, s[32:35], s64 offen offset:1792 sc1
    buffer_load_dwordx4 v[156:159], v32, s[32:35], s64 offen offset:2240 sc1
    buffer_load_dwordx4 v[160:163], v32, s[32:35], s64 offen offset:2688 sc1
    buffer_load_dwordx4 v[164:167], v32, s[32:35], s64 offen offset:3136 sc1
    buffer_load_dwordx4 v[168:171], v32, s[32:35], s64 offen offset:3584 sc1
    s_add_u32 s64, s64, 4032
    buffer_load_dwordx4 v[172:175], v32, s[32:35], s64 offen offset:0 sc1
    buffer_load_dwordx4 v[176:179], v32, s[32:35], s64 offen offset:448 sc1
    s_waitcnt vmcnt(18)
    v_pk_add_f32 v[100:101], v[100:101], v[104:105]
    v_pk_add_f32 v[102:103], v[102:103], v[106:107]
    s_waitcnt vmcnt(17)
    v_pk_add_f32 v[100:101], v[100:101], v[108:109]
    v_pk_add_f32 v[102:103], v[102:103], v[110:111]
    s_waitcnt vmcnt(16)
    v_pk_add_f32 v[100:101], v[100:101], v[112:113]
    v_pk_add_f32 v[102:103], v[102:103], v[114:115]
    s_waitcnt vmcnt(15)
    v_pk_add_f32 v[100:101], v[100:101], v[116:117]
    v_pk_add_f32 v[102:103], v[102:103], v[118:119]
    s_waitcnt vmcnt(14)
    v_pk_add_f32 v[100:101], v[100:101], v[120:121]
    v_pk_add_f32 v[102:103], v[102:103], v[122:123]
    s_waitcnt vmcnt(13)
    v_pk_add_f32 v[100:101], v[100:101], v[124:125]
    v_pk_add_f32 v[102:103], v[102:103], v[126:127]
    s_waitcnt vmcnt(12)
    v_pk_add_f32 v[100:101], v[100:101], v[128:129]
    v_pk_add_f32 v[102:103], v[102:103], v[130:131]
    s_waitcnt vmcnt(11)
    v_pk_add_f32 v[100:101], v[100:101], v[132:133]
    v_pk_add_f32 v[102:103], v[102:103], v[134:135]
    s_waitcnt vmcnt(10)
    v_pk_add_f32 v[100:101], v[100:101], v[136:137]
    v_pk_add_f32 v[102:103], v[102:103], v[138:139]
    s_waitcnt vmcnt(9)
    v_pk_add_f32 v[100:101], v[100:101], v[140:141]
    v_pk_add_f32 v[102:103], v[102:103], v[142:143]
    s_waitcnt vmcnt(8)
    v_pk_add_f32 v[100:101], v[100:101], v[144:145]
    v_pk_add_f32 v[102:103], v[102:103], v[146:147]
    s_waitcnt vmcnt(7)
    v_pk_add_f32 v[100:101], v[100:101], v[148:149]
    v_pk_add_f32 v[102:103], v[102:103], v[150:151]
    s_waitcnt vmcnt(6)
    v_pk_add_f32 v[100:101], v[100:101], v[152:153]
    v_pk_add_f32 v[102:103], v[102:103], v[154:155]
    s_waitcnt vmcnt(5)
    v_pk_add_f32 v[100:101], v[100:101], v[156:157]
    v_pk_add_f32 v[102:103], v[102:103], v[158:159]
    s_waitcnt vmcnt(4)
    v_pk_add_f32 v[100:101], v[100:101], v[160:161]
    v_pk_add_f32 v[102:103], v[102:103], v[162:163]
    s_waitcnt vmcnt(3)
    v_pk_add_f32 v[100:101], v[100:101], v[164:165]
    v_pk_add_f32 v[102:103], v[102:103], v[166:167]
    s_waitcnt vmcnt(2)
    v_pk_add_f32 v[100:101], v[100:101], v[168:169]
    v_pk_add_f32 v[102:103], v[102:103], v[170:171]
    s_waitcnt vmcnt(1)
    v_pk_add_f32 v[100:101], v[100:101], v[172:173]
    v_pk_add_f32 v[102:103], v[102:103], v[174:175]
    s_waitcnt vmcnt(0)
    v_pk_add_f32 v[100:101], v[100:101], v[176:177]
    v_pk_add_f32 v[102:103], v[102:103], v[178:179]
    v_cvt_pk_bf16_f32 v104, v100, v100
    v_and_b32 v112, 0xffff0000, v104
    v_sub_f32 v100, v100, v112
    v_cvt_pk_bf16_f32 v113, v100, v100
    v_and_b32 v112, 0xffff0000, v113
    v_sub_f32 v100, v100, v112
    v_cvt_pk_bf16_f32 v113, v100, v100
    v_and_b32 v104, 0xffff, v104
    v_or_b32 v104, v104, v112
    v_and_b32 v113, 0xffff, v113
    v_lshlrev_b32 v112, 16, v92
    v_or_b32 v105, v113, v112
    v_cvt_pk_bf16_f32 v106, v101, v101
    v_and_b32 v112, 0xffff0000, v106
    v_sub_f32 v101, v101, v112
    v_cvt_pk_bf16_f32 v113, v101, v101
    v_and_b32 v112, 0xffff0000, v113
    v_sub_f32 v101, v101, v112
    v_cvt_pk_bf16_f32 v113, v101, v101
    v_and_b32 v106, 0xffff, v106
    v_or_b32 v106, v106, v112
    v_and_b32 v113, 0xffff, v113
    v_and_b32 v112, 0xffff0000, v92
    v_or_b32 v107, v113, v112
    v_cvt_pk_bf16_f32 v108, v102, v102
    v_and_b32 v112, 0xffff0000, v108
    v_sub_f32 v102, v102, v112
    v_cvt_pk_bf16_f32 v113, v102, v102
    v_and_b32 v112, 0xffff0000, v113
    v_sub_f32 v102, v102, v112
    v_cvt_pk_bf16_f32 v113, v102, v102
    v_and_b32 v108, 0xffff, v108
    v_or_b32 v108, v108, v112
    v_and_b32 v113, 0xffff, v113
    v_lshlrev_b32 v112, 16, v93
    v_or_b32 v109, v113, v112
    v_cvt_pk_bf16_f32 v110, v103, v103
    v_and_b32 v112, 0xffff0000, v110
    v_sub_f32 v103, v103, v112
    v_cvt_pk_bf16_f32 v113, v103, v103
    v_and_b32 v112, 0xffff0000, v113
    v_sub_f32 v103, v103, v112
    v_cvt_pk_bf16_f32 v113, v103, v103
    v_and_b32 v110, 0xffff, v110
    v_or_b32 v110, v110, v112
    v_and_b32 v113, 0xffff, v113
    v_and_b32 v112, 0xffff0000, v93
    v_or_b32 v111, v113, v112
    s_mul_i32 s64, s69, 896
    s_add_u32 s64, s64, 49152
    v_lshlrev_b32 v32, 1, v32
    buffer_store_dwordx4 v[104:107], v32, s[32:35], s64 offen sc1
    buffer_store_dwordx4 v[108:111], v32, s[32:35], s64 offen offset:16 sc1
    s_lshl_b32 s64, s69, 7
    s_add_u32 s64, s64, 8192
    v_mov_b32 v30, s59
    v_mov_b32 v31, 0
    s_waitcnt vmcnt(0)
    buffer_store_dword v30, v31, s[32:35], s64 offen sc1
F_NOCB:
    s_mov_b32 s67, s87
    s_add_u32 s68, s87, 8192
    buffer_load_dwordx3 v[58:60], v1, s[32:35], s67 offen offset:0 sc1
    buffer_load_dwordx3 v[62:64], v1, s[32:35], s67 offen offset:1024 sc1
    buffer_load_dwordx3 v[66:68], v1, s[32:35], s67 offen offset:2048 sc1
    buffer_load_dwordx3 v[70:72], v1, s[32:35], s67 offen offset:3072 sc1
    buffer_load_dwordx3 v[74:76], v1, s[32:35], s68 offen offset:0 sc1
    buffer_load_dwordx3 v[78:80], v1, s[32:35], s68 offen offset:1024 sc1
    buffer_load_dwordx3 v[82:84], v1, s[32:35], s68 offen offset:2048 sc1
    buffer_load_dwordx3 v[86:88], v1, s[32:35], s68 offen offset:3072 sc1
    s_waitcnt vmcnt(6)
    v_xor_b32 v60, v60, v64
    s_waitcnt vmcnt(4)
    v_xor_b32 v68, v68, v72
    v_xor_b32 v64, v64, v72
    v_xor_b32 v72, s59, v72
    v_or3_b32 v60, v60, v64, v68
    v_or_b32 v60, v60, v72
    v_cmp_ne_u32 vcc, 0, v60
    s_cbranch_vccnz SPIN_28
BACK_29:
    v_add_f32 v58, v58, v62
    v_add_f32 v59, v59, v63
    v_add_f32 v66, v66, v70
    v_add_f32 v67, v67, v71
    v_add_f32 v58, v58, v66
    v_add_f32 v59, v59, v67
    s_nop 1
    v_permlane16_swap_b32 v58, v59
    v_add_f32 v58, v58, v59
    v_mov_b32 v59, v58
    s_nop 1
    v_permlane32_swap_b32 v58, v59
    v_add_f32 v58, v58, v59
    v_mul_f32 v30, 0x3acccccd, v58
    v_mul_f32 v31, 0x3acccccd, v58
    s_nop 1
    v_permlane16_swap_b32 v30, v31
    v_fma_f32 v31, -v30, v30, v31
    v_max_f32 v31, 0, v31
    v_cvt_pk_bf16_f32 v31, v31, v30
    v_and_b32 v30, 0xffff0000, v31
    v_lshlrev_b32 v31, 16, v31
    v_add_f32 v31, 0x3727c5ac, v31
    v_cvt_pk_bf16_f32 v31, v31, v31
    v_lshlrev_b32 v31, 16, v31
    v_sqrt_f32 v31, v31
    s_nop 0
    v_cvt_pk_bf16_f32 v31, v31, v31
    v_lshlrev_b32 v31, 16, v31
    v_rcp_f32 v31, v31
    s_nop 0
    v_mul_f32 v32, -v30, v31
    v_fma_f32 v58, v38, v31, v32
    v_fma_f32 v59, v39, v31, v32
    v_fma_f32 v60, v40, v31, v32
    v_fma_f32 v61, v41, v31, v32
    v_fma_f32 v62, v42, v31, v32
    v_fma_f32 v63, v43, v31, v32
    v_fma_f32 v64, v44, v31, v32
    v_fma_f32 v65, v45, v31, v32
    v_fma_f32 v66, v46, v31, v32
    v_fma_f32 v67, v47, v31, v32
    s_waitcnt vmcnt(2)
    v_xor_b32 v76, v76, v80
    s_waitcnt vmcnt(0)
    v_xor_b32 v84, v84, v88
    v_xor_b32 v80, v80, v88
    v_xor_b32 v88, s59, v88
    v_or3_b32 v76, v76, v80, v84
    v_or_b32 v76, v76, v88
    v_cmp_ne_u32 vcc, 0, v76
    s_cbranch_vccnz SPIN_30
BACK_31:
    v_add_f32 v74, v74, v78
    v_add_f32 v75, v75, v79
    v_add_f32 v82, v82, v86
    v_add_f32 v83, v83, v87
    v_add_f32 v74, v74, v82
    v_add_f32 v75, v75, v83
    s_nop 1
    v_permlane16_swap_b32 v74, v75
    v_add_f32 v74, v74, v75
    v_mov_b32 v75, v74
    s_nop 1
    v_permlane32_swap_b32 v74, v75
    v_add_f32 v74, v74, v75
    v_mul_f32 v30, 0x3acccccd, v74
    v_mul_f32 v31, 0x3acccccd, v74
    s_nop 1
    v_permlane16_swap_b32 v30, v31
    v_fma_f32 v31, -v30, v30, v31
    v_max_f32 v31, 0, v31
    v_cvt_pk_bf16_f32 v31, v31, v30
    v_and_b32 v30, 0xffff0000, v31
    v_lshlrev_b32 v31, 16, v31
    v_add_f32 v31, 0x3727c5ac, v31
    v_cvt_pk_bf16_f32 v31, v31, v31
    v_lshlrev_b32 v31, 16, v31
    v_sqrt_f32 v31, v31
    s_nop 0
    v_cvt_pk_bf16_f32 v31, v31, v31
    v_lshlrev_b32 v31, 16, v31
    v_rcp_f32 v31, v31
    s_nop 0
    v_mul_f32 v32, -v30, v31
    v_fma_f32 v74, v48, v31, v32
    v_fma_f32 v75, v49, v31, v32
    v_fma_f32 v76, v50, v31, v32
    v_fma_f32 v77, v51, v31, v32
    v_fma_f32 v78, v52, v31, v32
    v_fma_f32 v79, v53, v31, v32
    v_fma_f32 v80, v54, v31, v32
    v_fma_f32 v81, v55, v31, v32
    v_fma_f32 v82, v56, v31, v32
    v_fma_f32 v83, v57, v31, v32
    s_lshl_b32 s64, s52, 9
    s_add_u32 s64, s64, 65536
    v_lshlrev_b32 v31, 2, v0
    s_mov_b32 s63, 0
    s_branch POLLB_33
POLL_32:
    s_sleep 4
    s_add_u32 s63, s63, 1
    s_cmp_gt_u32 s63, 400000
    s_cbranch_scc1 POLLX_34
POLLB_33:
    buffer_load_dword v30, v31, s[32:35], s64 offen sc1
    s_waitcnt vmcnt(0)
    v_cmp_ne_u32 vcc, s59, v30
    s_cbranch_vccnz POLL_32
POLLX_34:
F_W1DONE:
    s_xor_b32 s64, s54, 1
    s_and_b32 s64, s64, 1
    s_sub_u32 s96, s81, 55296
    s_add_u32 s65, s81, 55296
    s_cmp_eq_u32 s64, 1
    s_cselect_b32 s96, s65, s96
    s_mul_i32 s94, s54, 10240
    s_sub_u32 s94, 40960, s94
    s_cmp_eq_u32 s54, 3
    s_cselect_b32 s94, -8192, s94
    s_lshl_b32 s64, s55, 2
    s_and_b32 s65, s54, 1
    s_add_u32 s64, s64, s65
    s_lshl_b32 s64, s64, 3
    s_add_u32 s64, s64, s56
    s_mul_i32 s68, s64, 2560
    s_lshr_b32 s65, s89, 1
    s_add_u32 s68, s68, s65
    s_add_u32 s68, s68, 6291456
    s_add_u32 s69, s68, 40960
    v_min_u32 v31, 19, v0
    v_lshlrev_b32 v31, 9, v31
    s_mul_i32 s64, s56, 10240
    s_lshr_b32 s65, s55, 3
    s_lshl_b32 s65, s65, 7
    s_add_u32 s64, s64, s65
    s_add_u32 s64, s64, 262144
    s_mov_b32 s63, 0
    s_branch POLLB_36
POLL_35:
    s_sleep 2
    s_add_u32 s63, s63, 1
    s_cmp_gt_u32 s63, 400000
    s_cbranch_scc1 POLLX_37
POLLB_36:
    buffer_load_dword v30, v31, s[32:35], s64 offen sc1
    s_waitcnt vmcnt(0)
    v_cmp_ne_u32 vcc, s59, v30
    s_cbranch_vccnz POLL_35
POLLX_37:
    buffer_load_dword v17, v4, s[32:35], s68 offen offset:0 sc1
    buffer_load_dword v18, v4, s[32:35], s68 offen offset:512 sc1
    buffer_load_dword v19, v4, s[32:35], s68 offen offset:1024 sc1
    buffer_load_dword v20, v4, s[32:35], s68 offen offset:1536 sc1
    buffer_load_dword v21, v4, s[32:35], s68 offen offset:2048 sc1
    buffer_load_dword v22, v4, s[32:35], s69 offen offset:0 sc1
    buffer_load_dword v23, v4, s[32:35], s69 offen offset:512 sc1
    buffer_load_dword v24, v4, s[32:35], s69 offen offset:1024 sc1
    buffer_load_dword v25, v4, s[32:35], s69 offen offset:1536 sc1
    buffer_load_dword v26, v4, s[32:35], s69 offen offset:2048 sc1
    s_waitcnt vmcnt(9)
    v_lshlrev_b32 v102, 16, v17
    v_and_b32 v103, 0xffff0000, v17
    s_waitcnt vmcnt(8)
    v_lshlrev_b32 v104, 16, v18
    v_and_b32 v105, 0xffff0000, v18
    s_waitcnt vmcnt(7)
    v_lshlrev_b32 v106, 16, v19
    v_and_b32 v107, 0xffff0000, v19
    s_waitcnt vmcnt(6)
    v_lshlrev_b32 v108, 16, v20
    v_and_b32 v109, 0xffff0000, v20
    s_waitcnt vmcnt(5)
    v_lshlrev_b32 v110, 16, v21
    v_and_b32 v111, 0xffff0000, v21
    v_pk_fma_f32 v[38:39], v[58:59], v[102:103], v[38:39]
    v_pk_fma_f32 v[40:41], v[60:61], v[104:105], v[40:41]
    v_pk_fma_f32 v[42:43], v[62:63], v[106:107], v[42:43]
    v_pk_fma_f32 v[44:45], v[64:65], v[108:109], v[44:45]
    v_pk_fma_f32 v[46:47], v[66:67], v[110:111], v[46:47]
    v_cvt_pk_bf16_f32 v6, v38, v39
    v_cvt_pk_bf16_f32 v7, v40, v41
    v_cvt_pk_bf16_f32 v8, v42, v43
    v_cvt_pk_bf16_f32 v9, v44, v45
    v_cvt_pk_bf16_f32 v10, v46, v47
    s_add_u32 s64, s77, 0
    s_add_u32 s65, s78, 0
    buffer_store_dwordx4 v[6:9], v1, s[32:35], s64 offen
    buffer_store_dword v10, v1, s[32:35], s65 offen
    s_waitcnt vmcnt(6)
    v_lshlrev_b32 v142, 16, v22
    v_and_b32 v143, 0xffff0000, v22
    s_waitcnt vmcnt(5)
    v_lshlrev_b32 v144, 16, v23
    v_and_b32 v145, 0xffff0000, v23
    s_waitcnt vmcnt(4)
    v_lshlrev_b32 v146, 16, v24
    v_and_b32 v147, 0xffff0000, v24
    s_waitcnt vmcnt(3)
    v_lshlrev_b32 v148, 16, v25
    v_and_b32 v149, 0xffff0000, v25
    s_waitcnt vmcnt(2)
    v_lshlrev_b32 v150, 16, v26
    v_and_b32 v151, 0xffff0000, v26
    v_pk_fma_f32 v[48:49], v[74:75], v[142:143], v[48:49]
    v_pk_fma_f32 v[50:51], v[76:77], v[144:145], v[50:51]
    v_pk_fma_f32 v[52:53], v[78:79], v[146:147], v[52:53]
    v_pk_fma_f32 v[54:55], v[80:81], v[148:149], v[54:55]
    v_pk_fma_f32 v[56:57], v[82:83], v[150:151], v[56:57]
    v_cvt_pk_bf16_f32 v12, v48, v49
    v_cvt_pk_bf16_f32 v13, v50, v51
    v_cvt_pk_bf16_f32 v14, v52, v53
    v_cvt_pk_bf16_f32 v15, v54, v55
    v_cvt_pk_bf16_f32 v16, v56, v57
    s_add_u32 s64, s77, 40960
    s_add_u32 s65, s78, 40960
    buffer_store_dwordx4 v[12:15], v1, s[32:35], s64 offen
    buffer_store_dword v16, v1, s[32:35], s65 offen
    s_add_u32 s65, s86, 524288
    v_add_f32 v112, v38, v39
    v_mul_f32 v113, v38, v38
    v_mul_f32 v115, v39, v39
    v_add_f32 v114, v40, v41
    v_fmac_f32 v113, v40, v40
    v_fmac_f32 v115, v41, v41
    v_fmac_f32 v113, v42, v42
    v_fmac_f32 v115, v43, v43
    v_add_f32 v112, v112, v42
    v_add_f32 v114, v114, v43
    v_fmac_f32 v113, v44, v44
    v_fmac_f32 v115, v45, v45
    v_add_f32 v112, v112, v44
    v_add_f32 v114, v114, v45
    v_fmac_f32 v113, v46, v46
    v_fmac_f32 v115, v47, v47
    v_add_f32 v112, v112, v46
    v_add_f32 v114, v114, v47
    v_add_f32 v112, v112, v114
    v_add_f32 v113, v113, v115
    v_lshlrev_b32 v115, 4, v2
    v_mov_b32 v114, s59
    v_permlane16_swap_b32 v112, v113
    v_add_f32 v112, v112, v113
    v_mov_b32 v113, v112
    s_nop 1
    v_permlane32_swap_b32 v112, v113
    v_add_f32 v112, v112, v113
    v_mov_b32 v113, v112
    s_nop 1
    v_permlane16_swap_b32 v112, v113
    buffer_store_dwordx3 v[112:114], v115, s[32:35], s65 offen offset:0
    v_mov_b32 v32, s59
    v_mov_b32 v33, 0
    s_waitcnt vmcnt(3)
    buffer_store_dword v32, v33, s[32:35], s83 offen offset:0
    v_mov_b32 v32, s59
    v_mov_b32 v33, 0
    s_waitcnt vmcnt(2)
    buffer_store_dword v32, v33, s[32:35], s83 offen offset:128
    s_add_u32 s65, s86, 532480
    v_add_f32 v152, v48, v49
    v_mul_f32 v153, v48, v48
    v_mul_f32 v155, v49, v49
    v_add_f32 v154, v50, v51
    v_fmac_f32 v153, v50, v50
    v_fmac_f32 v155, v51, v51
    v_fmac_f32 v153, v52, v52
    v_fmac_f32 v155, v53, v53
    v_add_f32 v152, v152, v52
    v_add_f32 v154, v154, v53
    v_fmac_f32 v153, v54, v54
    v_fmac_f32 v155, v55, v55
    v_add_f32 v152, v152, v54
    v_add_f32 v154, v154, v55
    v_fmac_f32 v153, v56, v56
    v_fmac_f32 v155, v57, v57
    v_add_f32 v152, v152, v56
    v_add_f32 v154, v154, v57
    v_add_f32 v152, v152, v154
    v_add_f32 v153, v153, v155
    v_lshlrev_b32 v155, 4, v2
    v_mov_b32 v154, s59
    v_permlane16_swap_b32 v152, v153
    v_add_f32 v152, v152, v153
    v_mov_b32 v153, v152
    s_nop 1
    v_permlane32_swap_b32 v152, v153
    v_add_f32 v152, v152, v153
    v_mov_b32 v153, v152
    s_nop 1
    v_permlane16_swap_b32 v152, v153
    buffer_store_dwordx3 v[152:154], v155, s[32:35], s65 offen offset:0
    s_cmp_ge_u32 s53, 20
    s_cbranch_scc1 F_RESTI
    v_mov_b32 v30, s59
    v_mov_b32 v31, 0
    buffer_store_dword v30, v31, s[32:35], s99 offen sc1
    s_mul_i32 s69, s54, 19456
    s_add_u32 m0, s69, 12288
    s_add_u32 s66, s92, m0
    buffer_load_dwordx4 v1, s[32:35], s66 offen sc1 lds
    s_add_u32 m0, s69, 13312
    s_add_u32 s66, s92, m0
    buffer_load_dwordx4 v1, s[32:35], s66 offen sc1 lds
    s_add_u32 m0, s69, 14336
    s_add_u32 s66, s92, m0
    buffer_load_dwordx4 v1, s[32:35], s66 offen sc1 lds
    s_add_u32 m0, s69, 15360
    s_add_u32 s66, s92, m0
    buffer_load_dwordx4 v1, s[32:35], s66 offen sc1 lds
    s_add_u32 m0, s69, 16384
    s_add_u32 s66, s92, m0
    buffer_load_dwordx4 v1, s[32:35], s66 offen sc1 lds
    s_add_u32 m0, s69, 17408
    s_add_u32 s66, s92, m0
    buffer_load_dwordx4 v1, s[32:35], s66 offen sc1 lds
    s_add_u32 m0, s69, 18432
    s_add_u32 s66, s92, m0
    buffer_load_dwordx4 v1, s[32:35], s66 offen sc1 lds
    s_barrier
    s_mul_i32 s69, s54, 16384
    s_add_u32 s69, s69, 77824
    s_add_u32 m0, s69, 0
    s_add_u32 s66, s92, m0
    buffer_load_dwordx4 v1, s[32:35], s66 offen sc1 lds
    s_add_u32 m0, s69, 1024
    s_add_u32 s66, s92, m0
    buffer_load_dwordx4 v1, s[32:35], s66 offen sc1 lds
    s_add_u32 m0, s69, 2048
    s_add_u32 s66, s92, m0
    buffer_load_dwordx4 v1, s[32:35], s66 offen sc1 lds
    s_add_u32 m0, s69, 3072
    s_add_u32 s66, s92, m0
    buffer_load_dwordx4 v1, s[32:35], s66 offen sc1 lds
    s_add_u32 m0, s69, 4096
    s_add_u32 s66, s92, m0
    buffer_load_dwordx4 v1, s[32:35], s66 offen sc1 lds
    s_add_u32 m0, s69, 5120
    s_add_u32 s66, s92, m0
    buffer_load_dwordx4 v1, s[32:35], s66 offen sc1 lds
    s_add_u32 m0, s69, 6144
    s_add_u32 s66, s92, m0
    buffer_load_dwordx4 v1, s[32:35], s66 offen sc1 lds
    s_add_u32 m0, s69, 7168
    s_add_u32 s66, s92, m0
    buffer_load_dwordx4 v1, s[32:35], s66 offen sc1 lds
    s_add_u32 m0, s69, 8192
    s_add_u32 s66, s92, m0
    buffer_load_dwordx4 v1, s[32:35], s66 offen sc1 lds
    s_add_u32 m0, s69, 9216
    s_add_u32 s66, s92, m0
    buffer_load_dwordx4 v1, s[32:35], s66 offen sc1 lds
    s_add_u32 m0, s69, 10240
    s_add_u32 s66, s92, m0
    buffer_load_dwordx4 v1, s[32:35], s66 offen sc1 lds
    s_add_u32 m0, s69, 11264
    s_add_u32 s66, s92, m0
    buffer_load_dwordx4 v1, s[32:35], s66 offen sc1 lds
    s_add_u32 m0, s69, 12288
    s_add_u32 s66, s92, m0
    buffer_load_dwordx4 v1, s[32:35], s66 offen sc1 lds
    s_add_u32 m0, s69, 13312
    s_add_u32 s66, s92, m0
    buffer_load_dwordx4 v1, s[32:35], s66 offen sc1 lds
    s_add_u32 m0, s69, 14336
    s_add_u32 s66, s92, m0
    buffer_load_dwordx4 v1, s[32:35], s66 offen sc1 lds
    s_add_u32 m0, s69, 15360
    s_add_u32 s66, s92, m0
    buffer_load_dwordx4 v1, s[32:35], s66 offen sc1 lds
    s_branch F_HAVEB
F_RESTI:
    s_mul_i32 s69, s54, 19456
    s_add_u32 m0, s69, 12288
    s_add_u32 s66, s92, m0
    buffer_load_dwordx4 v1, s[32:35], s66 offen sc1 lds
    s_add_u32 m0, s69, 13312
    s_add_u32 s66, s92, m0
    buffer_load_dwordx4 v1, s[32:35], s66 offen sc1 lds
    s_add_u32 m0, s69, 14336
    s_add_u32 s66, s92, m0
    buffer_load_dwordx4 v1, s[32:35], s66 offen sc1 lds
    s_add_u32 m0, s69, 15360
    s_add_u32 s66, s92, m0
    buffer_load_dwordx4 v1, s[32:35], s66 offen sc1 lds
    s_add_u32 m0, s69, 16384
    s_add_u32 s66, s92, m0
    buffer_load_dwordx4 v1, s[32:35], s66 offen sc1 lds
    s_add_u32 m0, s69, 17408
    s_add_u32 s66, s92, m0
    buffer_load_dwordx4 v1, s[32:35], s66 offen sc1 lds
    s_add_u32 m0, s69, 18432
    s_add_u32 s66, s92, m0
    buffer_load_dwordx4 v1, s[32:35], s66 offen sc1 lds
    s_mul_i32 s69, s54, 16384
    s_add_u32 s69, s69, 77824
    s_add_u32 m0, s69, 0
    s_add_u32 s66, s92, m0
    buffer_load_dwordx4 v1, s[32:35], s66 offen sc1 lds
    s_add_u32 m0, s69, 1024
    s_add_u32 s66, s92, m0
    buffer_load_dwordx4 v1, s[32:35], s66 offen sc1 lds
    s_add_u32 m0, s69, 2048
    s_add_u32 s66, s92, m0
    buffer_load_dwordx4 v1, s[32:35], s66 offen sc1 lds
    s_add_u32 m0, s69, 3072
    s_add_u32 s66, s92, m0
    buffer_load_dwordx4 v1, s[32:35], s66 offen sc1 lds
    s_add_u32 m0, s69, 4096
    s_add_u32 s66, s92, m0
    buffer_load_dwordx4 v1, s[32:35], s66 offen sc1 lds
    s_add_u32 m0, s69, 5120
    s_add_u32 s66, s92, m0
    buffer_load_dwordx4 v1, s[32:35], s66 offen sc1 lds
    s_add_u32 m0, s69, 6144
    s_add_u32 s66, s92, m0
    buffer_load_dwordx4 v1, s[32:35], s66 offen sc1 lds
    s_add_u32 m0, s69, 7168
    s_add_u32 s66, s92, m0
    buffer_load_dwordx4 v1, s[32:35], s66 offen sc1 lds
    s_add_u32 m0, s69, 8192
    s_add_u32 s66, s92, m0
    buffer_load_dwordx4 v1, s[32:35], s66 offen sc1 lds
    s_add_u32 m0, s69, 9216
    s_add_u32 s66, s92, m0
    buffer_load_dwordx4 v1, s[32:35], s66 offen sc1 lds
    s_add_u32 m0, s69, 10240
    s_add_u32 s66, s92, m0
    buffer_load_dwordx4 v1, s[32:35], s66 offen sc1 lds
    s_add_u32 m0, s69, 11264
    s_add_u32 s66, s92, m0
    buffer_load_dwordx4 v1, s[32:35], s66 offen sc1 lds
    s_add_u32 m0, s69, 12288
    s_add_u32 s66, s92, m0
    buffer_load_dwordx4 v1, s[32:35], s66 offen sc1 lds
    s_add_u32 m0, s69, 13312
    s_add_u32 s66, s92, m0
    buffer_load_dwordx4 v1, s[32:35], s66 offen sc1 lds
    s_add_u32 m0, s69, 14336
    s_add_u32 s66, s92, m0
    buffer_load_dwordx4 v1, s[32:35], s66 offen sc1 lds
    s_add_u32 m0, s69, 15360
    s_add_u32 s66, s92, m0
    buffer_load_dwordx4 v1, s[32:35], s66 offen sc1 lds
F_HAVEB:
    s_waitcnt vmcnt(0)
    s_barrier
    v_mov_b32 v121, v90
    s_mov_b64 s[100:101], 0xffff
    ds_read_b128 v[160:163], v1 offset:0
    ds_read_b128 v[164:167], v1 offset:1024
    ds_read_b128 v[168:171], v1 offset:2048
    ds_read_b128 v[172:175], v1 offset:3072
    ds_read_b128 v[176:179], v1 offset:4096
    ds_read_b128 v[180:183], v1 offset:5120
    v_and_b32 v31, 16, v0
    v_lshlrev_b32 v31, 3, v31
    v_lshl_add_u32 v31, v2, 2, v31
    s_mov_b32 s66, s82
    s_lshl_b32 s67, s58, 7
    s_add_u32 s67, s67, 8192
    v_writelane_b32 v121, s67, 63
    s_mov_b32 s67, 0
    buffer_load_dword v120, v121, s[32:35], s67 offen sc1
    s_mov_b32 s63, 0
    s_branch POLLB_41
POLL_40:
    s_sleep 2
    s_add_u32 s63, s63, 1
    s_cmp_gt_u32 s63, 400000
    s_cbranch_scc1 POLLX_42
POLLB_41:
    buffer_load_dword v30, v31, s[32:35], s66 offen sc1
    s_waitcnt vmcnt(0)
    v_cmp_ne_u32 vcc, s59, v30
    s_cbranch_vccnz POLL_40
POLLX_42:
    s_add_u32 s98, s76, 40960
    buffer_load_dwordx4 v[184:187], v1, s[32:35], s98 offen offset:0 sc1
    s_add_u32 s93, s76, 0
    buffer_load_dwordx4 v[188:191], v1, s[32:35], s93 offen offset:0 sc1
    buffer_load_dwordx4 v[192:195], v1, s[32:35], s98 offen offset:1024 sc1
    buffer_load_dwordx4 v[196:199], v1, s[32:35], s93 offen offset:1024 sc1
    buffer_load_dwordx4 v[200:203], v1, s[32:35], s98 offen offset:2048 sc1
    buffer_load_dwordx4 v[204:207], v1, s[32:35], s93 offen offset:2048 sc1
    v_cmp_ne_u32 vcc, s59, v120
    s_cbranch_vccnz SPIN_43
BACK_44:
    s_or_b32 s64, s2, s54
    s_cmp_eq_u32 s64, 0
    s_cselect_b32 s64, 0, 0x70000000
    v_mov_b32 v33, s59
    v_mov_b32 v34, 0
    buffer_store_dword v33, v34, s[32:35], s64 offen sc1
    s_waitcnt vmcnt(6) lgkmcnt(5)
    v_mfma_f32_16x16x32_bf16 v[92:95], v[160:163], v[184:187], 0
    buffer_load_dwordx4 v[208:211], v1, s[32:35], s98 offen offset:3072 sc1
    s_waitcnt vmcnt(6)
    v_mfma_f32_16x16x32_bf16 v[132:135], v[160:163], v[188:191], 0
    ds_read_b128 v[160:163], v1 offset:6144
    s_waitcnt lgkmcnt(5)
    v_mfma_f32_16x16x32_bf16 v[96:99], v[164:167], v[184:187], 0
    v_mfma_f32_16x16x32_bf16 v[136:139], v[164:167], v[188:191], 0
    ds_read_b128 v[164:167], v1 offset:7168
    s_waitcnt lgkmcnt(4)
    buffer_load_dwordx4 v[212:215], v1, s[32:35], s93 offen offset:3072 sc1
    v_mfma_f32_16x16x32_bf16 v[100:103], v[168:171], v[184:187], 0
    v_mfma_f32_16x16x32_bf16 v[140:143], v[168:171], v[188:191], 0
    ds_read_b128 v[168:171], v1 offset:8192
    v_mfma_f32_16x16x32_bf16 v[104:107], v[172:175], v[184:187], 0
    s_add_u32 s98, s98, 4096
    buffer_load_dwordx4 v[216:219], v1, s[32:35], s98 offen offset:0 sc1
    v_mfma_f32_16x16x32_bf16 v[144:147], v[172:175], v[188:191], 0
    ds_read_b128 v[172:175], v1 offset:9216
    s_waitcnt lgkmcnt(4)
    v_mfma_f32_16x16x32_bf16 v[108:111], v[176:179], v[184:187], 0
    v_mfma_f32_16x16x32_bf16 v[148:151], v[176:179], v[188:191], 0
    ds_read_b128 v[176:179], v1 offset:10240
    s_add_u32 s93, s93, 4096
    buffer_load_dwordx4 v[220:223], v1, s[32:35], s93 offen offset:0 sc1
    v_mfma_f32_16x16x32_bf16 v[112:115], v[180:183], v[184:187], 0
    v_mfma_f32_16x16x32_bf16 v[152:155], v[180:183], v[188:191], 0
    ds_read_b128 v[180:183], v1 offset:11264
    s_waitcnt lgkmcnt(4)
    v_mfma_f32_16x16x32_bf16 v[116:119], v[160:163], v[184:187], 0
    buffer_load_dwordx4 v[224:227], v1, s[32:35], s98 offen offset:1024 sc1
    v_mfma_f32_16x16x32_bf16 v[156:159], v[160:163], v[188:191], 0
    ds_read_b128 v[160:163], v1 offset:12288
    buffer_load_dwordx4 v[228:231], v1, s[32:35], s93 offen offset:1024 sc1
    s_waitcnt vmcnt(10)
    v_mfma_f32_16x16x32_bf16 v[92:95], v[164:167], v[192:195], v[92:95]
    s_waitcnt vmcnt(9)
    v_mfma_f32_16x16x32_bf16 v[132:135], v[164:167], v[196:199], v[132:135]
    ds_read_b128 v[164:167], v1 offset:13312
    s_waitcnt lgkmcnt(4)
    buffer_load_dwordx4 v[56:59], v1, s[32:35], s98 offen offset:2048 sc1
    v_mfma_f32_16x16x32_bf16 v[96:99], v[168:171], v[192:195], v[96:99]
    buffer_load_dwordx4 a[0:3], v35, s[32:35], s90 offen offset:0 sc1
    v_mfma_f32_16x16x32_bf16 v[136:139], v[168:171], v[196:199], v[136:139]
    ds_read_b128 v[168:171], v1 offset:14336
    v_mfma_f32_16x16x32_bf16 v[100:103], v[172:175], v[192:195], v[100:103]
    buffer_load_dwordx4 v[60:63], v1, s[32:35], s93 offen offset:2048 sc1
    v_mfma_f32_16x16x32_bf16 v[140:143], v[172:175], v[196:199], v[140:143]
    ds_read_b128 v[172:175], v1 offset:15360
    s_waitcnt lgkmcnt(4)
    v_mfma_f32_16x16x32_bf16 v[104:107], v[176:179], v[192:195], v[104:107]
    v_mfma_f32_16x16x32_bf16 v[144:147], v[176:179], v[196:199], v[144:147]
    ds_read_b128 v[176:179], v1 offset:16384
    buffer_load_dwordx4 v[64:67], v1, s[32:35], s98 offen offset:3072 sc1
    v_mfma_f32_16x16x32_bf16 v[108:111], v[180:183], v[192:195], v[108:111]
    buffer_load_dwordx4 a[4:7], v35, s[32:35], s90 offen offset:1024 sc1
    v_mfma_f32_16x16x32_bf16 v[148:151], v[180:183], v[196:199], v[148:151]
    ds_read_b128 v[180:183], v1 offset:17408
    s_waitcnt lgkmcnt(4)
    v_mfma_f32_16x16x32_bf16 v[112:115], v[160:163], v[192:195], v[112:115]
    buffer_load_dwordx4 v[68:71], v1, s[32:35], s93 offen offset:3072 sc1
    v_mfma_f32_16x16x32_bf16 v[152:155], v[160:163], v[196:199], v[152:155]
    ds_read_b128 v[160:163], v1 offset:18432
    v_mfma_f32_16x16x32_bf16 v[116:119], v[164:167], v[192:195], v[116:119]
    s_add_u32 s98, s98, 4096
    buffer_load_dwordx4 v[72:75], v1, s[32:35], s98 offen offset:0 sc1
    v_mfma_f32_16x16x32_bf16 v[156:159], v[164:167], v[196:199], v[156:159]
    ds_read_b128 v[164:167], v1 offset:19456
    s_waitcnt lgkmcnt(4)
    s_add_u32 s93, s93, 4096
    buffer_load_dwordx4 v[184:187], v1, s[32:35], s93 offen offset:0 sc1
    s_waitcnt vmcnt(16)
    v_mfma_f32_16x16x32_bf16 v[92:95], v[168:171], v[200:203], v[92:95]
    buffer_load_dwordx4 a[8:11], v35, s[32:35], s90 offen offset:2048 sc1
    s_waitcnt vmcnt(16)
    v_mfma_f32_16x16x32_bf16 v[132:135], v[168:171], v[204:207], v[132:135]
    ds_read_b128 v[168:171], v1 offset:20480
    v_mfma_f32_16x16x32_bf16 v[96:99], v[172:175], v[200:203], v[96:99]
    buffer_load_dwordx4 v[188:191], v1, s[32:35], s98 offen offset:1024 sc1
    v_mfma_f32_16x16x32_bf16 v[136:139], v[172:175], v[204:207], v[136:139]
    ds_read_b128 v[172:175], v1 offset:21504
    s_waitcnt lgkmcnt(4)
    v_mfma_f32_16x16x32_bf16 v[100:103], v[176:179], v[200:203], v[100:103]
    v_mfma_f32_16x16x32_bf16 v[140:143], v[176:179], v[204:207], v[140:143]
    ds_read_b128 v[176:179], v1 offset:22528
    buffer_load_dwordx4 v[192:195], v1, s[32:35], s93 offen offset:1024 sc1
    v_mfma_f32_16x16x32_bf16 v[104:107], v[180:183], v[200:203], v[104:107]
    buffer_load_dwordx4 a[12:15], v35, s[32:35], s90 offen offset:3072 sc1
    v_mfma_f32_16x16x32_bf16 v[144:147], v[180:183], v[204:207], v[144:147]
    ds_read_b128 v[180:183], v1 offset:23552
    s_waitcnt lgkmcnt(4)
    v_mfma_f32_16x16x32_bf16 v[108:111], v[160:163], v[200:203], v[108:111]
    buffer_load_dwordx4 v[196:199], v1, s[32:35], s98 offen offset:2048 sc1
    v_mfma_f32_16x16x32_bf16 v[148:151], v[160:163], v[204:207], v[148:151]
    ds_read_b128 v[160:163], v1 offset:24576
    v_mfma_f32_16x16x32_bf16 v[112:115], v[164:167], v[200:203], v[112:115]
    v_mfma_f32_16x16x32_bf16 v[152:155], v[164:167], v[204:207], v[152:155]
    ds_read_b128 v[164:167], v1 offset:25600
    s_waitcnt lgkmcnt(4)
    v_mfma_f32_16x16x32_bf16 v[116:119], v[168:171], v[200:203], v[116:119]
    buffer_load_dwordx4 v[200:203], v1, s[32:35], s93 offen offset:2048 sc1
    s_add_u32 s90, s90, 4096
    buffer_load_dwordx4 a[16:19], v35, s[32:35], s90 offen offset:0 sc1
    v_mfma_f32_16x16x32_bf16 v[156:159], v[168:171], v[204:207], v[156:159]
    ds_read_b128 v[168:171], v1 offset:26624
    buffer_load_dwordx4 v[204:207], v1, s[32:35], s98 offen offset:3072 sc1
    s_waitcnt vmcnt(21)
    v_mfma_f32_16x16x32_bf16 v[92:95], v[172:175], v[208:211], v[92:95]
    s_add_u32 s69, s88, 524288
    s_waitcnt vmcnt(20)
    v_mfma_f32_16x16x32_bf16 v[132:135], v[172:175], v[212:215], v[132:135]
    ds_read_b128 v[172:175], v1 offset:27648
    s_waitcnt lgkmcnt(4)
    v_mfma_f32_16x16x32_bf16 v[96:99], v[176:179], v[208:211], v[96:99]
    buffer_load_dwordx3 v[76:78], v1, s[32:35], s69 offen offset:0 sc1
    buffer_load_dwordx3 v[80:82], v1, s[32:35], s69 offen offset:1024 sc1
    v_mfma_f32_16x16x32_bf16 v[136:139], v[176:179], v[212:215], v[136:139]
    ds_read_b128 v[176:179], v1 offset:28672
    buffer_load_dwordx3 v[84:86], v1, s[32:35], s69 offen offset:2048 sc1
    v_mfma_f32_16x16x32_bf16 v[100:103], v[180:183], v[208:211], v[100:103]
    buffer_load_dwordx4 a[20:23], v35, s[32:35], s90 offen offset:1024 sc1
    buffer_load_dwordx3 v[88:90], v1, s[32:35], s69 offen offset:3072 sc1
    v_mfma_f32_16x16x32_bf16 v[140:143], v[180:183], v[212:215], v[140:143]
    ds_read_b128 v[180:183], v1 offset:29696
    s_waitcnt lgkmcnt(4)
    v_mfma_f32_16x16x32_bf16 v[104:107], v[160:163], v[208:211], v[104:107]
    v_mfma_f32_16x16x32_bf16 v[144:147], v[160:163], v[212:215], v[144:147]
    ds_read_b128 v[160:163], v1 offset:30720
    v_mfma_f32_16x16x32_bf16 v[108:111], v[164:167], v[208:211], v[108:111]
    v_mfma_f32_16x16x32_bf16 v[148:151], v[164:167], v[212:215], v[148:151]
    ds_read_b128 v[164:167], v1 offset:31744
    s_waitcnt lgkmcnt(4)
    v_mfma_f32_16x16x32_bf16 v[112:115], v[168:171], v[208:211], v[112:115]
    buffer_load_dwordx4 a[24:27], v35, s[32:35], s90 offen offset:2048 sc1
    v_mfma_f32_16x16x32_bf16 v[152:155], v[168:171], v[212:215], v[152:155]
    ds_read_b128 v[168:171], v1 offset:32768
    v_mfma_f32_16x16x32_bf16 v[116:119], v[172:175], v[208:211], v[116:119]
    buffer_load_dwordx4 v[208:211], v1, s[32:35], s93 offen offset:3072 sc1
    v_mfma_f32_16x16x32_bf16 v[156:159], v[172:175], v[212:215], v[156:159]
    ds_read_b128 v[172:175], v1 offset:33792
    s_waitcnt lgkmcnt(4)
    s_add_u32 s98, s98, 4096
    buffer_load_dwordx4 v[212:215], v1, s[32:35], s98 offen offset:0 sc1
    s_waitcnt vmcnt(27)
    v_mfma_f32_16x16x32_bf16 v[92:95], v[176:179], v[216:219], v[92:95]
    s_waitcnt vmcnt(26)
    v_mfma_f32_16x16x32_bf16 v[132:135], v[176:179], v[220:223], v[132:135]
    ds_read_b128 v[176:179], v1 offset:34816
    v_mfma_f32_16x16x32_bf16 v[96:99], v[180:183], v[216:219], v[96:99]
    buffer_load_dwordx4 a[28:31], v35, s[32:35], s90 offen offset:3072 sc1
    v_mfma_f32_16x16x32_bf16 v[136:139], v[180:183], v[220:223], v[136:139]
    ds_read_b128 v[180:183], v1 offset:35840
    s_waitcnt lgkmcnt(4)
    v_mfma_f32_16x16x32_bf16 v[100:103], v[160:163], v[216:219], v[100:103]
    v_mfma_f32_16x16x32_bf16 v[140:143], v[160:163], v[220:223], v[140:143]
    ds_read_b128 v[160:163], v1 offset:36864
    v_mfma_f32_16x16x32_bf16 v[104:107], v[164:167], v[216:219], v[104:107]
    v_mfma_f32_16x16x32_bf16 v[144:147], v[164:167], v[220:223], v[144:147]
    ds_read_b128 v[164:167], v1 offset:37888
    s_waitcnt lgkmcnt(4)
    v_mfma_f32_16x16x32_bf16 v[108:111], v[168:171], v[216:219], v[108:111]
    s_add_u32 s90, s90, 4096
    buffer_load_dwordx4 a[32:35], v35, s[32:35], s90 offen offset:0 sc1
    v_mfma_f32_16x16x32_bf16 v[148:151], v[168:171], v[220:223], v[148:151]
    ds_read_b128 v[168:171], v1 offset:38912
    v_mfma_f32_16x16x32_bf16 v[112:115], v[172:175], v[216:219], v[112:115]
    v_mfma_f32_16x16x32_bf16 v[152:155], v[172:175], v[220:223], v[152:155]
    ds_read_b128 v[172:175], v1 offset:39936
    s_waitcnt lgkmcnt(4)
    v_mfma_f32_16x16x32_bf16 v[116:119], v[176:179], v[216:219], v[116:119]
    s_add_u32 s93, s93, 4096
    buffer_load_dwordx4 v[216:219], v1, s[32:35], s93 offen offset:0 sc1
    v_mfma_f32_16x16x32_bf16 v[156:159], v[176:179], v[220:223], v[156:159]
    ds_read_b128 v[176:179], v1 offset:40960
    buffer_load_dwordx4 v[220:223], v1, s[32:35], s98 offen offset:1024 sc1
    s_waitcnt vmcnt(29)
    v_mfma_f32_16x16x32_bf16 v[92:95], v[180:183], v[224:227], v[92:95]
    buffer_load_dwordx4 a[36:39], v35, s[32:35], s90 offen offset:1024 sc1
    s_waitcnt vmcnt(29)
    v_mfma_f32_16x16x32_bf16 v[132:135], v[180:183], v[228:231], v[132:135]
    ds_read_b128 v[180:183], v1 offset:41984
    s_waitcnt lgkmcnt(4)
    v_mfma_f32_16x16x32_bf16 v[96:99], v[160:163], v[224:227], v[96:99]
    v_mfma_f32_16x16x32_bf16 v[136:139], v[160:163], v[228:231], v[136:139]
    ds_read_b128 v[160:163], v1 offset:43008
    v_mfma_f32_16x16x32_bf16 v[100:103], v[164:167], v[224:227], v[100:103]
    v_mfma_f32_16x16x32_bf16 v[140:143], v[164:167], v[228:231], v[140:143]
    ds_read_b128 v[164:167], v1 offset:44032
    s_waitcnt lgkmcnt(4)
    v_mfma_f32_16x16x32_bf16 v[104:107], v[168:171], v[224:227], v[104:107]
    buffer_load_dwordx4 a[40:43], v35, s[32:35], s90 offen offset:2048 sc1
    v_mfma_f32_16x16x32_bf16 v[144:147], v[168:171], v[228:231], v[144:147]
    ds_read_b128 v[168:171], v1 offset:45056
    v_mfma_f32_16x16x32_bf16 v[108:111], v[172:175], v[224:227], v[108:111]
    v_mfma_f32_16x16x32_bf16 v[148:151], v[172:175], v[228:231], v[148:151]
    ds_read_b128 v[172:175], v1 offset:46080
    s_waitcnt lgkmcnt(4)
    v_mfma_f32_16x16x32_bf16 v[112:115], v[176:179], v[224:227], v[112:115]
    s_waitcnt vmcnt(12)
    v_xor_b32 v78, v78, v82
    s_waitcnt vmcnt(9)
    v_xor_b32 v86, v86, v90
    v_xor_b32 v82, v82, v90
    v_xor_b32 v90, s59, v90
    v_or3_b32 v78, v78, v82, v86
    v_or_b32 v78, v78, v90
    v_cmp_ne_u32 vcc, 0, v78
    s_cbranch_vccnz SPIN_46
BACK_47:
    v_mfma_f32_16x16x32_bf16 v[152:155], v[176:179], v[228:231], v[152:155]
    ds_read_b128 v[176:179], v1 offset:47104
    v_mfma_f32_16x16x32_bf16 v[116:119], v[180:183], v[224:227], v[116:119]
    buffer_load_dwordx4 v[224:227], v1, s[32:35], s93 offen offset:1024 sc1
    buffer_load_dwordx4 a[44:47], v35, s[32:35], s90 offen offset:3072 sc1
    v_mfma_f32_16x16x32_bf16 v[156:159], v[180:183], v[228:231], v[156:159]
    ds_read_b128 v[180:183], v1 offset:48128
    s_waitcnt lgkmcnt(4)
    buffer_load_dwordx4 v[228:231], v1, s[32:35], s98 offen offset:2048 sc1
    v_mfma_f32_16x16x32_bf16 v[92:95], v[160:163], v[56:59], v[92:95]
    v_mfma_f32_16x16x32_bf16 v[132:135], v[160:163], v[60:63], v[132:135]
    ds_read_b128 v[160:163], v1 offset:49152
    v_mfma_f32_16x16x32_bf16 v[96:99], v[164:167], v[56:59], v[96:99]
    v_mfma_f32_16x16x32_bf16 v[136:139], v[164:167], v[60:63], v[136:139]
    ds_read_b128 v[164:167], v1 offset:50176
    s_waitcnt lgkmcnt(4)
    v_mfma_f32_16x16x32_bf16 v[100:103], v[168:171], v[56:59], v[100:103]
    s_add_u32 s90, s90, 4096
    buffer_load_dwordx4 a[48:51], v35, s[32:35], s90 offen offset:0 sc1
    v_mfma_f32_16x16x32_bf16 v[140:143], v[168:171], v[60:63], v[140:143]
    ds_read_b128 v[168:171], v1 offset:51200
    v_mfma_f32_16x16x32_bf16 v[104:107], v[172:175], v[56:59], v[104:107]
    v_add_f32 v76, v76, v80
    v_add_f32 v77, v77, v81
    v_mfma_f32_16x16x32_bf16 v[144:147], v[172:175], v[60:63], v[144:147]
    ds_read_b128 v[172:175], v1 offset:52224
    s_waitcnt lgkmcnt(4)
    v_mfma_f32_16x16x32_bf16 v[108:111], v[176:179], v[56:59], v[108:111]
    v_add_f32 v84, v84, v88
    v_add_f32 v85, v85, v89
    v_mfma_f32_16x16x32_bf16 v[148:151], v[176:179], v[60:63], v[148:151]
    ds_read_b128 v[176:179], v1 offset:53248
    v_add_f32 v76, v76, v84
    v_mfma_f32_16x16x32_bf16 v[112:115], v[180:183], v[56:59], v[112:115]
    buffer_load_dwordx4 a[52:55], v35, s[32:35], s90 offen offset:1024 sc1
    v_add_f32 v77, v77, v85
    v_mfma_f32_16x16x32_bf16 v[152:155], v[180:183], v[60:63], v[152:155]
    ds_read_b128 v[180:183], v1 offset:54272
    s_waitcnt lgkmcnt(4)
    v_mfma_f32_16x16x32_bf16 v[116:119], v[160:163], v[56:59], v[116:119]
    buffer_load_dwordx4 v[56:59], v1, s[32:35], s93 offen offset:2048 sc1
    v_permlane16_swap_b32 v76, v77
    v_mfma_f32_16x16x32_bf16 v[156:159], v[160:163], v[60:63], v[156:159]
    ds_read_b128 v[160:163], v1 offset:55296
    buffer_load_dwordx4 v[60:63], v1, s[32:35], s98 offen offset:3072 sc1
    v_mfma_f32_16x16x32_bf16 v[92:95], v[164:167], v[64:67], v[92:95]
    v_add_f32 v76, v76, v77
    v_mov_b32 v77, v76
    v_mfma_f32_16x16x32_bf16 v[132:135], v[164:167], v[68:71], v[132:135]
    ds_read_b128 v[164:167], v1 offset:56320
    s_waitcnt lgkmcnt(4)
    v_mfma_f32_16x16x32_bf16 v[96:99], v[168:171], v[64:67], v[96:99]
    buffer_load_dwordx4 a[56:59], v35, s[32:35], s90 offen offset:2048 sc1
    v_permlane32_swap_b32 v76, v77
    v_mfma_f32_16x16x32_bf16 v[136:139], v[168:171], v[68:71], v[136:139]
    ds_read_b128 v[168:171], v28 offset:0
    v_add_f32 v76, v76, v77
    v_mfma_f32_16x16x32_bf16 v[100:103], v[172:175], v[64:67], v[100:103]
    v_mul_f32 v80, 0x3acccccd, v76
    v_mul_f32 v81, 0x3acccccd, v76
    v_mfma_f32_16x16x32_bf16 v[140:143], v[172:175], v[68:71], v[140:143]
    ds_read_b128 v[172:175], v28 offset:1024
    s_waitcnt lgkmcnt(4)
    v_mfma_f32_16x16x32_bf16 v[104:107], v[176:179], v[64:67], v[104:107]
    v_permlane16_swap_b32 v80, v81
    v_fma_f32 v81, -v80, v80, v81
    v_mfma_f32_16x16x32_bf16 v[144:147], v[176:179], v[68:71], v[144:147]
    ds_read_b128 v[176:179], v28 offset:2048
    v_max_f32 v81, 0, v81
    v_mfma_f32_16x16x32_bf16 v[108:111], v[180:183], v[64:67], v[108:111]
    buffer_load_dwordx4 a[60:63], v35, s[32:35], s90 offen offset:3072 sc1
    v_cvt_pk_bf16_f32 v81, v81, v80
    v_mfma_f32_16x16x32_bf16 v[148:151], v[180:183], v[68:71], v[148:151]
    ds_read_b128 v[180:183], v28 offset:3072
    s_waitcnt lgkmcnt(4)
    v_mfma_f32_16x16x32_bf16 v[112:115], v[160:163], v[64:67], v[112:115]
    v_and_b32 v80, 0xffff0000, v81
    v_lshlrev_b32 v81, 16, v81
    v_mfma_f32_16x16x32_bf16 v[152:155], v[160:163], v[68:71], v[152:155]
    ds_read_b128 v[160:163], v28 offset:4096
    v_add_f32 v81, 0x3727c5ac, v81
    v_mfma_f32_16x16x32_bf16 v[116:119], v[164:167], v[64:67], v[116:119]
    buffer_load_dwordx4 v[64:67], v1, s[32:35], s93 offen offset:3072 sc1
    v_cvt_pk_bf16_f32 v81, v81, v81
    v_mfma_f32_16x16x32_bf16 v[156:159], v[164:167], v[68:71], v[156:159]
    ds_read_b128 v[164:167], v28 offset:5120
    s_waitcnt lgkmcnt(4)
    s_add_u32 s98, s98, 4096
    buffer_load_dwordx4 v[68:71], v1, s[32:35], s98 offen offset:0 sc1
    v_mfma_f32_16x16x32_bf16 v[92:95], v[168:171], v[72:75], v[92:95]
    s_add_u32 s90, s90, 4096
    buffer_load_dwordx4 a[64:67], v35, s[32:35], s90 offen offset:0 sc1
    v_mfma_f32_16x16x32_bf16 v[132:135], v[168:171], v[184:187], v[132:135]
    ds_read_b128 v[168:171], v28 offset:6144
    v_mfma_f32_16x16x32_bf16 v[96:99], v[172:175], v[72:75], v[96:99]
    v_lshlrev_b32 v81, 16, v81
    v_mfma_f32_16x16x32_bf16 v[136:139], v[172:175], v[184:187], v[136:139]
    ds_read_b128 v[172:175], v28 offset:7168
    s_waitcnt lgkmcnt(4)
    v_mfma_f32_16x16x32_bf16 v[100:103], v[176:179], v[72:75], v[100:103]
    v_sqrt_f32 v81, v81
    v_mfma_f32_16x16x32_bf16 v[140:143], v[176:179], v[184:187], v[140:143]
    ds_read_b128 v[176:179], v28 offset:8192
    v_cvt_pk_bf16_f32 v81, v81, v81
    v_mfma_f32_16x16x32_bf16 v[104:107], v[180:183], v[72:75], v[104:107]
    buffer_load_dwordx4 a[68:71], v35, s[32:35], s90 offen offset:1024 sc1
    v_lshlrev_b32 v81, 16, v81
    v_mfma_f32_16x16x32_bf16 v[144:147], v[180:183], v[184:187], v[144:147]
    ds_read_b128 v[180:183], v28 offset:9216
    s_waitcnt lgkmcnt(4)
    v_mfma_f32_16x16x32_bf16 v[108:111], v[160:163], v[72:75], v[108:111]
    v_rcp_f32 v82, v81
    v_mfma_f32_16x16x32_bf16 v[148:151], v[160:163], v[184:187], v[148:151]
    ds_read_b128 v[160:163], v28 offset:10240
    v_xor_b32 v80, 0x80000000, v80
    v_mfma_f32_16x16x32_bf16 v[112:115], v[164:167], v[72:75], v[112:115]
    v_lshrrev_b32 v83, 16, v80
    v_or_b32 v80, v80, v83
    v_mfma_f32_16x16x32_bf16 v[152:155], v[164:167], v[184:187], v[152:155]
    ds_read_b128 v[164:167], v28 offset:11264
    s_waitcnt lgkmcnt(4)
    v_mfma_f32_16x16x32_bf16 v[116:119], v[168:171], v[72:75], v[116:119]
    s_add_u32 s93, s93, 4096
    buffer_load_dwordx4 v[72:75], v1, s[32:35], s93 offen offset:0 sc1
    buffer_load_dwordx4 a[72:75], v35, s[32:35], s90 offen offset:2048 sc1
    v_mfma_f32_16x16x32_bf16 v[156:159], v[168:171], v[184:187], v[156:159]
    ds_read_b128 v[168:171], v28 offset:12288
    buffer_load_dwordx4 v[184:187], v1, s[32:35], s98 offen offset:1024 sc1
    v_mfma_f32_16x16x32_bf16 v[92:95], v[172:175], v[188:191], v[92:95]
    v_or_b32 v81, v81, v83
    v_mfma_f32_16x16x32_bf16 v[132:135], v[172:175], v[192:195], v[132:135]
    ds_read_b128 v[172:175], v28 offset:13312
    s_waitcnt lgkmcnt(4)
    v_mfma_f32_16x16x32_bf16 v[96:99], v[176:179], v[188:191], v[96:99]
    v_mul_f32 v54, 0x3fb8aa3b, v82
    v_cndmask_b32 v50, 0, v80, s[100:101]
    v_mfma_f32_16x16x32_bf16 v[136:139], v[176:179], v[192:195], v[136:139]
    ds_read_b128 v[176:179], v28 offset:14336
    v_cndmask_b32 v51, 0, v81, s[100:101]
    v_mfma_f32_16x16x32_bf16 v[100:103], v[180:183], v[188:191], v[100:103]
    buffer_load_dwordx4 a[76:79], v35, s[32:35], s90 offen offset:3072 sc1
    s_add_u32 s69, s88, 532480
    v_mfma_f32_16x16x32_bf16 v[140:143], v[180:183], v[192:195], v[140:143]
    ds_read_b128 v[180:183], v28 offset:15360
    s_waitcnt lgkmcnt(4)
    v_mfma_f32_16x16x32_bf16 v[104:107], v[160:163], v[188:191], v[104:107]
    buffer_load_dwordx3 v[76:78], v1, s[32:35], s69 offen offset:0 sc1
    buffer_load_dwordx3 v[80:82], v1, s[32:35], s69 offen offset:1024 sc1
    v_mfma_f32_16x16x32_bf16 v[144:147], v[160:163], v[192:195], v[144:147]
    ds_read_b128 v[160:163], v28 offset:16384
    buffer_load_dwordx3 v[84:86], v1, s[32:35], s69 offen offset:2048 sc1
    v_mfma_f32_16x16x32_bf16 v[108:111], v[164:167], v[188:191], v[108:111]
    buffer_load_dwordx3 v[88:90], v1, s[32:35], s69 offen offset:3072 sc1
    v_mfma_f32_16x16x32_bf16 v[148:151], v[164:167], v[192:195], v[148:151]
    ds_read_b128 v[164:167], v28 offset:17408
    s_waitcnt lgkmcnt(4)
    v_mfma_f32_16x16x32_bf16 v[112:115], v[168:171], v[188:191], v[112:115]
    s_add_u32 s90, s90, 4096
    buffer_load_dwordx4 a[80:83], v35, s[32:35], s90 offen offset:0 sc1
    v_mfma_f32_16x16x32_bf16 v[152:155], v[168:171], v[192:195], v[152:155]
    ds_read_b128 v[168:171], v28 offset:18432
    v_mfma_f32_16x16x32_bf16 v[116:119], v[172:175], v[188:191], v[116:119]
    buffer_load_dwordx4 v[188:191], v1, s[32:35], s93 offen offset:1024 sc1
    v_mfma_f32_16x16x32_bf16 v[156:159], v[172:175], v[192:195], v[156:159]
    ds_read_b128 v[172:175], v28 offset:19456
    s_waitcnt lgkmcnt(4)
    buffer_load_dwordx4 v[192:195], v1, s[32:35], s98 offen offset:2048 sc1
    v_mfma_f32_16x16x32_bf16 v[92:95], v[176:179], v[196:199], v[92:95]
    v_mfma_f32_16x16x32_bf16 v[132:135], v[176:179], v[200:203], v[132:135]
    ds_read_b128 v[176:179], v28 offset:20480
    v_mfma_f32_16x16x32_bf16 v[96:99], v[180:183], v[196:199], v[96:99]
    buffer_load_dwordx4 a[84:87], v35, s[32:35], s90 offen offset:1024 sc1
    v_mfma_f32_16x16x32_bf16 v[136:139], v[180:183], v[200:203], v[136:139]
    ds_read_b128 v[180:183], v28 offset:21504
    s_waitcnt lgkmcnt(4)
    v_mfma_f32_16x16x32_bf16 v[100:103], v[160:163], v[196:199], v[100:103]
    v_mfma_f32_16x16x32_bf16 v[140:143], v[160:163], v[200:203], v[140:143]
    ds_read_b128 v[160:163], v28 offset:22528
    v_mfma_f32_16x16x32_bf16 v[104:107], v[164:167], v[196:199], v[104:107]
    v_mfma_f32_16x16x32_bf16 v[144:147], v[164:167], v[200:203], v[144:147]
    ds_read_b128 v[164:167], v28 offset:23552
    s_waitcnt lgkmcnt(4)
    v_mfma_f32_16x16x32_bf16 v[108:111], v[168:171], v[196:199], v[108:111]
    buffer_load_dwordx4 a[88:91], v35, s[32:35], s90 offen offset:2048 sc1
    v_mfma_f32_16x16x32_bf16 v[148:151], v[168:171], v[200:203], v[148:151]
    ds_read_b128 v[168:171], v28 offset:24576
    v_mfma_f32_16x16x32_bf16 v[112:115], v[172:175], v[196:199], v[112:115]
    v_mfma_f32_16x16x32_bf16 v[152:155], v[172:175], v[200:203], v[152:155]
    ds_read_b128 v[172:175], v28 offset:25600
    s_waitcnt lgkmcnt(4)
    v_mfma_f32_16x16x32_bf16 v[116:119], v[176:179], v[196:199], v[116:119]
    buffer_load_dwordx4 v[196:199], v1, s[32:35], s93 offen offset:2048 sc1
    v_mfma_f32_16x16x32_bf16 v[156:159], v[176:179], v[200:203], v[156:159]
    ds_read_b128 v[176:179], v28 offset:26624
    buffer_load_dwordx4 v[200:203], v1, s[32:35], s98 offen offset:3072 sc1
    v_mfma_f32_16x16x32_bf16 v[92:95], v[180:183], v[204:207], v[92:95]
    buffer_load_dwordx4 a[92:95], v35, s[32:35], s90 offen offset:3072 sc1
    s_waitcnt vmcnt(36)
    v_mfma_f32_16x16x32_bf16 v[132:135], v[180:183], v[208:211], v[132:135]
    ds_read_b128 v[180:183], v28 offset:27648
    s_waitcnt lgkmcnt(4)
    v_mfma_f32_16x16x32_bf16 v[96:99], v[160:163], v[204:207], v[96:99]
    v_mfma_f32_16x16x32_bf16 v[136:139], v[160:163], v[208:211], v[136:139]
    ds_read_b128 v[160:163], v28 offset:28672
    v_mfma_f32_16x16x32_bf16 v[100:103], v[164:167], v[204:207], v[100:103]
    v_mfma_f32_16x16x32_bf16 v[140:143], v[164:167], v[208:211], v[140:143]
    ds_read_b128 v[164:167], v28 offset:29696
    s_waitcnt lgkmcnt(4)
    v_mfma_f32_16x16x32_bf16 v[104:107], v[168:171], v[204:207], v[104:107]
    s_add_u32 s90, s90, 4096
    buffer_load_dwordx4 a[96:99], v35, s[32:35], s90 offen offset:0 sc1
    v_mfma_f32_16x16x32_bf16 v[144:147], v[168:171], v[208:211], v[144:147]
    ds_read_b128 v[168:171], v28 offset:30720
    v_mfma_f32_16x16x32_bf16 v[108:111], v[172:175], v[204:207], v[108:111]
    v_mfma_f32_16x16x32_bf16 v[148:151], v[172:175], v[208:211], v[148:151]
    ds_read_b128 v[172:175], v28 offset:31744
    s_waitcnt lgkmcnt(4)
    v_mfma_f32_16x16x32_bf16 v[112:115], v[176:179], v[204:207], v[112:115]
    v_mfma_f32_16x16x32_bf16 v[152:155], v[176:179], v[208:211], v[152:155]
    ds_read_b128 v[176:179], v28 offset:32768
    s_waitcnt vmcnt(11)
    v_xor_b32 v78, v78, v82
    s_waitcnt vmcnt(9)
    v_xor_b32 v86, v86, v90
    v_xor_b32 v82, v82, v90
    v_xor_b32 v90, s59, v90
    v_or3_b32 v78, v78, v82, v86
    v_or_b32 v78, v78, v90
    v_cmp_ne_u32 vcc, 0, v78
    s_cbranch_vccnz SPIN_48
BACK_49:
    v_mfma_f32_16x16x32_bf16 v[116:119], v[180:183], v[204:207], v[116:119]
    buffer_load_dwordx4 v[204:207], v1, s[32:35], s93 offen offset:3072 sc1
    buffer_load_dwordx4 a[100:103], v35, s[32:35], s90 offen offset:1024 sc1
    v_mfma_f32_16x16x32_bf16 v[156:159], v[180:183], v[208:211], v[156:159]
    ds_read_b128 v[180:183], v28 offset:33792
    s_waitcnt lgkmcnt(4)
    v_mfma_f32_16x16x32_bf16 v[92:95], v[160:163], v[212:215], v[92:95]
    v_mfma_f32_16x16x32_bf16 v[132:135], v[160:163], v[216:219], v[132:135]
    ds_read_b128 v[160:163], v28 offset:34816
    v_mfma_f32_16x16x32_bf16 v[96:99], v[164:167], v[212:215], v[96:99]
    v_mfma_f32_16x16x32_bf16 v[136:139], v[164:167], v[216:219], v[136:139]
    ds_read_b128 v[164:167], v28 offset:35840
    s_waitcnt lgkmcnt(4)
    v_mfma_f32_16x16x32_bf16 v[100:103], v[168:171], v[212:215], v[100:103]
    buffer_load_dwordx4 a[104:107], v35, s[32:35], s90 offen offset:2048 sc1
    v_mfma_f32_16x16x32_bf16 v[140:143], v[168:171], v[216:219], v[140:143]
    ds_read_b128 v[168:171], v28 offset:36864
    v_mfma_f32_16x16x32_bf16 v[104:107], v[172:175], v[212:215], v[104:107]
    v_add_f32 v76, v76, v80
    v_add_f32 v77, v77, v81
    v_mfma_f32_16x16x32_bf16 v[144:147], v[172:175], v[216:219], v[144:147]
    ds_read_b128 v[172:175], v28 offset:37888
    s_waitcnt lgkmcnt(4)
    v_mfma_f32_16x16x32_bf16 v[108:111], v[176:179], v[212:215], v[108:111]
    v_add_f32 v84, v84, v88
    v_add_f32 v85, v85, v89
    v_mfma_f32_16x16x32_bf16 v[148:151], v[176:179], v[216:219], v[148:151]
    ds_read_b128 v[176:179], v28 offset:38912
    v_add_f32 v76, v76, v84
    v_mfma_f32_16x16x32_bf16 v[112:115], v[180:183], v[212:215], v[112:115]
    buffer_load_dwordx4 a[108:111], v35, s[32:35], s90 offen offset:3072 sc1
    v_add_f32 v77, v77, v85
    v_mfma_f32_16x16x32_bf16 v[152:155], v[180:183], v[216:219], v[152:155]
    ds_read_b128 v[180:183], v28 offset:39936
    s_waitcnt lgkmcnt(4)
    v_mfma_f32_16x16x32_bf16 v[116:119], v[160:163], v[212:215], v[116:119]
    v_permlane16_swap_b32 v76, v77
    v_add_f32 v76, v76, v77
    v_mfma_f32_16x16x32_bf16 v[156:159], v[160:163], v[216:219], v[156:159]
    ds_read_b128 v[160:163], v28 offset:40960
    v_mov_b32 v77, v76
    v_mfma_f32_16x16x32_bf16 v[92:95], v[164:167], v[220:223], v[92:95]
    s_nop 0
    v_permlane32_swap_b32 v76, v77
    v_add_f32 v76, v76, v77
    v_mfma_f32_16x16x32_bf16 v[132:135], v[164:167], v[224:227], v[132:135]
    ds_read_b128 v[164:167], v28 offset:41984
    s_waitcnt lgkmcnt(4)
    v_mfma_f32_16x16x32_bf16 v[96:99], v[168:171], v[220:223], v[96:99]
    s_add_u32 s90, s90, 4096
    buffer_load_dwordx4 a[112:115], v35, s[32:35], s90 offen offset:0 sc1
    v_mfma_f32_16x16x32_bf16 v[136:139], v[168:171], v[224:227], v[136:139]
    ds_read_b128 v[168:171], v28 offset:43008
    v_mul_f32 v80, 0x3acccccd, v76
    v_mfma_f32_16x16x32_bf16 v[100:103], v[172:175], v[220:223], v[100:103]
    v_mul_f32 v81, 0x3acccccd, v76
    s_nop 1
    v_permlane16_swap_b32 v80, v81
    v_mfma_f32_16x16x32_bf16 v[140:143], v[172:175], v[224:227], v[140:143]
    ds_read_b128 v[172:175], v28 offset:44032
    s_waitcnt lgkmcnt(4)
    v_mfma_f32_16x16x32_bf16 v[104:107], v[176:179], v[220:223], v[104:107]
    v_fma_f32 v81, -v80, v80, v81
    v_max_f32 v81, 0, v81
    v_mfma_f32_16x16x32_bf16 v[144:147], v[176:179], v[224:227], v[144:147]
    ds_read_b128 v[176:179], v28 offset:45056
    v_cvt_pk_bf16_f32 v81, v81, v80
    v_mfma_f32_16x16x32_bf16 v[108:111], v[180:183], v[220:223], v[108:111]
    buffer_load_dwordx4 a[116:119], v35, s[32:35], s90 offen offset:1024 sc1
    v_and_b32 v80, 0xffff0000, v81
    v_mfma_f32_16x16x32_bf16 v[148:151], v[180:183], v[224:227], v[148:151]
    ds_read_b128 v[180:183], v28 offset:46080
    s_waitcnt lgkmcnt(4)
    v_mfma_f32_16x16x32_bf16 v[112:115], v[160:163], v[220:223], v[112:115]
    v_lshlrev_b32 v81, 16, v81
    v_add_f32 v81, 0x3727c5ac, v81
    v_mfma_f32_16x16x32_bf16 v[152:155], v[160:163], v[224:227], v[152:155]
    ds_read_b128 v[160:163], v28 offset:47104
    v_cvt_pk_bf16_f32 v81, v81, v81
    v_mfma_f32_16x16x32_bf16 v[116:119], v[164:167], v[220:223], v[116:119]
    v_lshlrev_b32 v81, 16, v81
    v_sqrt_f32 v81, v81
    v_mfma_f32_16x16x32_bf16 v[156:159], v[164:167], v[224:227], v[156:159]
    ds_read_b128 v[164:167], v28 offset:48128
    s_waitcnt lgkmcnt(4)
    v_mfma_f32_16x16x32_bf16 v[92:95], v[168:171], v[228:231], v[92:95]
    buffer_load_dwordx4 a[120:123], v35, s[32:35], s90 offen offset:2048 sc1
    v_mfma_f32_16x16x32_bf16 v[132:135], v[168:171], v[56:59], v[132:135]
    ds_read_b128 v[168:171], v28 offset:49152
    v_cvt_pk_bf16_f32 v81, v81, v81
    v_mfma_f32_16x16x32_bf16 v[96:99], v[172:175], v[228:231], v[96:99]
    v_lshlrev_b32 v81, 16, v81
    v_rcp_f32 v82, v81
    v_mfma_f32_16x16x32_bf16 v[136:139], v[172:175], v[56:59], v[136:139]
    ds_read_b128 v[172:175], v28 offset:50176
    s_waitcnt lgkmcnt(4)
    v_mfma_f32_16x16x32_bf16 v[100:103], v[176:179], v[228:231], v[100:103]
    v_xor_b32 v80, 0x80000000, v80
    v_mfma_f32_16x16x32_bf16 v[140:143], v[176:179], v[56:59], v[140:143]
    ds_read_b128 v[176:179], v28 offset:51200
    v_lshrrev_b32 v83, 16, v80
    v_mfma_f32_16x16x32_bf16 v[104:107], v[180:183], v[228:231], v[104:107]
    buffer_load_dwordx4 a[124:127], v35, s[32:35], s90 offen offset:3072 sc1
    v_or_b32 v80, v80, v83
    v_mfma_f32_16x16x32_bf16 v[144:147], v[180:183], v[56:59], v[144:147]
    ds_read_b128 v[180:183], v28 offset:52224
    s_waitcnt lgkmcnt(4)
    v_mfma_f32_16x16x32_bf16 v[108:111], v[160:163], v[228:231], v[108:111]
    v_or_b32 v81, v81, v83
    v_mul_f32 v55, 0x3fb8aa3b, v82
    v_mfma_f32_16x16x32_bf16 v[148:151], v[160:163], v[56:59], v[148:151]
    ds_read_b128 v[160:163], v28 offset:53248
    v_cndmask_b32 v52, 0, v80, s[100:101]
    v_mfma_f32_16x16x32_bf16 v[112:115], v[164:167], v[228:231], v[112:115]
    v_cndmask_b32 v53, 0, v81, s[100:101]
    s_mul_i32 s64, s58, 896
    v_mfma_f32_16x16x32_bf16 v[152:155], v[164:167], v[56:59], v[152:155]
    ds_read_b128 v[164:167], v28 offset:54272
    s_waitcnt lgkmcnt(4)
    v_mfma_f32_16x16x32_bf16 v[116:119], v[168:171], v[228:231], v[116:119]
    s_add_u32 s90, s90, 4096
    buffer_load_dwordx4 a[128:131], v35, s[32:35], s90 offen offset:0 sc1
    v_mfma_f32_16x16x32_bf16 v[156:159], v[168:171], v[56:59], v[156:159]
    ds_read_b128 v[168:171], v28 offset:55296
    s_add_u32 s64, s64, 49152
    v_mfma_f32_16x16x32_bf16 v[92:95], v[172:175], v[60:63], v[92:95]
    s_mul_i32 s65, s54, 5120
    s_add_u32 s65, s65, 143360
    v_mfma_f32_16x16x32_bf16 v[132:135], v[172:175], v[64:67], v[132:135]
    ds_read_b128 v[172:175], v28 offset:56320
    s_waitcnt lgkmcnt(4)
    v_mfma_f32_16x16x32_bf16 v[96:99], v[176:179], v[60:63], v[96:99]
    v_lshl_add_u32 v124, v2, 3, s65
    s_mov_b32 m0, s65
    s_mov_b32 exec_hi, 0xffffff
    buffer_load_dwordx4 v1, s[32:35], s64 offen sc1 lds
    s_mov_b64 exec, -1
    v_mfma_f32_16x16x32_bf16 v[136:139], v[176:179], v[64:67], v[136:139]
    ds_read_b128 v[176:179], v29 offset:0
    v_mfma_f32_16x16x32_bf16 v[100:103], v[180:183], v[60:63], v[100:103]
    buffer_load_dwordx4 a[132:135], v35, s[32:35], s90 offen offset:1024 sc1
    v_mfma_f32_16x16x32_bf16 v[140:143], v[180:183], v[64:67], v[140:143]
    ds_read_b128 v[180:183], v29 offset:1024
    s_waitcnt lgkmcnt(4)
    v_mfma_f32_16x16x32_bf16 v[104:107], v[160:163], v[60:63], v[104:107]
    v_mfma_f32_16x16x32_bf16 v[144:147], v[160:163], v[64:67], v[144:147]
    ds_read_b128 v[160:163], v29 offset:2048
    v_mfma_f32_16x16x32_bf16 v[108:111], v[164:167], v[60:63], v[108:111]
    v_mfma_f32_16x16x32_bf16 v[148:151], v[164:167], v[64:67], v[148:151]
    ds_read_b128 v[164:167], v29 offset:3072
    s_waitcnt lgkmcnt(4)
    v_mfma_f32_16x16x32_bf16 v[112:115], v[168:171], v[60:63], v[112:115]
    buffer_load_dwordx4 a[136:139], v35, s[32:35], s90 offen offset:2048 sc1
    v_mfma_f32_16x16x32_bf16 v[152:155], v[168:171], v[64:67], v[152:155]
    ds_read_b128 v[168:171], v29 offset:4096
    v_mfma_f32_16x16x32_bf16 v[116:119], v[172:175], v[60:63], v[116:119]
    v_mfma_f32_16x16x32_bf16 v[156:159], v[172:175], v[64:67], v[156:159]
    ds_read_b128 v[172:175], v29 offset:5120
    s_waitcnt lgkmcnt(4)
    v_mfma_f32_16x16x32_bf16 v[92:95], v[176:179], v[68:71], v[92:95]
    v_mfma_f32_16x16x32_bf16 v[132:135], v[176:179], v[72:75], v[132:135]
    ds_read_b128 v[176:179], v29 offset:6144
    v_mfma_f32_16x16x32_bf16 v[96:99], v[180:183], v[68:71], v[96:99]
    buffer_load_dwordx4 a[140:143], v35, s[32:35], s90 offen offset:3072 sc1
    v_mfma_f32_16x16x32_bf16 v[136:139], v[180:183], v[72:75], v[136:139]
    ds_read_b128 v[180:183], v29 offset:7168
    s_waitcnt lgkmcnt(4)
    v_mfma_f32_16x16x32_bf16 v[100:103], v[160:163], v[68:71], v[100:103]
    v_mfma_f32_16x16x32_bf16 v[140:143], v[160:163], v[72:75], v[140:143]
    ds_read_b128 v[160:163], v29 offset:8192
    v_mfma_f32_16x16x32_bf16 v[104:107], v[164:167], v[68:71], v[104:107]
    v_mfma_f32_16x16x32_bf16 v[144:147], v[164:167], v[72:75], v[144:147]
    ds_read_b128 v[164:167], v29 offset:9216
    s_waitcnt lgkmcnt(4)
    v_mfma_f32_16x16x32_bf16 v[108:111], v[168:171], v[68:71], v[108:111]
    s_add_u32 s90, s90, 4096
    buffer_load_dwordx4 a[144:147], v35, s[32:35], s90 offen offset:0 sc1
    v_mfma_f32_16x16x32_bf16 v[148:151], v[168:171], v[72:75], v[148:151]
    ds_read_b128 v[168:171], v29 offset:10240
    v_mfma_f32_16x16x32_bf16 v[112:115], v[172:175], v[68:71], v[112:115]
    v_mfma_f32_16x16x32_bf16 v[152:155], v[172:175], v[72:75], v[152:155]
    ds_read_b128 v[172:175], v29 offset:11264
    s_waitcnt lgkmcnt(4)
    v_mfma_f32_16x16x32_bf16 v[116:119], v[176:179], v[68:71], v[116:119]
    v_mfma_f32_16x16x32_bf16 v[156:159], v[176:179], v[72:75], v[156:159]
    ds_read_b128 v[176:179], v29 offset:12288
    v_mfma_f32_16x16x32_bf16 v[92:95], v[180:183], v[184:187], v[92:95]
    buffer_load_dwordx4 a[148:151], v35, s[32:35], s90 offen offset:1024 sc1
    s_waitcnt vmcnt(22)
    v_mfma_f32_16x16x32_bf16 v[132:135], v[180:183], v[188:191], v[132:135]
    ds_read_b128 v[180:183], v29 offset:13312
    s_waitcnt lgkmcnt(4)
    v_mfma_f32_16x16x32_bf16 v[96:99], v[160:163], v[184:187], v[96:99]
    v_mfma_f32_16x16x32_bf16 v[136:139], v[160:163], v[188:191], v[136:139]
    ds_read_b128 v[160:163], v29 offset:14336
    v_mfma_f32_16x16x32_bf16 v[100:103], v[164:167], v[184:187], v[100:103]
    v_mfma_f32_16x16x32_bf16 v[140:143], v[164:167], v[188:191], v[140:143]
    ds_read_b128 v[164:167], v29 offset:15360
    s_waitcnt lgkmcnt(4)
    v_mfma_f32_16x16x32_bf16 v[104:107], v[168:171], v[184:187], v[104:107]
    buffer_load_dwordx4 a[152:155], v35, s[32:35], s90 offen offset:2048 sc1
    v_mfma_f32_16x16x32_bf16 v[144:147], v[168:171], v[188:191], v[144:147]
    ds_read_b128 v[168:171], v29 offset:16384
    v_mfma_f32_16x16x32_bf16 v[108:111], v[172:175], v[184:187], v[108:111]
    v_mfma_f32_16x16x32_bf16 v[148:151], v[172:175], v[188:191], v[148:151]
    ds_read_b128 v[172:175], v29 offset:17408
    s_waitcnt lgkmcnt(4)
    v_mfma_f32_16x16x32_bf16 v[112:115], v[176:179], v[184:187], v[112:115]
    s_waitcnt vmcnt(6)
    ds_read_b64 v[36:37], v124 offset:0
    v_mfma_f32_16x16x32_bf16 v[152:155], v[176:179], v[188:191], v[152:155]
    ds_read_b128 v[176:179], v29 offset:18432
    ds_read_b64 v[38:39], v124 offset:128
    v_mfma_f32_16x16x32_bf16 v[116:119], v[180:183], v[184:187], v[116:119]
    buffer_load_dwordx4 a[156:159], v35, s[32:35], s90 offen offset:3072 sc1
    ds_read_b64 v[40:41], v124 offset:256
    v_mfma_f32_16x16x32_bf16 v[156:159], v[180:183], v[188:191], v[156:159]
    ds_read_b128 v[180:183], v29 offset:19456
    s_waitcnt lgkmcnt(7)
    v_mfma_f32_16x16x32_bf16 v[92:95], v[160:163], v[192:195], v[92:95]
    ds_read_b64 v[42:43], v124 offset:384
    ds_read_b64 v[44:45], v124 offset:512
    v_mfma_f32_16x16x32_bf16 v[132:135], v[160:163], v[196:199], v[132:135]
    ds_read_b128 v[160:163], v29 offset:20480
    ds_read_b64 v[46:47], v124 offset:640
    v_mfma_f32_16x16x32_bf16 v[96:99], v[164:167], v[192:195], v[96:99]
    ds_read_b64 v[48:49], v124 offset:768
    v_mfma_f32_16x16x32_bf16 v[136:139], v[164:167], v[196:199], v[136:139]
    ds_read_b128 v[164:167], v29 offset:21504
    s_waitcnt lgkmcnt(11)
    v_mfma_f32_16x16x32_bf16 v[100:103], v[168:171], v[192:195], v[100:103]
    s_add_u32 s90, s90, 4096
    buffer_load_dwordx4 a[160:163], v35, s[32:35], s90 offen offset:0 sc1
    v_mfma_f32_16x16x32_bf16 v[140:143], v[168:171], v[196:199], v[140:143]
    ds_read_b128 v[168:171], v29 offset:22528
    v_mfma_f32_16x16x32_bf16 v[104:107], v[172:175], v[192:195], v[104:107]
    v_mfma_f32_16x16x32_bf16 v[144:147], v[172:175], v[196:199], v[144:147]
    ds_read_b128 v[172:175], v29 offset:23552
    s_waitcnt lgkmcnt(8)
    v_mfma_f32_16x16x32_bf16 v[108:111], v[176:179], v[192:195], v[108:111]
    v_mfma_f32_16x16x32_bf16 v[148:151], v[176:179], v[196:199], v[148:151]
    ds_read_b128 v[176:179], v29 offset:24576
    v_mfma_f32_16x16x32_bf16 v[112:115], v[180:183], v[192:195], v[112:115]
    buffer_load_dwordx4 a[164:167], v35, s[32:35], s90 offen offset:1024 sc1
    v_mfma_f32_16x16x32_bf16 v[152:155], v[180:183], v[196:199], v[152:155]
    ds_read_b128 v[180:183], v29 offset:25600
    s_waitcnt lgkmcnt(4)
    v_mfma_f32_16x16x32_bf16 v[116:119], v[160:163], v[192:195], v[116:119]
    v_mfma_f32_16x16x32_bf16 v[156:159], v[160:163], v[196:199], v[156:159]
    ds_read_b128 v[160:163], v29 offset:26624
    v_mfma_f32_16x16x32_bf16 v[92:95], v[164:167], v[200:203], v[92:95]
    v_mfma_f32_16x16x32_bf16 v[132:135], v[164:167], v[204:207], v[132:135]
    ds_read_b128 v[164:167], v29 offset:27648
    s_waitcnt lgkmcnt(4)
    v_mfma_f32_16x16x32_bf16 v[96:99], v[168:171], v[200:203], v[96:99]
    buffer_load_dwordx4 a[168:171], v35, s[32:35], s90 offen offset:2048 sc1
    v_mfma_f32_16x16x32_bf16 v[136:139], v[168:171], v[204:207], v[136:139]
    v_mfma_f32_16x16x32_bf16 v[100:103], v[172:175], v[200:203], v[100:103]
    v_mfma_f32_16x16x32_bf16 v[140:143], v[172:175], v[204:207], v[140:143]
    s_waitcnt lgkmcnt(2)
    v_mfma_f32_16x16x32_bf16 v[104:107], v[176:179], v[200:203], v[104:107]
    v_mfma_f32_16x16x32_bf16 v[144:147], v[176:179], v[204:207], v[144:147]
    v_mfma_f32_16x16x32_bf16 v[108:111], v[180:183], v[200:203], v[108:111]
    buffer_load_dwordx4 a[172:175], v35, s[32:35], s90 offen offset:3072 sc1
    v_mfma_f32_16x16x32_bf16 v[148:151], v[180:183], v[204:207], v[148:151]
    s_waitcnt lgkmcnt(0)
    v_mfma_f32_16x16x32_bf16 v[112:115], v[160:163], v[200:203], v[112:115]
    v_mfma_f32_16x16x32_bf16 v[152:155], v[160:163], v[204:207], v[152:155]
    v_mfma_f32_16x16x32_bf16 v[116:119], v[164:167], v[200:203], v[116:119]
    v_mfma_f32_16x16x32_bf16 v[156:159], v[164:167], v[204:207], v[156:159]
    v_mfma_f32_16x16x16_bf16 v[92:95], v[36:37], v[52:53], v[92:95]
    v_mfma_f32_16x16x16_bf16 v[96:99], v[38:39], v[52:53], v[96:99]
    v_mfma_f32_16x16x16_bf16 v[100:103], v[40:41], v[52:53], v[100:103]
    v_mfma_f32_16x16x16_bf16 v[104:107], v[42:43], v[52:53], v[104:107]
    v_mfma_f32_16x16x16_bf16 v[108:111], v[44:45], v[52:53], v[108:111]
    v_mfma_f32_16x16x16_bf16 v[112:115], v[46:47], v[52:53], v[112:115]
    v_mfma_f32_16x16x16_bf16 v[116:119], v[48:49], v[52:53], v[116:119]
    v_mfma_f32_16x16x16_bf16 v[132:135], v[36:37], v[50:51], v[132:135]
    v_mfma_f32_16x16x16_bf16 v[136:139], v[38:39], v[50:51], v[136:139]
    v_mfma_f32_16x16x16_bf16 v[140:143], v[40:41], v[50:51], v[140:143]
    v_mfma_f32_16x16x16_bf16 v[144:147], v[42:43], v[50:51], v[144:147]
    v_mfma_f32_16x16x16_bf16 v[148:151], v[44:45], v[50:51], v[148:151]
    v_mfma_f32_16x16x16_bf16 v[152:155], v[46:47], v[50:51], v[152:155]
    v_mfma_f32_16x16x16_bf16 v[156:159], v[48:49], v[50:51], v[156:159]
    v_mov_b32 v208, 0x3f317218
    v_mov_b32 v210, 0xbfb17218
    s_add_u32 s64, s79, 0
    s_add_u32 s65, s80, 0
    v_pk_mul_f32 v[132:133], v[132:133], v[54:55] op_sel:[0,0] op_sel_hi:[1,0]
    v_pk_mul_f32 v[134:135], v[134:135], v[54:55] op_sel:[0,0] op_sel_hi:[1,0]
    v_pk_mul_f32 v[136:137], v[136:137], v[54:55] op_sel:[0,0] op_sel_hi:[1,0]
    v_pk_mul_f32 v[138:139], v[138:139], v[54:55] op_sel:[0,0] op_sel_hi:[1,0]
    v_exp_f32 v192, v132
    v_exp_f32 v193, v133
    v_exp_f32 v194, v134
    s_add_u32 s90, s90, 4096
    buffer_load_dwordx4 a[176:179], v35, s[32:35], s90 offen offset:0 sc1
    v_exp_f32 v195, v135
    v_exp_f32 v196, v136
    v_exp_f32 v197, v137
    v_exp_f32 v198, v138
    v_exp_f32 v199, v139
    v_pk_add_f32 v[192:193], v[192:193], 1.0 op_sel_hi:[1,0]
    v_pk_add_f32 v[194:195], v[194:195], 1.0 op_sel_hi:[1,0]
    buffer_load_dwordx4 a[180:183], v35, s[32:35], s90 offen offset:1024 sc1
    v_pk_add_f32 v[196:197], v[196:197], 1.0 op_sel_hi:[1,0]
    v_pk_add_f32 v[198:199], v[198:199], 1.0 op_sel_hi:[1,0]
    v_pk_fma_f32 v[192:193], v[192:193], v[192:193], 1.0 op_sel_hi:[1,1,0]
    v_pk_fma_f32 v[194:195], v[194:195], v[194:195], 1.0 op_sel_hi:[1,1,0]
    v_pk_fma_f32 v[196:197], v[196:197], v[196:197], 1.0 op_sel_hi:[1,1,0]
    v_pk_fma_f32 v[198:199], v[198:199], v[198:199], 1.0 op_sel_hi:[1,1,0]
    v_rcp_f32 v192, v192
    buffer_load_dwordx4 a[184:187], v35, s[32:35], s90 offen offset:2048 sc1
    v_rcp_f32 v193, v193
    v_rcp_f32 v194, v194
    v_rcp_f32 v195, v195
    v_rcp_f32 v196, v196
    v_rcp_f32 v197, v197
    v_rcp_f32 v198, v198
    v_rcp_f32 v199, v199
    buffer_load_dwordx4 a[188:191], v35, s[32:35], s90 offen offset:3072 sc1
    v_pk_fma_f32 v[192:193], v[192:193], v[210:211], v[208:209] op_sel_hi:[1,0,0]
    v_pk_fma_f32 v[194:195], v[194:195], v[210:211], v[208:209] op_sel_hi:[1,0,0]
    v_pk_fma_f32 v[196:197], v[196:197], v[210:211], v[208:209] op_sel_hi:[1,0,0]
    v_pk_fma_f32 v[198:199], v[198:199], v[210:211], v[208:209] op_sel_hi:[1,0,0]
    v_pk_mul_f32 v[132:133], v[132:133], v[192:193]
    v_pk_mul_f32 v[134:135], v[134:135], v[194:195]
    v_pk_mul_f32 v[136:137], v[136:137], v[196:197]
    s_add_u32 s90, s90, 4096
    buffer_load_dwordx4 a[192:195], v35, s[32:35], s90 offen offset:0 sc1
    v_pk_mul_f32 v[138:139], v[138:139], v[198:199]
    v_cvt_pk_bf16_f32 v200, v132, v133
    v_cvt_pk_bf16_f32 v201, v134, v135
    v_cvt_pk_bf16_f32 v202, v136, v137
    v_cvt_pk_bf16_f32 v203, v138, v139
    buffer_store_dwordx4 v[200:203], v1, s[32:35], s64 offen offset:0 sc1
    v_pk_mul_f32 v[140:141], v[140:141], v[54:55] op_sel:[0,0] op_sel_hi:[1,0]
    v_pk_mul_f32 v[142:143], v[142:143], v[54:55] op_sel:[0,0] op_sel_hi:[1,0]
    v_pk_mul_f32 v[144:145], v[144:145], v[54:55] op_sel:[0,0] op_sel_hi:[1,0]
    v_pk_mul_f32 v[146:147], v[146:147], v[54:55] op_sel:[0,0] op_sel_hi:[1,0]
    v_exp_f32 v192, v140
    v_exp_f32 v193, v141
    buffer_load_dwordx4 a[196:199], v35, s[32:35], s90 offen offset:1024 sc1
    v_exp_f32 v194, v142
    v_exp_f32 v195, v143
    v_exp_f32 v196, v144
    v_exp_f32 v197, v145
    v_exp_f32 v198, v146
    v_exp_f32 v199, v147
    v_pk_add_f32 v[192:193], v[192:193], 1.0 op_sel_hi:[1,0]
    buffer_load_dwordx4 a[200:203], v35, s[32:35], s90 offen offset:2048 sc1
    v_pk_add_f32 v[194:195], v[194:195], 1.0 op_sel_hi:[1,0]
    v_pk_add_f32 v[196:197], v[196:197], 1.0 op_sel_hi:[1,0]
    v_pk_add_f32 v[198:199], v[198:199], 1.0 op_sel_hi:[1,0]
    v_pk_fma_f32 v[192:193], v[192:193], v[192:193], 1.0 op_sel_hi:[1,1,0]
    v_pk_fma_f32 v[194:195], v[194:195], v[194:195], 1.0 op_sel_hi:[1,1,0]
    v_pk_fma_f32 v[196:197], v[196:197], v[196:197], 1.0 op_sel_hi:[1,1,0]
    v_pk_fma_f32 v[198:199], v[198:199], v[198:199], 1.0 op_sel_hi:[1,1,0]
    buffer_load_dwordx4 a[204:207], v35, s[32:35], s90 offen offset:3072 sc1
    v_rcp_f32 v192, v192
    v_rcp_f32 v193, v193
    v_rcp_f32 v194, v194
    v_rcp_f32 v195, v195
    v_rcp_f32 v196, v196
    v_rcp_f32 v197, v197
    v_rcp_f32 v198, v198
    s_add_u32 s90, s90, 4096
    buffer_load_dwordx4 a[208:211], v35, s[32:35], s90 offen offset:0 sc1
    v_rcp_f32 v199, v199
    v_pk_fma_f32 v[192:193], v[192:193], v[210:211], v[208:209] op_sel_hi:[1,0,0]
    v_pk_fma_f32 v[194:195], v[194:195], v[210:211], v[208:209] op_sel_hi:[1,0,0]
    v_pk_fma_f32 v[196:197], v[196:197], v[210:211], v[208:209] op_sel_hi:[1,0,0]
    v_pk_fma_f32 v[198:199], v[198:199], v[210:211], v[208:209] op_sel_hi:[1,0,0]
    v_pk_mul_f32 v[140:141], v[140:141], v[192:193]
    v_pk_mul_f32 v[142:143], v[142:143], v[194:195]
    buffer_load_dwordx4 a[212:215], v35, s[32:35], s90 offen offset:1024 sc1
    v_pk_mul_f32 v[144:145], v[144:145], v[196:197]
    v_pk_mul_f32 v[146:147], v[146:147], v[198:199]
    v_cvt_pk_bf16_f32 v204, v140, v141
    v_cvt_pk_bf16_f32 v205, v142, v143
    v_cvt_pk_bf16_f32 v206, v144, v145
    v_cvt_pk_bf16_f32 v207, v146, v147
    buffer_store_dwordx4 v[204:207], v1, s[32:35], s64 offen offset:1024 sc1
    v_pk_mul_f32 v[148:149], v[148:149], v[54:55] op_sel:[0,0] op_sel_hi:[1,0]
    v_pk_mul_f32 v[150:151], v[150:151], v[54:55] op_sel:[0,0] op_sel_hi:[1,0]
    v_pk_mul_f32 v[152:153], v[152:153], v[54:55] op_sel:[0,0] op_sel_hi:[1,0]
    v_pk_mul_f32 v[154:155], v[154:155], v[54:55] op_sel:[0,0] op_sel_hi:[1,0]
    v_exp_f32 v192, v148
    buffer_load_dwordx4 a[216:219], v35, s[32:35], s90 offen offset:2048 sc1
    v_exp_f32 v193, v149
    v_exp_f32 v194, v150
    v_exp_f32 v195, v151
    v_exp_f32 v196, v152
    v_exp_f32 v197, v153
    v_exp_f32 v198, v154
    v_exp_f32 v199, v155
    buffer_load_dwordx4 a[220:223], v35, s[32:35], s90 offen offset:3072 sc1
    v_pk_add_f32 v[192:193], v[192:193], 1.0 op_sel_hi:[1,0]
    v_pk_add_f32 v[194:195], v[194:195], 1.0 op_sel_hi:[1,0]
    v_pk_add_f32 v[196:197], v[196:197], 1.0 op_sel_hi:[1,0]
    v_pk_add_f32 v[198:199], v[198:199], 1.0 op_sel_hi:[1,0]
    v_pk_fma_f32 v[192:193], v[192:193], v[192:193], 1.0 op_sel_hi:[1,1,0]
    v_pk_fma_f32 v[194:195], v[194:195], v[194:195], 1.0 op_sel_hi:[1,1,0]
    v_pk_fma_f32 v[196:197], v[196:197], v[196:197], 1.0 op_sel_hi:[1,1,0]
    s_add_u32 s90, s90, 4096
    buffer_load_dwordx4 a[224:227], v35, s[32:35], s90 offen offset:0 sc1
    v_pk_fma_f32 v[198:199], v[198:199], v[198:199], 1.0 op_sel_hi:[1,1,0]
    v_rcp_f32 v192, v192
    v_rcp_f32 v193, v193
    v_rcp_f32 v194, v194
    v_rcp_f32 v195, v195
    v_rcp_f32 v196, v196
    v_rcp_f32 v197, v197
    buffer_load_dwordx4 a[228:231], v35, s[32:35], s90 offen offset:1024 sc1
    v_rcp_f32 v198, v198
    v_rcp_f32 v199, v199
    v_pk_fma_f32 v[192:193], v[192:193], v[210:211], v[208:209] op_sel_hi:[1,0,0]
    v_pk_fma_f32 v[194:195], v[194:195], v[210:211], v[208:209] op_sel_hi:[1,0,0]
    v_pk_fma_f32 v[196:197], v[196:197], v[210:211], v[208:209] op_sel_hi:[1,0,0]
    v_pk_fma_f32 v[198:199], v[198:199], v[210:211], v[208:209] op_sel_hi:[1,0,0]
    v_pk_mul_f32 v[148:149], v[148:149], v[192:193]
    buffer_load_dwordx4 a[232:235], v35, s[32:35], s90 offen offset:2048 sc1
    v_pk_mul_f32 v[150:151], v[150:151], v[194:195]
    v_pk_mul_f32 v[152:153], v[152:153], v[196:197]
    v_pk_mul_f32 v[154:155], v[154:155], v[198:199]
    v_cvt_pk_bf16_f32 v200, v148, v149
    v_cvt_pk_bf16_f32 v201, v150, v151
    v_cvt_pk_bf16_f32 v202, v152, v153
    v_cvt_pk_bf16_f32 v203, v154, v155
    buffer_store_dwordx4 v[200:203], v1, s[32:35], s64 offen offset:2048 sc1
    v_pk_mul_f32 v[156:157], v[156:157], v[54:55] op_sel:[0,0] op_sel_hi:[1,0]
    v_pk_mul_f32 v[158:159], v[158:159], v[54:55] op_sel:[0,0] op_sel_hi:[1,0]
    v_exp_f32 v192, v156
    v_exp_f32 v193, v157
    buffer_load_dwordx4 a[236:239], v35, s[32:35], s90 offen offset:3072 sc1
    v_exp_f32 v194, v158
    v_exp_f32 v195, v159
    v_pk_add_f32 v[192:193], v[192:193], 1.0 op_sel_hi:[1,0]
    v_pk_add_f32 v[194:195], v[194:195], 1.0 op_sel_hi:[1,0]
    v_pk_fma_f32 v[192:193], v[192:193], v[192:193], 1.0 op_sel_hi:[1,1,0]
    v_pk_fma_f32 v[194:195], v[194:195], v[194:195], 1.0 op_sel_hi:[1,1,0]
    v_rcp_f32 v192, v192
    v_rcp_f32 v193, v193
    v_rcp_f32 v194, v194
    v_rcp_f32 v195, v195
    v_pk_fma_f32 v[192:193], v[192:193], v[210:211], v[208:209] op_sel_hi:[1,0,0]
    v_pk_fma_f32 v[194:195], v[194:195], v[210:211], v[208:209] op_sel_hi:[1,0,0]
    v_pk_mul_f32 v[156:157], v[156:157], v[192:193]
    v_pk_mul_f32 v[158:159], v[158:159], v[194:195]
    v_cvt_pk_bf16_f32 v204, v156, v157
    v_cvt_pk_bf16_f32 v205, v158, v159
    s_cmp_ge_u32 s58, 12
    s_cselect_b32 s80, 0x70000000, s80
    s_cselect_b32 s65, 0x70000000, s65
    buffer_store_dwordx2 v[204:205], v4, s[32:35], s65 offen sc1
    s_add_u32 s68, s85, 0
    v_bfe_u32 v121, v0, 1, 2
    v_lshlrev_b32 v121, 4, v121
    v_and_b32 v120, 1, v0
    v_lshl_add_u32 v121, v120, 2, v121
    s_add_u32 s67, s84, 0
    v_mov_b32 v208, 0x3f317218
    v_mov_b32 v210, 0xbfb17218
    s_add_u32 s64, s79, 110592
    s_add_u32 s65, s80, 110592
    v_pk_mul_f32 v[92:93], v[92:93], v[54:55] op_sel:[0,1] op_sel_hi:[1,1]
    v_pk_mul_f32 v[94:95], v[94:95], v[54:55] op_sel:[0,1] op_sel_hi:[1,1]
    v_pk_mul_f32 v[96:97], v[96:97], v[54:55] op_sel:[0,1] op_sel_hi:[1,1]
    v_pk_mul_f32 v[98:99], v[98:99], v[54:55] op_sel:[0,1] op_sel_hi:[1,1]
    v_exp_f32 v192, v92
    v_exp_f32 v193, v93
    v_exp_f32 v194, v94
    v_exp_f32 v195, v95
    v_exp_f32 v196, v96
    v_exp_f32 v197, v97
    v_exp_f32 v198, v98
    v_exp_f32 v199, v99
    v_mov_b32 v124, s59
    v_mov_b32 v125, 0
    s_waitcnt vmcnt(0)
    buffer_store_dword v124, v125, s[32:35], s68 offen offset:0
    v_pk_add_f32 v[192:193], v[192:193], 1.0 op_sel_hi:[1,0]
    v_pk_add_f32 v[194:195], v[194:195], 1.0 op_sel_hi:[1,0]
    v_pk_add_f32 v[196:197], v[196:197], 1.0 op_sel_hi:[1,0]
    v_pk_add_f32 v[198:199], v[198:199], 1.0 op_sel_hi:[1,0]
    v_pk_fma_f32 v[192:193], v[192:193], v[192:193], 1.0 op_sel_hi:[1,1,0]
    v_pk_fma_f32 v[194:195], v[194:195], v[194:195], 1.0 op_sel_hi:[1,1,0]
    v_pk_fma_f32 v[196:197], v[196:197], v[196:197], 1.0 op_sel_hi:[1,1,0]
    v_pk_fma_f32 v[198:199], v[198:199], v[198:199], 1.0 op_sel_hi:[1,1,0]
    v_rcp_f32 v192, v192
    v_rcp_f32 v193, v193
    v_rcp_f32 v194, v194
    v_rcp_f32 v195, v195
    v_rcp_f32 v196, v196
    buffer_load_dwordx4 a[240:243], v35, s[32:35], s91 offen offset:0 sc1
    v_rcp_f32 v197, v197
    v_rcp_f32 v198, v198
    v_rcp_f32 v199, v199
    v_pk_fma_f32 v[192:193], v[192:193], v[210:211], v[208:209] op_sel_hi:[1,0,0]
    v_pk_fma_f32 v[194:195], v[194:195], v[210:211], v[208:209] op_sel_hi:[1,0,0]
    buffer_load_dwordx4 a[244:247], v35, s[32:35], s91 offen offset:1024 sc1
    v_pk_fma_f32 v[196:197], v[196:197], v[210:211], v[208:209] op_sel_hi:[1,0,0]
    v_pk_fma_f32 v[198:199], v[198:199], v[210:211], v[208:209] op_sel_hi:[1,0,0]
    v_pk_mul_f32 v[92:93], v[92:93], v[192:193]
    v_pk_mul_f32 v[94:95], v[94:95], v[194:195]
    v_pk_mul_f32 v[96:97], v[96:97], v[196:197]
    buffer_load_dwordx4 a[248:251], v35, s[32:35], s91 offen offset:2048 sc1
    v_pk_mul_f32 v[98:99], v[98:99], v[198:199]
    v_cvt_pk_bf16_f32 v200, v92, v93
    v_cvt_pk_bf16_f32 v201, v94, v95
    v_cvt_pk_bf16_f32 v202, v96, v97
    v_cvt_pk_bf16_f32 v203, v98, v99
    buffer_store_dwordx4 v[200:203], v1, s[32:35], s64 offen offset:0 sc1
    v_pk_mul_f32 v[100:101], v[100:101], v[54:55] op_sel:[0,1] op_sel_hi:[1,1]
    v_pk_mul_f32 v[102:103], v[102:103], v[54:55] op_sel:[0,1] op_sel_hi:[1,1]
    v_pk_mul_f32 v[104:105], v[104:105], v[54:55] op_sel:[0,1] op_sel_hi:[1,1]
    v_pk_mul_f32 v[106:107], v[106:107], v[54:55] op_sel:[0,1] op_sel_hi:[1,1]
    buffer_load_dwordx4 a[252:255], v35, s[32:35], s91 offen offset:3072 sc1
    v_exp_f32 v192, v100
    v_exp_f32 v193, v101
    v_exp_f32 v194, v102
    v_exp_f32 v195, v103
    v_exp_f32 v196, v104
    s_add_u32 s91, s91, 4096
    buffer_load_dwordx4 v[232:235], v35, s[32:35], s91 offen offset:0 sc1
    v_exp_f32 v197, v105
    v_exp_f32 v198, v106
    v_exp_f32 v199, v107
    v_pk_add_f32 v[192:193], v[192:193], 1.0 op_sel_hi:[1,0]
    v_pk_add_f32 v[194:195], v[194:195], 1.0 op_sel_hi:[1,0]
    buffer_load_dwordx4 v[236:239], v35, s[32:35], s91 offen offset:1024 sc1
    v_pk_add_f32 v[196:197], v[196:197], 1.0 op_sel_hi:[1,0]
    v_pk_add_f32 v[198:199], v[198:199], 1.0 op_sel_hi:[1,0]
    v_pk_fma_f32 v[192:193], v[192:193], v[192:193], 1.0 op_sel_hi:[1,1,0]
    v_pk_fma_f32 v[194:195], v[194:195], v[194:195], 1.0 op_sel_hi:[1,1,0]
    v_pk_fma_f32 v[196:197], v[196:197], v[196:197], 1.0 op_sel_hi:[1,1,0]
    buffer_load_dwordx4 v[240:243], v35, s[32:35], s91 offen offset:2048 sc1
    v_pk_fma_f32 v[198:199], v[198:199], v[198:199], 1.0 op_sel_hi:[1,1,0]
    v_rcp_f32 v192, v192
    v_rcp_f32 v193, v193
    v_rcp_f32 v194, v194
    v_rcp_f32 v195, v195
    buffer_load_dwordx4 v[244:247], v35, s[32:35], s91 offen offset:3072 sc1
    v_rcp_f32 v196, v196
    v_rcp_f32 v197, v197
    v_rcp_f32 v198, v198
    v_rcp_f32 v199, v199
    v_pk_fma_f32 v[192:193], v[192:193], v[210:211], v[208:209] op_sel_hi:[1,0,0]
    s_add_u32 s91, s91, 4096
    buffer_load_dwordx4 v[248:251], v35, s[32:35], s91 offen offset:0 sc1
    v_pk_fma_f32 v[194:195], v[194:195], v[210:211], v[208:209] op_sel_hi:[1,0,0]
    v_pk_fma_f32 v[196:197], v[196:197], v[210:211], v[208:209] op_sel_hi:[1,0,0]
    v_pk_fma_f32 v[198:199], v[198:199], v[210:211], v[208:209] op_sel_hi:[1,0,0]
    v_pk_mul_f32 v[100:101], v[100:101], v[192:193]
    v_pk_mul_f32 v[102:103], v[102:103], v[194:195]
    buffer_load_dwordx4 v[252:255], v35, s[32:35], s91 offen offset:1024 sc1
    v_pk_mul_f32 v[104:105], v[104:105], v[196:197]
    v_pk_mul_f32 v[106:107], v[106:107], v[198:199]
    v_cvt_pk_bf16_f32 v204, v100, v101
    v_cvt_pk_bf16_f32 v205, v102, v103
    v_cvt_pk_bf16_f32 v206, v104, v105
    v_cvt_pk_bf16_f32 v207, v106, v107
    buffer_store_dwordx4 v[204:207], v1, s[32:35], s64 offen offset:1024 sc1
    buffer_load_dword v120, v121, s[32:35], s67 offen sc1
    v_pk_mul_f32 v[108:109], v[108:109], v[54:55] op_sel:[0,1] op_sel_hi:[1,1]
    v_pk_mul_f32 v[110:111], v[110:111], v[54:55] op_sel:[0,1] op_sel_hi:[1,1]
    v_pk_mul_f32 v[112:113], v[112:113], v[54:55] op_sel:[0,1] op_sel_hi:[1,1]
    v_pk_mul_f32 v[114:115], v[114:115], v[54:55] op_sel:[0,1] op_sel_hi:[1,1]
    v_exp_f32 v192, v108
    v_exp_f32 v193, v109
    v_exp_f32 v194, v110
    v_exp_f32 v195, v111
    v_exp_f32 v196, v112
    v_exp_f32 v197, v113
    v_exp_f32 v198, v114
    v_exp_f32 v199, v115
    v_pk_add_f32 v[192:193], v[192:193], 1.0 op_sel_hi:[1,0]
    v_pk_add_f32 v[194:195], v[194:195], 1.0 op_sel_hi:[1,0]
    v_pk_add_f32 v[196:197], v[196:197], 1.0 op_sel_hi:[1,0]
    v_pk_add_f32 v[198:199], v[198:199], 1.0 op_sel_hi:[1,0]
    v_pk_fma_f32 v[192:193], v[192:193], v[192:193], 1.0 op_sel_hi:[1,1,0]
    v_pk_fma_f32 v[194:195], v[194:195], v[194:195], 1.0 op_sel_hi:[1,1,0]
    v_pk_fma_f32 v[196:197], v[196:197], v[196:197], 1.0 op_sel_hi:[1,1,0]
    v_pk_fma_f32 v[198:199], v[198:199], v[198:199], 1.0 op_sel_hi:[1,1,0]
    v_rcp_f32 v192, v192
    v_rcp_f32 v193, v193
    v_rcp_f32 v194, v194
    v_rcp_f32 v195, v195
    v_rcp_f32 v196, v196
    v_rcp_f32 v197, v197
    v_rcp_f32 v198, v198
    v_rcp_f32 v199, v199
    v_pk_fma_f32 v[192:193], v[192:193], v[210:211], v[208:209] op_sel_hi:[1,0,0]
    v_pk_fma_f32 v[194:195], v[194:195], v[210:211], v[208:209] op_sel_hi:[1,0,0]
    v_pk_fma_f32 v[196:197], v[196:197], v[210:211], v[208:209] op_sel_hi:[1,0,0]
    v_pk_fma_f32 v[198:199], v[198:199], v[210:211], v[208:209] op_sel_hi:[1,0,0]
    v_pk_mul_f32 v[108:109], v[108:109], v[192:193]
    v_pk_mul_f32 v[110:111], v[110:111], v[194:195]
    v_pk_mul_f32 v[112:113], v[112:113], v[196:197]
    v_pk_mul_f32 v[114:115], v[114:115], v[198:199]
    v_cvt_pk_bf16_f32 v200, v108, v109
    v_cvt_pk_bf16_f32 v201, v110, v111
    v_cvt_pk_bf16_f32 v202, v112, v113
    v_cvt_pk_bf16_f32 v203, v114, v115
    buffer_store_dwordx4 v[200:203], v1, s[32:35], s64 offen offset:2048 sc1
    s_waitcnt vmcnt(1)
    v_cmp_ne_u32 vcc, s59, v120
    s_cbranch_vccnz SPIN_52
BACK_53:
    v_pk_mul_f32 v[116:117], v[116:117], v[54:55] op_sel:[0,1] op_sel_hi:[1,1]
    v_pk_mul_f32 v[118:119], v[118:119], v[54:55] op_sel:[0,1] op_sel_hi:[1,1]
    v_exp_f32 v192, v116
    s_add_u32 s95, s96, 0
    buffer_load_dwordx4 v[132:135], v1, s[32:35], s95 offen offset:0 sc1
    v_exp_f32 v193, v117
    v_exp_f32 v194, v118
    v_exp_f32 v195, v119
    buffer_load_dwordx4 v[136:139], v1, s[32:35], s95 offen offset:1024 sc1
    v_pk_add_f32 v[192:193], v[192:193], 1.0 op_sel_hi:[1,0]
    v_pk_add_f32 v[194:195], v[194:195], 1.0 op_sel_hi:[1,0]
    v_pk_fma_f32 v[192:193], v[192:193], v[192:193], 1.0 op_sel_hi:[1,1,0]
    buffer_load_dwordx4 v[140:143], v1, s[32:35], s95 offen offset:2048 sc1
    v_pk_fma_f32 v[194:195], v[194:195], v[194:195], 1.0 op_sel_hi:[1,1,0]
    v_rcp_f32 v192, v192
    v_rcp_f32 v193, v193
    buffer_load_dwordx4 v[144:147], v1, s[32:35], s95 offen offset:3072 sc1
    v_rcp_f32 v194, v194
    v_rcp_f32 v195, v195
    v_pk_fma_f32 v[192:193], v[192:193], v[210:211], v[208:209] op_sel_hi:[1,0,0]
    s_add_u32 s95, s95, 4096
    buffer_load_dwordx4 v[148:151], v1, s[32:35], s95 offen offset:0 sc1
    v_pk_fma_f32 v[194:195], v[194:195], v[210:211], v[208:209] op_sel_hi:[1,0,0]
    v_pk_mul_f32 v[116:117], v[116:117], v[192:193]
    v_pk_mul_f32 v[118:119], v[118:119], v[194:195]
    buffer_load_dwordx4 v[152:155], v1, s[32:35], s95 offen offset:1024 sc1
    v_cvt_pk_bf16_f32 v204, v116, v117
    v_cvt_pk_bf16_f32 v205, v118, v119
    buffer_store_dwordx2 v[204:205], v4, s[32:35], s65 offen sc1
    s_waitcnt vmcnt(6)
    v_mfma_f32_16x16x32_bf16 v[192:195], a[0:3], v[132:135], 0
    buffer_load_dwordx4 v[156:159], v1, s[32:35], s95 offen offset:2048 sc1
    v_mfma_f32_16x16x32_bf16 v[196:199], a[4:7], v[132:135], 0
    v_mfma_f32_16x16x32_bf16 v[200:203], a[8:11], v[132:135], 0
    v_mfma_f32_16x16x32_bf16 v[204:207], a[12:15], v[132:135], 0
    buffer_load_dwordx4 v[160:163], v1, s[32:35], s95 offen offset:3072 sc1
    v_mfma_f32_16x16x32_bf16 v[208:211], a[16:19], v[132:135], 0
    s_add_u32 s95, s95, 4096
    buffer_load_dwordx4 v[164:167], v1, s[32:35], s95 offen offset:0 sc1
    s_waitcnt vmcnt(8)
    v_mfma_f32_16x16x32_bf16 v[192:195], a[20:23], v[136:139], v[192:195]
    v_mfma_f32_16x16x32_bf16 v[196:199], a[24:27], v[136:139], v[196:199]
    buffer_load_dwordx4 v[168:171], v1, s[32:35], s95 offen offset:1024 sc1
    v_mfma_f32_16x16x32_bf16 v[200:203], a[28:31], v[136:139], v[200:203]
    v_mfma_f32_16x16x32_bf16 v[204:207], a[32:35], v[136:139], v[204:207]
    v_mfma_f32_16x16x32_bf16 v[208:211], a[36:39], v[136:139], v[208:211]
    buffer_load_dwordx4 v[172:175], v1, s[32:35], s95 offen offset:2048 sc1
    s_waitcnt vmcnt(9)
    v_mfma_f32_16x16x32_bf16 v[192:195], a[40:43], v[140:143], v[192:195]
    v_mfma_f32_16x16x32_bf16 v[196:199], a[44:47], v[140:143], v[196:199]
    s_add_u32 s68, s85, 4096
    v_mov_b32 v32, s59
    v_mfma_f32_16x16x32_bf16 v[200:203], a[48:51], v[140:143], v[200:203]
    buffer_load_dwordx4 v[176:179], v1, s[32:35], s95 offen offset:3072 sc1
    v_mov_b32 v33, 0
    v_mfma_f32_16x16x32_bf16 v[204:207], a[52:55], v[140:143], v[204:207]
    s_waitcnt vmcnt(6)
    buffer_store_dword v32, v33, s[32:35], s68 offen offset:0
    v_mfma_f32_16x16x32_bf16 v[208:211], a[56:59], v[140:143], v[208:211]
    s_add_u32 s95, s95, s94
    buffer_load_dwordx2 v[180:181], v4, s[32:35], s95 offen offset:0 sc1
    buffer_load_dwordx2 v[182:183], v4, s[32:35], s95 offen offset:512 sc1
    v_mfma_f32_16x16x32_bf16 v[192:195], a[60:63], v[144:147], v[192:195]
    buffer_load_dwordx2 v[184:185], v4, s[32:35], s95 offen offset:1024 sc1
    buffer_load_dwordx2 v[186:187], v4, s[32:35], s95 offen offset:1536 sc1
    v_mfma_f32_16x16x32_bf16 v[196:199], a[64:67], v[144:147], v[196:199]
    v_bfe_u32 v121, v0, 1, 2
    v_mfma_f32_16x16x32_bf16 v[200:203], a[68:71], v[144:147], v[200:203]
    v_lshlrev_b32 v121, 4, v121
    v_and_b32 v120, 1, v0
    v_mfma_f32_16x16x32_bf16 v[204:207], a[72:75], v[144:147], v[204:207]
    s_add_u32 s99, s81, 0
    buffer_load_dwordx4 v[188:191], v1, s[32:35], s99 offen offset:0 sc1
    v_mfma_f32_16x16x32_bf16 v[208:211], a[76:79], v[144:147], v[208:211]
    buffer_load_dwordx4 v[132:135], v1, s[32:35], s99 offen offset:1024 sc1
    v_lshl_add_u32 v121, v120, 2, v121
    v_mfma_f32_16x16x32_bf16 v[192:195], a[80:83], v[148:151], v[192:195]
    s_add_u32 s67, s84, 4096
    v_mfma_f32_16x16x32_bf16 v[196:199], a[84:87], v[148:151], v[196:199]
    buffer_load_dwordx4 v[136:139], v1, s[32:35], s99 offen offset:2048 sc1
    v_mfma_f32_16x16x32_bf16 v[200:203], a[88:91], v[148:151], v[200:203]
    v_mfma_f32_16x16x32_bf16 v[204:207], a[92:95], v[148:151], v[204:207]
    v_mfma_f32_16x16x32_bf16 v[208:211], a[96:99], v[148:151], v[208:211]
    buffer_load_dwordx4 v[140:143], v1, s[32:35], s99 offen offset:3072 sc1
    v_mfma_f32_16x16x32_bf16 v[192:195], a[100:103], v[152:155], v[192:195]
    v_mfma_f32_16x16x32_bf16 v[196:199], a[104:107], v[152:155], v[196:199]
    v_mfma_f32_16x16x32_bf16 v[200:203], a[108:111], v[152:155], v[200:203]
    s_add_u32 s99, s99, 4096
    buffer_load_dwordx4 v[144:147], v1, s[32:35], s99 offen offset:0 sc1
    v_mfma_f32_16x16x32_bf16 v[204:207], a[112:115], v[152:155], v[204:207]
    v_mfma_f32_16x16x32_bf16 v[208:211], a[116:119], v[152:155], v[208:211]
    buffer_load_dwordx4 v[148:151], v1, s[32:35], s99 offen offset:1024 sc1
    s_waitcnt vmcnt(16)
    v_mfma_f32_16x16x32_bf16 v[192:195], a[120:123], v[156:159], v[192:195]
    buffer_load_dwordx4 v[152:155], v1, s[32:35], s99 offen offset:2048 sc1
    v_mfma_f32_16x16x32_bf16 v[196:199], a[124:127], v[156:159], v[196:199]
    v_mfma_f32_16x16x32_bf16 v[200:203], a[128:131], v[156:159], v[200:203]
    v_mfma_f32_16x16x32_bf16 v[204:207], a[132:135], v[156:159], v[204:207]
    v_mfma_f32_16x16x32_bf16 v[208:211], a[136:139], v[156:159], v[208:211]
    buffer_load_dwordx4 v[156:159], v1, s[32:35], s99 offen offset:3072 sc1
    s_waitcnt vmcnt(17)
    v_mfma_f32_16x16x32_bf16 v[192:195], a[140:143], v[160:163], v[192:195]
    v_mfma_f32_16x16x32_bf16 v[196:199], a[144:147], v[160:163], v[196:199]
    v_mfma_f32_16x16x32_bf16 v[200:203], a[148:151], v[160:163], v[200:203]
    v_mfma_f32_16x16x32_bf16 v[204:207], a[152:155], v[160:163], v[204:207]
    v_mfma_f32_16x16x32_bf16 v[208:211], a[156:159], v[160:163], v[208:211]
    s_add_u32 s99, s99, 4096
    buffer_load_dwordx4 v[160:163], v1, s[32:35], s99 offen offset:0 sc1
    s_waitcnt vmcnt(17)
    v_mfma_f32_16x16x32_bf16 v[192:195], a[160:163], v[164:167], v[192:195]
    v_mfma_f32_16x16x32_bf16 v[196:199], a[164:167], v[164:167], v[196:199]
    v_mfma_f32_16x16x32_bf16 v[200:203], a[168:171], v[164:167], v[200:203]
    v_mfma_f32_16x16x32_bf16 v[204:207], a[172:175], v[164:167], v[204:207]
    v_mfma_f32_16x16x32_bf16 v[208:211], a[176:179], v[164:167], v[208:211]
    buffer_load_dwordx4 v[164:167], v1, s[32:35], s99 offen offset:1024 sc1
    s_waitcnt vmcnt(17)
    v_mfma_f32_16x16x32_bf16 v[192:195], a[180:183], v[168:171], v[192:195]
    v_mfma_f32_16x16x32_bf16 v[196:199], a[184:187], v[168:171], v[196:199]
    v_mfma_f32_16x16x32_bf16 v[200:203], a[188:191], v[168:171], v[200:203]
    v_mfma_f32_16x16x32_bf16 v[204:207], a[192:195], v[168:171], v[204:207]
    v_mfma_f32_16x16x32_bf16 v[208:211], a[196:199], v[168:171], v[208:211]
    buffer_load_dwordx4 v[168:171], v1, s[32:35], s99 offen offset:2048 sc1
    s_waitcnt vmcnt(17)
    v_mfma_f32_16x16x32_bf16 v[192:195], a[200:203], v[172:175], v[192:195]
    v_mfma_f32_16x16x32_bf16 v[196:199], a[204:207], v[172:175], v[196:199]
    v_mfma_f32_16x16x32_bf16 v[200:203], a[208:211], v[172:175], v[200:203]
    v_mfma_f32_16x16x32_bf16 v[204:207], a[212:215], v[172:175], v[204:207]
    v_mfma_f32_16x16x32_bf16 v[208:211], a[216:219], v[172:175], v[208:211]
    buffer_load_dwordx4 v[172:175], v1, s[32:35], s99 offen offset:3072 sc1
    s_waitcnt vmcnt(17)
    v_mfma_f32_16x16x32_bf16 v[192:195], a[220:223], v[176:179], v[192:195]
    v_mfma_f32_16x16x32_bf16 v[196:199], a[224:227], v[176:179], v[196:199]
    v_mfma_f32_16x16x32_bf16 v[200:203], a[228:231], v[176:179], v[200:203]
    v_mfma_f32_16x16x32_bf16 v[204:207], a[232:235], v[176:179], v[204:207]
    v_mfma_f32_16x16x32_bf16 v[208:211], a[236:239], v[176:179], v[208:211]
    s_add_u32 s99, s99, s94
    buffer_load_dwordx2 v[176:177], v4, s[32:35], s99 offen offset:0 sc1
    buffer_load_dwordx2 v[178:179], v4, s[32:35], s99 offen offset:512 sc1
    s_waitcnt vmcnt(16)
    v_mfma_f32_16x16x32_bf16 v[192:195], a[240:243], v[180:183], v[192:195]
    v_mfma_f32_16x16x32_bf16 v[196:199], a[244:247], v[180:183], v[196:199]
    v_mfma_f32_16x16x32_bf16 v[200:203], a[248:251], v[180:183], v[200:203]
    v_mfma_f32_16x16x32_bf16 v[204:207], a[252:255], v[180:183], v[204:207]
    buffer_load_dword v120, v121, s[32:35], s67 offen sc1
    v_mfma_f32_16x16x32_bf16 v[208:211], v[232:235], v[180:183], v[208:211]
    buffer_load_dwordx2 v[180:181], v4, s[32:35], s99 offen offset:1024 sc1
    buffer_load_dwordx2 v[182:183], v4, s[32:35], s99 offen offset:1536 sc1
    s_waitcnt vmcnt(17)
    v_mfma_f32_16x16x32_bf16 v[192:195], v[236:239], v[184:187], v[192:195]
    v_mfma_f32_16x16x32_bf16 v[196:199], v[240:243], v[184:187], v[196:199]
    v_mfma_f32_16x16x32_bf16 v[200:203], v[244:247], v[184:187], v[200:203]
    v_mfma_f32_16x16x32_bf16 v[204:207], v[248:251], v[184:187], v[204:207]
    v_mfma_f32_16x16x32_bf16 v[208:211], v[252:255], v[184:187], v[208:211]
    s_waitcnt vmcnt(16)
    v_mfma_f32_16x16x32_bf16 v[212:215], a[0:3], v[188:191], 0
    v_mfma_f32_16x16x32_bf16 v[216:219], a[4:7], v[188:191], 0
    v_mfma_f32_16x16x32_bf16 v[220:223], a[8:11], v[188:191], 0
    s_xor_b32 s68, s54, 0
    s_mul_i32 s68, s68, 5120
    v_mfma_f32_16x16x32_bf16 v[224:227], a[12:15], v[188:191], 0
    s_add_u32 s68, s68, 143360
    v_add_u32 v33, s68, v1
    v_mfma_f32_16x16x32_bf16 v[228:231], a[16:19], v[188:191], 0
    ds_write_b128 v33, v[192:195] offset:0
    ds_write_b128 v33, v[196:199] offset:1024
    s_waitcnt vmcnt(15)
    v_mfma_f32_16x16x32_bf16 v[212:215], a[20:23], v[132:135], v[212:215]
    ds_write_b128 v33, v[200:203] offset:2048
    ds_write_b128 v33, v[204:207] offset:3072
    v_mfma_f32_16x16x32_bf16 v[216:219], a[24:27], v[132:135], v[216:219]
    ds_write_b128 v33, v[208:211] offset:4096
    s_xor_b32 s68, s54, 1
    v_mfma_f32_16x16x32_bf16 v[220:223], a[28:31], v[132:135], v[220:223]
    s_mul_i32 s68, s68, 5120
    s_add_u32 s68, s68, 143360
    v_mfma_f32_16x16x32_bf16 v[224:227], a[32:35], v[132:135], v[224:227]
    v_add_u32 v33, s68, v1
    s_xor_b32 s68, s54, 3
    v_mfma_f32_16x16x32_bf16 v[228:231], a[36:39], v[132:135], v[228:231]
    s_mul_i32 s68, s68, 5120
    s_add_u32 s68, s68, 143368
    s_waitcnt vmcnt(14)
    v_mfma_f32_16x16x32_bf16 v[212:215], a[40:43], v[136:139], v[212:215]
    s_waitcnt vmcnt(2)
    v_cmp_ne_u32 vcc, s59, v120
    s_cbranch_vccnz SPIN_55
BACK_56:
    v_add_u32 v34, s68, v1
    v_mfma_f32_16x16x32_bf16 v[216:219], a[44:47], v[136:139], v[216:219]
    s_add_u32 s95, s96, 110592
    buffer_load_dwordx4 v[184:187], v1, s[32:35], s95 offen offset:0 sc1
    v_mfma_f32_16x16x32_bf16 v[220:223], a[48:51], v[136:139], v[220:223]
    v_mfma_f32_16x16x32_bf16 v[224:227], a[52:55], v[136:139], v[224:227]
    v_mfma_f32_16x16x32_bf16 v[228:231], a[56:59], v[136:139], v[228:231]
    buffer_load_dwordx4 v[188:191], v1, s[32:35], s95 offen offset:1024 sc1
    v_mfma_f32_16x16x32_bf16 v[212:215], a[60:63], v[140:143], v[212:215]
    v_mfma_f32_16x16x32_bf16 v[216:219], a[64:67], v[140:143], v[216:219]
    v_mfma_f32_16x16x32_bf16 v[220:223], a[68:71], v[140:143], v[220:223]
    buffer_load_dwordx4 v[132:135], v1, s[32:35], s95 offen offset:2048 sc1
    v_mfma_f32_16x16x32_bf16 v[224:227], a[72:75], v[140:143], v[224:227]
    v_mfma_f32_16x16x32_bf16 v[228:231], a[76:79], v[140:143], v[228:231]
    buffer_load_dwordx4 v[136:139], v1, s[32:35], s95 offen offset:3072 sc1
    s_waitcnt lgkmcnt(0)
    v_mfma_f32_16x16x32_bf16 v[212:215], a[80:83], v[144:147], v[212:215]
    s_add_u32 s95, s95, 4096
    buffer_load_dwordx4 v[140:143], v1, s[32:35], s95 offen offset:0 sc1
    v_mfma_f32_16x16x32_bf16 v[216:219], a[84:87], v[144:147], v[216:219]
    s_barrier
    ds_read_b64 v[192:193], v33 offset:0
    v_mfma_f32_16x16x32_bf16 v[220:223], a[88:91], v[144:147], v[220:223]
    ds_read_b64 v[194:195], v33 offset:1024
    ds_read_b64 v[196:197], v33 offset:2048
    v_mfma_f32_16x16x32_bf16 v[224:227], a[92:95], v[144:147], v[224:227]
    ds_read_b64 v[198:199], v33 offset:3072
    ds_read_b64 v[200:201], v33 offset:4096
    v_mfma_f32_16x16x32_bf16 v[228:231], a[96:99], v[144:147], v[228:231]
    buffer_load_dwordx4 v[144:147], v1, s[32:35], s95 offen offset:1024 sc1
    ds_read_b64 v[202:203], v34 offset:0
    v_mfma_f32_16x16x32_bf16 v[212:215], a[100:103], v[148:151], v[212:215]
    ds_read_b64 v[204:205], v34 offset:1024
    ds_read_b64 v[206:207], v34 offset:2048
    v_mfma_f32_16x16x32_bf16 v[216:219], a[104:107], v[148:151], v[216:219]
    ds_read_b64 v[208:209], v34 offset:3072
    ds_read_b64 v[210:211], v34 offset:4096
    v_mfma_f32_16x16x32_bf16 v[220:223], a[108:111], v[148:151], v[220:223]
    v_mfma_f32_16x16x32_bf16 v[224:227], a[112:115], v[148:151], v[224:227]
    v_mfma_f32_16x16x32_bf16 v[228:231], a[116:119], v[148:151], v[228:231]
    buffer_load_dwordx4 v[148:151], v1, s[32:35], s95 offen offset:2048 sc1
    v_mfma_f32_16x16x32_bf16 v[212:215], a[120:123], v[152:155], v[212:215]
    v_mfma_f32_16x16x32_bf16 v[216:219], a[124:127], v[152:155], v[216:219]
    v_mfma_f32_16x16x32_bf16 v[220:223], a[128:131], v[152:155], v[220:223]
    v_mfma_f32_16x16x32_bf16 v[224:227], a[132:135], v[152:155], v[224:227]
    v_mfma_f32_16x16x32_bf16 v[228:231], a[136:139], v[152:155], v[228:231]
    buffer_load_dwordx4 v[152:155], v1, s[32:35], s95 offen offset:3072 sc1
    v_mfma_f32_16x16x32_bf16 v[212:215], a[140:143], v[156:159], v[212:215]
    v_mfma_f32_16x16x32_bf16 v[216:219], a[144:147], v[156:159], v[216:219]
    s_waitcnt lgkmcnt(4)
    v_add_f32 v192, v192, v202
    v_add_f32 v193, v193, v203
    v_mfma_f32_16x16x32_bf16 v[220:223], a[148:151], v[156:159], v[220:223]
    s_waitcnt lgkmcnt(3)
    v_add_f32 v194, v194, v204
    v_add_f32 v195, v195, v205
    v_mfma_f32_16x16x32_bf16 v[224:227], a[152:155], v[156:159], v[224:227]
    s_waitcnt lgkmcnt(2)
    v_add_f32 v196, v196, v206
    v_add_f32 v197, v197, v207
    v_mfma_f32_16x16x32_bf16 v[228:231], a[156:159], v[156:159], v[228:231]
    s_add_u32 s95, s95, 4096
    buffer_load_dwordx4 v[156:159], v1, s[32:35], s95 offen offset:0 sc1
    v_mfma_f32_16x16x32_bf16 v[212:215], a[160:163], v[160:163], v[212:215]
    s_waitcnt lgkmcnt(1)
    v_add_f32 v198, v198, v208
    v_add_f32 v199, v199, v209
    v_mfma_f32_16x16x32_bf16 v[216:219], a[164:167], v[160:163], v[216:219]
    s_waitcnt lgkmcnt(0)
    v_add_f32 v200, v200, v210
    v_add_f32 v201, v201, v211
    v_mfma_f32_16x16x32_bf16 v[220:223], a[168:171], v[160:163], v[220:223]
    v_lshlrev_b32 v202, 16, v6
    v_and_b32 v203, 0xffff0000, v6
    v_mfma_f32_16x16x32_bf16 v[224:227], a[172:175], v[160:163], v[224:227]
    v_lshlrev_b32 v204, 16, v7
    v_and_b32 v205, 0xffff0000, v7
    v_mfma_f32_16x16x32_bf16 v[228:231], a[176:179], v[160:163], v[228:231]
    buffer_load_dwordx4 v[160:163], v1, s[32:35], s95 offen offset:1024 sc1
    v_lshlrev_b32 v206, 16, v8
    v_mfma_f32_16x16x32_bf16 v[212:215], a[180:183], v[164:167], v[212:215]
    v_and_b32 v207, 0xffff0000, v8
    v_lshlrev_b32 v208, 16, v9
    v_mfma_f32_16x16x32_bf16 v[216:219], a[184:187], v[164:167], v[216:219]
    v_and_b32 v209, 0xffff0000, v9
    v_lshlrev_b32 v210, 16, v10
    v_mfma_f32_16x16x32_bf16 v[220:223], a[188:191], v[164:167], v[220:223]
    v_and_b32 v211, 0xffff0000, v10
    v_add_f32 v192, v192, v202
    v_mfma_f32_16x16x32_bf16 v[224:227], a[192:195], v[164:167], v[224:227]
    v_add_f32 v193, v193, v203
    v_add_f32 v194, v194, v204
    v_mfma_f32_16x16x32_bf16 v[228:231], a[196:199], v[164:167], v[228:231]
    buffer_load_dwordx4 v[164:167], v1, s[32:35], s95 offen offset:2048 sc1
    v_add_f32 v195, v195, v205
    v_mfma_f32_16x16x32_bf16 v[212:215], a[200:203], v[168:171], v[212:215]
    v_add_f32 v196, v196, v206
    v_add_f32 v197, v197, v207
    v_mfma_f32_16x16x32_bf16 v[216:219], a[204:207], v[168:171], v[216:219]
    v_add_f32 v198, v198, v208
    v_add_f32 v199, v199, v209
    v_mfma_f32_16x16x32_bf16 v[220:223], a[208:211], v[168:171], v[220:223]
    v_add_f32 v200, v200, v210
    v_add_f32 v201, v201, v211
    v_mfma_f32_16x16x32_bf16 v[224:227], a[212:215], v[168:171], v[224:227]
    v_subrev_u32 v35, 8, v34
    v_mov_b32 v34, v33
    v_mfma_f32_16x16x32_bf16 v[228:231], a[216:219], v[168:171], v[228:231]
    buffer_load_dwordx4 v[168:171], v1, s[32:35], s95 offen offset:3072 sc1
    v_mfma_f32_16x16x32_bf16 v[212:215], a[220:223], v[172:175], v[212:215]
    v_mfma_f32_16x16x32_bf16 v[216:219], a[224:227], v[172:175], v[216:219]
    v_mfma_f32_16x16x32_bf16 v[220:223], a[228:231], v[172:175], v[220:223]
    v_mfma_f32_16x16x32_bf16 v[224:227], a[232:235], v[172:175], v[224:227]
    v_mfma_f32_16x16x32_bf16 v[228:231], a[236:239], v[172:175], v[228:231]
    s_add_u32 s95, s95, s94
    buffer_load_dwordx2 v[172:173], v4, s[32:35], s95 offen offset:0 sc1
    buffer_load_dwordx2 v[174:175], v4, s[32:35], s95 offen offset:512 sc1
    v_mfma_f32_16x16x32_bf16 v[212:215], a[240:243], v[176:179], v[212:215]
    v_mfma_f32_16x16x32_bf16 v[216:219], a[244:247], v[176:179], v[216:219]
    v_mfma_f32_16x16x32_bf16 v[220:223], a[248:251], v[176:179], v[220:223]
    v_mfma_f32_16x16x32_bf16 v[224:227], a[252:255], v[176:179], v[224:227]
    v_mfma_f32_16x16x32_bf16 v[228:231], v[232:235], v[176:179], v[228:231]
    buffer_load_dwordx2 v[176:177], v4, s[32:35], s95 offen offset:1024 sc1
    buffer_load_dwordx2 v[178:179], v4, s[32:35], s95 offen offset:1536 sc1
    s_waitcnt vmcnt(16)
    v_mfma_f32_16x16x32_bf16 v[212:215], v[236:239], v[180:183], v[212:215]
    v_mfma_f32_16x16x32_bf16 v[216:219], v[240:243], v[180:183], v[216:219]
    v_mfma_f32_16x16x32_bf16 v[220:223], v[244:247], v[180:183], v[220:223]
    v_mfma_f32_16x16x32_bf16 v[224:227], v[248:251], v[180:183], v[224:227]
    v_mfma_f32_16x16x32_bf16 v[228:231], v[252:255], v[180:183], v[228:231]
    s_add_u32 s99, s81, 110592
    buffer_load_dwordx4 v[180:183], v1, s[32:35], s99 offen offset:0 sc1
    s_waitcnt vmcnt(16)
    v_mfma_f32_16x16x32_bf16 v[92:95], a[0:3], v[184:187], 0
    v_mfma_f32_16x16x32_bf16 v[96:99], a[4:7], v[184:187], 0
    v_mfma_f32_16x16x32_bf16 v[100:103], a[8:11], v[184:187], 0
    ds_write_b64 v34, v[214:215] offset:0
    ds_write_b64 v34, v[218:219] offset:1024
    v_mfma_f32_16x16x32_bf16 v[104:107], a[12:15], v[184:187], 0
    ds_write_b64 v34, v[222:223] offset:2048
    ds_write_b64 v34, v[226:227] offset:3072
    v_mfma_f32_16x16x32_bf16 v[108:111], a[16:19], v[184:187], 0
    buffer_load_dwordx4 v[184:187], v1, s[32:35], s99 offen offset:1024 sc1
    ds_write_b64 v34, v[230:231] offset:4096
    s_waitcnt vmcnt(16)
    v_mfma_f32_16x16x32_bf16 v[92:95], a[20:23], v[188:191], v[92:95]
    v_add_f32 v192, v192, v212
    v_add_f32 v193, v193, v213
    v_mfma_f32_16x16x32_bf16 v[96:99], a[24:27], v[188:191], v[96:99]
    v_add_f32 v194, v194, v216
    v_add_f32 v195, v195, v217
    v_mfma_f32_16x16x32_bf16 v[100:103], a[28:31], v[188:191], v[100:103]
    v_add_f32 v196, v196, v220
    v_add_f32 v197, v197, v221
    v_mfma_f32_16x16x32_bf16 v[104:107], a[32:35], v[188:191], v[104:107]
    v_add_f32 v198, v198, v224
    v_add_f32 v199, v199, v225
    v_mfma_f32_16x16x32_bf16 v[108:111], a[36:39], v[188:191], v[108:111]
    buffer_load_dwordx4 v[188:191], v1, s[32:35], s99 offen offset:2048 sc1
    v_add_f32 v200, v200, v228
    s_waitcnt vmcnt(16)
    v_mfma_f32_16x16x32_bf16 v[92:95], a[40:43], v[132:135], v[92:95]
    v_add_f32 v201, v201, v229
    v_mfma_f32_16x16x32_bf16 v[96:99], a[44:47], v[132:135], v[96:99]
    v_mfma_f32_16x16x32_bf16 v[100:103], a[48:51], v[132:135], v[100:103]
    v_mfma_f32_16x16x32_bf16 v[104:107], a[52:55], v[132:135], v[104:107]
    s_waitcnt lgkmcnt(0)
    s_barrier
    v_mfma_f32_16x16x32_bf16 v[108:111], a[56:59], v[132:135], v[108:111]
    buffer_load_dwordx4 v[132:135], v1, s[32:35], s99 offen offset:3072 sc1
    ds_read_b64 v[202:203], v35 offset:0
    s_waitcnt vmcnt(16)
    v_mfma_f32_16x16x32_bf16 v[92:95], a[60:63], v[136:139], v[92:95]
    ds_read_b64 v[204:205], v35 offset:1024
    ds_read_b64 v[206:207], v35 offset:2048
    v_mfma_f32_16x16x32_bf16 v[96:99], a[64:67], v[136:139], v[96:99]
    ds_read_b64 v[208:209], v35 offset:3072
    ds_read_b64 v[210:211], v35 offset:4096
    v_mfma_f32_16x16x32_bf16 v[100:103], a[68:71], v[136:139], v[100:103]
    v_mfma_f32_16x16x32_bf16 v[104:107], a[72:75], v[136:139], v[104:107]
    v_mfma_f32_16x16x32_bf16 v[108:111], a[76:79], v[136:139], v[108:111]
    s_add_u32 s99, s99, 4096
    buffer_load_dwordx4 v[136:139], v1, s[32:35], s99 offen offset:0 sc1
    s_waitcnt vmcnt(16)
    v_mfma_f32_16x16x32_bf16 v[92:95], a[80:83], v[140:143], v[92:95]
    v_mfma_f32_16x16x32_bf16 v[96:99], a[84:87], v[140:143], v[96:99]
    v_mfma_f32_16x16x32_bf16 v[100:103], a[88:91], v[140:143], v[100:103]
    s_waitcnt lgkmcnt(4)
    v_add_f32 v192, v192, v202
    v_add_f32 v193, v193, v203
    v_mfma_f32_16x16x32_bf16 v[104:107], a[92:95], v[140:143], v[104:107]
    s_waitcnt lgkmcnt(3)
    v_add_f32 v194, v194, v204
    v_add_f32 v195, v195, v205
    v_mfma_f32_16x16x32_bf16 v[108:111], a[96:99], v[140:143], v[108:111]
    buffer_load_dwordx4 v[140:143], v1, s[32:35], s99 offen offset:1024 sc1
    s_waitcnt lgkmcnt(2)
    v_add_f32 v196, v196, v206
    s_waitcnt vmcnt(16)
    v_mfma_f32_16x16x32_bf16 v[92:95], a[100:103], v[144:147], v[92:95]
    v_add_f32 v197, v197, v207
    s_waitcnt lgkmcnt(1)
    v_add_f32 v198, v198, v208
    v_mfma_f32_16x16x32_bf16 v[96:99], a[104:107], v[144:147], v[96:99]
    v_add_f32 v199, v199, v209
    s_waitcnt lgkmcnt(0)
    v_add_f32 v200, v200, v210
    v_mfma_f32_16x16x32_bf16 v[100:103], a[108:111], v[144:147], v[100:103]
    v_add_f32 v201, v201, v211
    s_add_u32 s64, s86, 0
    v_mfma_f32_16x16x32_bf16 v[104:107], a[112:115], v[144:147], v[104:107]
    v_add_f32 v212, v192, v193
    v_mul_f32 v213, v192, v192
    v_mfma_f32_16x16x32_bf16 v[108:111], a[116:119], v[144:147], v[108:111]
    buffer_load_dwordx4 v[144:147], v1, s[32:35], s99 offen offset:2048 sc1
    v_mul_f32 v215, v193, v193
    s_waitcnt vmcnt(16)
    v_mfma_f32_16x16x32_bf16 v[92:95], a[120:123], v[148:151], v[92:95]
    v_add_f32 v214, v194, v195
    v_fmac_f32 v213, v194, v194
    v_mfma_f32_16x16x32_bf16 v[96:99], a[124:127], v[148:151], v[96:99]
    v_fmac_f32 v215, v195, v195
    v_fmac_f32 v213, v196, v196
    v_mfma_f32_16x16x32_bf16 v[100:103], a[128:131], v[148:151], v[100:103]
    v_fmac_f32 v215, v197, v197
    v_add_f32 v212, v212, v196
    v_mfma_f32_16x16x32_bf16 v[104:107], a[132:135], v[148:151], v[104:107]
    v_add_f32 v214, v214, v197
    v_fmac_f32 v213, v198, v198
    v_mfma_f32_16x16x32_bf16 v[108:111], a[136:139], v[148:151], v[108:111]
    buffer_load_dwordx4 v[148:151], v1, s[32:35], s99 offen offset:3072 sc1
    v_fmac_f32 v215, v199, v199
    s_waitcnt vmcnt(16)
    v_mfma_f32_16x16x32_bf16 v[92:95], a[140:143], v[152:155], v[92:95]
    v_add_f32 v212, v212, v198
    v_add_f32 v214, v214, v199
    v_mfma_f32_16x16x32_bf16 v[96:99], a[144:147], v[152:155], v[96:99]
    v_fmac_f32 v213, v200, v200
    v_fmac_f32 v215, v201, v201
    v_mfma_f32_16x16x32_bf16 v[100:103], a[148:151], v[152:155], v[100:103]
    v_add_f32 v212, v212, v200
    v_add_f32 v214, v214, v201
    v_mfma_f32_16x16x32_bf16 v[104:107], a[152:155], v[152:155], v[104:107]
    v_add_f32 v212, v212, v214
    v_add_f32 v213, v213, v215
    v_mfma_f32_16x16x32_bf16 v[108:111], a[156:159], v[152:155], v[108:111]
    s_add_u32 s99, s99, 4096
    buffer_load_dwordx4 v[152:155], v1, s[32:35], s99 offen offset:0 sc1
    s_waitcnt vmcnt(16)
    v_mfma_f32_16x16x32_bf16 v[92:95], a[160:163], v[156:159], v[92:95]
    v_lshlrev_b32 v215, 4, v2
    v_mov_b32 v214, s97
    v_mfma_f32_16x16x32_bf16 v[96:99], a[164:167], v[156:159], v[96:99]
    v_permlane16_swap_b32 v212, v213
    v_add_f32 v212, v212, v213
    v_mfma_f32_16x16x32_bf16 v[100:103], a[168:171], v[156:159], v[100:103]
    v_mov_b32 v213, v212
    s_nop 1
    v_permlane32_swap_b32 v212, v213
    v_mfma_f32_16x16x32_bf16 v[104:107], a[172:175], v[156:159], v[104:107]
    v_add_f32 v212, v212, v213
    v_mov_b32 v213, v212
    v_mfma_f32_16x16x32_bf16 v[108:111], a[176:179], v[156:159], v[108:111]
    buffer_load_dwordx4 v[156:159], v1, s[32:35], s99 offen offset:1024 sc1
    v_permlane16_swap_b32 v212, v213
    s_waitcnt vmcnt(16)
    v_mfma_f32_16x16x32_bf16 v[92:95], a[180:183], v[160:163], v[92:95]
    buffer_store_dwordx3 v[212:214], v215, s[32:35], s64 offen offset:0
    s_barrier
    v_mfma_f32_16x16x32_bf16 v[96:99], a[184:187], v[160:163], v[96:99]
    s_add_u32 s69, s87, 0
    buffer_load_dwordx3 v[212:214], v1, s[32:35], s69 offen offset:0 sc1
    v_mfma_f32_16x16x32_bf16 v[100:103], a[188:191], v[160:163], v[100:103]
    buffer_load_dwordx3 v[216:218], v1, s[32:35], s69 offen offset:1024 sc1
    buffer_load_dwordx3 v[220:222], v1, s[32:35], s69 offen offset:2048 sc1
    v_mfma_f32_16x16x32_bf16 v[104:107], a[192:195], v[160:163], v[104:107]
    buffer_load_dwordx3 v[224:226], v1, s[32:35], s69 offen offset:3072 sc1
    v_mfma_f32_16x16x32_bf16 v[108:111], a[196:199], v[160:163], v[108:111]
    buffer_load_dwordx4 v[160:163], v1, s[32:35], s99 offen offset:2048 sc1
    s_waitcnt vmcnt(21)
    v_mfma_f32_16x16x32_bf16 v[92:95], a[200:203], v[164:167], v[92:95]
    v_mfma_f32_16x16x32_bf16 v[96:99], a[204:207], v[164:167], v[96:99]
    v_mfma_f32_16x16x32_bf16 v[100:103], a[208:211], v[164:167], v[100:103]
    v_mfma_f32_16x16x32_bf16 v[104:107], a[212:215], v[164:167], v[104:107]
    v_mfma_f32_16x16x32_bf16 v[108:111], a[216:219], v[164:167], v[108:111]
    buffer_load_dwordx4 v[164:167], v1, s[32:35], s99 offen offset:3072 sc1
    s_waitcnt vmcnt(21)
    v_mfma_f32_16x16x32_bf16 v[92:95], a[220:223], v[168:171], v[92:95]
    v_mfma_f32_16x16x32_bf16 v[96:99], a[224:227], v[168:171], v[96:99]
    v_mfma_f32_16x16x32_bf16 v[100:103], a[228:231], v[168:171], v[100:103]
    v_mfma_f32_16x16x32_bf16 v[104:107], a[232:235], v[168:171], v[104:107]
    v_mfma_f32_16x16x32_bf16 v[108:111], a[236:239], v[168:171], v[108:111]
    s_add_u32 s99, s99, s94
    buffer_load_dwordx2 v[168:169], v4, s[32:35], s99 offen offset:0 sc1
    buffer_load_dwordx2 v[170:171], v4, s[32:35], s99 offen offset:512 sc1
    s_waitcnt vmcnt(21)
    v_mfma_f32_16x16x32_bf16 v[92:95], a[240:243], v[172:175], v[92:95]
    s_waitcnt vmcnt(6)
    v_xor_b32 v214, v214, v218
    s_waitcnt vmcnt(4)
    v_xor_b32 v222, v222, v226
    v_xor_b32 v218, v218, v226
    v_xor_b32 v226, s97, v226
    v_or3_b32 v214, v214, v218, v222
    v_or_b32 v214, v214, v226
    v_cmp_ne_u32 vcc, 0, v214
    s_cbranch_vccnz SPIN_60
BACK_61:
    v_mfma_f32_16x16x32_bf16 v[96:99], a[244:247], v[172:175], v[96:99]
    v_mfma_f32_16x16x32_bf16 v[100:103], a[248:251], v[172:175], v[100:103]
    v_mfma_f32_16x16x32_bf16 v[104:107], a[252:255], v[172:175], v[104:107]
    v_add_f32 v212, v212, v216
    v_mfma_f32_16x16x32_bf16 v[108:111], v[232:235], v[172:175], v[108:111]
    buffer_load_dwordx2 v[172:173], v4, s[32:35], s99 offen offset:1024 sc1
    buffer_load_dwordx2 v[174:175], v4, s[32:35], s99 offen offset:1536 sc1
    v_mfma_f32_16x16x32_bf16 v[92:95], v[236:239], v[176:179], v[92:95]
    v_add_f32 v213, v213, v217
    v_add_f32 v220, v220, v224
    v_mfma_f32_16x16x32_bf16 v[96:99], v[240:243], v[176:179], v[96:99]
    v_add_f32 v221, v221, v225
    v_add_f32 v212, v212, v220
    v_mfma_f32_16x16x32_bf16 v[100:103], v[244:247], v[176:179], v[100:103]
    v_add_f32 v213, v213, v221
    s_nop 1
    v_permlane16_swap_b32 v212, v213
    v_mfma_f32_16x16x32_bf16 v[104:107], v[248:251], v[176:179], v[104:107]
    v_add_f32 v212, v212, v213
    v_mov_b32 v213, v212
    v_mfma_f32_16x16x32_bf16 v[108:111], v[252:255], v[176:179], v[108:111]
    s_nop 0
    v_permlane32_swap_b32 v212, v213
    v_add_f32 v212, v212, v213
    v_mfma_f32_16x16x32_bf16 v[112:115], a[0:3], v[180:183], 0
    v_mul_f32 v30, 0x3acccccd, v212
    v_mul_f32 v31, 0x3acccccd, v212
    v_mfma_f32_16x16x32_bf16 v[116:119], a[4:7], v[180:183], 0
    s_nop 0
    v_permlane16_swap_b32 v30, v31
    v_fma_f32 v31, -v30, v30, v31
    v_mfma_f32_16x16x32_bf16 v[120:123], a[8:11], v[180:183], 0
    v_max_f32 v31, 0, v31
    v_cvt_pk_bf16_f32 v31, v31, v30
    v_mfma_f32_16x16x32_bf16 v[124:127], a[12:15], v[180:183], 0
    v_and_b32 v30, 0xffff0000, v31
    v_lshlrev_b32 v31, 16, v31
    v_mfma_f32_16x16x32_bf16 v[128:131], a[16:19], v[180:183], 0
    v_add_f32 v31, 0x3727c5ac, v31
    v_cvt_pk_bf16_f32 v31, v31, v31
    v_mfma_f32_16x16x32_bf16 v[112:115], a[20:23], v[184:187], v[112:115]
    v_lshlrev_b32 v31, 16, v31
    v_sqrt_f32 v31, v31
    v_mfma_f32_16x16x32_bf16 v[116:119], a[24:27], v[184:187], v[116:119]
    v_cvt_pk_bf16_f32 v31, v31, v31
    v_lshlrev_b32 v31, 16, v31
    v_mfma_f32_16x16x32_bf16 v[120:123], a[28:31], v[184:187], v[120:123]
    v_rcp_f32 v31, v31
    v_mfma_f32_16x16x32_bf16 v[124:127], a[32:35], v[184:187], v[124:127]
    v_mul_f32 v32, -v30, v31
    v_lshlrev_b32 v202, 16, v17
    v_mfma_f32_16x16x32_bf16 v[128:131], a[36:39], v[184:187], v[128:131]
    v_and_b32 v203, 0xffff0000, v17
    v_lshlrev_b32 v204, 16, v18
    v_mfma_f32_16x16x32_bf16 v[112:115], a[40:43], v[188:191], v[112:115]
    v_and_b32 v205, 0xffff0000, v18
    v_lshlrev_b32 v206, 16, v19
    v_mfma_f32_16x16x32_bf16 v[116:119], a[44:47], v[188:191], v[116:119]
    v_and_b32 v207, 0xffff0000, v19
    v_lshlrev_b32 v208, 16, v20
    v_mfma_f32_16x16x32_bf16 v[120:123], a[48:51], v[188:191], v[120:123]
    v_and_b32 v209, 0xffff0000, v20
    v_lshlrev_b32 v210, 16, v21
    v_mfma_f32_16x16x32_bf16 v[124:127], a[52:55], v[188:191], v[124:127]
    v_and_b32 v211, 0xffff0000, v21
    v_fma_f32 v212, v192, v31, v32
    v_mfma_f32_16x16x32_bf16 v[128:131], a[56:59], v[188:191], v[128:131]
    v_fma_f32 v213, v193, v31, v32
    v_fma_f32 v214, v194, v31, v32
    v_mfma_f32_16x16x32_bf16 v[112:115], a[60:63], v[132:135], v[112:115]
    v_fma_f32 v215, v195, v31, v32
    v_fma_f32 v216, v196, v31, v32
    v_mfma_f32_16x16x32_bf16 v[116:119], a[64:67], v[132:135], v[116:119]
    v_fma_f32 v217, v197, v31, v32
    v_fma_f32 v218, v198, v31, v32
    v_mfma_f32_16x16x32_bf16 v[120:123], a[68:71], v[132:135], v[120:123]
    v_fma_f32 v219, v199, v31, v32
    v_fma_f32 v220, v200, v31, v32
    v_mfma_f32_16x16x32_bf16 v[124:127], a[72:75], v[132:135], v[124:127]
    v_fma_f32 v221, v201, v31, v32
    v_fmac_f32 v192, v212, v202
    v_mfma_f32_16x16x32_bf16 v[128:131], a[76:79], v[132:135], v[128:131]
    v_fmac_f32 v193, v213, v203
    v_fmac_f32 v194, v214, v204
    v_mfma_f32_16x16x32_bf16 v[112:115], a[80:83], v[136:139], v[112:115]
    v_fmac_f32 v195, v215, v205
    v_fmac_f32 v196, v216, v206
    v_mfma_f32_16x16x32_bf16 v[116:119], a[84:87], v[136:139], v[116:119]
    v_fmac_f32 v197, v217, v207
    v_fmac_f32 v198, v218, v208
    v_mfma_f32_16x16x32_bf16 v[120:123], a[88:91], v[136:139], v[120:123]
    v_fmac_f32 v199, v219, v209
    v_fmac_f32 v200, v220, v210
    v_mfma_f32_16x16x32_bf16 v[124:127], a[92:95], v[136:139], v[124:127]
    v_fmac_f32 v201, v221, v211
    v_cvt_pk_bf16_f32 v6, v192, v193
    v_mfma_f32_16x16x32_bf16 v[128:131], a[96:99], v[136:139], v[128:131]
    v_cvt_pk_bf16_f32 v7, v194, v195
    v_cvt_pk_bf16_f32 v8, v196, v197
    v_mfma_f32_16x16x32_bf16 v[112:115], a[100:103], v[140:143], v[112:115]
    v_cvt_pk_bf16_f32 v9, v198, v199
    v_cvt_pk_bf16_f32 v10, v200, v201
    v_mfma_f32_16x16x32_bf16 v[116:119], a[104:107], v[140:143], v[116:119]
    s_add_u32 s64, s77, 0
    s_add_u32 s65, s78, 0
    v_mfma_f32_16x16x32_bf16 v[120:123], a[108:111], v[140:143], v[120:123]
    buffer_store_dwordx4 v[6:9], v1, s[32:35], s64 offen
    buffer_store_dword v10, v1, s[32:35], s65 offen
    v_mfma_f32_16x16x32_bf16 v[124:127], a[112:115], v[140:143], v[124:127]
    s_add_u32 s65, s86, 524288
    v_add_f32 v212, v192, v193
    v_mfma_f32_16x16x32_bf16 v[128:131], a[116:119], v[140:143], v[128:131]
    v_mul_f32 v213, v192, v192
    v_mul_f32 v215, v193, v193
    v_mfma_f32_16x16x32_bf16 v[112:115], a[120:123], v[144:147], v[112:115]
    v_add_f32 v214, v194, v195
    v_fmac_f32 v213, v194, v194
    v_mfma_f32_16x16x32_bf16 v[116:119], a[124:127], v[144:147], v[116:119]
    v_fmac_f32 v215, v195, v195
    v_fmac_f32 v213, v196, v196
    v_mfma_f32_16x16x32_bf16 v[120:123], a[128:131], v[144:147], v[120:123]
    v_fmac_f32 v215, v197, v197
    v_add_f32 v212, v212, v196
    v_mfma_f32_16x16x32_bf16 v[124:127], a[132:135], v[144:147], v[124:127]
    v_add_f32 v214, v214, v197
    v_fmac_f32 v213, v198, v198
    v_mfma_f32_16x16x32_bf16 v[128:131], a[136:139], v[144:147], v[128:131]
    v_fmac_f32 v215, v199, v199
    v_add_f32 v212, v212, v198
    v_mfma_f32_16x16x32_bf16 v[112:115], a[140:143], v[148:151], v[112:115]
    v_add_f32 v214, v214, v199
    v_fmac_f32 v213, v200, v200
    v_mfma_f32_16x16x32_bf16 v[116:119], a[144:147], v[148:151], v[116:119]
    v_fmac_f32 v215, v201, v201
    v_add_f32 v212, v212, v200
    v_mfma_f32_16x16x32_bf16 v[120:123], a[148:151], v[148:151], v[120:123]
    v_add_f32 v214, v214, v201
    v_add_f32 v212, v212, v214
    v_mfma_f32_16x16x32_bf16 v[124:127], a[152:155], v[148:151], v[124:127]
    v_add_f32 v213, v213, v215
    v_lshlrev_b32 v215, 4, v2
    v_mfma_f32_16x16x32_bf16 v[128:131], a[156:159], v[148:151], v[128:131]
    v_mov_b32 v214, s97
    v_permlane16_swap_b32 v212, v213
    v_mfma_f32_16x16x32_bf16 v[112:115], a[160:163], v[152:155], v[112:115]
    v_add_f32 v212, v212, v213
    v_mov_b32 v213, v212
    v_mfma_f32_16x16x32_bf16 v[116:119], a[164:167], v[152:155], v[116:119]
    s_nop 0
    v_permlane32_swap_b32 v212, v213
    v_add_f32 v212, v212, v213
    v_mfma_f32_16x16x32_bf16 v[120:123], a[168:171], v[152:155], v[120:123]
    v_mov_b32 v213, v212
    s_nop 1
    v_permlane16_swap_b32 v212, v213
    v_mfma_f32_16x16x32_bf16 v[124:127], a[172:175], v[152:155], v[124:127]
    s_add_u32 s64, s83, 0
    v_mov_b32 v30, s97
    v_mfma_f32_16x16x32_bf16 v[128:131], a[176:179], v[152:155], v[128:131]
    v_mov_b32 v31, 0
    s_waitcnt vmcnt(0)
    v_mfma_f32_16x16x32_bf16 v[112:115], a[180:183], v[156:159], v[112:115]
    buffer_store_dword v30, v31, s[32:35], s64 offen offset:0
    buffer_store_dwordx3 v[212:214], v215, s[32:35], s65 offen offset:0
    v_mfma_f32_16x16x32_bf16 v[116:119], a[184:187], v[156:159], v[116:119]
    s_xor_b32 s68, s54, 0
    s_mul_i32 s68, s68, 5120
    v_mfma_f32_16x16x32_bf16 v[120:123], a[188:191], v[156:159], v[120:123]
    s_add_u32 s68, s68, 143360
    v_add_u32 v33, s68, v1
    v_mfma_f32_16x16x32_bf16 v[124:127], a[192:195], v[156:159], v[124:127]
    ds_write_b128 v33, v[92:95] offset:0
    ds_write_b128 v33, v[96:99] offset:1024
    v_mfma_f32_16x16x32_bf16 v[128:131], a[196:199], v[156:159], v[128:131]
    ds_write_b128 v33, v[100:103] offset:2048
    ds_write_b128 v33, v[104:107] offset:3072
    v_mfma_f32_16x16x32_bf16 v[112:115], a[200:203], v[160:163], v[112:115]
    ds_write_b128 v33, v[108:111] offset:4096
    s_xor_b32 s68, s54, 1
    v_mfma_f32_16x16x32_bf16 v[116:119], a[204:207], v[160:163], v[116:119]
    s_mul_i32 s68, s68, 5120
    s_add_u32 s68, s68, 143360
    v_mfma_f32_16x16x32_bf16 v[120:123], a[208:211], v[160:163], v[120:123]
    v_add_u32 v33, s68, v1
    s_xor_b32 s68, s54, 3
    v_mfma_f32_16x16x32_bf16 v[124:127], a[212:215], v[160:163], v[124:127]
    s_mul_i32 s68, s68, 5120
    s_add_u32 s68, s68, 143368
    v_mfma_f32_16x16x32_bf16 v[128:131], a[216:219], v[160:163], v[128:131]
    v_add_u32 v34, s68, v1
    v_mfma_f32_16x16x32_bf16 v[112:115], a[220:223], v[164:167], v[112:115]
    v_mfma_f32_16x16x32_bf16 v[116:119], a[224:227], v[164:167], v[116:119]
    v_mfma_f32_16x16x32_bf16 v[120:123], a[228:231], v[164:167], v[120:123]
    v_mfma_f32_16x16x32_bf16 v[124:127], a[232:235], v[164:167], v[124:127]
    v_mfma_f32_16x16x32_bf16 v[128:131], a[236:239], v[164:167], v[128:131]
    v_mfma_f32_16x16x32_bf16 v[112:115], a[240:243], v[168:171], v[112:115]
    v_mfma_f32_16x16x32_bf16 v[116:119], a[244:247], v[168:171], v[116:119]
    s_waitcnt lgkmcnt(0)
    s_barrier
    v_mfma_f32_16x16x32_bf16 v[120:123], a[248:251], v[168:171], v[120:123]
    ds_read_b64 v[92:93], v33 offset:0
    ds_read_b64 v[94:95], v33 offset:1024
    v_mfma_f32_16x16x32_bf16 v[124:127], a[252:255], v[168:171], v[124:127]
    ds_read_b64 v[96:97], v33 offset:2048
    ds_read_b64 v[98:99], v33 offset:3072
    v_mfma_f32_16x16x32_bf16 v[128:131], v[232:235], v[168:171], v[128:131]
    ds_read_b64 v[100:101], v33 offset:4096
    ds_read_b64 v[102:103], v34 offset:0
    v_mfma_f32_16x16x32_bf16 v[112:115], v[236:239], v[172:175], v[112:115]
    ds_read_b64 v[104:105], v34 offset:1024
    ds_read_b64 v[106:107], v34 offset:2048
    v_mfma_f32_16x16x32_bf16 v[116:119], v[240:243], v[172:175], v[116:119]
    ds_read_b64 v[108:109], v34 offset:3072
    ds_read_b64 v[110:111], v34 offset:4096
    v_mfma_f32_16x16x32_bf16 v[120:123], v[244:247], v[172:175], v[120:123]
    v_mfma_f32_16x16x32_bf16 v[124:127], v[248:251], v[172:175], v[124:127]
    v_mfma_f32_16x16x32_bf16 v[128:131], v[252:255], v[172:175], v[128:131]
    s_waitcnt lgkmcnt(4)
    v_add_f32 v92, v92, v102
    v_add_f32 v93, v93, v103
    s_waitcnt lgkmcnt(3)
    v_add_f32 v94, v94, v104
    v_add_f32 v95, v95, v105
    s_waitcnt lgkmcnt(2)
    v_add_f32 v96, v96, v106
    v_add_f32 v97, v97, v107
    s_waitcnt lgkmcnt(1)
    v_add_f32 v98, v98, v108
    v_add_f32 v99, v99, v109
    s_waitcnt lgkmcnt(0)
    v_add_f32 v100, v100, v110
    v_add_f32 v101, v101, v111
    v_lshlrev_b32 v102, 16, v12
    v_and_b32 v103, 0xffff0000, v12
    v_lshlrev_b32 v104, 16, v13
    v_and_b32 v105, 0xffff0000, v13
    v_lshlrev_b32 v106, 16, v14
    v_and_b32 v107, 0xffff0000, v14
    v_lshlrev_b32 v108, 16, v15
    v_and_b32 v109, 0xffff0000, v15
    v_lshlrev_b32 v110, 16, v16
    v_and_b32 v111, 0xffff0000, v16
    v_add_f32 v92, v92, v102
    v_add_f32 v93, v93, v103
    v_add_f32 v94, v94, v104
    v_add_f32 v95, v95, v105
    v_add_f32 v96, v96, v106
    v_add_f32 v97, v97, v107
    v_add_f32 v98, v98, v108
    v_add_f32 v99, v99, v109
    v_add_f32 v100, v100, v110
    v_add_f32 v101, v101, v111
    v_subrev_u32 v35, 8, v34
    v_mov_b32 v34, v33
    v_lshlrev_b32 v31, 2, v2
    s_add_u32 s66, s82, 0
    buffer_load_dword v30, v31, s[32:35], s66 offen sc1
    ds_read_b128 v[160:163], v1 offset:0
    ds_read_b128 v[164:167], v1 offset:1024
    ds_read_b128 v[168:171], v1 offset:2048
    ds_read_b128 v[172:175], v1 offset:3072
    ds_read_b128 v[176:179], v1 offset:4096
    ds_read_b128 v[180:183], v1 offset:5120
    ds_read_b128 v[184:187], v1 offset:6144
    ds_read_b128 v[188:191], v1 offset:7168
    ds_read_b128 v[192:195], v1 offset:8192
    ds_read_b128 v[196:199], v1 offset:9216
    ds_read_b128 v[200:203], v1 offset:10240
    ds_read_b128 v[204:207], v1 offset:11264
    ds_write_b64 v34, v[114:115] offset:0
    ds_write_b64 v34, v[118:119] offset:1024
    ds_write_b64 v34, v[122:123] offset:2048
    ds_write_b64 v34, v[126:127] offset:3072
    ds_write_b64 v34, v[130:131] offset:4096
    v_pk_add_f32 v[92:93], v[92:93], v[112:113]
    v_pk_add_f32 v[94:95], v[94:95], v[116:117]
    v_pk_add_f32 v[96:97], v[96:97], v[120:121]
    v_pk_add_f32 v[98:99], v[98:99], v[124:125]
    v_pk_add_f32 v[100:101], v[100:101], v[128:129]
    s_waitcnt vmcnt(0)
    v_cmp_ne_u32 vcc, s97, v30
    s_cbranch_vccnz SPIN_63
BACK_64:
    s_add_u32 s93, s76, 0
    buffer_load_dwordx4 v[208:211], v1, s[32:35], s93 offen offset:0 sc1
    buffer_load_dwordx4 v[212:215], v1, s[32:35], s93 offen offset:1024 sc1
    buffer_load_dwordx4 v[216:219], v1, s[32:35], s93 offen offset:2048 sc1
    buffer_load_dwordx4 v[220:223], v1, s[32:35], s93 offen offset:3072 sc1
    s_add_u32 s93, s93, 4096
    buffer_load_dwordx4 v[224:227], v1, s[32:35], s93 offen offset:0 sc1
    buffer_load_dwordx4 v[228:231], v1, s[32:35], s93 offen offset:1024 sc1
    s_waitcnt lgkmcnt(0)
    s_barrier
    ds_read_b64 v[102:103], v35 offset:0
    ds_read_b64 v[104:105], v35 offset:1024
    ds_read_b64 v[106:107], v35 offset:2048
    ds_read_b64 v[108:109], v35 offset:3072
    ds_read_b64 v[110:111], v35 offset:4096
    s_waitcnt lgkmcnt(4)
    v_pk_add_f32 v[92:93], v[92:93], v[102:103]
    s_waitcnt lgkmcnt(3)
    v_pk_add_f32 v[94:95], v[94:95], v[104:105]
    s_waitcnt lgkmcnt(2)
    v_pk_add_f32 v[96:97], v[96:97], v[106:107]
    s_waitcnt lgkmcnt(1)
    v_pk_add_f32 v[98:99], v[98:99], v[108:109]
    s_waitcnt lgkmcnt(0)
    v_pk_add_f32 v[100:101], v[100:101], v[110:111]
    s_add_u32 s67, s88, 524288
    buffer_load_dwordx3 v[116:118], v1, s[32:35], s67 offen offset:0 sc1
    buffer_load_dwordx3 v[120:122], v1, s[32:35], s67 offen offset:1024 sc1
    buffer_load_dwordx3 v[124:126], v1, s[32:35], s67 offen offset:2048 sc1
    buffer_load_dwordx3 v[128:130], v1, s[32:35], s67 offen offset:3072 sc1
    s_add_u32 s64, s86, 8192
    v_add_f32 v112, v92, v93
    v_mul_f32 v113, v92, v92
    v_mul_f32 v115, v93, v93
    v_add_f32 v114, v94, v95
    v_fmac_f32 v113, v94, v94
    v_fmac_f32 v115, v95, v95
    v_fmac_f32 v113, v96, v96
    v_fmac_f32 v115, v97, v97
    v_add_f32 v112, v112, v96
    v_add_f32 v114, v114, v97
    v_fmac_f32 v113, v98, v98
    v_fmac_f32 v115, v99, v99
    v_add_f32 v112, v112, v98
    v_add_f32 v114, v114, v99
    v_fmac_f32 v113, v100, v100
    v_fmac_f32 v115, v101, v101
    v_add_f32 v112, v112, v100
    v_add_f32 v114, v114, v101
    v_add_f32 v112, v112, v114
    v_add_f32 v113, v113, v115
    v_lshlrev_b32 v115, 4, v2
    v_mov_b32 v114, s97
    v_permlane16_swap_b32 v112, v113
    v_add_f32 v112, v112, v113
    v_mov_b32 v113, v112
    s_nop 1
    v_permlane32_swap_b32 v112, v113
    v_add_f32 v112, v112, v113
    v_mov_b32 v113, v112
    s_nop 1
    v_permlane16_swap_b32 v112, v113
    buffer_store_dwordx3 v[112:114], v115, s[32:35], s64 offen offset:0
    s_waitcnt vmcnt(10)
    v_mfma_f32_16x16x32_bf16 v[132:135], v[160:163], v[208:211], 0
    ds_read_b128 v[160:163], v1 offset:12288
    s_barrier
    v_mfma_f32_16x16x32_bf16 v[136:139], v[164:167], v[208:211], 0
    ds_read_b128 v[164:167], v1 offset:13312
    v_mfma_f32_16x16x32_bf16 v[140:143], v[168:171], v[208:211], 0
    ds_read_b128 v[168:171], v1 offset:14336
    v_mfma_f32_16x16x32_bf16 v[144:147], v[172:175], v[208:211], 0
    ds_read_b128 v[172:175], v1 offset:15360
    v_mfma_f32_16x16x32_bf16 v[148:151], v[176:179], v[208:211], 0
    ds_read_b128 v[176:179], v1 offset:16384
    v_mfma_f32_16x16x32_bf16 v[152:155], v[180:183], v[208:211], 0
    ds_read_b128 v[180:183], v1 offset:17408
    s_waitcnt vmcnt(3)
    v_xor_b32 v118, v118, v122
    s_waitcnt vmcnt(1)
    v_xor_b32 v126, v126, v130
    v_xor_b32 v122, v122, v130
    v_xor_b32 v130, s97, v130
    v_or3_b32 v118, v118, v122, v126
    v_or_b32 v118, v118, v130
    v_cmp_ne_u32 vcc, 0, v118
    s_cbranch_vccnz SPIN_65
BACK_66:
    v_mfma_f32_16x16x32_bf16 v[156:159], v[184:187], v[208:211], 0
    ds_read_b128 v[184:187], v1 offset:18432
    buffer_load_dwordx4 v[208:211], v1, s[32:35], s93 offen offset:2048 sc1
    v_mfma_f32_16x16x32_bf16 v[132:135], v[188:191], v[212:215], v[132:135]
    ds_read_b128 v[188:191], v1 offset:19456
    v_mfma_f32_16x16x32_bf16 v[136:139], v[192:195], v[212:215], v[136:139]
    ds_read_b128 v[192:195], v1 offset:20480
    v_mfma_f32_16x16x32_bf16 v[140:143], v[196:199], v[212:215], v[140:143]
    ds_read_b128 v[196:199], v1 offset:21504
    v_mfma_f32_16x16x32_bf16 v[144:147], v[200:203], v[212:215], v[144:147]
    ds_read_b128 v[200:203], v1 offset:22528
    v_add_f32 v116, v116, v120
    v_add_f32 v117, v117, v121
    v_mfma_f32_16x16x32_bf16 v[148:151], v[204:207], v[212:215], v[148:151]
    ds_read_b128 v[204:207], v1 offset:23552
    s_waitcnt lgkmcnt(8)
    v_add_f32 v124, v124, v128
    v_mfma_f32_16x16x32_bf16 v[152:155], v[160:163], v[212:215], v[152:155]
    ds_read_b128 v[160:163], v1 offset:24576
    v_add_f32 v125, v125, v129
    v_add_f32 v116, v116, v124
    v_mfma_f32_16x16x32_bf16 v[156:159], v[164:167], v[212:215], v[156:159]
    ds_read_b128 v[164:167], v1 offset:25600
    buffer_load_dwordx4 v[212:215], v1, s[32:35], s93 offen offset:3072 sc1
    v_add_f32 v117, v117, v125
    v_mfma_f32_16x16x32_bf16 v[132:135], v[168:171], v[216:219], v[132:135]
    ds_read_b128 v[168:171], v1 offset:26624
    v_permlane16_swap_b32 v116, v117
    v_add_f32 v116, v116, v117
    v_mfma_f32_16x16x32_bf16 v[136:139], v[172:175], v[216:219], v[136:139]
    ds_read_b128 v[172:175], v1 offset:27648
    s_waitcnt lgkmcnt(8)
    v_mov_b32 v117, v116
    v_mfma_f32_16x16x32_bf16 v[140:143], v[176:179], v[216:219], v[140:143]
    ds_read_b128 v[176:179], v1 offset:28672
    v_permlane32_swap_b32 v116, v117
    v_add_f32 v116, v116, v117
    v_mfma_f32_16x16x32_bf16 v[144:147], v[180:183], v[216:219], v[144:147]
    ds_read_b128 v[180:183], v1 offset:29696
    v_mul_f32 v120, 0x3acccccd, v116
    v_mul_f32 v121, 0x3acccccd, v116
    v_mfma_f32_16x16x32_bf16 v[148:151], v[184:187], v[216:219], v[148:151]
    ds_read_b128 v[184:187], v1 offset:30720
    v_permlane16_swap_b32 v120, v121
    v_fma_f32 v121, -v120, v120, v121
    v_mfma_f32_16x16x32_bf16 v[152:155], v[188:191], v[216:219], v[152:155]
    ds_read_b128 v[188:191], v1 offset:31744
    s_waitcnt lgkmcnt(8)
    v_max_f32 v121, 0, v121
    v_mfma_f32_16x16x32_bf16 v[156:159], v[192:195], v[216:219], v[156:159]
    ds_read_b128 v[192:195], v1 offset:32768
    s_add_u32 s93, s93, 4096
    buffer_load_dwordx4 v[216:219], v1, s[32:35], s93 offen offset:0 sc1
    v_mfma_f32_16x16x32_bf16 v[132:135], v[196:199], v[220:223], v[132:135]
    ds_read_b128 v[196:199], v1 offset:33792
    v_cvt_pk_bf16_f32 v121, v121, v120
    v_and_b32 v120, 0xffff0000, v121
    v_mfma_f32_16x16x32_bf16 v[136:139], v[200:203], v[220:223], v[136:139]
    ds_read_b128 v[200:203], v1 offset:34816
    v_lshlrev_b32 v121, 16, v121
    v_add_f32 v121, 0x3727c5ac, v121
    v_mfma_f32_16x16x32_bf16 v[140:143], v[204:207], v[220:223], v[140:143]
    ds_read_b128 v[204:207], v1 offset:35840
    s_waitcnt lgkmcnt(8)
    v_cvt_pk_bf16_f32 v121, v121, v121
    v_mfma_f32_16x16x32_bf16 v[144:147], v[160:163], v[220:223], v[144:147]
    ds_read_b128 v[160:163], v1 offset:36864
    v_lshlrev_b32 v121, 16, v121
    v_sqrt_f32 v121, v121
    v_mfma_f32_16x16x32_bf16 v[148:151], v[164:167], v[220:223], v[148:151]
    ds_read_b128 v[164:167], v1 offset:37888
    v_cvt_pk_bf16_f32 v121, v121, v121
    v_mfma_f32_16x16x32_bf16 v[152:155], v[168:171], v[220:223], v[152:155]
    ds_read_b128 v[168:171], v1 offset:38912
    v_lshlrev_b32 v121, 16, v121
    v_rcp_f32 v122, v121
    v_mfma_f32_16x16x32_bf16 v[156:159], v[172:175], v[220:223], v[156:159]
    ds_read_b128 v[172:175], v1 offset:39936
    s_waitcnt lgkmcnt(8)
    buffer_load_dwordx4 v[220:223], v1, s[32:35], s93 offen offset:1024 sc1
    v_mfma_f32_16x16x32_bf16 v[132:135], v[176:179], v[224:227], v[132:135]
    ds_read_b128 v[176:179], v1 offset:40960
    v_xor_b32 v120, 0x80000000, v120
    v_mfma_f32_16x16x32_bf16 v[136:139], v[180:183], v[224:227], v[136:139]
    ds_read_b128 v[180:183], v1 offset:41984
    v_lshrrev_b32 v123, 16, v120
    v_or_b32 v120, v120, v123
    v_mfma_f32_16x16x32_bf16 v[140:143], v[184:187], v[224:227], v[140:143]
    ds_read_b128 v[184:187], v1 offset:43008
    v_or_b32 v121, v121, v123
    v_mul_f32 v54, 0x3fb8aa3b, v122
    v_mfma_f32_16x16x32_bf16 v[144:147], v[188:191], v[224:227], v[144:147]
    ds_read_b128 v[188:191], v1 offset:44032
    s_waitcnt lgkmcnt(8)
    v_cndmask_b32 v50, 0, v120, s[100:101]
    v_mfma_f32_16x16x32_bf16 v[148:151], v[192:195], v[224:227], v[148:151]
    ds_read_b128 v[192:195], v1 offset:45056
    v_cndmask_b32 v51, 0, v121, s[100:101]
    s_add_u32 s69, s87, 8192
    v_mfma_f32_16x16x32_bf16 v[152:155], v[196:199], v[224:227], v[152:155]
    ds_read_b128 v[196:199], v1 offset:46080
    buffer_load_dwordx3 v[112:114], v1, s[32:35], s69 offen offset:0 sc1
    buffer_load_dwordx3 v[116:118], v1, s[32:35], s69 offen offset:1024 sc1
    v_mfma_f32_16x16x32_bf16 v[156:159], v[200:203], v[224:227], v[156:159]
    ds_read_b128 v[200:203], v1 offset:47104
    buffer_load_dwordx4 v[224:227], v1, s[32:35], s93 offen offset:2048 sc1
    buffer_load_dwordx3 v[120:122], v1, s[32:35], s69 offen offset:2048 sc1
    v_mfma_f32_16x16x32_bf16 v[132:135], v[204:207], v[228:231], v[132:135]
    ds_read_b128 v[204:207], v1 offset:48128
    s_waitcnt lgkmcnt(8)
    buffer_load_dwordx3 v[124:126], v1, s[32:35], s69 offen offset:3072 sc1
    v_mfma_f32_16x16x32_bf16 v[136:139], v[160:163], v[228:231], v[136:139]
    ds_read_b128 v[160:163], v1 offset:49152
    v_mfma_f32_16x16x32_bf16 v[140:143], v[164:167], v[228:231], v[140:143]
    ds_read_b128 v[164:167], v1 offset:50176
    v_mfma_f32_16x16x32_bf16 v[144:147], v[168:171], v[228:231], v[144:147]
    ds_read_b128 v[168:171], v1 offset:51200
    v_mfma_f32_16x16x32_bf16 v[148:151], v[172:175], v[228:231], v[148:151]
    ds_read_b128 v[172:175], v1 offset:52224
    s_waitcnt lgkmcnt(8)
    s_waitcnt vmcnt(3)
    v_xor_b32 v114, v114, v118
    s_waitcnt vmcnt(0)
    v_xor_b32 v122, v122, v126
    v_xor_b32 v118, v118, v126
    v_xor_b32 v126, s97, v126
    v_or3_b32 v114, v114, v118, v122
    v_or_b32 v114, v114, v126
    v_cmp_ne_u32 vcc, 0, v114
    s_cbranch_vccnz SPIN_67
BACK_68:
    v_add_f32 v112, v112, v116
    v_add_f32 v113, v113, v117
    v_add_f32 v120, v120, v124
    v_add_f32 v121, v121, v125
    v_add_f32 v112, v112, v120
    v_add_f32 v113, v113, v121
    s_nop 1
    v_permlane16_swap_b32 v112, v113
    v_add_f32 v112, v112, v113
    v_mov_b32 v113, v112
    s_nop 1
    v_permlane32_swap_b32 v112, v113
    v_add_f32 v112, v112, v113
    v_mul_f32 v30, 0x3acccccd, v112
    v_mul_f32 v31, 0x3acccccd, v112
    s_nop 1
    v_permlane16_swap_b32 v30, v31
    v_fma_f32 v31, -v30, v30, v31
    v_max_f32 v31, 0, v31
    v_cvt_pk_bf16_f32 v31, v31, v30
    v_and_b32 v30, 0xffff0000, v31
    v_lshlrev_b32 v31, 16, v31
    v_add_f32 v31, 0x3727c5ac, v31
    v_cvt_pk_bf16_f32 v31, v31, v31
    v_lshlrev_b32 v31, 16, v31
    v_sqrt_f32 v31, v31
    s_nop 0
    v_cvt_pk_bf16_f32 v31, v31, v31
    v_lshlrev_b32 v31, 16, v31
    v_rcp_f32 v31, v31
    s_nop 0
    v_mul_f32 v32, -v30, v31
    v_lshlrev_b32 v102, 16, v22
    v_and_b32 v103, 0xffff0000, v22
    v_lshlrev_b32 v104, 16, v23
    v_and_b32 v105, 0xffff0000, v23
    v_lshlrev_b32 v106, 16, v24
    v_and_b32 v107, 0xffff0000, v24
    v_lshlrev_b32 v108, 16, v25
    v_and_b32 v109, 0xffff0000, v25
    v_lshlrev_b32 v110, 16, v26
    v_and_b32 v111, 0xffff0000, v26
    v_pk_fma_f32 v[112:113], v[92:93], v[30:31], v[32:33] op_sel:[0,1,0] op_sel_hi:[1,1,0]
    v_pk_fma_f32 v[114:115], v[94:95], v[30:31], v[32:33] op_sel:[0,1,0] op_sel_hi:[1,1,0]
    v_pk_fma_f32 v[116:117], v[96:97], v[30:31], v[32:33] op_sel:[0,1,0] op_sel_hi:[1,1,0]
    v_pk_fma_f32 v[118:119], v[98:99], v[30:31], v[32:33] op_sel:[0,1,0] op_sel_hi:[1,1,0]
    v_pk_fma_f32 v[120:121], v[100:101], v[30:31], v[32:33] op_sel:[0,1,0] op_sel_hi:[1,1,0]
    v_pk_fma_f32 v[92:93], v[112:113], v[102:103], v[92:93]
    v_pk_fma_f32 v[94:95], v[114:115], v[104:105], v[94:95]
    v_pk_fma_f32 v[96:97], v[116:117], v[106:107], v[96:97]
    v_pk_fma_f32 v[98:99], v[118:119], v[108:109], v[98:99]
    v_pk_fma_f32 v[100:101], v[120:121], v[110:111], v[100:101]
    v_cvt_pk_bf16_f32 v12, v92, v93
    v_cvt_pk_bf16_f32 v13, v94, v95
    v_cvt_pk_bf16_f32 v14, v96, v97
    v_cvt_pk_bf16_f32 v15, v98, v99
    v_cvt_pk_bf16_f32 v16, v100, v101
    s_add_u32 s64, s77, 40960
    s_add_u32 s65, s78, 40960
    buffer_store_dwordx4 v[12:15], v1, s[32:35], s64 offen
    buffer_store_dword v16, v1, s[32:35], s65 offen
    v_mfma_f32_16x16x32_bf16 v[152:155], v[176:179], v[228:231], v[152:155]
    ds_read_b128 v[176:179], v1 offset:53248
    v_mfma_f32_16x16x32_bf16 v[156:159], v[180:183], v[228:231], v[156:159]
    ds_read_b128 v[180:183], v1 offset:54272
    buffer_load_dwordx4 v[228:231], v1, s[32:35], s93 offen offset:3072 sc1
    v_mfma_f32_16x16x32_bf16 v[132:135], v[184:187], v[208:211], v[132:135]
    ds_read_b128 v[184:187], v1 offset:55296
    v_mfma_f32_16x16x32_bf16 v[136:139], v[188:191], v[208:211], v[136:139]
    ds_read_b128 v[188:191], v1 offset:56320
    s_waitcnt lgkmcnt(8)
    v_mfma_f32_16x16x32_bf16 v[140:143], v[192:195], v[208:211], v[140:143]
    ds_read_b128 v[192:195], v28 offset:0
    v_mfma_f32_16x16x32_bf16 v[144:147], v[196:199], v[208:211], v[144:147]
    ds_read_b128 v[196:199], v28 offset:1024
    v_mfma_f32_16x16x32_bf16 v[148:151], v[200:203], v[208:211], v[148:151]
    ds_read_b128 v[200:203], v28 offset:2048
    v_mfma_f32_16x16x32_bf16 v[152:155], v[204:207], v[208:211], v[152:155]
    ds_read_b128 v[204:207], v28 offset:3072
    s_waitcnt lgkmcnt(8)
    v_mfma_f32_16x16x32_bf16 v[156:159], v[160:163], v[208:211], v[156:159]
    ds_read_b128 v[160:163], v28 offset:4096
    s_add_u32 s93, s93, 4096
    buffer_load_dwordx4 v[208:211], v1, s[32:35], s93 offen offset:0 sc1
    v_mfma_f32_16x16x32_bf16 v[132:135], v[164:167], v[212:215], v[132:135]
    ds_read_b128 v[164:167], v28 offset:5120
    v_mfma_f32_16x16x32_bf16 v[136:139], v[168:171], v[212:215], v[136:139]
    ds_read_b128 v[168:171], v28 offset:6144
    s_add_u32 s64, s83, 128
    v_mfma_f32_16x16x32_bf16 v[140:143], v[172:175], v[212:215], v[140:143]
    ds_read_b128 v[172:175], v28 offset:7168
    s_waitcnt lgkmcnt(8)
    v_mfma_f32_16x16x32_bf16 v[144:147], v[176:179], v[212:215], v[144:147]
    ds_read_b128 v[176:179], v28 offset:8192
    v_mov_b32 v30, s97
    v_mfma_f32_16x16x32_bf16 v[148:151], v[180:183], v[212:215], v[148:151]
    ds_read_b128 v[180:183], v28 offset:9216
    v_mov_b32 v31, 0
    v_mfma_f32_16x16x32_bf16 v[152:155], v[184:187], v[212:215], v[152:155]
    ds_read_b128 v[184:187], v28 offset:10240
    s_waitcnt vmcnt(2)
    v_mfma_f32_16x16x32_bf16 v[156:159], v[188:191], v[212:215], v[156:159]
    ds_read_b128 v[188:191], v28 offset:11264
    s_waitcnt lgkmcnt(8)
    buffer_load_dwordx4 v[212:215], v1, s[32:35], s93 offen offset:1024 sc1
    v_mfma_f32_16x16x32_bf16 v[132:135], v[192:195], v[216:219], v[132:135]
    ds_read_b128 v[192:195], v28 offset:12288
    v_mfma_f32_16x16x32_bf16 v[136:139], v[196:199], v[216:219], v[136:139]
    ds_read_b128 v[196:199], v28 offset:13312
    buffer_store_dword v30, v31, s[32:35], s64 offen offset:0
    v_mfma_f32_16x16x32_bf16 v[140:143], v[200:203], v[216:219], v[140:143]
    ds_read_b128 v[200:203], v28 offset:14336
    s_add_u32 s65, s86, 532480
    v_mfma_f32_16x16x32_bf16 v[144:147], v[204:207], v[216:219], v[144:147]
    ds_read_b128 v[204:207], v28 offset:15360
    s_waitcnt lgkmcnt(8)
    v_mfma_f32_16x16x32_bf16 v[148:151], v[160:163], v[216:219], v[148:151]
    ds_read_b128 v[160:163], v28 offset:16384
    v_add_f32 v112, v92, v93
    v_mfma_f32_16x16x32_bf16 v[152:155], v[164:167], v[216:219], v[152:155]
    ds_read_b128 v[164:167], v28 offset:17408
    v_mul_f32 v113, v92, v92
    v_mfma_f32_16x16x32_bf16 v[156:159], v[168:171], v[216:219], v[156:159]
    ds_read_b128 v[168:171], v28 offset:18432
    buffer_load_dwordx4 v[216:219], v1, s[32:35], s93 offen offset:2048 sc1
    v_mfma_f32_16x16x32_bf16 v[132:135], v[172:175], v[220:223], v[132:135]
    ds_read_b128 v[172:175], v28 offset:19456
    s_waitcnt lgkmcnt(8)
    v_mfma_f32_16x16x32_bf16 v[136:139], v[176:179], v[220:223], v[136:139]
    ds_read_b128 v[176:179], v28 offset:20480
    v_mul_f32 v115, v93, v93
    v_mfma_f32_16x16x32_bf16 v[140:143], v[180:183], v[220:223], v[140:143]
    ds_read_b128 v[180:183], v28 offset:21504
    v_add_f32 v114, v94, v95
    v_mfma_f32_16x16x32_bf16 v[144:147], v[184:187], v[220:223], v[144:147]
    ds_read_b128 v[184:187], v28 offset:22528
    v_fmac_f32 v113, v94, v94
    v_mfma_f32_16x16x32_bf16 v[148:151], v[188:191], v[220:223], v[148:151]
    ds_read_b128 v[188:191], v28 offset:23552
    s_waitcnt lgkmcnt(8)
    v_mfma_f32_16x16x32_bf16 v[152:155], v[192:195], v[220:223], v[152:155]
    ds_read_b128 v[192:195], v28 offset:24576
    v_fmac_f32 v115, v95, v95
    v_mfma_f32_16x16x32_bf16 v[156:159], v[196:199], v[220:223], v[156:159]
    ds_read_b128 v[196:199], v28 offset:25600
    buffer_load_dwordx4 v[220:223], v1, s[32:35], s93 offen offset:3072 sc1
    v_mfma_f32_16x16x32_bf16 v[132:135], v[200:203], v[224:227], v[132:135]
    ds_read_b128 v[200:203], v28 offset:26624
    v_fmac_f32 v113, v96, v96
    v_mfma_f32_16x16x32_bf16 v[136:139], v[204:207], v[224:227], v[136:139]
    ds_read_b128 v[204:207], v28 offset:27648
    s_waitcnt lgkmcnt(8)
    v_mfma_f32_16x16x32_bf16 v[140:143], v[160:163], v[224:227], v[140:143]
    ds_read_b128 v[160:163], v28 offset:28672
    v_fmac_f32 v115, v97, v97
    v_mfma_f32_16x16x32_bf16 v[144:147], v[164:167], v[224:227], v[144:147]
    ds_read_b128 v[164:167], v28 offset:29696
    v_add_f32 v112, v112, v96
    v_mfma_f32_16x16x32_bf16 v[148:151], v[168:171], v[224:227], v[148:151]
    ds_read_b128 v[168:171], v28 offset:30720
    v_add_f32 v114, v114, v97
    v_mfma_f32_16x16x32_bf16 v[152:155], v[172:175], v[224:227], v[152:155]
    ds_read_b128 v[172:175], v28 offset:31744
    s_waitcnt lgkmcnt(8)
    v_mfma_f32_16x16x32_bf16 v[156:159], v[176:179], v[224:227], v[156:159]
    ds_read_b128 v[176:179], v28 offset:32768
    s_add_u32 s93, s93, 4096
    buffer_load_dwordx4 v[224:227], v1, s[32:35], s93 offen offset:0 sc1
    s_waitcnt vmcnt(6)
    v_mfma_f32_16x16x32_bf16 v[132:135], v[180:183], v[228:231], v[132:135]
    ds_read_b128 v[180:183], v28 offset:33792
    v_mfma_f32_16x16x32_bf16 v[136:139], v[184:187], v[228:231], v[136:139]
    ds_read_b128 v[184:187], v28 offset:34816
    v_fmac_f32 v113, v98, v98
    v_mfma_f32_16x16x32_bf16 v[140:143], v[188:191], v[228:231], v[140:143]
    ds_read_b128 v[188:191], v28 offset:35840
    s_waitcnt lgkmcnt(8)
    v_mfma_f32_16x16x32_bf16 v[144:147], v[192:195], v[228:231], v[144:147]
    ds_read_b128 v[192:195], v28 offset:36864
    v_fmac_f32 v115, v99, v99
    v_mfma_f32_16x16x32_bf16 v[148:151], v[196:199], v[228:231], v[148:151]
    ds_read_b128 v[196:199], v28 offset:37888
    v_add_f32 v112, v112, v98
    v_mfma_f32_16x16x32_bf16 v[152:155], v[200:203], v[228:231], v[152:155]
    ds_read_b128 v[200:203], v28 offset:38912
    v_add_f32 v114, v114, v99
    v_mfma_f32_16x16x32_bf16 v[156:159], v[204:207], v[228:231], v[156:159]
    ds_read_b128 v[204:207], v28 offset:39936
    s_waitcnt lgkmcnt(8)
    buffer_load_dwordx4 v[228:231], v1, s[32:35], s93 offen offset:1024 sc1
    s_waitcnt vmcnt(6)
    v_mfma_f32_16x16x32_bf16 v[132:135], v[160:163], v[208:211], v[132:135]
    ds_read_b128 v[160:163], v28 offset:40960
    v_mfma_f32_16x16x32_bf16 v[136:139], v[164:167], v[208:211], v[136:139]
    ds_read_b128 v[164:167], v28 offset:41984
    v_fmac_f32 v113, v100, v100
    v_mfma_f32_16x16x32_bf16 v[140:143], v[168:171], v[208:211], v[140:143]
    ds_read_b128 v[168:171], v28 offset:43008
    v_fmac_f32 v115, v101, v101
    v_mfma_f32_16x16x32_bf16 v[144:147], v[172:175], v[208:211], v[144:147]
    ds_read_b128 v[172:175], v28 offset:44032
    s_waitcnt lgkmcnt(8)
    v_mfma_f32_16x16x32_bf16 v[148:151], v[176:179], v[208:211], v[148:151]
    ds_read_b128 v[176:179], v28 offset:45056
    v_add_f32 v112, v112, v100
    v_mfma_f32_16x16x32_bf16 v[152:155], v[180:183], v[208:211], v[152:155]
    ds_read_b128 v[180:183], v28 offset:46080
    v_add_f32 v114, v114, v101
    v_mfma_f32_16x16x32_bf16 v[156:159], v[184:187], v[208:211], v[156:159]
    ds_read_b128 v[184:187], v28 offset:47104
    buffer_load_dwordx4 v[208:211], v1, s[32:35], s93 offen offset:2048 sc1
    s_waitcnt vmcnt(6)
    v_mfma_f32_16x16x32_bf16 v[132:135], v[188:191], v[212:215], v[132:135]
    ds_read_b128 v[188:191], v28 offset:48128
    s_waitcnt lgkmcnt(8)
    v_mfma_f32_16x16x32_bf16 v[136:139], v[192:195], v[212:215], v[136:139]
    ds_read_b128 v[192:195], v28 offset:49152
    v_add_f32 v112, v112, v114
    v_mfma_f32_16x16x32_bf16 v[140:143], v[196:199], v[212:215], v[140:143]
    ds_read_b128 v[196:199], v28 offset:50176
    v_add_f32 v113, v113, v115
    v_mfma_f32_16x16x32_bf16 v[144:147], v[200:203], v[212:215], v[144:147]
    ds_read_b128 v[200:203], v28 offset:51200
    v_lshlrev_b32 v115, 4, v2
    v_mfma_f32_16x16x32_bf16 v[148:151], v[204:207], v[212:215], v[148:151]
    ds_read_b128 v[204:207], v28 offset:52224
    s_waitcnt lgkmcnt(8)
    v_mfma_f32_16x16x32_bf16 v[152:155], v[160:163], v[212:215], v[152:155]
    ds_read_b128 v[160:163], v28 offset:53248
    v_mov_b32 v114, s97
    v_mfma_f32_16x16x32_bf16 v[156:159], v[164:167], v[212:215], v[156:159]
    ds_read_b128 v[164:167], v28 offset:54272
    buffer_load_dwordx4 v[212:215], v1, s[32:35], s93 offen offset:3072 sc1
    s_waitcnt vmcnt(5)
    v_mfma_f32_16x16x32_bf16 v[132:135], v[168:171], v[216:219], v[132:135]
    ds_read_b128 v[168:171], v28 offset:55296
    v_permlane16_swap_b32 v112, v113
    v_mfma_f32_16x16x32_bf16 v[136:139], v[172:175], v[216:219], v[136:139]
    ds_read_b128 v[172:175], v28 offset:56320
    s_waitcnt lgkmcnt(8)
    v_mfma_f32_16x16x32_bf16 v[140:143], v[176:179], v[216:219], v[140:143]
    ds_read_b128 v[176:179], v29 offset:0
    v_add_f32 v112, v112, v113
    v_mfma_f32_16x16x32_bf16 v[144:147], v[180:183], v[216:219], v[144:147]
    ds_read_b128 v[180:183], v29 offset:1024
    v_mov_b32 v113, v112
    v_mfma_f32_16x16x32_bf16 v[148:151], v[184:187], v[216:219], v[148:151]
    ds_read_b128 v[184:187], v29 offset:2048
    v_permlane32_swap_b32 v112, v113
    v_mfma_f32_16x16x32_bf16 v[152:155], v[188:191], v[216:219], v[152:155]
    ds_read_b128 v[188:191], v29 offset:3072
    s_waitcnt lgkmcnt(8)
    v_mfma_f32_16x16x32_bf16 v[156:159], v[192:195], v[216:219], v[156:159]
    ds_read_b128 v[192:195], v29 offset:4096
    v_add_f32 v112, v112, v113
    s_waitcnt vmcnt(4)
    v_mfma_f32_16x16x32_bf16 v[132:135], v[196:199], v[220:223], v[132:135]
    ds_read_b128 v[196:199], v29 offset:5120
    v_mov_b32 v113, v112
    v_mfma_f32_16x16x32_bf16 v[136:139], v[200:203], v[220:223], v[136:139]
    ds_read_b128 v[200:203], v29 offset:6144
    v_permlane16_swap_b32 v112, v113
    v_mfma_f32_16x16x32_bf16 v[140:143], v[204:207], v[220:223], v[140:143]
    ds_read_b128 v[204:207], v29 offset:7168
    s_waitcnt lgkmcnt(8)
    v_mfma_f32_16x16x32_bf16 v[144:147], v[160:163], v[220:223], v[144:147]
    ds_read_b128 v[160:163], v29 offset:8192
    buffer_store_dwordx3 v[112:114], v115, s[32:35], s65 offen offset:0
    v_mfma_f32_16x16x32_bf16 v[148:151], v[164:167], v[220:223], v[148:151]
    ds_read_b128 v[164:167], v29 offset:9216
    v_mfma_f32_16x16x32_bf16 v[152:155], v[168:171], v[220:223], v[152:155]
    ds_read_b128 v[168:171], v29 offset:10240
    v_mfma_f32_16x16x32_bf16 v[156:159], v[172:175], v[220:223], v[156:159]
    ds_read_b128 v[172:175], v29 offset:11264
    s_waitcnt lgkmcnt(8)
    s_waitcnt vmcnt(4)
    v_mfma_f32_16x16x32_bf16 v[132:135], v[176:179], v[224:227], v[132:135]
    ds_read_b128 v[176:179], v29 offset:12288
    v_mfma_f32_16x16x32_bf16 v[136:139], v[180:183], v[224:227], v[136:139]
    ds_read_b128 v[180:183], v29 offset:13312
    v_mfma_f32_16x16x32_bf16 v[140:143], v[184:187], v[224:227], v[140:143]
    ds_read_b128 v[184:187], v29 offset:14336
    v_mfma_f32_16x16x32_bf16 v[144:147], v[188:191], v[224:227], v[144:147]
    ds_read_b128 v[188:191], v29 offset:15360
    s_waitcnt lgkmcnt(8)
    v_mfma_f32_16x16x32_bf16 v[148:151], v[192:195], v[224:227], v[148:151]
    ds_read_b128 v[192:195], v29 offset:16384
    v_mfma_f32_16x16x32_bf16 v[152:155], v[196:199], v[224:227], v[152:155]
    ds_read_b128 v[196:199], v29 offset:17408
    v_mfma_f32_16x16x32_bf16 v[156:159], v[200:203], v[224:227], v[156:159]
    ds_read_b128 v[200:203], v29 offset:18432
    s_waitcnt vmcnt(3)
    v_mfma_f32_16x16x32_bf16 v[132:135], v[204:207], v[228:231], v[132:135]
    ds_read_b128 v[204:207], v29 offset:19456
    s_waitcnt lgkmcnt(8)
    v_mfma_f32_16x16x32_bf16 v[136:139], v[160:163], v[228:231], v[136:139]
    ds_read_b128 v[160:163], v29 offset:20480
    v_mfma_f32_16x16x32_bf16 v[140:143], v[164:167], v[228:231], v[140:143]
    ds_read_b128 v[164:167], v29 offset:21504
    v_mfma_f32_16x16x32_bf16 v[144:147], v[168:171], v[228:231], v[144:147]
    ds_read_b128 v[168:171], v29 offset:22528
    v_mfma_f32_16x16x32_bf16 v[148:151], v[172:175], v[228:231], v[148:151]
    ds_read_b128 v[172:175], v29 offset:23552
    s_waitcnt lgkmcnt(8)
    v_mfma_f32_16x16x32_bf16 v[152:155], v[176:179], v[228:231], v[152:155]
    ds_read_b128 v[176:179], v29 offset:24576
    v_mfma_f32_16x16x32_bf16 v[156:159], v[180:183], v[228:231], v[156:159]
    ds_read_b128 v[180:183], v29 offset:25600
    s_waitcnt vmcnt(2)
    v_mfma_f32_16x16x32_bf16 v[132:135], v[184:187], v[208:211], v[132:135]
    ds_read_b128 v[184:187], v29 offset:26624
    v_mfma_f32_16x16x32_bf16 v[136:139], v[188:191], v[208:211], v[136:139]
    ds_read_b128 v[188:191], v29 offset:27648
    s_waitcnt lgkmcnt(8)
    v_mfma_f32_16x16x32_bf16 v[140:143], v[192:195], v[208:211], v[140:143]
    ds_read_b128 v[192:195], v1 offset:0
    v_mfma_f32_16x16x32_bf16 v[144:147], v[196:199], v[208:211], v[144:147]
    ds_read_b128 v[196:199], v1 offset:1024
    v_mfma_f32_16x16x32_bf16 v[148:151], v[200:203], v[208:211], v[148:151]
    ds_read_b128 v[200:203], v1 offset:2048
    v_mfma_f32_16x16x32_bf16 v[152:155], v[204:207], v[208:211], v[152:155]
    ds_read_b128 v[204:207], v1 offset:3072
    s_waitcnt lgkmcnt(8)
    v_mfma_f32_16x16x32_bf16 v[156:159], v[160:163], v[208:211], v[156:159]
    ds_read_b128 v[160:163], v1 offset:4096
    s_waitcnt vmcnt(1)
    v_mfma_f32_16x16x32_bf16 v[132:135], v[164:167], v[212:215], v[132:135]
    ds_read_b128 v[164:167], v1 offset:5120
    v_mfma_f32_16x16x32_bf16 v[136:139], v[168:171], v[212:215], v[136:139]
    ds_read_b128 v[168:171], v1 offset:6144
    v_mfma_f32_16x16x32_bf16 v[140:143], v[172:175], v[212:215], v[140:143]
    ds_read_b128 v[172:175], v1 offset:7168
    s_waitcnt lgkmcnt(8)
    v_mfma_f32_16x16x32_bf16 v[144:147], v[176:179], v[212:215], v[144:147]
    ds_read_b128 v[176:179], v1 offset:8192
    v_mfma_f32_16x16x32_bf16 v[148:151], v[180:183], v[212:215], v[148:151]
    ds_read_b128 v[180:183], v1 offset:9216
    v_mfma_f32_16x16x32_bf16 v[152:155], v[184:187], v[212:215], v[152:155]
    ds_read_b128 v[184:187], v1 offset:10240
    v_mfma_f32_16x16x32_bf16 v[156:159], v[188:191], v[212:215], v[156:159]
    ds_read_b128 v[188:191], v1 offset:11264
    s_waitcnt lgkmcnt(8)
    v_mfma_f32_16x16x16_bf16 v[132:135], v[36:37], v[50:51], v[132:135]
    v_mfma_f32_16x16x16_bf16 v[136:139], v[38:39], v[50:51], v[136:139]
    v_mfma_f32_16x16x16_bf16 v[140:143], v[40:41], v[50:51], v[140:143]
    v_mfma_f32_16x16x16_bf16 v[144:147], v[42:43], v[50:51], v[144:147]
    v_mfma_f32_16x16x16_bf16 v[148:151], v[44:45], v[50:51], v[148:151]
    v_mfma_f32_16x16x16_bf16 v[152:155], v[46:47], v[50:51], v[152:155]
    v_mfma_f32_16x16x16_bf16 v[156:159], v[48:49], v[50:51], v[156:159]
    v_lshlrev_b32 v121, 2, v2
    s_add_u32 s66, s82, 128
    buffer_load_dword v120, v121, s[32:35], s66 offen sc1
    v_mov_b32 v108, 0x3f317218
    v_mov_b32 v110, 0xbfb17218
    s_add_u32 s64, s79, 0
    s_add_u32 s65, s80, 0
    v_pk_mul_f32 v[132:133], v[132:133], v[54:55] op_sel:[0,0] op_sel_hi:[1,0]
    v_pk_mul_f32 v[134:135], v[134:135], v[54:55] op_sel:[0,0] op_sel_hi:[1,0]
    v_pk_mul_f32 v[136:137], v[136:137], v[54:55] op_sel:[0,0] op_sel_hi:[1,0]
    v_pk_mul_f32 v[138:139], v[138:139], v[54:55] op_sel:[0,0] op_sel_hi:[1,0]
    v_exp_f32 v92, v132
    v_exp_f32 v93, v133
    v_exp_f32 v94, v134
    v_exp_f32 v95, v135
    v_exp_f32 v96, v136
    v_exp_f32 v97, v137
    v_exp_f32 v98, v138
    v_exp_f32 v99, v139
    v_pk_add_f32 v[92:93], v[92:93], 1.0 op_sel_hi:[1,0]
    v_pk_add_f32 v[94:95], v[94:95], 1.0 op_sel_hi:[1,0]
    v_pk_add_f32 v[96:97], v[96:97], 1.0 op_sel_hi:[1,0]
    v_pk_add_f32 v[98:99], v[98:99], 1.0 op_sel_hi:[1,0]
    v_pk_fma_f32 v[92:93], v[92:93], v[92:93], 1.0 op_sel_hi:[1,1,0]
    v_pk_fma_f32 v[94:95], v[94:95], v[94:95], 1.0 op_sel_hi:[1,1,0]
    v_pk_fma_f32 v[96:97], v[96:97], v[96:97], 1.0 op_sel_hi:[1,1,0]
    v_pk_fma_f32 v[98:99], v[98:99], v[98:99], 1.0 op_sel_hi:[1,1,0]
    v_rcp_f32 v92, v92
    v_rcp_f32 v93, v93
    v_rcp_f32 v94, v94
    v_rcp_f32 v95, v95
    v_rcp_f32 v96, v96
    v_rcp_f32 v97, v97
    v_rcp_f32 v98, v98
    v_rcp_f32 v99, v99
    v_pk_fma_f32 v[92:93], v[92:93], v[110:111], v[108:109] op_sel_hi:[1,0,0]
    v_pk_fma_f32 v[94:95], v[94:95], v[110:111], v[108:109] op_sel_hi:[1,0,0]
    v_pk_fma_f32 v[96:97], v[96:97], v[110:111], v[108:109] op_sel_hi:[1,0,0]
    v_pk_fma_f32 v[98:99], v[98:99], v[110:111], v[108:109] op_sel_hi:[1,0,0]
    v_pk_mul_f32 v[132:133], v[132:133], v[92:93]
    v_pk_mul_f32 v[134:135], v[134:135], v[94:95]
    v_pk_mul_f32 v[136:137], v[136:137], v[96:97]
    v_pk_mul_f32 v[138:139], v[138:139], v[98:99]
    v_cvt_pk_bf16_f32 v100, v132, v133
    v_cvt_pk_bf16_f32 v101, v134, v135
    v_cvt_pk_bf16_f32 v102, v136, v137
    v_cvt_pk_bf16_f32 v103, v138, v139
    buffer_store_dwordx4 v[100:103], v1, s[32:35], s64 offen offset:0 sc1
    v_pk_mul_f32 v[140:141], v[140:141], v[54:55] op_sel:[0,0] op_sel_hi:[1,0]
    v_pk_mul_f32 v[142:143], v[142:143], v[54:55] op_sel:[0,0] op_sel_hi:[1,0]
    v_pk_mul_f32 v[144:145], v[144:145], v[54:55] op_sel:[0,0] op_sel_hi:[1,0]
    v_pk_mul_f32 v[146:147], v[146:147], v[54:55] op_sel:[0,0] op_sel_hi:[1,0]
    v_exp_f32 v92, v140
    v_exp_f32 v93, v141
    v_exp_f32 v94, v142
    v_exp_f32 v95, v143
    v_exp_f32 v96, v144
    v_exp_f32 v97, v145
    v_exp_f32 v98, v146
    v_exp_f32 v99, v147
    v_pk_add_f32 v[92:93], v[92:93], 1.0 op_sel_hi:[1,0]
    v_pk_add_f32 v[94:95], v[94:95], 1.0 op_sel_hi:[1,0]
    v_pk_add_f32 v[96:97], v[96:97], 1.0 op_sel_hi:[1,0]
    v_pk_add_f32 v[98:99], v[98:99], 1.0 op_sel_hi:[1,0]
    v_pk_fma_f32 v[92:93], v[92:93], v[92:93], 1.0 op_sel_hi:[1,1,0]
    v_pk_fma_f32 v[94:95], v[94:95], v[94:95], 1.0 op_sel_hi:[1,1,0]
    v_pk_fma_f32 v[96:97], v[96:97], v[96:97], 1.0 op_sel_hi:[1,1,0]
    v_pk_fma_f32 v[98:99], v[98:99], v[98:99], 1.0 op_sel_hi:[1,1,0]
    v_rcp_f32 v92, v92
    v_rcp_f32 v93, v93
    v_rcp_f32 v94, v94
    v_rcp_f32 v95, v95
    v_rcp_f32 v96, v96
    v_rcp_f32 v97, v97
    v_rcp_f32 v98, v98
    v_rcp_f32 v99, v99
    v_pk_fma_f32 v[92:93], v[92:93], v[110:111], v[108:109] op_sel_hi:[1,0,0]
    v_pk_fma_f32 v[94:95], v[94:95], v[110:111], v[108:109] op_sel_hi:[1,0,0]
    v_pk_fma_f32 v[96:97], v[96:97], v[110:111], v[108:109] op_sel_hi:[1,0,0]
    v_pk_fma_f32 v[98:99], v[98:99], v[110:111], v[108:109] op_sel_hi:[1,0,0]
    v_pk_mul_f32 v[140:141], v[140:141], v[92:93]
    v_pk_mul_f32 v[142:143], v[142:143], v[94:95]
    v_pk_mul_f32 v[144:145], v[144:145], v[96:97]
    v_pk_mul_f32 v[146:147], v[146:147], v[98:99]
    v_cvt_pk_bf16_f32 v104, v140, v141
    v_cvt_pk_bf16_f32 v105, v142, v143
    v_cvt_pk_bf16_f32 v106, v144, v145
    v_cvt_pk_bf16_f32 v107, v146, v147
    buffer_store_dwordx4 v[104:107], v1, s[32:35], s64 offen offset:1024 sc1
    s_waitcnt vmcnt(2)
    v_cmp_ne_u32 vcc, s97, v120
    s_cbranch_vccnz SPIN_71
BACK_72:
    v_pk_mul_f32 v[148:149], v[148:149], v[54:55] op_sel:[0,0] op_sel_hi:[1,0]
    v_pk_mul_f32 v[150:151], v[150:151], v[54:55] op_sel:[0,0] op_sel_hi:[1,0]
    v_pk_mul_f32 v[152:153], v[152:153], v[54:55] op_sel:[0,0] op_sel_hi:[1,0]
    s_add_u32 s98, s76, 40960
    buffer_load_dwordx4 v[216:219], v1, s[32:35], s98 offen offset:0 sc1
    v_pk_mul_f32 v[154:155], v[154:155], v[54:55] op_sel:[0,0] op_sel_hi:[1,0]
    v_exp_f32 v92, v148
    v_exp_f32 v93, v149
    v_exp_f32 v94, v150
    v_exp_f32 v95, v151
    buffer_load_dwordx4 v[220:223], v1, s[32:35], s98 offen offset:1024 sc1
    v_exp_f32 v96, v152
    v_exp_f32 v97, v153
    v_exp_f32 v98, v154
    v_exp_f32 v99, v155
    v_pk_add_f32 v[92:93], v[92:93], 1.0 op_sel_hi:[1,0]
    buffer_load_dwordx4 v[224:227], v1, s[32:35], s98 offen offset:2048 sc1
    v_pk_add_f32 v[94:95], v[94:95], 1.0 op_sel_hi:[1,0]
    v_pk_add_f32 v[96:97], v[96:97], 1.0 op_sel_hi:[1,0]
    v_pk_add_f32 v[98:99], v[98:99], 1.0 op_sel_hi:[1,0]
    v_pk_fma_f32 v[92:93], v[92:93], v[92:93], 1.0 op_sel_hi:[1,1,0]
    v_pk_fma_f32 v[94:95], v[94:95], v[94:95], 1.0 op_sel_hi:[1,1,0]
    buffer_load_dwordx4 v[228:231], v1, s[32:35], s98 offen offset:3072 sc1
    v_pk_fma_f32 v[96:97], v[96:97], v[96:97], 1.0 op_sel_hi:[1,1,0]
    v_pk_fma_f32 v[98:99], v[98:99], v[98:99], 1.0 op_sel_hi:[1,1,0]
    v_rcp_f32 v92, v92
    v_rcp_f32 v93, v93
    v_rcp_f32 v94, v94
    s_add_u32 s98, s98, 4096
    buffer_load_dwordx4 v[208:211], v1, s[32:35], s98 offen offset:0 sc1
    v_rcp_f32 v95, v95
    v_rcp_f32 v96, v96
    v_rcp_f32 v97, v97
    v_rcp_f32 v98, v98
    v_rcp_f32 v99, v99
    buffer_load_dwordx4 v[212:215], v1, s[32:35], s98 offen offset:1024 sc1
    v_pk_fma_f32 v[92:93], v[92:93], v[110:111], v[108:109] op_sel_hi:[1,0,0]
    v_pk_fma_f32 v[94:95], v[94:95], v[110:111], v[108:109] op_sel_hi:[1,0,0]
    v_pk_fma_f32 v[96:97], v[96:97], v[110:111], v[108:109] op_sel_hi:[1,0,0]
    v_pk_fma_f32 v[98:99], v[98:99], v[110:111], v[108:109] op_sel_hi:[1,0,0]
    v_pk_mul_f32 v[148:149], v[148:149], v[92:93]
    v_pk_mul_f32 v[150:151], v[150:151], v[94:95]
    v_pk_mul_f32 v[152:153], v[152:153], v[96:97]
    v_pk_mul_f32 v[154:155], v[154:155], v[98:99]
    v_cvt_pk_bf16_f32 v100, v148, v149
    v_cvt_pk_bf16_f32 v101, v150, v151
    v_cvt_pk_bf16_f32 v102, v152, v153
    v_cvt_pk_bf16_f32 v103, v154, v155
    buffer_store_dwordx4 v[100:103], v1, s[32:35], s64 offen offset:2048 sc1
    v_pk_mul_f32 v[156:157], v[156:157], v[54:55] op_sel:[0,0] op_sel_hi:[1,0]
    v_pk_mul_f32 v[158:159], v[158:159], v[54:55] op_sel:[0,0] op_sel_hi:[1,0]
    v_exp_f32 v92, v156
    v_exp_f32 v93, v157
    v_exp_f32 v94, v158
    v_exp_f32 v95, v159
    v_pk_add_f32 v[92:93], v[92:93], 1.0 op_sel_hi:[1,0]
    v_pk_add_f32 v[94:95], v[94:95], 1.0 op_sel_hi:[1,0]
    v_pk_fma_f32 v[92:93], v[92:93], v[92:93], 1.0 op_sel_hi:[1,1,0]
    v_pk_fma_f32 v[94:95], v[94:95], v[94:95], 1.0 op_sel_hi:[1,1,0]
    v_rcp_f32 v92, v92
    v_rcp_f32 v93, v93
    v_rcp_f32 v94, v94
    v_rcp_f32 v95, v95
    v_pk_fma_f32 v[92:93], v[92:93], v[110:111], v[108:109] op_sel_hi:[1,0,0]
    v_pk_fma_f32 v[94:95], v[94:95], v[110:111], v[108:109] op_sel_hi:[1,0,0]
    v_pk_mul_f32 v[156:157], v[156:157], v[92:93]
    v_pk_mul_f32 v[158:159], v[158:159], v[94:95]
    v_cvt_pk_bf16_f32 v104, v156, v157
    v_cvt_pk_bf16_f32 v105, v158, v159
    buffer_store_dwordx2 v[104:105], v4, s[32:35], s65 offen sc1
    s_waitcnt vmcnt(7)
    v_mfma_f32_16x16x32_bf16 v[92:95], v[192:195], v[216:219], 0
    ds_read_b128 v[192:195], v1 offset:12288
    v_mfma_f32_16x16x32_bf16 v[96:99], v[196:199], v[216:219], 0
    ds_read_b128 v[196:199], v1 offset:13312
    v_mfma_f32_16x16x32_bf16 v[100:103], v[200:203], v[216:219], 0
    ds_read_b128 v[200:203], v1 offset:14336
    v_mfma_f32_16x16x32_bf16 v[104:107], v[204:207], v[216:219], 0
    ds_read_b128 v[204:207], v1 offset:15360
    s_waitcnt lgkmcnt(8)
    v_mfma_f32_16x16x32_bf16 v[108:111], v[160:163], v[216:219], 0
    ds_read_b128 v[160:163], v1 offset:16384
    v_mfma_f32_16x16x32_bf16 v[112:115], v[164:167], v[216:219], 0
    ds_read_b128 v[164:167], v1 offset:17408
    v_mfma_f32_16x16x32_bf16 v[116:119], v[168:171], v[216:219], 0
    ds_read_b128 v[168:171], v1 offset:18432
    buffer_load_dwordx4 v[216:219], v1, s[32:35], s98 offen offset:2048 sc1
    s_waitcnt vmcnt(7)
    v_mfma_f32_16x16x32_bf16 v[92:95], v[172:175], v[220:223], v[92:95]
    ds_read_b128 v[172:175], v1 offset:19456
    s_waitcnt lgkmcnt(8)
    v_mfma_f32_16x16x32_bf16 v[96:99], v[176:179], v[220:223], v[96:99]
    ds_read_b128 v[176:179], v1 offset:20480
    v_mfma_f32_16x16x32_bf16 v[100:103], v[180:183], v[220:223], v[100:103]
    ds_read_b128 v[180:183], v1 offset:21504
    v_mfma_f32_16x16x32_bf16 v[104:107], v[184:187], v[220:223], v[104:107]
    ds_read_b128 v[184:187], v1 offset:22528
    v_mfma_f32_16x16x32_bf16 v[108:111], v[188:191], v[220:223], v[108:111]
    ds_read_b128 v[188:191], v1 offset:23552
    s_waitcnt lgkmcnt(8)
    v_mfma_f32_16x16x32_bf16 v[112:115], v[192:195], v[220:223], v[112:115]
    ds_read_b128 v[192:195], v1 offset:24576
    v_mfma_f32_16x16x32_bf16 v[116:119], v[196:199], v[220:223], v[116:119]
    ds_read_b128 v[196:199], v1 offset:25600
    buffer_load_dwordx4 v[220:223], v1, s[32:35], s98 offen offset:3072 sc1
    s_waitcnt vmcnt(7)
    v_mfma_f32_16x16x32_bf16 v[92:95], v[200:203], v[224:227], v[92:95]
    ds_read_b128 v[200:203], v1 offset:26624
    v_mfma_f32_16x16x32_bf16 v[96:99], v[204:207], v[224:227], v[96:99]
    ds_read_b128 v[204:207], v1 offset:27648
    s_waitcnt lgkmcnt(8)
    v_mfma_f32_16x16x32_bf16 v[100:103], v[160:163], v[224:227], v[100:103]
    ds_read_b128 v[160:163], v1 offset:28672
    v_mfma_f32_16x16x32_bf16 v[104:107], v[164:167], v[224:227], v[104:107]
    ds_read_b128 v[164:167], v1 offset:29696
    v_mfma_f32_16x16x32_bf16 v[108:111], v[168:171], v[224:227], v[108:111]
    ds_read_b128 v[168:171], v1 offset:30720
    v_mfma_f32_16x16x32_bf16 v[112:115], v[172:175], v[224:227], v[112:115]
    ds_read_b128 v[172:175], v1 offset:31744
    s_waitcnt lgkmcnt(8)
    v_mfma_f32_16x16x32_bf16 v[116:119], v[176:179], v[224:227], v[116:119]
    ds_read_b128 v[176:179], v1 offset:32768
    s_add_u32 s98, s98, 4096
    buffer_load_dwordx4 v[224:227], v1, s[32:35], s98 offen offset:0 sc1
    s_waitcnt vmcnt(7)
    v_mfma_f32_16x16x32_bf16 v[92:95], v[180:183], v[228:231], v[92:95]
    ds_read_b128 v[180:183], v1 offset:33792
    v_mfma_f32_16x16x32_bf16 v[96:99], v[184:187], v[228:231], v[96:99]
    ds_read_b128 v[184:187], v1 offset:34816
    s_add_u32 s68, s85, 0
    v_mfma_f32_16x16x32_bf16 v[100:103], v[188:191], v[228:231], v[100:103]
    ds_read_b128 v[188:191], v1 offset:35840
    s_waitcnt lgkmcnt(8)
    v_mfma_f32_16x16x32_bf16 v[104:107], v[192:195], v[228:231], v[104:107]
    ds_read_b128 v[192:195], v1 offset:36864
    v_mov_b32 v32, s97
    v_mfma_f32_16x16x32_bf16 v[108:111], v[196:199], v[228:231], v[108:111]
    ds_read_b128 v[196:199], v1 offset:37888
    v_mov_b32 v33, 0
    v_mfma_f32_16x16x32_bf16 v[112:115], v[200:203], v[228:231], v[112:115]
    ds_read_b128 v[200:203], v1 offset:38912
    s_waitcnt vmcnt(3)
    v_mfma_f32_16x16x32_bf16 v[116:119], v[204:207], v[228:231], v[116:119]
    ds_read_b128 v[204:207], v1 offset:39936
    s_waitcnt lgkmcnt(8)
    buffer_load_dwordx4 v[228:231], v1, s[32:35], s98 offen offset:1024 sc1
    v_mfma_f32_16x16x32_bf16 v[92:95], v[160:163], v[208:211], v[92:95]
    ds_read_b128 v[160:163], v1 offset:40960
    v_mfma_f32_16x16x32_bf16 v[96:99], v[164:167], v[208:211], v[96:99]
    ds_read_b128 v[164:167], v1 offset:41984
    buffer_store_dword v32, v33, s[32:35], s68 offen offset:0
    v_mfma_f32_16x16x32_bf16 v[100:103], v[168:171], v[208:211], v[100:103]
    ds_read_b128 v[168:171], v1 offset:43008
    s_add_u32 s69, s88, 532480
    v_mfma_f32_16x16x32_bf16 v[104:107], v[172:175], v[208:211], v[104:107]
    ds_read_b128 v[172:175], v1 offset:44032
    s_waitcnt lgkmcnt(8)
    v_mfma_f32_16x16x32_bf16 v[108:111], v[176:179], v[208:211], v[108:111]
    ds_read_b128 v[176:179], v1 offset:45056
    buffer_load_dwordx3 v[120:122], v1, s[32:35], s69 offen offset:0 sc1
    v_mfma_f32_16x16x32_bf16 v[112:115], v[180:183], v[208:211], v[112:115]
    ds_read_b128 v[180:183], v1 offset:46080
    buffer_load_dwordx3 v[124:126], v1, s[32:35], s69 offen offset:1024 sc1
    v_mfma_f32_16x16x32_bf16 v[116:119], v[184:187], v[208:211], v[116:119]
    ds_read_b128 v[184:187], v1 offset:47104
    buffer_load_dwordx4 v[208:211], v1, s[32:35], s98 offen offset:2048 sc1
    v_mfma_f32_16x16x32_bf16 v[92:95], v[188:191], v[212:215], v[92:95]
    ds_read_b128 v[188:191], v1 offset:48128
    s_waitcnt lgkmcnt(8)
    v_mfma_f32_16x16x32_bf16 v[96:99], v[192:195], v[212:215], v[96:99]
    ds_read_b128 v[192:195], v1 offset:49152
    buffer_load_dwordx3 v[128:130], v1, s[32:35], s69 offen offset:2048 sc1
    v_mfma_f32_16x16x32_bf16 v[100:103], v[196:199], v[212:215], v[100:103]
    ds_read_b128 v[196:199], v1 offset:50176
    buffer_load_dwordx3 v[132:134], v1, s[32:35], s69 offen offset:3072 sc1
    v_mfma_f32_16x16x32_bf16 v[104:107], v[200:203], v[212:215], v[104:107]
    ds_read_b128 v[200:203], v1 offset:51200
    v_mfma_f32_16x16x32_bf16 v[108:111], v[204:207], v[212:215], v[108:111]
    ds_read_b128 v[204:207], v1 offset:52224
    s_waitcnt lgkmcnt(8)
    v_mfma_f32_16x16x32_bf16 v[112:115], v[160:163], v[212:215], v[112:115]
    ds_read_b128 v[160:163], v1 offset:53248
    v_mfma_f32_16x16x32_bf16 v[116:119], v[164:167], v[212:215], v[116:119]
    ds_read_b128 v[164:167], v1 offset:54272
    buffer_load_dwordx4 v[212:215], v1, s[32:35], s98 offen offset:3072 sc1
    s_waitcnt vmcnt(10)
    v_mfma_f32_16x16x32_bf16 v[92:95], v[168:171], v[216:219], v[92:95]
    ds_read_b128 v[168:171], v1 offset:55296
    v_mfma_f32_16x16x32_bf16 v[96:99], v[172:175], v[216:219], v[96:99]
    ds_read_b128 v[172:175], v1 offset:56320
    s_waitcnt lgkmcnt(8)
    v_mfma_f32_16x16x32_bf16 v[100:103], v[176:179], v[216:219], v[100:103]
    ds_read_b128 v[176:179], v28 offset:0
    v_mfma_f32_16x16x32_bf16 v[104:107], v[180:183], v[216:219], v[104:107]
    ds_read_b128 v[180:183], v28 offset:1024
    v_mfma_f32_16x16x32_bf16 v[108:111], v[184:187], v[216:219], v[108:111]
    ds_read_b128 v[184:187], v28 offset:2048
    v_mfma_f32_16x16x32_bf16 v[112:115], v[188:191], v[216:219], v[112:115]
    ds_read_b128 v[188:191], v28 offset:3072
    s_waitcnt lgkmcnt(8)
    v_mfma_f32_16x16x32_bf16 v[116:119], v[192:195], v[216:219], v[116:119]
    ds_read_b128 v[192:195], v28 offset:4096
    s_add_u32 s98, s98, 4096
    buffer_load_dwordx4 v[216:219], v1, s[32:35], s98 offen offset:0 sc1
    s_waitcnt vmcnt(10)
    v_mfma_f32_16x16x32_bf16 v[92:95], v[196:199], v[220:223], v[92:95]
    ds_read_b128 v[196:199], v28 offset:5120
    v_mfma_f32_16x16x32_bf16 v[96:99], v[200:203], v[220:223], v[96:99]
    ds_read_b128 v[200:203], v28 offset:6144
    v_mfma_f32_16x16x32_bf16 v[100:103], v[204:207], v[220:223], v[100:103]
    ds_read_b128 v[204:207], v28 offset:7168
    s_waitcnt lgkmcnt(8)
    v_mfma_f32_16x16x32_bf16 v[104:107], v[160:163], v[220:223], v[104:107]
    ds_read_b128 v[160:163], v28 offset:8192
    v_mfma_f32_16x16x32_bf16 v[108:111], v[164:167], v[220:223], v[108:111]
    ds_read_b128 v[164:167], v28 offset:9216
    v_mfma_f32_16x16x32_bf16 v[112:115], v[168:171], v[220:223], v[112:115]
    ds_read_b128 v[168:171], v28 offset:10240
    v_mfma_f32_16x16x32_bf16 v[116:119], v[172:175], v[220:223], v[116:119]
    ds_read_b128 v[172:175], v28 offset:11264
    s_waitcnt lgkmcnt(8)
    buffer_load_dwordx4 v[220:223], v1, s[32:35], s98 offen offset:1024 sc1
    s_waitcnt vmcnt(10)
    v_mfma_f32_16x16x32_bf16 v[92:95], v[176:179], v[224:227], v[92:95]
    ds_read_b128 v[176:179], v28 offset:12288
    v_mfma_f32_16x16x32_bf16 v[96:99], v[180:183], v[224:227], v[96:99]
    ds_read_b128 v[180:183], v28 offset:13312
    v_mfma_f32_16x16x32_bf16 v[100:103], v[184:187], v[224:227], v[100:103]
    ds_read_b128 v[184:187], v28 offset:14336
    v_mfma_f32_16x16x32_bf16 v[104:107], v[188:191], v[224:227], v[104:107]
    ds_read_b128 v[188:191], v28 offset:15360
    s_waitcnt lgkmcnt(8)
    v_mfma_f32_16x16x32_bf16 v[108:111], v[192:195], v[224:227], v[108:111]
    ds_read_b128 v[192:195], v28 offset:16384
    v_mfma_f32_16x16x32_bf16 v[112:115], v[196:199], v[224:227], v[112:115]
    ds_read_b128 v[196:199], v28 offset:17408
    v_mfma_f32_16x16x32_bf16 v[116:119], v[200:203], v[224:227], v[116:119]
    ds_read_b128 v[200:203], v28 offset:18432
    buffer_load_dwordx4 v[224:227], v1, s[32:35], s98 offen offset:2048 sc1
    s_waitcnt vmcnt(10)
    v_mfma_f32_16x16x32_bf16 v[92:95], v[204:207], v[228:231], v[92:95]
    ds_read_b128 v[204:207], v28 offset:19456
    s_waitcnt lgkmcnt(8)
    v_mfma_f32_16x16x32_bf16 v[96:99], v[160:163], v[228:231], v[96:99]
    ds_read_b128 v[160:163], v28 offset:20480
    v_mfma_f32_16x16x32_bf16 v[100:103], v[164:167], v[228:231], v[100:103]
    ds_read_b128 v[164:167], v28 offset:21504
    v_mfma_f32_16x16x32_bf16 v[104:107], v[168:171], v[228:231], v[104:107]
    ds_read_b128 v[168:171], v28 offset:22528
    v_mfma_f32_16x16x32_bf16 v[108:111], v[172:175], v[228:231], v[108:111]
    ds_read_b128 v[172:175], v28 offset:23552
    s_waitcnt lgkmcnt(8)
    v_mfma_f32_16x16x32_bf16 v[112:115], v[176:179], v[228:231], v[112:115]
    ds_read_b128 v[176:179], v28 offset:24576
    v_mfma_f32_16x16x32_bf16 v[116:119], v[180:183], v[228:231], v[116:119]
    ds_read_b128 v[180:183], v28 offset:25600
    buffer_load_dwordx4 v[228:231], v1, s[32:35], s98 offen offset:3072 sc1
    s_waitcnt vmcnt(7)
    v_mfma_f32_16x16x32_bf16 v[92:95], v[184:187], v[208:211], v[92:95]
    ds_read_b128 v[184:187], v28 offset:26624
    v_xor_b32 v122, v122, v126
    s_waitcnt vmcnt(5)
    v_xor_b32 v130, v130, v134
    v_xor_b32 v126, v126, v134
    v_xor_b32 v134, s97, v134
    v_or3_b32 v122, v122, v126, v130
    v_or_b32 v122, v122, v134
    v_cmp_ne_u32 vcc, 0, v122
    s_cbranch_vccnz SPIN_73
BACK_74:
    v_mfma_f32_16x16x32_bf16 v[96:99], v[188:191], v[208:211], v[96:99]
    ds_read_b128 v[188:191], v28 offset:27648
    s_waitcnt lgkmcnt(8)
    v_mfma_f32_16x16x32_bf16 v[100:103], v[192:195], v[208:211], v[100:103]
    ds_read_b128 v[192:195], v28 offset:28672
    v_mfma_f32_16x16x32_bf16 v[104:107], v[196:199], v[208:211], v[104:107]
    ds_read_b128 v[196:199], v28 offset:29696
    v_mfma_f32_16x16x32_bf16 v[108:111], v[200:203], v[208:211], v[108:111]
    ds_read_b128 v[200:203], v28 offset:30720
    v_mfma_f32_16x16x32_bf16 v[112:115], v[204:207], v[208:211], v[112:115]
    ds_read_b128 v[204:207], v28 offset:31744
    s_waitcnt lgkmcnt(8)
    v_mfma_f32_16x16x32_bf16 v[116:119], v[160:163], v[208:211], v[116:119]
    ds_read_b128 v[160:163], v28 offset:32768
    s_add_u32 s98, s98, 4096
    buffer_load_dwordx4 v[208:211], v1, s[32:35], s98 offen offset:0 sc1
    s_waitcnt vmcnt(5)
    v_mfma_f32_16x16x32_bf16 v[92:95], v[164:167], v[212:215], v[92:95]
    ds_read_b128 v[164:167], v28 offset:33792
    v_mfma_f32_16x16x32_bf16 v[96:99], v[168:171], v[212:215], v[96:99]
    ds_read_b128 v[168:171], v28 offset:34816
    v_mfma_f32_16x16x32_bf16 v[100:103], v[172:175], v[212:215], v[100:103]
    ds_read_b128 v[172:175], v28 offset:35840
    s_waitcnt lgkmcnt(8)
    v_mfma_f32_16x16x32_bf16 v[104:107], v[176:179], v[212:215], v[104:107]
    ds_read_b128 v[176:179], v28 offset:36864
    v_mfma_f32_16x16x32_bf16 v[108:111], v[180:183], v[212:215], v[108:111]
    ds_read_b128 v[180:183], v28 offset:37888
    v_mfma_f32_16x16x32_bf16 v[112:115], v[184:187], v[212:215], v[112:115]
    ds_read_b128 v[184:187], v28 offset:38912
    v_mfma_f32_16x16x32_bf16 v[116:119], v[188:191], v[212:215], v[116:119]
    ds_read_b128 v[188:191], v28 offset:39936
    s_waitcnt lgkmcnt(8)
    buffer_load_dwordx4 v[212:215], v1, s[32:35], s98 offen offset:1024 sc1
    s_waitcnt vmcnt(5)
    v_mfma_f32_16x16x32_bf16 v[92:95], v[192:195], v[216:219], v[92:95]
    ds_read_b128 v[192:195], v28 offset:40960
    v_mfma_f32_16x16x32_bf16 v[96:99], v[196:199], v[216:219], v[96:99]
    ds_read_b128 v[196:199], v28 offset:41984
    v_add_f32 v120, v120, v124
    v_mfma_f32_16x16x32_bf16 v[100:103], v[200:203], v[216:219], v[100:103]
    ds_read_b128 v[200:203], v28 offset:43008
    v_add_f32 v121, v121, v125
    v_mfma_f32_16x16x32_bf16 v[104:107], v[204:207], v[216:219], v[104:107]
    ds_read_b128 v[204:207], v28 offset:44032
    s_waitcnt lgkmcnt(8)
    v_mfma_f32_16x16x32_bf16 v[108:111], v[160:163], v[216:219], v[108:111]
    ds_read_b128 v[160:163], v28 offset:45056
    v_add_f32 v128, v128, v132
    v_mfma_f32_16x16x32_bf16 v[112:115], v[164:167], v[216:219], v[112:115]
    ds_read_b128 v[164:167], v28 offset:46080
    v_add_f32 v129, v129, v133
    v_mfma_f32_16x16x32_bf16 v[116:119], v[168:171], v[216:219], v[116:119]
    ds_read_b128 v[168:171], v28 offset:47104
    buffer_load_dwordx4 v[216:219], v1, s[32:35], s98 offen offset:2048 sc1
    s_waitcnt vmcnt(5)
    v_mfma_f32_16x16x32_bf16 v[92:95], v[172:175], v[220:223], v[92:95]
    ds_read_b128 v[172:175], v28 offset:48128
    s_waitcnt lgkmcnt(8)
    v_mfma_f32_16x16x32_bf16 v[96:99], v[176:179], v[220:223], v[96:99]
    ds_read_b128 v[176:179], v28 offset:49152
    v_add_f32 v120, v120, v128
    v_mfma_f32_16x16x32_bf16 v[100:103], v[180:183], v[220:223], v[100:103]
    ds_read_b128 v[180:183], v28 offset:50176
    v_add_f32 v121, v121, v129
    v_mfma_f32_16x16x32_bf16 v[104:107], v[184:187], v[220:223], v[104:107]
    ds_read_b128 v[184:187], v28 offset:51200
    v_permlane16_swap_b32 v120, v121
    v_mfma_f32_16x16x32_bf16 v[108:111], v[188:191], v[220:223], v[108:111]
    ds_read_b128 v[188:191], v28 offset:52224
    s_waitcnt lgkmcnt(8)
    v_mfma_f32_16x16x32_bf16 v[112:115], v[192:195], v[220:223], v[112:115]
    ds_read_b128 v[192:195], v28 offset:53248
    v_add_f32 v120, v120, v121
    v_mfma_f32_16x16x32_bf16 v[116:119], v[196:199], v[220:223], v[116:119]
    ds_read_b128 v[196:199], v28 offset:54272
    buffer_load_dwordx4 v[220:223], v1, s[32:35], s98 offen offset:3072 sc1
    s_waitcnt vmcnt(5)
    v_mfma_f32_16x16x32_bf16 v[92:95], v[200:203], v[224:227], v[92:95]
    ds_read_b128 v[200:203], v28 offset:55296
    v_mov_b32 v121, v120
    v_mfma_f32_16x16x32_bf16 v[96:99], v[204:207], v[224:227], v[96:99]
    ds_read_b128 v[204:207], v28 offset:56320
    s_waitcnt lgkmcnt(8)
    v_mfma_f32_16x16x32_bf16 v[100:103], v[160:163], v[224:227], v[100:103]
    ds_read_b128 v[160:163], v29 offset:0
    v_permlane32_swap_b32 v120, v121
    v_mfma_f32_16x16x32_bf16 v[104:107], v[164:167], v[224:227], v[104:107]
    ds_read_b128 v[164:167], v29 offset:1024
    v_add_f32 v120, v120, v121
    v_mfma_f32_16x16x32_bf16 v[108:111], v[168:171], v[224:227], v[108:111]
    ds_read_b128 v[168:171], v29 offset:2048
    v_mul_f32 v124, 0x3acccccd, v120
    v_mfma_f32_16x16x32_bf16 v[112:115], v[172:175], v[224:227], v[112:115]
    ds_read_b128 v[172:175], v29 offset:3072
    s_waitcnt lgkmcnt(8)
    v_mfma_f32_16x16x32_bf16 v[116:119], v[176:179], v[224:227], v[116:119]
    ds_read_b128 v[176:179], v29 offset:4096
    v_mul_f32 v125, 0x3acccccd, v120
    s_waitcnt vmcnt(4)
    v_mfma_f32_16x16x32_bf16 v[92:95], v[180:183], v[228:231], v[92:95]
    ds_read_b128 v[180:183], v29 offset:5120
    v_permlane16_swap_b32 v124, v125
    v_mfma_f32_16x16x32_bf16 v[96:99], v[184:187], v[228:231], v[96:99]
    ds_read_b128 v[184:187], v29 offset:6144
    v_fma_f32 v125, -v124, v124, v125
    v_mfma_f32_16x16x32_bf16 v[100:103], v[188:191], v[228:231], v[100:103]
    ds_read_b128 v[188:191], v29 offset:7168
    s_waitcnt lgkmcnt(8)
    v_mfma_f32_16x16x32_bf16 v[104:107], v[192:195], v[228:231], v[104:107]
    ds_read_b128 v[192:195], v29 offset:8192
    v_max_f32 v125, 0, v125
    v_mfma_f32_16x16x32_bf16 v[108:111], v[196:199], v[228:231], v[108:111]
    ds_read_b128 v[196:199], v29 offset:9216
    v_cvt_pk_bf16_f32 v125, v125, v124
    v_mfma_f32_16x16x32_bf16 v[112:115], v[200:203], v[228:231], v[112:115]
    ds_read_b128 v[200:203], v29 offset:10240
    v_and_b32 v124, 0xffff0000, v125
    v_mfma_f32_16x16x32_bf16 v[116:119], v[204:207], v[228:231], v[116:119]
    ds_read_b128 v[204:207], v29 offset:11264
    s_waitcnt lgkmcnt(8)
    s_waitcnt vmcnt(3)
    v_mfma_f32_16x16x32_bf16 v[92:95], v[160:163], v[208:211], v[92:95]
    ds_read_b128 v[160:163], v29 offset:12288
    v_lshlrev_b32 v125, 16, v125
    v_mfma_f32_16x16x32_bf16 v[96:99], v[164:167], v[208:211], v[96:99]
    ds_read_b128 v[164:167], v29 offset:13312
    v_add_f32 v125, 0x3727c5ac, v125
    v_mfma_f32_16x16x32_bf16 v[100:103], v[168:171], v[208:211], v[100:103]
    ds_read_b128 v[168:171], v29 offset:14336
    v_cvt_pk_bf16_f32 v125, v125, v125
    v_mfma_f32_16x16x32_bf16 v[104:107], v[172:175], v[208:211], v[104:107]
    ds_read_b128 v[172:175], v29 offset:15360
    s_waitcnt lgkmcnt(8)
    v_mfma_f32_16x16x32_bf16 v[108:111], v[176:179], v[208:211], v[108:111]
    ds_read_b128 v[176:179], v29 offset:16384
    v_lshlrev_b32 v125, 16, v125
    v_mfma_f32_16x16x32_bf16 v[112:115], v[180:183], v[208:211], v[112:115]
    ds_read_b128 v[180:183], v29 offset:17408
    v_sqrt_f32 v125, v125
    v_mfma_f32_16x16x32_bf16 v[116:119], v[184:187], v[208:211], v[116:119]
    ds_read_b128 v[184:187], v29 offset:18432
    s_waitcnt vmcnt(2)
    v_mfma_f32_16x16x32_bf16 v[92:95], v[188:191], v[212:215], v[92:95]
    ds_read_b128 v[188:191], v29 offset:19456
    s_waitcnt lgkmcnt(8)
    v_mfma_f32_16x16x32_bf16 v[96:99], v[192:195], v[212:215], v[96:99]
    ds_read_b128 v[192:195], v29 offset:20480
    v_cvt_pk_bf16_f32 v125, v125, v125
    v_mfma_f32_16x16x32_bf16 v[100:103], v[196:199], v[212:215], v[100:103]
    ds_read_b128 v[196:199], v29 offset:21504
    v_lshlrev_b32 v125, 16, v125
    v_mfma_f32_16x16x32_bf16 v[104:107], v[200:203], v[212:215], v[104:107]
    ds_read_b128 v[200:203], v29 offset:22528
    v_rcp_f32 v126, v125
    v_mfma_f32_16x16x32_bf16 v[108:111], v[204:207], v[212:215], v[108:111]
    ds_read_b128 v[204:207], v29 offset:23552
    s_waitcnt lgkmcnt(8)
    v_mfma_f32_16x16x32_bf16 v[112:115], v[160:163], v[212:215], v[112:115]
    ds_read_b128 v[160:163], v29 offset:24576
    v_mfma_f32_16x16x32_bf16 v[116:119], v[164:167], v[212:215], v[116:119]
    ds_read_b128 v[164:167], v29 offset:25600
    v_xor_b32 v124, 0x80000000, v124
    s_waitcnt vmcnt(1)
    v_mfma_f32_16x16x32_bf16 v[92:95], v[168:171], v[216:219], v[92:95]
    ds_read_b128 v[168:171], v29 offset:26624
    v_lshrrev_b32 v127, 16, v124
    v_mfma_f32_16x16x32_bf16 v[96:99], v[172:175], v[216:219], v[96:99]
    ds_read_b128 v[172:175], v29 offset:27648
    s_waitcnt lgkmcnt(8)
    v_mfma_f32_16x16x32_bf16 v[100:103], v[176:179], v[216:219], v[100:103]
    v_or_b32 v124, v124, v127
    v_or_b32 v125, v125, v127
    v_mfma_f32_16x16x32_bf16 v[104:107], v[180:183], v[216:219], v[104:107]
    v_mul_f32 v55, 0x3fb8aa3b, v126
    v_cndmask_b32 v52, 0, v124, s[100:101]
    v_mfma_f32_16x16x32_bf16 v[108:111], v[184:187], v[216:219], v[108:111]
    v_cndmask_b32 v53, 0, v125, s[100:101]
    v_bfe_u32 v121, v0, 1, 2
    v_mfma_f32_16x16x32_bf16 v[112:115], v[188:191], v[216:219], v[112:115]
    s_waitcnt lgkmcnt(4)
    v_lshlrev_b32 v121, 4, v121
    v_mfma_f32_16x16x32_bf16 v[116:119], v[192:195], v[216:219], v[116:119]
    v_and_b32 v120, 1, v0
    v_lshl_add_u32 v121, v120, 2, v121
    s_waitcnt vmcnt(0)
    v_mfma_f32_16x16x32_bf16 v[92:95], v[196:199], v[220:223], v[92:95]
    s_add_u32 s67, s84, 0
    buffer_load_dword v120, v121, s[32:35], s67 offen sc1
    v_mfma_f32_16x16x32_bf16 v[96:99], v[200:203], v[220:223], v[96:99]
    v_mfma_f32_16x16x32_bf16 v[100:103], v[204:207], v[220:223], v[100:103]
    s_waitcnt lgkmcnt(0)
    v_mfma_f32_16x16x32_bf16 v[104:107], v[160:163], v[220:223], v[104:107]
    v_mfma_f32_16x16x32_bf16 v[108:111], v[164:167], v[220:223], v[108:111]
    v_mfma_f32_16x16x32_bf16 v[112:115], v[168:171], v[220:223], v[112:115]
    v_mfma_f32_16x16x32_bf16 v[116:119], v[172:175], v[220:223], v[116:119]
    v_mfma_f32_16x16x16_bf16 v[92:95], v[36:37], v[52:53], v[92:95]
    v_mfma_f32_16x16x16_bf16 v[96:99], v[38:39], v[52:53], v[96:99]
    v_mfma_f32_16x16x16_bf16 v[100:103], v[40:41], v[52:53], v[100:103]
    v_mfma_f32_16x16x16_bf16 v[104:107], v[42:43], v[52:53], v[104:107]
    v_mfma_f32_16x16x16_bf16 v[108:111], v[44:45], v[52:53], v[108:111]
    v_mfma_f32_16x16x16_bf16 v[112:115], v[46:47], v[52:53], v[112:115]
    v_mfma_f32_16x16x16_bf16 v[116:119], v[48:49], v[52:53], v[116:119]
    s_waitcnt vmcnt(0)
    v_cmp_ne_u32 vcc, s97, v120
    s_cbranch_vccnz SPIN_75
BACK_76:
    v_mov_b32 v208, 0x3f317218
    v_mov_b32 v210, 0xbfb17218
    s_add_u32 s64, s79, 110592
    s_add_u32 s65, s80, 110592
    v_pk_mul_f32 v[92:93], v[92:93], v[54:55] op_sel:[0,1] op_sel_hi:[1,1]
    v_pk_mul_f32 v[94:95], v[94:95], v[54:55] op_sel:[0,1] op_sel_hi:[1,1]
    v_pk_mul_f32 v[96:97], v[96:97], v[54:55] op_sel:[0,1] op_sel_hi:[1,1]
    v_pk_mul_f32 v[98:99], v[98:99], v[54:55] op_sel:[0,1] op_sel_hi:[1,1]
    v_exp_f32 v192, v92
    v_exp_f32 v193, v93
    v_exp_f32 v194, v94
    s_add_u32 s95, s96, 0
    buffer_load_dwordx4 v[132:135], v1, s[32:35], s95 offen offset:0 sc1
    v_exp_f32 v195, v95
    v_exp_f32 v196, v96
    v_exp_f32 v197, v97
    v_exp_f32 v198, v98
    v_exp_f32 v199, v99
    v_pk_add_f32 v[192:193], v[192:193], 1.0 op_sel_hi:[1,0]
    v_pk_add_f32 v[194:195], v[194:195], 1.0 op_sel_hi:[1,0]
    buffer_load_dwordx4 v[136:139], v1, s[32:35], s95 offen offset:1024 sc1
    v_pk_add_f32 v[196:197], v[196:197], 1.0 op_sel_hi:[1,0]
    v_pk_add_f32 v[198:199], v[198:199], 1.0 op_sel_hi:[1,0]
    v_pk_fma_f32 v[192:193], v[192:193], v[192:193], 1.0 op_sel_hi:[1,1,0]
    v_pk_fma_f32 v[194:195], v[194:195], v[194:195], 1.0 op_sel_hi:[1,1,0]
    v_pk_fma_f32 v[196:197], v[196:197], v[196:197], 1.0 op_sel_hi:[1,1,0]
    v_pk_fma_f32 v[198:199], v[198:199], v[198:199], 1.0 op_sel_hi:[1,1,0]
    v_rcp_f32 v192, v192
    buffer_load_dwordx4 v[140:143], v1, s[32:35], s95 offen offset:2048 sc1
    v_rcp_f32 v193, v193
    v_rcp_f32 v194, v194
    v_rcp_f32 v195, v195
    v_rcp_f32 v196, v196
    v_rcp_f32 v197, v197
    v_rcp_f32 v198, v198
    v_rcp_f32 v199, v199
    buffer_load_dwordx4 v[144:147], v1, s[32:35], s95 offen offset:3072 sc1
    v_pk_fma_f32 v[192:193], v[192:193], v[210:211], v[208:209] op_sel_hi:[1,0,0]
    v_pk_fma_f32 v[194:195], v[194:195], v[210:211], v[208:209] op_sel_hi:[1,0,0]
    v_pk_fma_f32 v[196:197], v[196:197], v[210:211], v[208:209] op_sel_hi:[1,0,0]
    v_pk_fma_f32 v[198:199], v[198:199], v[210:211], v[208:209] op_sel_hi:[1,0,0]
    v_pk_mul_f32 v[92:93], v[92:93], v[192:193]
    v_pk_mul_f32 v[94:95], v[94:95], v[194:195]
    v_pk_mul_f32 v[96:97], v[96:97], v[196:197]
    s_add_u32 s95, s95, 4096
    buffer_load_dwordx4 v[148:151], v1, s[32:35], s95 offen offset:0 sc1
    v_pk_mul_f32 v[98:99], v[98:99], v[198:199]
    v_cvt_pk_bf16_f32 v200, v92, v93
    v_cvt_pk_bf16_f32 v201, v94, v95
    v_cvt_pk_bf16_f32 v202, v96, v97
    v_cvt_pk_bf16_f32 v203, v98, v99
    buffer_store_dwordx4 v[200:203], v1, s[32:35], s64 offen offset:0 sc1
    v_pk_mul_f32 v[100:101], v[100:101], v[54:55] op_sel:[0,1] op_sel_hi:[1,1]
    v_pk_mul_f32 v[102:103], v[102:103], v[54:55] op_sel:[0,1] op_sel_hi:[1,1]
    v_pk_mul_f32 v[104:105], v[104:105], v[54:55] op_sel:[0,1] op_sel_hi:[1,1]
    v_pk_mul_f32 v[106:107], v[106:107], v[54:55] op_sel:[0,1] op_sel_hi:[1,1]
    v_exp_f32 v192, v100
    v_exp_f32 v193, v101
    buffer_load_dwordx4 v[152:155], v1, s[32:35], s95 offen offset:1024 sc1
    v_exp_f32 v194, v102
    v_exp_f32 v195, v103
    v_exp_f32 v196, v104
    v_exp_f32 v197, v105
    v_exp_f32 v198, v106
    v_exp_f32 v199, v107
    v_pk_add_f32 v[192:193], v[192:193], 1.0 op_sel_hi:[1,0]
    buffer_load_dwordx4 v[156:159], v1, s[32:35], s95 offen offset:2048 sc1
    v_pk_add_f32 v[194:195], v[194:195], 1.0 op_sel_hi:[1,0]
    v_pk_add_f32 v[196:197], v[196:197], 1.0 op_sel_hi:[1,0]
    v_pk_add_f32 v[198:199], v[198:199], 1.0 op_sel_hi:[1,0]
    v_pk_fma_f32 v[192:193], v[192:193], v[192:193], 1.0 op_sel_hi:[1,1,0]
    v_pk_fma_f32 v[194:195], v[194:195], v[194:195], 1.0 op_sel_hi:[1,1,0]
    v_pk_fma_f32 v[196:197], v[196:197], v[196:197], 1.0 op_sel_hi:[1,1,0]
    v_pk_fma_f32 v[198:199], v[198:199], v[198:199], 1.0 op_sel_hi:[1,1,0]
    buffer_load_dwordx4 v[160:163], v1, s[32:35], s95 offen offset:3072 sc1
    v_rcp_f32 v192, v192
    v_rcp_f32 v193, v193
    v_rcp_f32 v194, v194
    v_rcp_f32 v195, v195
    v_rcp_f32 v196, v196
    v_rcp_f32 v197, v197
    v_rcp_f32 v198, v198
    s_add_u32 s95, s95, 4096
    buffer_load_dwordx4 v[164:167], v1, s[32:35], s95 offen offset:0 sc1
    v_rcp_f32 v199, v199
    v_pk_fma_f32 v[192:193], v[192:193], v[210:211], v[208:209] op_sel_hi:[1,0,0]
    v_pk_fma_f32 v[194:195], v[194:195], v[210:211], v[208:209] op_sel_hi:[1,0,0]
    v_pk_fma_f32 v[196:197], v[196:197], v[210:211], v[208:209] op_sel_hi:[1,0,0]
    v_pk_fma_f32 v[198:199], v[198:199], v[210:211], v[208:209] op_sel_hi:[1,0,0]
    v_pk_mul_f32 v[100:101], v[100:101], v[192:193]
    v_pk_mul_f32 v[102:103], v[102:103], v[194:195]
    buffer_load_dwordx4 v[168:171], v1, s[32:35], s95 offen offset:1024 sc1
    v_pk_mul_f32 v[104:105], v[104:105], v[196:197]
    v_pk_mul_f32 v[106:107], v[106:107], v[198:199]
    v_cvt_pk_bf16_f32 v204, v100, v101
    v_cvt_pk_bf16_f32 v205, v102, v103
    v_cvt_pk_bf16_f32 v206, v104, v105
    v_cvt_pk_bf16_f32 v207, v106, v107
    buffer_store_dwordx4 v[204:207], v1, s[32:35], s64 offen offset:1024 sc1
    v_pk_mul_f32 v[108:109], v[108:109], v[54:55] op_sel:[0,1] op_sel_hi:[1,1]
    v_pk_mul_f32 v[110:111], v[110:111], v[54:55] op_sel:[0,1] op_sel_hi:[1,1]
    v_pk_mul_f32 v[112:113], v[112:113], v[54:55] op_sel:[0,1] op_sel_hi:[1,1]
    v_pk_mul_f32 v[114:115], v[114:115], v[54:55] op_sel:[0,1] op_sel_hi:[1,1]
    v_exp_f32 v192, v108
    buffer_load_dwordx4 v[172:175], v1, s[32:35], s95 offen offset:2048 sc1
    v_exp_f32 v193, v109
    v_exp_f32 v194, v110
    v_exp_f32 v195, v111
    v_exp_f32 v196, v112
    v_exp_f32 v197, v113
    v_exp_f32 v198, v114
    v_exp_f32 v199, v115
    buffer_load_dwordx4 v[176:179], v1, s[32:35], s95 offen offset:3072 sc1
    v_pk_add_f32 v[192:193], v[192:193], 1.0 op_sel_hi:[1,0]
    v_pk_add_f32 v[194:195], v[194:195], 1.0 op_sel_hi:[1,0]
    v_pk_add_f32 v[196:197], v[196:197], 1.0 op_sel_hi:[1,0]
    v_pk_add_f32 v[198:199], v[198:199], 1.0 op_sel_hi:[1,0]
    v_pk_fma_f32 v[192:193], v[192:193], v[192:193], 1.0 op_sel_hi:[1,1,0]
    v_pk_fma_f32 v[194:195], v[194:195], v[194:195], 1.0 op_sel_hi:[1,1,0]
    v_pk_fma_f32 v[196:197], v[196:197], v[196:197], 1.0 op_sel_hi:[1,1,0]
    s_add_u32 s95, s95, s94
    buffer_load_dwordx2 v[180:181], v4, s[32:35], s95 offen offset:0 sc1
    buffer_load_dwordx2 v[182:183], v4, s[32:35], s95 offen offset:512 sc1
    v_pk_fma_f32 v[198:199], v[198:199], v[198:199], 1.0 op_sel_hi:[1,1,0]
    v_rcp_f32 v192, v192
    v_rcp_f32 v193, v193
    v_rcp_f32 v194, v194
    v_rcp_f32 v195, v195
    v_rcp_f32 v196, v196
    v_rcp_f32 v197, v197
    buffer_load_dwordx2 v[184:185], v4, s[32:35], s95 offen offset:1024 sc1
    buffer_load_dwordx2 v[186:187], v4, s[32:35], s95 offen offset:1536 sc1
    v_rcp_f32 v198, v198
    v_rcp_f32 v199, v199
    v_pk_fma_f32 v[192:193], v[192:193], v[210:211], v[208:209] op_sel_hi:[1,0,0]
    v_pk_fma_f32 v[194:195], v[194:195], v[210:211], v[208:209] op_sel_hi:[1,0,0]
    v_pk_fma_f32 v[196:197], v[196:197], v[210:211], v[208:209] op_sel_hi:[1,0,0]
    v_pk_fma_f32 v[198:199], v[198:199], v[210:211], v[208:209] op_sel_hi:[1,0,0]
    v_pk_mul_f32 v[108:109], v[108:109], v[192:193]
    s_add_u32 s99, s81, 0
    buffer_load_dwordx4 v[188:191], v1, s[32:35], s99 offen offset:0 sc1
    v_pk_mul_f32 v[110:111], v[110:111], v[194:195]
    v_pk_mul_f32 v[112:113], v[112:113], v[196:197]
    v_pk_mul_f32 v[114:115], v[114:115], v[198:199]
    v_cvt_pk_bf16_f32 v200, v108, v109
    v_cvt_pk_bf16_f32 v201, v110, v111
    v_cvt_pk_bf16_f32 v202, v112, v113
    v_cvt_pk_bf16_f32 v203, v114, v115
    buffer_store_dwordx4 v[200:203], v1, s[32:35], s64 offen offset:2048 sc1
    v_pk_mul_f32 v[116:117], v[116:117], v[54:55] op_sel:[0,1] op_sel_hi:[1,1]
    v_pk_mul_f32 v[118:119], v[118:119], v[54:55] op_sel:[0,1] op_sel_hi:[1,1]
    v_exp_f32 v192, v116
    v_exp_f32 v193, v117
    v_exp_f32 v194, v118
    v_exp_f32 v195, v119
    v_pk_add_f32 v[192:193], v[192:193], 1.0 op_sel_hi:[1,0]
    v_pk_add_f32 v[194:195], v[194:195], 1.0 op_sel_hi:[1,0]
    v_pk_fma_f32 v[192:193], v[192:193], v[192:193], 1.0 op_sel_hi:[1,1,0]
    v_pk_fma_f32 v[194:195], v[194:195], v[194:195], 1.0 op_sel_hi:[1,1,0]
    v_rcp_f32 v192, v192
    v_rcp_f32 v193, v193
    v_rcp_f32 v194, v194
    v_rcp_f32 v195, v195
    v_pk_fma_f32 v[192:193], v[192:193], v[210:211], v[208:209] op_sel_hi:[1,0,0]
    v_pk_fma_f32 v[194:195], v[194:195], v[210:211], v[208:209] op_sel_hi:[1,0,0]
    v_pk_mul_f32 v[116:117], v[116:117], v[192:193]
    v_pk_mul_f32 v[118:119], v[118:119], v[194:195]
    v_cvt_pk_bf16_f32 v204, v116, v117
    v_cvt_pk_bf16_f32 v205, v118, v119
    buffer_store_dwordx2 v[204:205], v4, s[32:35], s65 offen sc1
    s_waitcnt vmcnt(20)
    v_mfma_f32_16x16x32_bf16 v[192:195], a[0:3], v[132:135], 0
    v_mfma_f32_16x16x32_bf16 v[196:199], a[4:7], v[132:135], 0
    v_mfma_f32_16x16x32_bf16 v[200:203], a[8:11], v[132:135], 0
    v_mfma_f32_16x16x32_bf16 v[204:207], a[12:15], v[132:135], 0
    v_mfma_f32_16x16x32_bf16 v[208:211], a[16:19], v[132:135], 0
    buffer_load_dwordx4 v[132:135], v1, s[32:35], s99 offen offset:1024 sc1
    s_waitcnt vmcnt(20)
    v_mfma_f32_16x16x32_bf16 v[192:195], a[20:23], v[136:139], v[192:195]
    v_mfma_f32_16x16x32_bf16 v[196:199], a[24:27], v[136:139], v[196:199]
    v_mfma_f32_16x16x32_bf16 v[200:203], a[28:31], v[136:139], v[200:203]
    v_mfma_f32_16x16x32_bf16 v[204:207], a[32:35], v[136:139], v[204:207]
    v_mfma_f32_16x16x32_bf16 v[208:211], a[36:39], v[136:139], v[208:211]
    buffer_load_dwordx4 v[136:139], v1, s[32:35], s99 offen offset:2048 sc1
    s_waitcnt vmcnt(20)
    v_mfma_f32_16x16x32_bf16 v[192:195], a[40:43], v[140:143], v[192:195]
    v_mfma_f32_16x16x32_bf16 v[196:199], a[44:47], v[140:143], v[196:199]
    s_add_u32 s68, s85, 4096
    v_mov_b32 v32, s97
    v_mfma_f32_16x16x32_bf16 v[200:203], a[48:51], v[140:143], v[200:203]
    v_mov_b32 v33, 0
    s_waitcnt vmcnt(2)
    v_mfma_f32_16x16x32_bf16 v[204:207], a[52:55], v[140:143], v[204:207]
    buffer_store_dword v32, v33, s[32:35], s68 offen offset:0
    v_bfe_u32 v121, v0, 1, 2
    v_mfma_f32_16x16x32_bf16 v[208:211], a[56:59], v[140:143], v[208:211]
    buffer_load_dwordx4 v[140:143], v1, s[32:35], s99 offen offset:3072 sc1
    v_lshlrev_b32 v121, 4, v121
    v_mfma_f32_16x16x32_bf16 v[192:195], a[60:63], v[144:147], v[192:195]
    v_and_b32 v120, 1, v0
    v_lshl_add_u32 v121, v120, 2, v121
    v_mfma_f32_16x16x32_bf16 v[196:199], a[64:67], v[144:147], v[196:199]
    s_add_u32 s67, s84, 4096
    v_mfma_f32_16x16x32_bf16 v[200:203], a[68:71], v[144:147], v[200:203]
    v_mfma_f32_16x16x32_bf16 v[204:207], a[72:75], v[144:147], v[204:207]
    v_mfma_f32_16x16x32_bf16 v[208:211], a[76:79], v[144:147], v[208:211]
    s_add_u32 s99, s99, 4096
    buffer_load_dwordx4 v[144:147], v1, s[32:35], s99 offen offset:0 sc1
    v_mfma_f32_16x16x32_bf16 v[192:195], a[80:83], v[148:151], v[192:195]
    v_mfma_f32_16x16x32_bf16 v[196:199], a[84:87], v[148:151], v[196:199]
    v_mfma_f32_16x16x32_bf16 v[200:203], a[88:91], v[148:151], v[200:203]
    v_mfma_f32_16x16x32_bf16 v[204:207], a[92:95], v[148:151], v[204:207]
    v_mfma_f32_16x16x32_bf16 v[208:211], a[96:99], v[148:151], v[208:211]
    buffer_load_dwordx4 v[148:151], v1, s[32:35], s99 offen offset:1024 sc1
    v_mfma_f32_16x16x32_bf16 v[192:195], a[100:103], v[152:155], v[192:195]
    v_mfma_f32_16x16x32_bf16 v[196:199], a[104:107], v[152:155], v[196:199]
    v_mfma_f32_16x16x32_bf16 v[200:203], a[108:111], v[152:155], v[200:203]
    v_mfma_f32_16x16x32_bf16 v[204:207], a[112:115], v[152:155], v[204:207]
    v_mfma_f32_16x16x32_bf16 v[208:211], a[116:119], v[152:155], v[208:211]
    buffer_load_dwordx4 v[152:155], v1, s[32:35], s99 offen offset:2048 sc1
    v_mfma_f32_16x16x32_bf16 v[192:195], a[120:123], v[156:159], v[192:195]
    v_mfma_f32_16x16x32_bf16 v[196:199], a[124:127], v[156:159], v[196:199]
    v_mfma_f32_16x16x32_bf16 v[200:203], a[128:131], v[156:159], v[200:203]
    v_mfma_f32_16x16x32_bf16 v[204:207], a[132:135], v[156:159], v[204:207]
    v_mfma_f32_16x16x32_bf16 v[208:211], a[136:139], v[156:159], v[208:211]
    buffer_load_dwordx4 v[156:159], v1, s[32:35], s99 offen offset:3072 sc1
    v_mfma_f32_16x16x32_bf16 v[192:195], a[140:143], v[160:163], v[192:195]
    v_mfma_f32_16x16x32_bf16 v[196:199], a[144:147], v[160:163], v[196:199]
    v_mfma_f32_16x16x32_bf16 v[200:203], a[148:151], v[160:163], v[200:203]
    v_mfma_f32_16x16x32_bf16 v[204:207], a[152:155], v[160:163], v[204:207]
    v_mfma_f32_16x16x32_bf16 v[208:211], a[156:159], v[160:163], v[208:211]
    s_add_u32 s99, s99, 4096
    buffer_load_dwordx4 v[160:163], v1, s[32:35], s99 offen offset:0 sc1
    v_mfma_f32_16x16x32_bf16 v[192:195], a[160:163], v[164:167], v[192:195]
    v_mfma_f32_16x16x32_bf16 v[196:199], a[164:167], v[164:167], v[196:199]
    v_mfma_f32_16x16x32_bf16 v[200:203], a[168:171], v[164:167], v[200:203]
    v_mfma_f32_16x16x32_bf16 v[204:207], a[172:175], v[164:167], v[204:207]
    v_mfma_f32_16x16x32_bf16 v[208:211], a[176:179], v[164:167], v[208:211]
    buffer_load_dwordx4 v[164:167], v1, s[32:35], s99 offen offset:1024 sc1
    v_mfma_f32_16x16x32_bf16 v[192:195], a[180:183], v[168:171], v[192:195]
    v_mfma_f32_16x16x32_bf16 v[196:199], a[184:187], v[168:171], v[196:199]
    v_mfma_f32_16x16x32_bf16 v[200:203], a[188:191], v[168:171], v[200:203]
    v_mfma_f32_16x16x32_bf16 v[204:207], a[192:195], v[168:171], v[204:207]
    v_mfma_f32_16x16x32_bf16 v[208:211], a[196:199], v[168:171], v[208:211]
    buffer_load_dwordx4 v[168:171], v1, s[32:35], s99 offen offset:2048 sc1
    v_mfma_f32_16x16x32_bf16 v[192:195], a[200:203], v[172:175], v[192:195]
    v_mfma_f32_16x16x32_bf16 v[196:199], a[204:207], v[172:175], v[196:199]
    v_mfma_f32_16x16x32_bf16 v[200:203], a[208:211], v[172:175], v[200:203]
    v_mfma_f32_16x16x32_bf16 v[204:207], a[212:215], v[172:175], v[204:207]
    v_mfma_f32_16x16x32_bf16 v[208:211], a[216:219], v[172:175], v[208:211]
    buffer_load_dwordx4 v[172:175], v1, s[32:35], s99 offen offset:3072 sc1
    v_mfma_f32_16x16x32_bf16 v[192:195], a[220:223], v[176:179], v[192:195]
    v_mfma_f32_16x16x32_bf16 v[196:199], a[224:227], v[176:179], v[196:199]
    v_mfma_f32_16x16x32_bf16 v[200:203], a[228:231], v[176:179], v[200:203]
    v_mfma_f32_16x16x32_bf16 v[204:207], a[232:235], v[176:179], v[204:207]
    v_mfma_f32_16x16x32_bf16 v[208:211], a[236:239], v[176:179], v[208:211]
    s_add_u32 s99, s99, s94
    buffer_load_dwordx2 v[176:177], v4, s[32:35], s99 offen offset:0 sc1
    buffer_load_dwordx2 v[178:179], v4, s[32:35], s99 offen offset:512 sc1
    v_mfma_f32_16x16x32_bf16 v[192:195], a[240:243], v[180:183], v[192:195]
    buffer_load_dword v120, v121, s[32:35], s67 offen sc1
    v_mfma_f32_16x16x32_bf16 v[196:199], a[244:247], v[180:183], v[196:199]
    v_mfma_f32_16x16x32_bf16 v[200:203], a[248:251], v[180:183], v[200:203]
    v_mfma_f32_16x16x32_bf16 v[204:207], a[252:255], v[180:183], v[204:207]
    v_mfma_f32_16x16x32_bf16 v[208:211], v[232:235], v[180:183], v[208:211]
    buffer_load_dwordx2 v[180:181], v4, s[32:35], s99 offen offset:1024 sc1
    buffer_load_dwordx2 v[182:183], v4, s[32:35], s99 offen offset:1536 sc1
    v_mfma_f32_16x16x32_bf16 v[192:195], v[236:239], v[184:187], v[192:195]
    v_mfma_f32_16x16x32_bf16 v[196:199], v[240:243], v[184:187], v[196:199]
    v_mfma_f32_16x16x32_bf16 v[200:203], v[244:247], v[184:187], v[200:203]
    v_mfma_f32_16x16x32_bf16 v[204:207], v[248:251], v[184:187], v[204:207]
    v_mfma_f32_16x16x32_bf16 v[208:211], v[252:255], v[184:187], v[208:211]
    v_mfma_f32_16x16x32_bf16 v[212:215], a[0:3], v[188:191], 0
    v_mfma_f32_16x16x32_bf16 v[216:219], a[4:7], v[188:191], 0
    v_mfma_f32_16x16x32_bf16 v[220:223], a[8:11], v[188:191], 0
    s_xor_b32 s68, s54, 0
    s_mul_i32 s68, s68, 5120
    v_mfma_f32_16x16x32_bf16 v[224:227], a[12:15], v[188:191], 0
    s_add_u32 s68, s68, 143360
    v_add_u32 v33, s68, v1
    v_mfma_f32_16x16x32_bf16 v[228:231], a[16:19], v[188:191], 0
    ds_write_b128 v33, v[192:195] offset:0
    ds_write_b128 v33, v[196:199] offset:1024
    s_waitcnt vmcnt(16)
    v_mfma_f32_16x16x32_bf16 v[212:215], a[20:23], v[132:135], v[212:215]
    ds_write_b128 v33, v[200:203] offset:2048
    ds_write_b128 v33, v[204:207] offset:3072
    v_mfma_f32_16x16x32_bf16 v[216:219], a[24:27], v[132:135], v[216:219]
    ds_write_b128 v33, v[208:211] offset:4096
    s_xor_b32 s68, s54, 1
    v_mfma_f32_16x16x32_bf16 v[220:223], a[28:31], v[132:135], v[220:223]
    s_mul_i32 s68, s68, 5120
    s_add_u32 s68, s68, 143360
    v_mfma_f32_16x16x32_bf16 v[224:227], a[32:35], v[132:135], v[224:227]
    v_add_u32 v33, s68, v1
    s_xor_b32 s68, s54, 3
    v_mfma_f32_16x16x32_bf16 v[228:231], a[36:39], v[132:135], v[228:231]
    s_mul_i32 s68, s68, 5120
    s_add_u32 s68, s68, 143368
    s_waitcnt vmcnt(15)
    v_mfma_f32_16x16x32_bf16 v[212:215], a[40:43], v[136:139], v[212:215]
    s_waitcnt vmcnt(2)
    v_cmp_ne_u32 vcc, s97, v120
    s_cbranch_vccnz SPIN_79
BACK_80:
    v_add_u32 v34, s68, v1
    v_mfma_f32_16x16x32_bf16 v[216:219], a[44:47], v[136:139], v[216:219]
    s_add_u32 s95, s96, 110592
    buffer_load_dwordx4 v[184:187], v1, s[32:35], s95 offen offset:0 sc1
    v_mfma_f32_16x16x32_bf16 v[220:223], a[48:51], v[136:139], v[220:223]
    v_mfma_f32_16x16x32_bf16 v[224:227], a[52:55], v[136:139], v[224:227]
    v_mfma_f32_16x16x32_bf16 v[228:231], a[56:59], v[136:139], v[228:231]
    buffer_load_dwordx4 v[188:191], v1, s[32:35], s95 offen offset:1024 sc1
    v_mfma_f32_16x16x32_bf16 v[212:215], a[60:63], v[140:143], v[212:215]
    v_mfma_f32_16x16x32_bf16 v[216:219], a[64:67], v[140:143], v[216:219]
    v_mfma_f32_16x16x32_bf16 v[220:223], a[68:71], v[140:143], v[220:223]
    buffer_load_dwordx4 v[132:135], v1, s[32:35], s95 offen offset:2048 sc1
    v_mfma_f32_16x16x32_bf16 v[224:227], a[72:75], v[140:143], v[224:227]
    v_mfma_f32_16x16x32_bf16 v[228:231], a[76:79], v[140:143], v[228:231]
    buffer_load_dwordx4 v[136:139], v1, s[32:35], s95 offen offset:3072 sc1
    s_waitcnt lgkmcnt(0)
    v_mfma_f32_16x16x32_bf16 v[212:215], a[80:83], v[144:147], v[212:215]
    s_add_u32 s95, s95, 4096
    buffer_load_dwordx4 v[140:143], v1, s[32:35], s95 offen offset:0 sc1
    v_mfma_f32_16x16x32_bf16 v[216:219], a[84:87], v[144:147], v[216:219]
    s_barrier
    ds_read_b64 v[192:193], v33 offset:0
    v_mfma_f32_16x16x32_bf16 v[220:223], a[88:91], v[144:147], v[220:223]
    ds_read_b64 v[194:195], v33 offset:1024
    ds_read_b64 v[196:197], v33 offset:2048
    v_mfma_f32_16x16x32_bf16 v[224:227], a[92:95], v[144:147], v[224:227]
    ds_read_b64 v[198:199], v33 offset:3072
    ds_read_b64 v[200:201], v33 offset:4096
    v_mfma_f32_16x16x32_bf16 v[228:231], a[96:99], v[144:147], v[228:231]
    buffer_load_dwordx4 v[144:147], v1, s[32:35], s95 offen offset:1024 sc1
    ds_read_b64 v[202:203], v34 offset:0
    v_mfma_f32_16x16x32_bf16 v[212:215], a[100:103], v[148:151], v[212:215]
    ds_read_b64 v[204:205], v34 offset:1024
    ds_read_b64 v[206:207], v34 offset:2048
    v_mfma_f32_16x16x32_bf16 v[216:219], a[104:107], v[148:151], v[216:219]
    ds_read_b64 v[208:209], v34 offset:3072
    ds_read_b64 v[210:211], v34 offset:4096
    v_mfma_f32_16x16x32_bf16 v[220:223], a[108:111], v[148:151], v[220:223]
    v_mfma_f32_16x16x32_bf16 v[224:227], a[112:115], v[148:151], v[224:227]
    v_mfma_f32_16x16x32_bf16 v[228:231], a[116:119], v[148:151], v[228:231]
    buffer_load_dwordx4 v[148:151], v1, s[32:35], s95 offen offset:2048 sc1
    v_mfma_f32_16x16x32_bf16 v[212:215], a[120:123], v[152:155], v[212:215]
    v_mfma_f32_16x16x32_bf16 v[216:219], a[124:127], v[152:155], v[216:219]
    v_mfma_f32_16x16x32_bf16 v[220:223], a[128:131], v[152:155], v[220:223]
    v_mfma_f32_16x16x32_bf16 v[224:227], a[132:135], v[152:155], v[224:227]
    v_mfma_f32_16x16x32_bf16 v[228:231], a[136:139], v[152:155], v[228:231]
    buffer_load_dwordx4 v[152:155], v1, s[32:35], s95 offen offset:3072 sc1
    v_mfma_f32_16x16x32_bf16 v[212:215], a[140:143], v[156:159], v[212:215]
    v_mfma_f32_16x16x32_bf16 v[216:219], a[144:147], v[156:159], v[216:219]
    s_waitcnt lgkmcnt(4)
    v_add_f32 v192, v192, v202
    v_add_f32 v193, v193, v203
    v_mfma_f32_16x16x32_bf16 v[220:223], a[148:151], v[156:159], v[220:223]
    s_waitcnt lgkmcnt(3)
    v_add_f32 v194, v194, v204
    v_add_f32 v195, v195, v205
    v_mfma_f32_16x16x32_bf16 v[224:227], a[152:155], v[156:159], v[224:227]
    s_waitcnt lgkmcnt(2)
    v_add_f32 v196, v196, v206
    v_add_f32 v197, v197, v207
    v_mfma_f32_16x16x32_bf16 v[228:231], a[156:159], v[156:159], v[228:231]
    s_add_u32 s95, s95, 4096
    buffer_load_dwordx4 v[156:159], v1, s[32:35], s95 offen offset:0 sc1
    v_mfma_f32_16x16x32_bf16 v[212:215], a[160:163], v[160:163], v[212:215]
    s_waitcnt lgkmcnt(1)
    v_add_f32 v198, v198, v208
    v_add_f32 v199, v199, v209
    v_mfma_f32_16x16x32_bf16 v[216:219], a[164:167], v[160:163], v[216:219]
    s_waitcnt lgkmcnt(0)
    v_add_f32 v200, v200, v210
    v_add_f32 v201, v201, v211
    v_mfma_f32_16x16x32_bf16 v[220:223], a[168:171], v[160:163], v[220:223]
    v_lshlrev_b32 v202, 16, v6
    v_and_b32 v203, 0xffff0000, v6
    v_mfma_f32_16x16x32_bf16 v[224:227], a[172:175], v[160:163], v[224:227]
    v_lshlrev_b32 v204, 16, v7
    v_and_b32 v205, 0xffff0000, v7
    v_mfma_f32_16x16x32_bf16 v[228:231], a[176:179], v[160:163], v[228:231]
    buffer_load_dwordx4 v[160:163], v1, s[32:35], s95 offen offset:1024 sc1
    v_lshlrev_b32 v206, 16, v8
    v_mfma_f32_16x16x32_bf16 v[212:215], a[180:183], v[164:167], v[212:215]
    v_and_b32 v207, 0xffff0000, v8
    v_lshlrev_b32 v208, 16, v9
    v_mfma_f32_16x16x32_bf16 v[216:219], a[184:187], v[164:167], v[216:219]
    v_and_b32 v209, 0xffff0000, v9
    v_lshlrev_b32 v210, 16, v10
    v_mfma_f32_16x16x32_bf16 v[220:223], a[188:191], v[164:167], v[220:223]
    v_and_b32 v211, 0xffff0000, v10
    v_add_f32 v192, v192, v202
    v_mfma_f32_16x16x32_bf16 v[224:227], a[192:195], v[164:167], v[224:227]
    v_add_f32 v193, v193, v203
    v_add_f32 v194, v194, v204
    v_mfma_f32_16x16x32_bf16 v[228:231], a[196:199], v[164:167], v[228:231]
    buffer_load_dwordx4 v[164:167], v1, s[32:35], s95 offen offset:2048 sc1
    v_add_f32 v195, v195, v205
    v_mfma_f32_16x16x32_bf16 v[212:215], a[200:203], v[168:171], v[212:215]
    v_add_f32 v196, v196, v206
    v_add_f32 v197, v197, v207
    v_mfma_f32_16x16x32_bf16 v[216:219], a[204:207], v[168:171], v[216:219]
    v_add_f32 v198, v198, v208
    v_add_f32 v199, v199, v209
    v_mfma_f32_16x16x32_bf16 v[220:223], a[208:211], v[168:171], v[220:223]
    v_add_f32 v200, v200, v210
    v_add_f32 v201, v201, v211
    v_mfma_f32_16x16x32_bf16 v[224:227], a[212:215], v[168:171], v[224:227]
    v_subrev_u32 v35, 8, v34
    v_mov_b32 v34, v33
    v_mfma_f32_16x16x32_bf16 v[228:231], a[216:219], v[168:171], v[228:231]
    buffer_load_dwordx4 v[168:171], v1, s[32:35], s95 offen offset:3072 sc1
    v_mfma_f32_16x16x32_bf16 v[212:215], a[220:223], v[172:175], v[212:215]
    v_mfma_f32_16x16x32_bf16 v[216:219], a[224:227], v[172:175], v[216:219]
    v_mfma_f32_16x16x32_bf16 v[220:223], a[228:231], v[172:175], v[220:223]
    v_mfma_f32_16x16x32_bf16 v[224:227], a[232:235], v[172:175], v[224:227]
    v_mfma_f32_16x16x32_bf16 v[228:231], a[236:239], v[172:175], v[228:231]
    s_add_u32 s95, s95, s94
    buffer_load_dwordx2 v[172:173], v4, s[32:35], s95 offen offset:0 sc1
    buffer_load_dwordx2 v[174:175], v4, s[32:35], s95 offen offset:512 sc1
    v_mfma_f32_16x16x32_bf16 v[212:215], a[240:243], v[176:179], v[212:215]
    v_mfma_f32_16x16x32_bf16 v[216:219], a[244:247], v[176:179], v[216:219]
    v_mfma_f32_16x16x32_bf16 v[220:223], a[248:251], v[176:179], v[220:223]
    v_mfma_f32_16x16x32_bf16 v[224:227], a[252:255], v[176:179], v[224:227]
    v_mfma_f32_16x16x32_bf16 v[228:231], v[232:235], v[176:179], v[228:231]
    buffer_load_dwordx2 v[176:177], v4, s[32:35], s95 offen offset:1024 sc1
    buffer_load_dwordx2 v[178:179], v4, s[32:35], s95 offen offset:1536 sc1
    s_waitcnt vmcnt(16)
    v_mfma_f32_16x16x32_bf16 v[212:215], v[236:239], v[180:183], v[212:215]
    v_mfma_f32_16x16x32_bf16 v[216:219], v[240:243], v[180:183], v[216:219]
    v_mfma_f32_16x16x32_bf16 v[220:223], v[244:247], v[180:183], v[220:223]
    v_mfma_f32_16x16x32_bf16 v[224:227], v[248:251], v[180:183], v[224:227]
    v_mfma_f32_16x16x32_bf16 v[228:231], v[252:255], v[180:183], v[228:231]
    s_add_u32 s99, s81, 110592
    buffer_load_dwordx4 v[180:183], v1, s[32:35], s99 offen offset:0 sc1
    s_waitcnt vmcnt(16)
    v_mfma_f32_16x16x32_bf16 v[92:95], a[0:3], v[184:187], 0
    v_mfma_f32_16x16x32_bf16 v[96:99], a[4:7], v[184:187], 0
    v_mfma_f32_16x16x32_bf16 v[100:103], a[8:11], v[184:187], 0
    ds_write_b64 v34, v[214:215] offset:0
    ds_write_b64 v34, v[218:219] offset:1024
    v_mfma_f32_16x16x32_bf16 v[104:107], a[12:15], v[184:187], 0
    ds_write_b64 v34, v[222:223] offset:2048
    ds_write_b64 v34, v[226:227] offset:3072
    v_mfma_f32_16x16x32_bf16 v[108:111], a[16:19], v[184:187], 0
    buffer_load_dwordx4 v[184:187], v1, s[32:35], s99 offen offset:1024 sc1
    ds_write_b64 v34, v[230:231] offset:4096
    s_waitcnt vmcnt(16)
    v_mfma_f32_16x16x32_bf16 v[92:95], a[20:23], v[188:191], v[92:95]
    v_add_f32 v192, v192, v212
    v_add_f32 v193, v193, v213
    v_mfma_f32_16x16x32_bf16 v[96:99], a[24:27], v[188:191], v[96:99]
    v_add_f32 v194, v194, v216
    v_add_f32 v195, v195, v217
    v_mfma_f32_16x16x32_bf16 v[100:103], a[28:31], v[188:191], v[100:103]
    v_add_f32 v196, v196, v220
    v_add_f32 v197, v197, v221
    v_mfma_f32_16x16x32_bf16 v[104:107], a[32:35], v[188:191], v[104:107]
    v_add_f32 v198, v198, v224
    v_add_f32 v199, v199, v225
    v_mfma_f32_16x16x32_bf16 v[108:111], a[36:39], v[188:191], v[108:111]
    buffer_load_dwordx4 v[188:191], v1, s[32:35], s99 offen offset:2048 sc1
    v_add_f32 v200, v200, v228
    s_waitcnt vmcnt(16)
    v_mfma_f32_16x16x32_bf16 v[92:95], a[40:43], v[132:135], v[92:95]
    v_add_f32 v201, v201, v229
    v_mfma_f32_16x16x32_bf16 v[96:99], a[44:47], v[132:135], v[96:99]
    v_mfma_f32_16x16x32_bf16 v[100:103], a[48:51], v[132:135], v[100:103]
    v_mfma_f32_16x16x32_bf16 v[104:107], a[52:55], v[132:135], v[104:107]
    s_waitcnt lgkmcnt(0)
    s_barrier
    v_mfma_f32_16x16x32_bf16 v[108:111], a[56:59], v[132:135], v[108:111]
    buffer_load_dwordx4 v[132:135], v1, s[32:35], s99 offen offset:3072 sc1
    ds_read_b64 v[202:203], v35 offset:0
    s_waitcnt vmcnt(16)
    v_mfma_f32_16x16x32_bf16 v[92:95], a[60:63], v[136:139], v[92:95]
    ds_read_b64 v[204:205], v35 offset:1024
    ds_read_b64 v[206:207], v35 offset:2048
    v_mfma_f32_16x16x32_bf16 v[96:99], a[64:67], v[136:139], v[96:99]
    ds_read_b64 v[208:209], v35 offset:3072
    ds_read_b64 v[210:211], v35 offset:4096
    v_mfma_f32_16x16x32_bf16 v[100:103], a[68:71], v[136:139], v[100:103]
    v_mfma_f32_16x16x32_bf16 v[104:107], a[72:75], v[136:139], v[104:107]
    v_mfma_f32_16x16x32_bf16 v[108:111], a[76:79], v[136:139], v[108:111]
    s_add_u32 s99, s99, 4096
    buffer_load_dwordx4 v[136:139], v1, s[32:35], s99 offen offset:0 sc1
    s_waitcnt vmcnt(16)
    v_mfma_f32_16x16x32_bf16 v[92:95], a[80:83], v[140:143], v[92:95]
    v_mfma_f32_16x16x32_bf16 v[96:99], a[84:87], v[140:143], v[96:99]
    v_mfma_f32_16x16x32_bf16 v[100:103], a[88:91], v[140:143], v[100:103]
    v_mfma_f32_16x16x32_bf16 v[104:107], a[92:95], v[140:143], v[104:107]
    s_waitcnt lgkmcnt(4)
    v_add_f32 v192, v192, v202
    v_add_f32 v193, v193, v203
    v_mfma_f32_16x16x32_bf16 v[108:111], a[96:99], v[140:143], v[108:111]
    buffer_load_dwordx4 v[140:143], v1, s[32:35], s99 offen offset:1024 sc1
    s_waitcnt lgkmcnt(3)
    v_add_f32 v194, v194, v204
    s_waitcnt vmcnt(16)
    v_mfma_f32_16x16x32_bf16 v[92:95], a[100:103], v[144:147], v[92:95]
    v_add_f32 v195, v195, v205
    s_waitcnt lgkmcnt(2)
    v_add_f32 v196, v196, v206
    v_mfma_f32_16x16x32_bf16 v[96:99], a[104:107], v[144:147], v[96:99]
    v_add_f32 v197, v197, v207
    s_waitcnt lgkmcnt(1)
    v_add_f32 v198, v198, v208
    v_mfma_f32_16x16x32_bf16 v[100:103], a[108:111], v[144:147], v[100:103]
    v_add_f32 v199, v199, v209
    s_waitcnt lgkmcnt(0)
    v_add_f32 v200, v200, v210
    v_mfma_f32_16x16x32_bf16 v[104:107], a[112:115], v[144:147], v[104:107]
    v_add_f32 v201, v201, v211
    s_barrier
    v_mfma_f32_16x16x32_bf16 v[108:111], a[116:119], v[144:147], v[108:111]
    buffer_load_dwordx4 v[144:147], v1, s[32:35], s99 offen offset:2048 sc1
    s_and_b32 s65, s54, 1
    s_lshl_b32 s64, s55, 2
    s_add_u32 s64, s64, s65
    s_mul_i32 s64, s64, 20480
    s_mul_i32 s65, s56, 160
    s_add_u32 s64, s64, s65
    s_lshr_b32 s65, s54, 1
    s_lshl_b32 s65, s65, 2
    s_add_u32 s64, s64, s65
    v_mul_u32_u24 v30, 1280, v2
    v_lshl_add_u32 v30, v3, 3, v30
    v_add_u32 v30, s64, v30
    v_add_u32 v31, 40960, v30
    s_waitcnt vmcnt(16)
    v_mfma_f32_16x16x32_bf16 v[92:95], a[120:123], v[148:151], v[92:95]
    v_mfma_f32_16x16x32_bf16 v[96:99], a[124:127], v[148:151], v[96:99]
    v_mfma_f32_16x16x32_bf16 v[100:103], a[128:131], v[148:151], v[100:103]
    v_mfma_f32_16x16x32_bf16 v[104:107], a[132:135], v[148:151], v[104:107]
    v_mfma_f32_16x16x32_bf16 v[108:111], a[136:139], v[148:151], v[108:111]
    buffer_load_dwordx4 v[148:151], v1, s[32:35], s99 offen offset:3072 sc1
    s_waitcnt vmcnt(16)
    v_mfma_f32_16x16x32_bf16 v[92:95], a[140:143], v[152:155], v[92:95]
    v_mfma_f32_16x16x32_bf16 v[96:99], a[144:147], v[152:155], v[96:99]
    v_mfma_f32_16x16x32_bf16 v[100:103], a[148:151], v[152:155], v[100:103]
    v_mfma_f32_16x16x32_bf16 v[104:107], a[152:155], v[152:155], v[104:107]
    v_mfma_f32_16x16x32_bf16 v[108:111], a[156:159], v[152:155], v[108:111]
    s_add_u32 s99, s99, 4096
    buffer_load_dwordx4 v[152:155], v1, s[32:35], s99 offen offset:0 sc1
    s_waitcnt vmcnt(16)
    v_mfma_f32_16x16x32_bf16 v[92:95], a[160:163], v[156:159], v[92:95]
    v_mfma_f32_16x16x32_bf16 v[96:99], a[164:167], v[156:159], v[96:99]
    v_mfma_f32_16x16x32_bf16 v[100:103], a[168:171], v[156:159], v[100:103]
    v_mfma_f32_16x16x32_bf16 v[104:107], a[172:175], v[156:159], v[104:107]
    v_mfma_f32_16x16x32_bf16 v[108:111], a[176:179], v[156:159], v[108:111]
    buffer_load_dwordx4 v[156:159], v1, s[32:35], s99 offen offset:1024 sc1
    s_waitcnt vmcnt(16)
    v_mfma_f32_16x16x32_bf16 v[92:95], a[180:183], v[160:163], v[92:95]
    v_mfma_f32_16x16x32_bf16 v[96:99], a[184:187], v[160:163], v[96:99]
    v_mfma_f32_16x16x32_bf16 v[100:103], a[188:191], v[160:163], v[100:103]
    v_mfma_f32_16x16x32_bf16 v[104:107], a[192:195], v[160:163], v[104:107]
    v_mfma_f32_16x16x32_bf16 v[108:111], a[196:199], v[160:163], v[108:111]
    buffer_load_dwordx4 v[160:163], v1, s[32:35], s99 offen offset:2048 sc1
    s_waitcnt vmcnt(16)
    v_mfma_f32_16x16x32_bf16 v[92:95], a[200:203], v[164:167], v[92:95]
    v_mfma_f32_16x16x32_bf16 v[96:99], a[204:207], v[164:167], v[96:99]
    v_mfma_f32_16x16x32_bf16 v[100:103], a[208:211], v[164:167], v[100:103]
    v_mfma_f32_16x16x32_bf16 v[104:107], a[212:215], v[164:167], v[104:107]
    v_mfma_f32_16x16x32_bf16 v[108:111], a[216:219], v[164:167], v[108:111]
    buffer_load_dwordx4 v[164:167], v1, s[32:35], s99 offen offset:3072 sc1
    s_waitcnt vmcnt(16)
    v_mfma_f32_16x16x32_bf16 v[92:95], a[220:223], v[168:171], v[92:95]
    v_mfma_f32_16x16x32_bf16 v[96:99], a[224:227], v[168:171], v[96:99]
    v_mfma_f32_16x16x32_bf16 v[100:103], a[228:231], v[168:171], v[100:103]
    v_mfma_f32_16x16x32_bf16 v[104:107], a[232:235], v[168:171], v[104:107]
    v_mfma_f32_16x16x32_bf16 v[108:111], a[236:239], v[168:171], v[108:111]
    s_add_u32 s99, s99, s94
    buffer_load_dwordx2 v[168:169], v4, s[32:35], s99 offen offset:0 sc1
    buffer_load_dwordx2 v[170:171], v4, s[32:35], s99 offen offset:512 sc1
    s_waitcnt vmcnt(16)
    v_mfma_f32_16x16x32_bf16 v[92:95], a[240:243], v[172:175], v[92:95]
    v_mfma_f32_16x16x32_bf16 v[96:99], a[244:247], v[172:175], v[96:99]
    v_mfma_f32_16x16x32_bf16 v[100:103], a[248:251], v[172:175], v[100:103]
    s_lshl_b32 s64, s54, 8
    s_or_b32 s64, s64, s53
    s_cmp_lg_u32 s64, 31
    s_cbranch_scc1 NOWB_83
    buffer_wbl2 sc1
NOWB_83:
    v_mfma_f32_16x16x32_bf16 v[104:107], a[252:255], v[172:175], v[104:107]
    v_mfma_f32_16x16x32_bf16 v[108:111], v[232:235], v[172:175], v[108:111]
    buffer_load_dwordx2 v[172:173], v4, s[32:35], s99 offen offset:1024 sc1
    buffer_load_dwordx2 v[174:175], v4, s[32:35], s99 offen offset:1536 sc1
    s_waitcnt vmcnt(16)
    v_mfma_f32_16x16x32_bf16 v[92:95], v[236:239], v[176:179], v[92:95]
    v_mfma_f32_16x16x32_bf16 v[96:99], v[240:243], v[176:179], v[96:99]
    v_mfma_f32_16x16x32_bf16 v[100:103], v[244:247], v[176:179], v[100:103]
    v_mfma_f32_16x16x32_bf16 v[104:107], v[248:251], v[176:179], v[104:107]
    v_mfma_f32_16x16x32_bf16 v[108:111], v[252:255], v[176:179], v[108:111]
    s_waitcnt vmcnt(15)
    v_mfma_f32_16x16x32_bf16 v[112:115], a[0:3], v[180:183], 0
    v_mfma_f32_16x16x32_bf16 v[116:119], a[4:7], v[180:183], 0
    v_mfma_f32_16x16x32_bf16 v[120:123], a[8:11], v[180:183], 0
    s_xor_b32 s68, s54, 0
    s_mul_i32 s68, s68, 5120
    v_mfma_f32_16x16x32_bf16 v[124:127], a[12:15], v[180:183], 0
    s_add_u32 s68, s68, 143360
    v_add_u32 v33, s68, v1
    v_mfma_f32_16x16x32_bf16 v[128:131], a[16:19], v[180:183], 0
    ds_write_b128 v33, v[92:95] offset:0
    ds_write_b128 v33, v[96:99] offset:1024
    s_waitcnt vmcnt(14)
    v_mfma_f32_16x16x32_bf16 v[112:115], a[20:23], v[184:187], v[112:115]
    ds_write_b128 v33, v[100:103] offset:2048
    ds_write_b128 v33, v[104:107] offset:3072
    v_mfma_f32_16x16x32_bf16 v[116:119], a[24:27], v[184:187], v[116:119]
    ds_write_b128 v33, v[108:111] offset:4096
    s_xor_b32 s68, s54, 1
    v_mfma_f32_16x16x32_bf16 v[120:123], a[28:31], v[184:187], v[120:123]
    s_mul_i32 s68, s68, 5120
    s_add_u32 s68, s68, 143360
    v_mfma_f32_16x16x32_bf16 v[124:127], a[32:35], v[184:187], v[124:127]
    v_add_u32 v33, s68, v1
    s_xor_b32 s68, s54, 3
    v_mfma_f32_16x16x32_bf16 v[128:131], a[36:39], v[184:187], v[128:131]
    s_mul_i32 s68, s68, 5120
    s_add_u32 s68, s68, 143368
    s_waitcnt vmcnt(13)
    v_mfma_f32_16x16x32_bf16 v[112:115], a[40:43], v[188:191], v[112:115]
    v_add_u32 v34, s68, v1
    v_mfma_f32_16x16x32_bf16 v[116:119], a[44:47], v[188:191], v[116:119]
    v_mfma_f32_16x16x32_bf16 v[120:123], a[48:51], v[188:191], v[120:123]
    v_mfma_f32_16x16x32_bf16 v[124:127], a[52:55], v[188:191], v[124:127]
    v_mfma_f32_16x16x32_bf16 v[128:131], a[56:59], v[188:191], v[128:131]
    s_waitcnt vmcnt(12)
    v_mfma_f32_16x16x32_bf16 v[112:115], a[60:63], v[132:135], v[112:115]
    v_mfma_f32_16x16x32_bf16 v[116:119], a[64:67], v[132:135], v[116:119]
    v_mfma_f32_16x16x32_bf16 v[120:123], a[68:71], v[132:135], v[120:123]
    s_waitcnt lgkmcnt(0)
    s_barrier
    v_mfma_f32_16x16x32_bf16 v[124:127], a[72:75], v[132:135], v[124:127]
    ds_read_b64 v[92:93], v33 offset:0
    ds_read_b64 v[94:95], v33 offset:1024
    v_mfma_f32_16x16x32_bf16 v[128:131], a[76:79], v[132:135], v[128:131]
    ds_read_b64 v[96:97], v33 offset:2048
    ds_read_b64 v[98:99], v33 offset:3072
    s_waitcnt vmcnt(11)
    v_mfma_f32_16x16x32_bf16 v[112:115], a[80:83], v[136:139], v[112:115]
    ds_read_b64 v[100:101], v33 offset:4096
    ds_read_b64 v[102:103], v34 offset:0
    v_mfma_f32_16x16x32_bf16 v[116:119], a[84:87], v[136:139], v[116:119]
    ds_read_b64 v[104:105], v34 offset:1024
    ds_read_b64 v[106:107], v34 offset:2048
    v_mfma_f32_16x16x32_bf16 v[120:123], a[88:91], v[136:139], v[120:123]
    ds_read_b64 v[108:109], v34 offset:3072
    ds_read_b64 v[110:111], v34 offset:4096
    v_mfma_f32_16x16x32_bf16 v[124:127], a[92:95], v[136:139], v[124:127]
    v_mfma_f32_16x16x32_bf16 v[128:131], a[96:99], v[136:139], v[128:131]
    s_waitcnt vmcnt(10)
    v_mfma_f32_16x16x32_bf16 v[112:115], a[100:103], v[140:143], v[112:115]
    v_mfma_f32_16x16x32_bf16 v[116:119], a[104:107], v[140:143], v[116:119]
    v_mfma_f32_16x16x32_bf16 v[120:123], a[108:111], v[140:143], v[120:123]
    v_mfma_f32_16x16x32_bf16 v[124:127], a[112:115], v[140:143], v[124:127]
    v_mfma_f32_16x16x32_bf16 v[128:131], a[116:119], v[140:143], v[128:131]
    s_waitcnt vmcnt(9)
    v_mfma_f32_16x16x32_bf16 v[112:115], a[120:123], v[144:147], v[112:115]
    v_mfma_f32_16x16x32_bf16 v[116:119], a[124:127], v[144:147], v[116:119]
    v_mfma_f32_16x16x32_bf16 v[120:123], a[128:131], v[144:147], v[120:123]
    s_waitcnt lgkmcnt(4)
    v_add_f32 v92, v92, v102
    v_add_f32 v93, v93, v103
    v_mfma_f32_16x16x32_bf16 v[124:127], a[132:135], v[144:147], v[124:127]
    s_waitcnt lgkmcnt(3)
    v_add_f32 v94, v94, v104
    v_add_f32 v95, v95, v105
    v_mfma_f32_16x16x32_bf16 v[128:131], a[136:139], v[144:147], v[128:131]
    s_waitcnt lgkmcnt(2)
    v_add_f32 v96, v96, v106
    v_add_f32 v97, v97, v107
    s_waitcnt vmcnt(8)
    v_mfma_f32_16x16x32_bf16 v[112:115], a[140:143], v[148:151], v[112:115]
    s_waitcnt lgkmcnt(1)
    v_add_f32 v98, v98, v108
    v_add_f32 v99, v99, v109
    v_mfma_f32_16x16x32_bf16 v[116:119], a[144:147], v[148:151], v[116:119]
    s_waitcnt lgkmcnt(0)
    v_add_f32 v100, v100, v110
    v_add_f32 v101, v101, v111
    v_mfma_f32_16x16x32_bf16 v[120:123], a[148:151], v[148:151], v[120:123]
    v_lshlrev_b32 v102, 16, v12
    v_and_b32 v103, 0xffff0000, v12
    v_mfma_f32_16x16x32_bf16 v[124:127], a[152:155], v[148:151], v[124:127]
    v_lshlrev_b32 v104, 16, v13
    v_and_b32 v105, 0xffff0000, v13
    v_mfma_f32_16x16x32_bf16 v[128:131], a[156:159], v[148:151], v[128:131]
    v_lshlrev_b32 v106, 16, v14
    v_and_b32 v107, 0xffff0000, v14
    s_waitcnt vmcnt(7)
    v_mfma_f32_16x16x32_bf16 v[112:115], a[160:163], v[152:155], v[112:115]
    v_lshlrev_b32 v108, 16, v15
    v_and_b32 v109, 0xffff0000, v15
    v_mfma_f32_16x16x32_bf16 v[116:119], a[164:167], v[152:155], v[116:119]
    v_lshlrev_b32 v110, 16, v16
    v_and_b32 v111, 0xffff0000, v16
    v_mfma_f32_16x16x32_bf16 v[120:123], a[168:171], v[152:155], v[120:123]
    v_add_f32 v92, v92, v102
    v_add_f32 v93, v93, v103
    v_mfma_f32_16x16x32_bf16 v[124:127], a[172:175], v[152:155], v[124:127]
    v_add_f32 v94, v94, v104
    v_add_f32 v95, v95, v105
    v_mfma_f32_16x16x32_bf16 v[128:131], a[176:179], v[152:155], v[128:131]
    v_add_f32 v96, v96, v106
    v_add_f32 v97, v97, v107
    s_waitcnt vmcnt(6)
    v_mfma_f32_16x16x32_bf16 v[112:115], a[180:183], v[156:159], v[112:115]
    v_add_f32 v98, v98, v108
    v_add_f32 v99, v99, v109
    v_mfma_f32_16x16x32_bf16 v[116:119], a[184:187], v[156:159], v[116:119]
    v_add_f32 v100, v100, v110
    v_add_f32 v101, v101, v111
    v_mfma_f32_16x16x32_bf16 v[120:123], a[188:191], v[156:159], v[120:123]
    v_subrev_u32 v35, 8, v34
    v_mov_b32 v34, v33
    v_mfma_f32_16x16x32_bf16 v[124:127], a[192:195], v[156:159], v[124:127]
    v_cvt_pk_bf16_f32 v202, v192, v193
    v_cvt_pk_bf16_f32 v203, v194, v195
    v_mfma_f32_16x16x32_bf16 v[128:131], a[196:199], v[156:159], v[128:131]
    v_cvt_pk_bf16_f32 v204, v196, v197
    v_cvt_pk_bf16_f32 v205, v198, v199
    s_waitcnt vmcnt(5)
    v_mfma_f32_16x16x32_bf16 v[112:115], a[200:203], v[160:163], v[112:115]
    v_cvt_pk_bf16_f32 v206, v200, v201
    global_store_dword v30, v202, s[24:25] offset:0
    v_mfma_f32_16x16x32_bf16 v[116:119], a[204:207], v[160:163], v[116:119]
    global_store_dword v30, v203, s[24:25] offset:32
    global_store_dword v30, v204, s[24:25] offset:64
    v_mfma_f32_16x16x32_bf16 v[120:123], a[208:211], v[160:163], v[120:123]
    global_store_dword v30, v205, s[24:25] offset:96
    global_store_dword v30, v206, s[24:25] offset:128
    v_mfma_f32_16x16x32_bf16 v[124:127], a[212:215], v[160:163], v[124:127]
    v_mfma_f32_16x16x32_bf16 v[128:131], a[216:219], v[160:163], v[128:131]
    s_waitcnt vmcnt(9)
    v_mfma_f32_16x16x32_bf16 v[112:115], a[220:223], v[164:167], v[112:115]
    v_mfma_f32_16x16x32_bf16 v[116:119], a[224:227], v[164:167], v[116:119]
    v_mfma_f32_16x16x32_bf16 v[120:123], a[228:231], v[164:167], v[120:123]
    v_mfma_f32_16x16x32_bf16 v[124:127], a[232:235], v[164:167], v[124:127]
    v_mfma_f32_16x16x32_bf16 v[128:131], a[236:239], v[164:167], v[128:131]
    s_waitcnt vmcnt(7)
    v_mfma_f32_16x16x32_bf16 v[112:115], a[240:243], v[168:171], v[112:115]
    v_mfma_f32_16x16x32_bf16 v[116:119], a[244:247], v[168:171], v[116:119]
    v_mfma_f32_16x16x32_bf16 v[120:123], a[248:251], v[168:171], v[120:123]
    v_mfma_f32_16x16x32_bf16 v[124:127], a[252:255], v[168:171], v[124:127]
    v_mfma_f32_16x16x32_bf16 v[128:131], v[232:235], v[168:171], v[128:131]
    s_waitcnt vmcnt(5)
    v_mfma_f32_16x16x32_bf16 v[112:115], v[236:239], v[172:175], v[112:115]
    v_mfma_f32_16x16x32_bf16 v[116:119], v[240:243], v[172:175], v[116:119]
    v_mfma_f32_16x16x32_bf16 v[120:123], v[244:247], v[172:175], v[120:123]
    v_mfma_f32_16x16x32_bf16 v[124:127], v[248:251], v[172:175], v[124:127]
    v_mfma_f32_16x16x32_bf16 v[128:131], v[252:255], v[172:175], v[128:131]
    s_nop 3
    ds_write_b64 v34, v[114:115] offset:0
    ds_write_b64 v34, v[118:119] offset:1024
    ds_write_b64 v34, v[122:123] offset:2048
    ds_write_b64 v34, v[126:127] offset:3072
    ds_write_b64 v34, v[130:131] offset:4096
    v_pk_add_f32 v[92:93], v[92:93], v[112:113]
    v_pk_add_f32 v[94:95], v[94:95], v[116:117]
    v_pk_add_f32 v[96:97], v[96:97], v[120:121]
    v_pk_add_f32 v[98:99], v[98:99], v[124:125]
    v_pk_add_f32 v[100:101], v[100:101], v[128:129]
    s_waitcnt lgkmcnt(0)
    s_barrier
    ds_read_b64 v[102:103], v35 offset:0
    ds_read_b64 v[104:105], v35 offset:1024
    ds_read_b64 v[106:107], v35 offset:2048
    ds_read_b64 v[108:109], v35 offset:3072
    ds_read_b64 v[110:111], v35 offset:4096
    s_waitcnt lgkmcnt(4)
    v_pk_add_f32 v[92:93], v[92:93], v[102:103]
    s_waitcnt lgkmcnt(3)
    v_pk_add_f32 v[94:95], v[94:95], v[104:105]
    s_waitcnt lgkmcnt(2)
    v_pk_add_f32 v[96:97], v[96:97], v[106:107]
    s_waitcnt lgkmcnt(1)
    v_pk_add_f32 v[98:99], v[98:99], v[108:109]
    s_waitcnt lgkmcnt(0)
    v_pk_add_f32 v[100:101], v[100:101], v[110:111]
    v_cvt_pk_bf16_f32 v102, v92, v93
    v_cvt_pk_bf16_f32 v103, v94, v95
    v_cvt_pk_bf16_f32 v104, v96, v97
    v_cvt_pk_bf16_f32 v105, v98, v99
    v_cvt_pk_bf16_f32 v106, v100, v101
    global_store_dword v31, v102, s[24:25] offset:0
    global_store_dword v31, v103, s[24:25] offset:32
    global_store_dword v31, v104, s[24:25] offset:64
    global_store_dword v31, v105, s[24:25] offset:96
    global_store_dword v31, v106, s[24:25] offset:128
    s_endpgm
PREP_W:
    s_sub_u32 s64, s53, 20
    s_lshl_b32 s64, s64, 2
    s_add_u32 s64, s64, s54
    s_mov_b32 s50, 2211840
    v_mov_b32 v32, 0
    s_cmp_ge_u32 s64, 40
    s_cbranch_scc1 WU2_85
    s_mul_i32 s65, s52, 40
    s_add_u32 s64, s64, s65
    s_and_b32 s71, s64, 15
    s_lshr_b32 s70, s64, 4
    s_mul_i32 s64, s71, 20
    s_add_u32 s64, s64, s70
    s_mul_i32 s98, s64, 7168
    s_add_u32 s98, s98, 31457280
    s_mul_i32 s101, s64, 448
    s_add_u32 s101, s101, 73728
    s_lshr_b32 s65, s70, 1
    s_mul_i32 s65, s65, 80
    s_and_b32 s66, s70, 1
    s_lshl_b32 s66, s66, 1
    s_add_u32 s65, s65, s66
    s_add_u32 s66, s65, 32
    s_sub_u32 s67, s70, 16
    s_mul_i32 s67, s67, 160
    s_add_u32 s68, s67, 64
    s_add_u32 s67, s67, 144
    s_cmp_ge_u32 s70, 16
    s_cselect_b32 s65, s68, s65
    s_cselect_b32 s66, s67, s66
    s_cselect_b32 s67, 0, 14
    v_mov_b32 v32, s67
    s_mul_i32 s65, s65, 3456
    s_mul_i32 s66, s66, 3456
    s_lshl_b32 s70, s64, 7
    s_add_u32 s99, s70, 393216
    s_mul_i32 s67, s71, 7
    s_mul_i32 s68, s71, 6
    s_add_u32 s68, s68, 12
    s_cmp_ge_u32 s71, 12
    s_cselect_b32 s67, s68, s67
    s_lshl_b32 s67, s67, 5
    s_add_u32 s65, s65, s67
    s_add_u32 s66, s66, s67
    s_mov_b32 s67, 3456
    s_mov_b32 s68, 14
    s_branch WUE_86
WU2_85:
    s_sub_u32 s64, s64, 40
    s_mov_b32 s101, s64
    s_min_u32 s64, s64, 53
    s_mul_i32 s65, s52, 54
    s_add_u32 s64, s64, s65
    s_and_b32 s71, s64, 7
    s_lshr_b32 s70, s64, 3
    s_mul_i32 s64, s71, 54
    s_add_u32 s64, s64, s70
    s_mul_i32 s98, s64, 5120
    s_add_u32 s98, s98, 34603008
    s_mul_i32 s65, s70, 21846
    s_lshr_b32 s65, s65, 16
    s_mul_i32 s66, s65, 3
    s_sub_u32 s66, s70, s66
    s_mul_i32 s67, s65, 7
    s_mul_i32 s68, s65, 6
    s_add_u32 s68, s68, 12
    s_cmp_ge_u32 s65, 12
    s_cselect_b32 s65, s68, s67
    s_lshl_b32 s66, s66, 1
    s_add_u32 s65, s65, s66
    s_add_u32 s66, s65, 1
    s_sub_u32 s67, s70, 48
    s_mul_i32 s67, s67, 14
    s_add_u32 s68, s67, 6
    s_add_u32 s67, s67, 13
    s_cmp_ge_u32 s70, 48
    s_cselect_b32 s65, s68, s65
    s_cselect_b32 s66, s67, s66
    s_mul_i32 s65, s65, 20480
    s_mul_i32 s66, s66, 20480
    s_lshl_b32 s70, s64, 7
    s_add_u32 s99, s70, 434176
    s_mul_i32 s67, s71, 160
    s_add_u32 s65, s65, s67
    s_add_u32 s66, s66, s67
    s_mov_b32 s67, 1280
    s_mov_b32 s68, 10
    s_cmp_ge_u32 s101, 54
    s_cselect_b32 s65, 0x70000000, s65
    s_cselect_b32 s66, 0x70000000, s66
    s_cselect_b32 s98, 0x70000000, s98
    s_cselect_b32 s99, 0x70000000, s99
WUE_86:
    s_lshl_b32 s100, s68, 4
    v_cvt_f32_u32 v30, v0
    v_cvt_f32_u32 v31, s68
    v_add_f32 v30, 0.5, v30
    v_rcp_f32 v31, v31
    s_nop 0
    v_mul_f32 v30, v30, v31
    v_cvt_u32_f32 v30, v30
    v_mul_lo_u32 v31, v30, s68
    v_sub_u32 v31, v0, v31
    v_lshlrev_b32 v31, 4, v31
    v_cmp_gt_u32 vcc, 4, v30
    v_lshrrev_b32 v33, 1, v30
    v_mad_u32_u24 v30, v33, v32, v30
    v_mul_lo_u32 v30, v30, s67
    v_add_u32 v84, v31, v30
    s_mov_b32 s30, s65
    s_mov_b32 s31, s66
    s_lshl_b32 s74, s67, 2
    s_mov_b32 s75, vcc_hi
    v_lshrrev_b32 v32, 2, v0
    v_mul_lo_u32 v32, v32, s100
    v_and_b32 v33, 3, v0
    v_lshl_add_u32 v32, v33, 3, v32
    s_mul_i32 s64, s54, 7168
    s_add_u32 s64, s64, 78592
    v_add_u32 v85, s64, v32
    s_lshl_b32 s65, s100, 4
    v_add_u32 v86, s65, v85
    s_branch PREP_DONE
ROLE_W:
    s_branch ROLE_DONE
MID_W:
    s_cmp_eq_u32 s100, 224
    s_cselect_b32 s48, s18, s22
    s_cselect_b32 s49, s19, s23
    s_mul_i32 s71, s54, 7168
    s_add_u32 m0, s71, 78592
    s_lshl_b32 s71, s100, 2
    s_mov_b32 exec_hi, s75
    buffer_load_dwordx4 v84, s[48:51], s30 offen nt lds
    s_add_u32 m0, m0, s71
    s_add_u32 s30, s30, s74
    buffer_load_dwordx4 v84, s[48:51], s30 offen nt lds
    s_add_u32 m0, m0, s71
    s_add_u32 s30, s30, s74
    buffer_load_dwordx4 v84, s[48:51], s30 offen nt lds
    s_add_u32 m0, m0, s71
    s_add_u32 s30, s30, s74
    buffer_load_dwordx4 v84, s[48:51], s30 offen nt lds
    s_add_u32 m0, m0, s71
    s_add_u32 s30, s30, s74
    buffer_load_dwordx4 v84, s[48:51], s31 offen nt lds
    s_add_u32 m0, m0, s71
    s_add_u32 s31, s31, s74
    buffer_load_dwordx4 v84, s[48:51], s31 offen nt lds
    s_add_u32 m0, m0, s71
    s_add_u32 s31, s31, s74
    buffer_load_dwordx4 v84, s[48:51], s31 offen nt lds
    s_add_u32 m0, m0, s71
    s_add_u32 s31, s31, s74
    buffer_load_dwordx4 v84, s[48:51], s31 offen nt lds
    s_mov_b64 exec, -1
    s_waitcnt vmcnt(0)
    ds_read_b64_tr_b16 v[200:201], v85 offset:0
    ds_read_b64_tr_b16 v[202:203], v86 offset:0
    ds_read_b64_tr_b16 v[204:205], v85 offset:32
    ds_read_b64_tr_b16 v[206:207], v86 offset:32
    ds_read_b64_tr_b16 v[208:209], v85 offset:64
    ds_read_b64_tr_b16 v[210:211], v86 offset:64
    ds_read_b64_tr_b16 v[212:213], v85 offset:96
    ds_read_b64_tr_b16 v[214:215], v86 offset:96
    ds_read_b64_tr_b16 v[216:217], v85 offset:128
    ds_read_b64_tr_b16 v[218:219], v86 offset:128
    ds_read_b64_tr_b16 v[220:221], v85 offset:160
    ds_read_b64_tr_b16 v[222:223], v86 offset:160
    ds_read_b64_tr_b16 v[224:225], v85 offset:192
    ds_read_b64_tr_b16 v[226:227], v86 offset:192
    s_waitcnt lgkmcnt(12)
    buffer_store_dwordx4 v[200:203], v1, s[32:35], s98 offen offset:0 sc1
    s_waitcnt lgkmcnt(10)
    buffer_store_dwordx4 v[204:207], v1, s[32:35], s98 offen offset:1024 sc1
    s_waitcnt lgkmcnt(8)
    buffer_store_dwordx4 v[208:211], v1, s[32:35], s98 offen offset:2048 sc1
    s_waitcnt lgkmcnt(6)
    buffer_store_dwordx4 v[212:215], v1, s[32:35], s98 offen offset:3072 sc1
    s_add_u32 s98, s98, 4096
    s_waitcnt lgkmcnt(4)
    buffer_store_dwordx4 v[216:219], v1, s[32:35], s98 offen offset:0 sc1
    s_cmp_lt_u32 s100, 224
    s_cbranch_scc1 WSKIP_87
    s_waitcnt lgkmcnt(2)
    buffer_store_dwordx4 v[220:223], v1, s[32:35], s98 offen offset:1024 sc1
    s_waitcnt lgkmcnt(0)
    buffer_store_dwordx4 v[224:227], v1, s[32:35], s98 offen offset:2048 sc1
    v_mov_b32 v64, 0x3f803f80
    v_mov_b32 v65, 0x3f803f80
    v_mov_b32 v66, 0x3f803f80
    v_mov_b32 v67, 0x3f803f80
    v_lshlrev_b32 v68, 4, v3
    s_nop 0
    v_mfma_f32_16x16x32_bf16 v[120:123], v[200:203], v[64:67], 0
    v_mfma_f32_16x16x32_bf16 v[124:127], v[204:207], v[64:67], 0
    v_mfma_f32_16x16x32_bf16 v[128:131], v[208:211], v[64:67], 0
    v_mfma_f32_16x16x32_bf16 v[132:135], v[212:215], v[64:67], 0
    v_mfma_f32_16x16x32_bf16 v[136:139], v[216:219], v[64:67], 0
    v_mfma_f32_16x16x32_bf16 v[140:143], v[220:223], v[64:67], 0
    v_mfma_f32_16x16x32_bf16 v[144:147], v[224:227], v[64:67], 0
    s_nop 7
    s_mov_b32 exec_lo, 0x00010001
    s_mov_b32 exec_hi, 0x00010001
    buffer_store_dwordx4 v[120:123], v68, s[32:35], s101 offen offset:0 sc1
    buffer_store_dwordx4 v[124:127], v68, s[32:35], s101 offen offset:64 sc1
    buffer_store_dwordx4 v[128:131], v68, s[32:35], s101 offen offset:128 sc1
    buffer_store_dwordx4 v[132:135], v68, s[32:35], s101 offen offset:192 sc1
    buffer_store_dwordx4 v[136:139], v68, s[32:35], s101 offen offset:256 sc1
    buffer_store_dwordx4 v[140:143], v68, s[32:35], s101 offen offset:320 sc1
    buffer_store_dwordx4 v[144:147], v68, s[32:35], s101 offen offset:384 sc1
    s_mov_b64 exec, -1
WSKIP_87:
    v_mov_b32 v30, s59
    v_mov_b32 v31, 0
    s_waitcnt vmcnt(0)
    buffer_store_dword v30, v31, s[32:35], s99 offen sc1
    s_branch CHECK
SPIN_15:
    s_mov_b32 s63, 0
    s_branch POLLB_90
POLL_89:
    s_sleep 2
    s_add_u32 s63, s63, 1
    s_cmp_gt_u32 s63, 400000
    s_cbranch_scc1 POLLX_91
POLLB_90:
    buffer_load_dword v34, v91, s[32:35], 0 offen sc1
    s_waitcnt vmcnt(0)
    v_cmp_ne_u32 vcc, s59, v34
    s_cbranch_vccnz POLL_89
POLLX_91:
    s_branch BACK_16
SPIN_17:
    s_mov_b32 s63, 0
    s_branch POLLB_93
POLL_92:
    s_sleep 2
    s_add_u32 s63, s63, 1
    s_cmp_gt_u32 s63, 400000
    s_cbranch_scc1 POLLX_94
POLLB_93:
    buffer_load_dwordx3 v[58:60], v1, s[32:35], s67 offen offset:0 sc1
    buffer_load_dwordx3 v[62:64], v1, s[32:35], s67 offen offset:1024 sc1
    buffer_load_dwordx3 v[66:68], v1, s[32:35], s67 offen offset:2048 sc1
    buffer_load_dwordx3 v[70:72], v1, s[32:35], s67 offen offset:3072 sc1
    s_waitcnt vmcnt(0)
    v_cmp_ne_u32 vcc, s59, v60
    s_cbranch_vccnz POLL_92
    v_cmp_ne_u32 vcc, s59, v64
    s_cbranch_vccnz POLL_92
    v_cmp_ne_u32 vcc, s59, v68
    s_cbranch_vccnz POLL_92
    v_cmp_ne_u32 vcc, s59, v72
    s_cbranch_vccnz POLL_92
POLLX_94:
    s_branch BACK_18
SPIN_19:
    s_mov_b32 s63, 0
    s_branch POLLB_96
POLL_95:
    s_sleep 2
    s_add_u32 s63, s63, 1
    s_cmp_gt_u32 s63, 400000
    s_cbranch_scc1 POLLX_97
POLLB_96:
    buffer_load_dwordx3 v[74:76], v1, s[32:35], s68 offen offset:0 sc1
    buffer_load_dwordx3 v[78:80], v1, s[32:35], s68 offen offset:1024 sc1
    buffer_load_dwordx3 v[82:84], v1, s[32:35], s68 offen offset:2048 sc1
    buffer_load_dwordx3 v[86:88], v1, s[32:35], s68 offen offset:3072 sc1
    s_waitcnt vmcnt(0)
    v_cmp_ne_u32 vcc, s59, v76
    s_cbranch_vccnz POLL_95
    v_cmp_ne_u32 vcc, s59, v80
    s_cbranch_vccnz POLL_95
    v_cmp_ne_u32 vcc, s59, v84
    s_cbranch_vccnz POLL_95
    v_cmp_ne_u32 vcc, s59, v88
    s_cbranch_vccnz POLL_95
POLLX_97:
    s_branch BACK_20
SPIN_28:
    s_mov_b32 s63, 0
    s_branch POLLB_99
POLL_98:
    s_sleep 2
    s_add_u32 s63, s63, 1
    s_cmp_gt_u32 s63, 400000
    s_cbranch_scc1 POLLX_100
POLLB_99:
    buffer_load_dwordx3 v[58:60], v1, s[32:35], s67 offen offset:0 sc1
    buffer_load_dwordx3 v[62:64], v1, s[32:35], s67 offen offset:1024 sc1
    buffer_load_dwordx3 v[66:68], v1, s[32:35], s67 offen offset:2048 sc1
    buffer_load_dwordx3 v[70:72], v1, s[32:35], s67 offen offset:3072 sc1
    s_waitcnt vmcnt(0)
    v_cmp_ne_u32 vcc, s59, v60
    s_cbranch_vccnz POLL_98
    v_cmp_ne_u32 vcc, s59, v64
    s_cbranch_vccnz POLL_98
    v_cmp_ne_u32 vcc, s59, v68
    s_cbranch_vccnz POLL_98
    v_cmp_ne_u32 vcc, s59, v72
    s_cbranch_vccnz POLL_98
POLLX_100:
    s_branch BACK_29
SPIN_30:
    s_mov_b32 s63, 0
    s_branch POLLB_102
POLL_101:
    s_sleep 2
    s_add_u32 s63, s63, 1
    s_cmp_gt_u32 s63, 400000
    s_cbranch_scc1 POLLX_103
POLLB_102:
    buffer_load_dwordx3 v[74:76], v1, s[32:35], s68 offen offset:0 sc1
    buffer_load_dwordx3 v[78:80], v1, s[32:35], s68 offen offset:1024 sc1
    buffer_load_dwordx3 v[82:84], v1, s[32:35], s68 offen offset:2048 sc1
    buffer_load_dwordx3 v[86:88], v1, s[32:35], s68 offen offset:3072 sc1
    s_waitcnt vmcnt(0)
    v_cmp_ne_u32 vcc, s59, v76
    s_cbranch_vccnz POLL_101
    v_cmp_ne_u32 vcc, s59, v80
    s_cbranch_vccnz POLL_101
    v_cmp_ne_u32 vcc, s59, v84
    s_cbranch_vccnz POLL_101
    v_cmp_ne_u32 vcc, s59, v88
    s_cbranch_vccnz POLL_101
POLLX_103:
    s_branch BACK_31
SPIN_43:
    s_mov_b32 s63, 0
    s_branch POLLB_105
POLL_104:
    s_sleep 2
    s_add_u32 s63, s63, 1
    s_cmp_gt_u32 s63, 400000
    s_cbranch_scc1 POLLX_106
POLLB_105:
    buffer_load_dword v120, v121, s[32:35], s67 offen sc1
    s_waitcnt vmcnt(0)
    v_cmp_ne_u32 vcc, s59, v120
    s_cbranch_vccnz POLL_104
POLLX_106:
    s_branch BACK_44
SPIN_46:
    s_mov_b32 s63, 0
    s_branch POLLB_108
POLL_107:
    s_sleep 2
    s_add_u32 s63, s63, 1
    s_cmp_gt_u32 s63, 400000
    s_cbranch_scc1 POLLX_109
POLLB_108:
    buffer_load_dwordx3 v[76:78], v1, s[32:35], s69 offen offset:0 sc1
    buffer_load_dwordx3 v[80:82], v1, s[32:35], s69 offen offset:1024 sc1
    buffer_load_dwordx3 v[84:86], v1, s[32:35], s69 offen offset:2048 sc1
    buffer_load_dwordx3 v[88:90], v1, s[32:35], s69 offen offset:3072 sc1
    s_waitcnt vmcnt(0)
    v_cmp_ne_u32 vcc, s59, v78
    s_cbranch_vccnz POLL_107
    v_cmp_ne_u32 vcc, s59, v82
    s_cbranch_vccnz POLL_107
    v_cmp_ne_u32 vcc, s59, v86
    s_cbranch_vccnz POLL_107
    v_cmp_ne_u32 vcc, s59, v90
    s_cbranch_vccnz POLL_107
POLLX_109:
    s_branch BACK_47
SPIN_48:
    s_mov_b32 s63, 0
    s_branch POLLB_111
POLL_110:
    s_sleep 2
    s_add_u32 s63, s63, 1
    s_cmp_gt_u32 s63, 400000
    s_cbranch_scc1 POLLX_112
POLLB_111:
    buffer_load_dwordx3 v[76:78], v1, s[32:35], s69 offen offset:0 sc1
    buffer_load_dwordx3 v[80:82], v1, s[32:35], s69 offen offset:1024 sc1
    buffer_load_dwordx3 v[84:86], v1, s[32:35], s69 offen offset:2048 sc1
    buffer_load_dwordx3 v[88:90], v1, s[32:35], s69 offen offset:3072 sc1
    s_waitcnt vmcnt(0)
    v_cmp_ne_u32 vcc, s59, v78
    s_cbranch_vccnz POLL_110
    v_cmp_ne_u32 vcc, s59, v82
    s_cbranch_vccnz POLL_110
    v_cmp_ne_u32 vcc, s59, v86
    s_cbranch_vccnz POLL_110
    v_cmp_ne_u32 vcc, s59, v90
    s_cbranch_vccnz POLL_110
POLLX_112:
    s_branch BACK_49
SPIN_52:
    s_mov_b32 s63, 0
    s_branch POLLB_114
POLL_113:
    s_sleep 2
    s_add_u32 s63, s63, 1
    s_cmp_gt_u32 s63, 400000
    s_cbranch_scc1 POLLX_115
POLLB_114:
    buffer_load_dword v120, v121, s[32:35], s67 offen sc1
    s_waitcnt vmcnt(0)
    v_cmp_ne_u32 vcc, s59, v120
    s_cbranch_vccnz POLL_113
POLLX_115:
    s_branch BACK_53
SPIN_55:
    s_mov_b32 s63, 0
    s_branch POLLB_117
POLL_116:
    s_sleep 2
    s_add_u32 s63, s63, 1
    s_cmp_gt_u32 s63, 400000
    s_cbranch_scc1 POLLX_118
POLLB_117:
    buffer_load_dword v120, v121, s[32:35], s67 offen sc1
    s_waitcnt vmcnt(0)
    v_cmp_ne_u32 vcc, s59, v120
    s_cbranch_vccnz POLL_116
POLLX_118:
    s_branch BACK_56
SPIN_60:
    s_mov_b32 s63, 0
    s_branch POLLB_120
POLL_119:
    s_sleep 2
    s_add_u32 s63, s63, 1
    s_cmp_gt_u32 s63, 400000
    s_cbranch_scc1 POLLX_121
POLLB_120:
    buffer_load_dwordx3 v[212:214], v1, s[32:35], s69 offen offset:0 sc1
    buffer_load_dwordx3 v[216:218], v1, s[32:35], s69 offen offset:1024 sc1
    buffer_load_dwordx3 v[220:222], v1, s[32:35], s69 offen offset:2048 sc1
    buffer_load_dwordx3 v[224:226], v1, s[32:35], s69 offen offset:3072 sc1
    s_waitcnt vmcnt(0)
    v_cmp_ne_u32 vcc, s97, v214
    s_cbranch_vccnz POLL_119
    v_cmp_ne_u32 vcc, s97, v218
    s_cbranch_vccnz POLL_119
    v_cmp_ne_u32 vcc, s97, v222
    s_cbranch_vccnz POLL_119
    v_cmp_ne_u32 vcc, s97, v226
    s_cbranch_vccnz POLL_119
POLLX_121:
    s_branch BACK_61
SPIN_63:
    s_mov_b32 s63, 0
    s_branch POLLB_123
POLL_122:
    s_sleep 2
    s_add_u32 s63, s63, 1
    s_cmp_gt_u32 s63, 400000
    s_cbranch_scc1 POLLX_124
POLLB_123:
    buffer_load_dword v30, v31, s[32:35], s66 offen sc1
    s_waitcnt vmcnt(0)
    v_cmp_ne_u32 vcc, s97, v30
    s_cbranch_vccnz POLL_122
POLLX_124:
    s_branch BACK_64
SPIN_65:
    s_mov_b32 s63, 0
    s_branch POLLB_126
POLL_125:
    s_sleep 2
    s_add_u32 s63, s63, 1
    s_cmp_gt_u32 s63, 400000
    s_cbranch_scc1 POLLX_127
POLLB_126:
    buffer_load_dwordx3 v[116:118], v1, s[32:35], s67 offen offset:0 sc1
    buffer_load_dwordx3 v[120:122], v1, s[32:35], s67 offen offset:1024 sc1
    buffer_load_dwordx3 v[124:126], v1, s[32:35], s67 offen offset:2048 sc1
    buffer_load_dwordx3 v[128:130], v1, s[32:35], s67 offen offset:3072 sc1
    s_waitcnt vmcnt(0)
    v_cmp_ne_u32 vcc, s97, v118
    s_cbranch_vccnz POLL_125
    v_cmp_ne_u32 vcc, s97, v122
    s_cbranch_vccnz POLL_125
    v_cmp_ne_u32 vcc, s97, v126
    s_cbranch_vccnz POLL_125
    v_cmp_ne_u32 vcc, s97, v130
    s_cbranch_vccnz POLL_125
POLLX_127:
    s_branch BACK_66
SPIN_67:
    s_mov_b32 s63, 0
    s_branch POLLB_129
POLL_128:
    s_sleep 2
    s_add_u32 s63, s63, 1
    s_cmp_gt_u32 s63, 400000
    s_cbranch_scc1 POLLX_130
POLLB_129:
    buffer_load_dwordx3 v[112:114], v1, s[32:35], s69 offen offset:0 sc1
    buffer_load_dwordx3 v[116:118], v1, s[32:35], s69 offen offset:1024 sc1
    buffer_load_dwordx3 v[120:122], v1, s[32:35], s69 offen offset:2048 sc1
    buffer_load_dwordx3 v[124:126], v1, s[32:35], s69 offen offset:3072 sc1
    s_waitcnt vmcnt(0)
    v_cmp_ne_u32 vcc, s97, v114
    s_cbranch_vccnz POLL_128
    v_cmp_ne_u32 vcc, s97, v118
    s_cbranch_vccnz POLL_128
    v_cmp_ne_u32 vcc, s97, v122
    s_cbranch_vccnz POLL_128
    v_cmp_ne_u32 vcc, s97, v126
    s_cbranch_vccnz POLL_128
POLLX_130:
    s_branch BACK_68
SPIN_71:
    s_mov_b32 s63, 0
    s_branch POLLB_132
POLL_131:
    s_sleep 2
    s_add_u32 s63, s63, 1
    s_cmp_gt_u32 s63, 400000
    s_cbranch_scc1 POLLX_133
POLLB_132:
    buffer_load_dword v120, v121, s[32:35], s66 offen sc1
    s_waitcnt vmcnt(0)
    v_cmp_ne_u32 vcc, s97, v120
    s_cbranch_vccnz POLL_131
POLLX_133:
    s_branch BACK_72
SPIN_73:
    s_mov_b32 s63, 0
    s_branch POLLB_135
POLL_134:
    s_sleep 2
    s_add_u32 s63, s63, 1
    s_cmp_gt_u32 s63, 400000
    s_cbranch_scc1 POLLX_136
POLLB_135:
    buffer_load_dwordx3 v[120:122], v1, s[32:35], s69 offen offset:0 sc1
    buffer_load_dwordx3 v[124:126], v1, s[32:35], s69 offen offset:1024 sc1
    buffer_load_dwordx3 v[128:130], v1, s[32:35], s69 offen offset:2048 sc1
    buffer_load_dwordx3 v[132:134], v1, s[32:35], s69 offen offset:3072 sc1
    s_waitcnt vmcnt(0)
    v_cmp_ne_u32 vcc, s97, v122
    s_cbranch_vccnz POLL_134
    v_cmp_ne_u32 vcc, s97, v126
    s_cbranch_vccnz POLL_134
    v_cmp_ne_u32 vcc, s97, v130
    s_cbranch_vccnz POLL_134
    v_cmp_ne_u32 vcc, s97, v134
    s_cbranch_vccnz POLL_134
POLLX_136:
    s_branch BACK_74
SPIN_75:
    s_mov_b32 s63, 0
    s_branch POLLB_138
POLL_137:
    s_sleep 2
    s_add_u32 s63, s63, 1
    s_cmp_gt_u32 s63, 400000
    s_cbranch_scc1 POLLX_139
POLLB_138:
    buffer_load_dword v120, v121, s[32:35], s67 offen sc1
    s_waitcnt vmcnt(0)
    v_cmp_ne_u32 vcc, s97, v120
    s_cbranch_vccnz POLL_137
POLLX_139:
    s_branch BACK_76
SPIN_79:
    s_mov_b32 s63, 0
    s_branch POLLB_141
POLL_140:
    s_sleep 2
    s_add_u32 s63, s63, 1
    s_cmp_gt_u32 s63, 400000
    s_cbranch_scc1 POLLX_142
POLLB_141:
    buffer_load_dword v120, v121, s[32:35], s67 offen sc1
    s_waitcnt vmcnt(0)
    v_cmp_ne_u32 vcc, s97, v120
    s_cbranch_vccnz POLL_140
POLLX_142:
    s_branch BACK_80
SLOW:
    v_mov_b32 v30, s59
    v_mov_b32 v31, 0
    s_add_u32 s64, s69, 65536
    buffer_store_dword v30, v31, s[32:35], s64 offen sc1
    s_cmp_ge_u32 s53, 20
    s_cbranch_scc1 S_W_PHASE
    s_lshl_b32 s64, s52, 9
    s_add_u32 s64, s64, 69632
    ds_read_b64 v[92:93], v36 offset:0
    ds_read_b64 v[94:95], v36 offset:8
    ds_read_b64 v[96:97], v36 offset:512
    ds_read_b64 v[98:99], v36 offset:520
    ds_read_b64 v[100:101], v36 offset:1024
    ds_read_b64 v[102:103], v36 offset:1032
    ds_read_b64 v[104:105], v36 offset:1536
    ds_read_b64 v[106:107], v36 offset:1544
    ds_read_b64 v[108:109], v36 offset:2048
    ds_read_b64 v[110:111], v36 offset:2056
    ds_read_b64 v[112:113], v36 offset:2560
    ds_read_b64 v[114:115], v36 offset:2568
    ds_read_b64 v[116:117], v36 offset:3072
    ds_read_b64 v[118:119], v36 offset:3080
    ds_read_b64 v[120:121], v36 offset:3584
    ds_read_b64 v[122:123], v36 offset:3592
    v_and_b32 v33, 31, v0
    s_mul_i32 s65, s54, 12
    v_add_u32 v90, s65, v33
    s_lshl_b32 s66, s54, 1
    s_add_u32 s66, s66, 36
    v_add_u32 v91, s66, v33
    v_cmp_gt_u32 vcc, 12, v33
    s_nop 1
    v_cndmask_b32 v90, v91, v90, vcc
    s_add_u32 s66, s66, 13
    s_min_u32 s66, s66, 53
    v_min_u32 v90, s66, v90
    s_mul_i32 s65, s56, 6912
    s_add_u32 s65, s65, 434176
    v_lshl_add_u32 v90, v90, 7, s65
    v_min_u32 v91, 19, v0
    s_mul_i32 s65, s58, 2560
    s_add_u32 s65, s65, 393216
    v_lshl_add_u32 v91, v91, 7, s65
    s_lshr_b32 s65, s89, 2
    v_xor_b32 v35, s65, v0
    v_lshlrev_b32 v35, 4, v35
    s_mul_i32 s92, s58, 143360
    s_add_u32 s92, s92, 31457280
    s_mov_b32 s63, 0
    s_branch POLLB_144
POLL_143:
    s_sleep 4
    s_add_u32 s63, s63, 1
    s_cmp_gt_u32 s63, 400000
    s_cbranch_scc1 POLLX_145
POLLB_144:
    buffer_load_dwordx2 v[30:31], v4, s[32:35], s64 offen sc1
    s_waitcnt vmcnt(0)
    v_cmp_ne_u32 vcc, s59, v30
    s_cbranch_vccnz POLL_143
    v_cmp_ne_u32 vcc, s59, v31
    s_cbranch_vccnz POLL_143
POLLX_145:
    s_lshl_b32 s64, s3, 2
    s_add_u32 s64, s64, s54
    s_lshl_b32 s64, s64, 12
    s_add_u32 s64, s64, 3145728
    s_add_u32 m0, s67, 16640
    s_nop 0
    buffer_load_dwordx4 v1, s[32:35], s64 offen offset:0 sc1 lds
    buffer_load_dwordx4 v1, s[32:35], s64 offen offset:1024 sc1 lds
    buffer_load_dwordx4 v1, s[32:35], s64 offen offset:2048 sc1 lds
    buffer_load_dwordx4 v1, s[32:35], s64 offen offset:3072 sc1 lds
    s_waitcnt vmcnt(0)
    ds_read_b128 v[156:159], v37 offset:3584
    ds_read_b128 v[160:163], v37 offset:3072
    ds_read_b128 v[164:167], v37 offset:2560
    ds_read_b128 v[168:171], v37 offset:2048
    ds_read_b128 v[172:175], v37 offset:1536
    ds_read_b128 v[176:179], v37 offset:1024
    ds_read_b128 v[180:183], v37 offset:512
    ds_read_b128 v[184:187], v37 offset:0
    s_waitcnt lgkmcnt(7)
    v_mfma_f32_16x16x32_bf16 v[220:223], v[252:255], v[156:159], 0
    s_mov_b32 s48, s22
    s_mov_b32 s49, s23
    s_waitcnt lgkmcnt(6)
    v_mfma_f32_16x16x32_bf16 v[224:227], v[252:255], v[160:163], 0
    s_mul_i32 s69, s54, 19456
    s_add_u32 m0, s69, 9216
    s_add_u32 s66, s30, 0
    s_mov_b32 exec_hi, 255
    buffer_load_dwordx4 v84, s[48:51], s66 offen nt lds
    s_mov_b64 exec, -1
    s_waitcnt lgkmcnt(5)
    v_mfma_f32_16x16x32_bf16 v[228:231], v[252:255], v[164:167], 0
    s_waitcnt lgkmcnt(4)
    v_mfma_f32_16x16x32_bf16 v[232:235], v[252:255], v[168:171], 0
    s_waitcnt lgkmcnt(3)
    v_mfma_f32_16x16x32_bf16 v[236:239], v[252:255], v[172:175], 0
    s_waitcnt lgkmcnt(2)
    v_mfma_f32_16x16x32_bf16 v[240:243], v[252:255], v[176:179], 0
    s_waitcnt lgkmcnt(1)
    v_mfma_f32_16x16x32_bf16 v[244:247], v[252:255], v[180:183], 0
    s_add_u32 m0, s69, 9856
    s_add_u32 s66, s30, 5120
    s_mov_b32 exec_hi, 255
    buffer_load_dwordx4 v84, s[48:51], s66 offen nt lds
    s_mov_b64 exec, -1
    s_waitcnt lgkmcnt(0)
    v_mfma_f32_16x16x32_bf16 v[248:251], v[252:255], v[184:187], 0
    v_mfma_f32_16x16x32_bf16 v[220:223], v[92:95], v[156:159], v[220:223]
    v_mfma_f32_16x16x32_bf16 v[224:227], v[92:95], v[160:163], v[224:227]
    v_mfma_f32_16x16x32_bf16 v[224:227], v[96:99], v[156:159], v[224:227]
    s_add_u32 m0, s69, 10496
    s_add_u32 s66, s30, 10240
    s_mov_b32 exec_hi, 255
    buffer_load_dwordx4 v84, s[48:51], s66 offen nt lds
    s_mov_b64 exec, -1
    v_mfma_f32_16x16x32_bf16 v[228:231], v[96:99], v[160:163], v[228:231]
    v_mfma_f32_16x16x32_bf16 v[228:231], v[92:95], v[164:167], v[228:231]
    v_mfma_f32_16x16x32_bf16 v[228:231], v[100:103], v[156:159], v[228:231]
    v_mfma_f32_16x16x32_bf16 v[232:235], v[96:99], v[164:167], v[232:235]
    s_add_u32 m0, s69, 11136
    s_add_u32 s66, s30, 15360
    s_mov_b32 exec_hi, 255
    buffer_load_dwordx4 v84, s[48:51], s66 offen nt lds
    s_mov_b64 exec, -1
    v_mfma_f32_16x16x32_bf16 v[232:235], v[100:103], v[160:163], v[232:235]
    v_mfma_f32_16x16x32_bf16 v[236:239], v[100:103], v[164:167], v[236:239]
    ds_read_b128 v[188:191], v37 offset:3648
    v_mfma_f32_16x16x32_bf16 v[232:235], v[92:95], v[168:171], v[232:235]
    ds_read_b64 v[124:125], v36 offset:64
    v_mfma_f32_16x16x32_bf16 v[232:235], v[104:107], v[156:159], v[232:235]
    ds_read_b64 v[126:127], v36 offset:72
    v_mfma_f32_16x16x32_bf16 v[236:239], v[96:99], v[168:171], v[236:239]
    ds_read_b128 v[192:195], v37 offset:3136
    s_add_u32 m0, s69, 11776
    s_add_u32 s66, s31, 0
    s_mov_b32 exec_hi, 255
    buffer_load_dwordx4 v84, s[48:51], s66 offen nt lds
    s_mov_b64 exec, -1
    v_mfma_f32_16x16x32_bf16 v[236:239], v[104:107], v[160:163], v[236:239]
    ds_read_b64 v[128:129], v36 offset:576
    v_mfma_f32_16x16x32_bf16 v[240:243], v[100:103], v[168:171], v[240:243]
    ds_read_b64 v[130:131], v36 offset:584
    v_mfma_f32_16x16x32_bf16 v[240:243], v[104:107], v[164:167], v[240:243]
    ds_read_b128 v[196:199], v37 offset:2624
    v_mfma_f32_16x16x32_bf16 v[244:247], v[104:107], v[168:171], v[244:247]
    ds_read_b64 v[132:133], v36 offset:1088
    v_mfma_f32_16x16x32_bf16 v[236:239], v[92:95], v[172:175], v[236:239]
    ds_read_b64 v[134:135], v36 offset:1096
    v_mfma_f32_16x16x32_bf16 v[236:239], v[108:111], v[156:159], v[236:239]
    ds_read_b128 v[200:203], v37 offset:2112
    v_mfma_f32_16x16x32_bf16 v[240:243], v[96:99], v[172:175], v[240:243]
    ds_read_b64 v[136:137], v36 offset:1600
    s_add_u32 m0, s69, 12416
    s_add_u32 s66, s31, 5120
    s_mov_b32 exec_hi, 255
    buffer_load_dwordx4 v84, s[48:51], s66 offen nt lds
    s_mov_b64 exec, -1
    v_mfma_f32_16x16x32_bf16 v[240:243], v[108:111], v[160:163], v[240:243]
    ds_read_b64 v[138:139], v36 offset:1608
    v_mfma_f32_16x16x32_bf16 v[244:247], v[100:103], v[172:175], v[244:247]
    ds_read_b128 v[204:207], v37 offset:1600
    v_mfma_f32_16x16x32_bf16 v[244:247], v[108:111], v[164:167], v[244:247]
    ds_read_b64 v[140:141], v36 offset:2112
    v_mfma_f32_16x16x32_bf16 v[248:251], v[104:107], v[172:175], v[248:251]
    ds_read_b64 v[142:143], v36 offset:2120
    v_mfma_f32_16x16x32_bf16 v[248:251], v[108:111], v[168:171], v[248:251]
    ds_read_b128 v[208:211], v37 offset:1088
    v_mfma_f32_16x16x32_bf16 v[240:243], v[92:95], v[176:179], v[240:243]
    ds_read_b64 v[144:145], v36 offset:2624
    v_mfma_f32_16x16x32_bf16 v[240:243], v[112:115], v[156:159], v[240:243]
    ds_read_b64 v[146:147], v36 offset:2632
    s_add_u32 m0, s69, 13056
    s_add_u32 s66, s31, 10240
    s_mov_b32 exec_hi, 255
    buffer_load_dwordx4 v84, s[48:51], s66 offen nt lds
    s_mov_b64 exec, -1
    v_mfma_f32_16x16x32_bf16 v[244:247], v[96:99], v[176:179], v[244:247]
    ds_read_b128 v[212:215], v37 offset:576
    v_mfma_f32_16x16x32_bf16 v[244:247], v[112:115], v[160:163], v[244:247]
    ds_read_b64 v[148:149], v36 offset:3136
    v_mfma_f32_16x16x32_bf16 v[248:251], v[100:103], v[176:179], v[248:251]
    ds_read_b64 v[150:151], v36 offset:3144
    v_mfma_f32_16x16x32_bf16 v[248:251], v[112:115], v[164:167], v[248:251]
    ds_read_b128 v[216:219], v37 offset:64
    v_mfma_f32_16x16x32_bf16 v[244:247], v[92:95], v[180:183], v[244:247]
    ds_read_b64 v[152:153], v36 offset:3648
    v_mfma_f32_16x16x32_bf16 v[244:247], v[116:119], v[156:159], v[244:247]
    ds_read_b64 v[154:155], v36 offset:3656
    v_mfma_f32_16x16x32_bf16 v[248:251], v[96:99], v[180:183], v[248:251]
    s_add_u32 m0, s69, 13696
    s_add_u32 s66, s31, 15360
    s_mov_b32 exec_hi, 255
    buffer_load_dwordx4 v84, s[48:51], s66 offen nt lds
    s_mov_b64 exec, -1
    v_mfma_f32_16x16x32_bf16 v[248:251], v[116:119], v[160:163], v[248:251]
    v_mfma_f32_16x16x32_bf16 v[248:251], v[92:95], v[184:187], v[248:251]
    v_mfma_f32_16x16x32_bf16 v[248:251], v[120:123], v[156:159], v[248:251]
    s_waitcnt lgkmcnt(15)
    v_mfma_f32_16x16x32_bf16 v[220:223], v[124:127], v[188:191], v[220:223]
    v_mul_u32_u24 v30, 205, v0
    v_lshrrev_b32 v30, 11, v30
    v_mul_u32_u24 v83, 1120, v30
    v_lshl_add_u32 v83, v0, 4, v83
    s_lshl_b32 s64, s55, 2
    s_and_b32 s65, s54, 1
    s_add_u32 s64, s64, s65
    s_mul_i32 s64, s64, 20480
    s_mul_i32 s65, s56, 160
    s_add_u32 s70, s64, s65
    s_mov_b32 s44, s4
    s_mov_b32 s45, s5
    s_mul_i32 s71, s54, 19456
    v_mfma_f32_16x16x32_bf16 v[224:227], v[124:127], v[192:195], v[224:227]
    v_mfma_f32_16x16x32_bf16 v[224:227], v[128:131], v[188:191], v[224:227]
    v_mfma_f32_16x16x32_bf16 v[228:231], v[128:131], v[192:195], v[228:231]
    v_mfma_f32_16x16x32_bf16 v[228:231], v[124:127], v[196:199], v[228:231]
    v_mfma_f32_16x16x32_bf16 v[228:231], v[132:135], v[188:191], v[228:231]
    v_mfma_f32_16x16x32_bf16 v[232:235], v[128:131], v[196:199], v[232:235]
    v_mfma_f32_16x16x32_bf16 v[232:235], v[132:135], v[192:195], v[232:235]
    s_add_u32 m0, s71, 14336
    s_add_u32 s66, s70, 0
    s_mov_b32 exec_hi, 262143
    buffer_load_dwordx4 v83, s[44:47], s66 offen nt lds
    s_mov_b64 exec, -1
    v_mfma_f32_16x16x32_bf16 v[236:239], v[132:135], v[196:199], v[236:239]
    ds_read_b128 v[156:159], v37 offset:3712
    s_waitcnt lgkmcnt(15)
    v_mfma_f32_16x16x32_bf16 v[232:235], v[124:127], v[200:203], v[232:235]
    ds_read_b64 v[92:93], v36 offset:128
    s_waitcnt lgkmcnt(14)
    v_mfma_f32_16x16x32_bf16 v[232:235], v[136:139], v[188:191], v[232:235]
    ds_read_b64 v[94:95], v36 offset:136
    v_mfma_f32_16x16x32_bf16 v[236:239], v[128:131], v[200:203], v[236:239]
    ds_read_b128 v[160:163], v37 offset:3200
    v_mfma_f32_16x16x32_bf16 v[236:239], v[136:139], v[192:195], v[236:239]
    ds_read_b64 v[96:97], v36 offset:640
    v_mfma_f32_16x16x32_bf16 v[240:243], v[132:135], v[200:203], v[240:243]
    ds_read_b64 v[98:99], v36 offset:648
    v_mfma_f32_16x16x32_bf16 v[240:243], v[136:139], v[196:199], v[240:243]
    ds_read_b128 v[164:167], v37 offset:2688
    s_add_u32 m0, s71, 15136
    s_add_u32 s66, s70, 6400
    s_mov_b32 exec_hi, 262143
    buffer_load_dwordx4 v83, s[44:47], s66 offen nt lds
    s_mov_b64 exec, -1
    v_mfma_f32_16x16x32_bf16 v[244:247], v[136:139], v[200:203], v[244:247]
    ds_read_b64 v[100:101], v36 offset:1152
    s_waitcnt lgkmcnt(15)
    v_mfma_f32_16x16x32_bf16 v[236:239], v[124:127], v[204:207], v[236:239]
    ds_read_b64 v[102:103], v36 offset:1160
    v_mfma_f32_16x16x32_bf16 v[236:239], v[140:143], v[188:191], v[236:239]
    ds_read_b128 v[168:171], v37 offset:2176
    v_mfma_f32_16x16x32_bf16 v[240:243], v[128:131], v[204:207], v[240:243]
    ds_read_b64 v[104:105], v36 offset:1664
    v_mfma_f32_16x16x32_bf16 v[240:243], v[140:143], v[192:195], v[240:243]
    ds_read_b64 v[106:107], v36 offset:1672
    v_mfma_f32_16x16x32_bf16 v[244:247], v[132:135], v[204:207], v[244:247]
    ds_read_b128 v[172:175], v37 offset:1664
    v_mfma_f32_16x16x32_bf16 v[244:247], v[140:143], v[196:199], v[244:247]
    ds_read_b64 v[108:109], v36 offset:2176
    s_add_u32 m0, s71, 15936
    s_add_u32 s66, s70, 12800
    s_mov_b32 exec_hi, 262143
    buffer_load_dwordx4 v83, s[44:47], s66 offen nt lds
    s_mov_b64 exec, -1
    v_mfma_f32_16x16x32_bf16 v[248:251], v[136:139], v[204:207], v[248:251]
    ds_read_b64 v[110:111], v36 offset:2184
    v_mfma_f32_16x16x32_bf16 v[248:251], v[140:143], v[200:203], v[248:251]
    ds_read_b128 v[176:179], v37 offset:1152
    v_mfma_f32_16x16x32_bf16 v[240:243], v[124:127], v[208:211], v[240:243]
    ds_read_b64 v[112:113], v36 offset:2688
    s_waitcnt lgkmcnt(15)
    v_mfma_f32_16x16x32_bf16 v[240:243], v[144:147], v[188:191], v[240:243]
    ds_read_b64 v[114:115], v36 offset:2696
    v_mfma_f32_16x16x32_bf16 v[244:247], v[128:131], v[208:211], v[244:247]
    ds_read_b128 v[180:183], v37 offset:640
    v_mfma_f32_16x16x32_bf16 v[244:247], v[144:147], v[192:195], v[244:247]
    ds_read_b64 v[116:117], v36 offset:3200
    v_mfma_f32_16x16x32_bf16 v[248:251], v[132:135], v[208:211], v[248:251]
    ds_read_b64 v[118:119], v36 offset:3208
    s_add_u32 m0, s71, 16736
    s_add_u32 s66, s70, 19200
    s_mov_b32 exec_hi, 0
    s_mov_b32 exec_lo, 1023
    buffer_load_dwordx4 v83, s[44:47], s66 offen nt lds
    s_mov_b64 exec, -1
    v_mfma_f32_16x16x32_bf16 v[248:251], v[144:147], v[196:199], v[248:251]
    ds_read_b128 v[184:187], v37 offset:128
    v_mfma_f32_16x16x32_bf16 v[244:247], v[124:127], v[212:215], v[244:247]
    ds_read_b64 v[120:121], v36 offset:3712
    v_mfma_f32_16x16x32_bf16 v[244:247], v[148:151], v[188:191], v[244:247]
    ds_read_b64 v[122:123], v36 offset:3720
    v_mfma_f32_16x16x32_bf16 v[248:251], v[128:131], v[212:215], v[248:251]
    v_mfma_f32_16x16x32_bf16 v[248:251], v[148:151], v[192:195], v[248:251]
    v_mfma_f32_16x16x32_bf16 v[248:251], v[124:127], v[216:219], v[248:251]
    s_add_u32 m0, s71, 16896
    s_add_u32 s66, s70, 40960
    s_mov_b32 exec_hi, 262143
    buffer_load_dwordx4 v83, s[44:47], s66 offen nt lds
    s_mov_b64 exec, -1
    v_mfma_f32_16x16x32_bf16 v[248:251], v[152:155], v[188:191], v[248:251]
    s_waitcnt lgkmcnt(15)
    v_mfma_f32_16x16x32_bf16 v[220:223], v[92:95], v[156:159], v[220:223]
    v_mfma_f32_16x16x32_bf16 v[224:227], v[92:95], v[160:163], v[224:227]
    v_mfma_f32_16x16x32_bf16 v[224:227], v[96:99], v[156:159], v[224:227]
    s_add_u32 m0, s71, 17696
    s_add_u32 s66, s70, 47360
    s_mov_b32 exec_hi, 262143
    buffer_load_dwordx4 v83, s[44:47], s66 offen nt lds
    s_mov_b64 exec, -1
    v_mfma_f32_16x16x32_bf16 v[228:231], v[96:99], v[160:163], v[228:231]
    v_mfma_f32_16x16x32_bf16 v[228:231], v[92:95], v[164:167], v[228:231]
    v_mfma_f32_16x16x32_bf16 v[228:231], v[100:103], v[156:159], v[228:231]
    v_mfma_f32_16x16x32_bf16 v[232:235], v[96:99], v[164:167], v[232:235]
    s_add_u32 m0, s71, 18496
    s_add_u32 s66, s70, 53760
    s_mov_b32 exec_hi, 262143
    buffer_load_dwordx4 v83, s[44:47], s66 offen nt lds
    s_mov_b64 exec, -1
    v_mfma_f32_16x16x32_bf16 v[232:235], v[100:103], v[160:163], v[232:235]
    v_mfma_f32_16x16x32_bf16 v[236:239], v[100:103], v[164:167], v[236:239]
    ds_read_b128 v[188:191], v37 offset:3776
    s_waitcnt lgkmcnt(15)
    v_mfma_f32_16x16x32_bf16 v[232:235], v[92:95], v[168:171], v[232:235]
    ds_read_b64 v[124:125], v36 offset:192
    s_waitcnt lgkmcnt(14)
    v_mfma_f32_16x16x32_bf16 v[232:235], v[104:107], v[156:159], v[232:235]
    ds_read_b64 v[126:127], v36 offset:200
    v_mfma_f32_16x16x32_bf16 v[236:239], v[96:99], v[168:171], v[236:239]
    ds_read_b128 v[192:195], v37 offset:3264
    s_add_u32 m0, s71, 19296
    s_add_u32 s66, s70, 60160
    s_mov_b32 exec_hi, 0
    s_mov_b32 exec_lo, 1023
    buffer_load_dwordx4 v83, s[44:47], s66 offen nt lds
    s_mov_b64 exec, -1
    v_mfma_f32_16x16x32_bf16 v[236:239], v[104:107], v[160:163], v[236:239]
    ds_read_b64 v[128:129], v36 offset:704
    v_mfma_f32_16x16x32_bf16 v[240:243], v[100:103], v[168:171], v[240:243]
    ds_read_b64 v[130:131], v36 offset:712
    v_mfma_f32_16x16x32_bf16 v[240:243], v[104:107], v[164:167], v[240:243]
    ds_read_b128 v[196:199], v37 offset:2752
    v_mfma_f32_16x16x32_bf16 v[244:247], v[104:107], v[168:171], v[244:247]
    ds_read_b64 v[132:133], v36 offset:1216
    s_waitcnt lgkmcnt(15)
    v_mfma_f32_16x16x32_bf16 v[236:239], v[92:95], v[172:175], v[236:239]
    ds_read_b64 v[134:135], v36 offset:1224
    v_mfma_f32_16x16x32_bf16 v[236:239], v[108:111], v[156:159], v[236:239]
    ds_read_b128 v[200:203], v37 offset:2240
    v_mfma_f32_16x16x32_bf16 v[240:243], v[96:99], v[172:175], v[240:243]
    ds_read_b64 v[136:137], v36 offset:1728
    v_mov_b32 v26, v85
    v_mfma_f32_16x16x32_bf16 v[240:243], v[108:111], v[160:163], v[240:243]
    ds_read_b64 v[138:139], v36 offset:1736
    v_mfma_f32_16x16x32_bf16 v[244:247], v[100:103], v[172:175], v[244:247]
    ds_read_b128 v[204:207], v37 offset:1728
    v_mfma_f32_16x16x32_bf16 v[244:247], v[108:111], v[164:167], v[244:247]
    ds_read_b64 v[140:141], v36 offset:2240
    v_mfma_f32_16x16x32_bf16 v[248:251], v[104:107], v[172:175], v[248:251]
    ds_read_b64 v[142:143], v36 offset:2248
    v_mfma_f32_16x16x32_bf16 v[248:251], v[108:111], v[168:171], v[248:251]
    ds_read_b128 v[208:211], v37 offset:1216
    v_mfma_f32_16x16x32_bf16 v[240:243], v[92:95], v[176:179], v[240:243]
    ds_read_b64 v[144:145], v36 offset:2752
    s_waitcnt lgkmcnt(15)
    v_mfma_f32_16x16x32_bf16 v[240:243], v[112:115], v[156:159], v[240:243]
    ds_read_b64 v[146:147], v36 offset:2760
    v_mfma_f32_16x16x32_bf16 v[244:247], v[96:99], v[176:179], v[244:247]
    ds_read_b128 v[212:215], v37 offset:704
    v_mfma_f32_16x16x32_bf16 v[244:247], v[112:115], v[160:163], v[244:247]
    ds_read_b64 v[148:149], v36 offset:3264
    v_mfma_f32_16x16x32_bf16 v[248:251], v[100:103], v[176:179], v[248:251]
    ds_read_b64 v[150:151], v36 offset:3272
    v_mfma_f32_16x16x32_bf16 v[248:251], v[112:115], v[164:167], v[248:251]
    ds_read_b128 v[216:219], v37 offset:192
    v_mfma_f32_16x16x32_bf16 v[244:247], v[92:95], v[180:183], v[244:247]
    ds_read_b64 v[152:153], v36 offset:3776
    v_mfma_f32_16x16x32_bf16 v[244:247], v[116:119], v[156:159], v[244:247]
    ds_read_b64 v[154:155], v36 offset:3784
    v_mfma_f32_16x16x32_bf16 v[248:251], v[96:99], v[180:183], v[248:251]
    v_mfma_f32_16x16x32_bf16 v[248:251], v[116:119], v[160:163], v[248:251]
    v_mfma_f32_16x16x32_bf16 v[248:251], v[92:95], v[184:187], v[248:251]
    v_mfma_f32_16x16x32_bf16 v[248:251], v[120:123], v[156:159], v[248:251]
    s_waitcnt lgkmcnt(15)
    v_mfma_f32_16x16x32_bf16 v[220:223], v[124:127], v[188:191], v[220:223]
    v_mfma_f32_16x16x32_bf16 v[224:227], v[124:127], v[192:195], v[224:227]
    v_mfma_f32_16x16x32_bf16 v[224:227], v[128:131], v[188:191], v[224:227]
    v_mfma_f32_16x16x32_bf16 v[228:231], v[128:131], v[192:195], v[228:231]
    v_mfma_f32_16x16x32_bf16 v[228:231], v[124:127], v[196:199], v[228:231]
    v_mfma_f32_16x16x32_bf16 v[228:231], v[132:135], v[188:191], v[228:231]
    v_mfma_f32_16x16x32_bf16 v[232:235], v[128:131], v[196:199], v[232:235]
    v_mfma_f32_16x16x32_bf16 v[232:235], v[132:135], v[192:195], v[232:235]
    v_mfma_f32_16x16x32_bf16 v[236:239], v[132:135], v[196:199], v[236:239]
    ds_read_b128 v[156:159], v37 offset:3840
    s_waitcnt lgkmcnt(15)
    v_mfma_f32_16x16x32_bf16 v[232:235], v[124:127], v[200:203], v[232:235]
    ds_read_b64 v[92:93], v36 offset:256
    s_waitcnt lgkmcnt(14)
    v_mfma_f32_16x16x32_bf16 v[232:235], v[136:139], v[188:191], v[232:235]
    ds_read_b64 v[94:95], v36 offset:264
    v_mfma_f32_16x16x32_bf16 v[236:239], v[128:131], v[200:203], v[236:239]
    ds_read_b128 v[160:163], v37 offset:3328
    v_mfma_f32_16x16x32_bf16 v[236:239], v[136:139], v[192:195], v[236:239]
    ds_read_b64 v[96:97], v36 offset:768
    v_mfma_f32_16x16x32_bf16 v[240:243], v[132:135], v[200:203], v[240:243]
    ds_read_b64 v[98:99], v36 offset:776
    v_mfma_f32_16x16x32_bf16 v[240:243], v[136:139], v[196:199], v[240:243]
    ds_read_b128 v[164:167], v37 offset:2816
    v_mfma_f32_16x16x32_bf16 v[244:247], v[136:139], v[200:203], v[244:247]
    ds_read_b64 v[100:101], v36 offset:1280
    s_waitcnt lgkmcnt(15)
    v_mfma_f32_16x16x32_bf16 v[236:239], v[124:127], v[204:207], v[236:239]
    ds_read_b64 v[102:103], v36 offset:1288
    v_mfma_f32_16x16x32_bf16 v[236:239], v[140:143], v[188:191], v[236:239]
    ds_read_b128 v[168:171], v37 offset:2304
    v_mfma_f32_16x16x32_bf16 v[240:243], v[128:131], v[204:207], v[240:243]
    ds_read_b64 v[104:105], v36 offset:1792
    v_mfma_f32_16x16x32_bf16 v[240:243], v[140:143], v[192:195], v[240:243]
    ds_read_b64 v[106:107], v36 offset:1800
    v_mfma_f32_16x16x32_bf16 v[244:247], v[132:135], v[204:207], v[244:247]
    ds_read_b128 v[172:175], v37 offset:1792
    v_mfma_f32_16x16x32_bf16 v[244:247], v[140:143], v[196:199], v[244:247]
    ds_read_b64 v[108:109], v36 offset:2304
    v_mfma_f32_16x16x32_bf16 v[248:251], v[136:139], v[204:207], v[248:251]
    ds_read_b64 v[110:111], v36 offset:2312
    v_mfma_f32_16x16x32_bf16 v[248:251], v[140:143], v[200:203], v[248:251]
    ds_read_b128 v[176:179], v37 offset:1280
    v_mfma_f32_16x16x32_bf16 v[240:243], v[124:127], v[208:211], v[240:243]
    ds_read_b64 v[112:113], v36 offset:2816
    s_waitcnt lgkmcnt(15)
    v_mfma_f32_16x16x32_bf16 v[240:243], v[144:147], v[188:191], v[240:243]
    ds_read_b64 v[114:115], v36 offset:2824
    v_mfma_f32_16x16x32_bf16 v[244:247], v[128:131], v[208:211], v[244:247]
    ds_read_b128 v[180:183], v37 offset:768
    v_mfma_f32_16x16x32_bf16 v[244:247], v[144:147], v[192:195], v[244:247]
    ds_read_b64 v[116:117], v36 offset:3328
    v_mfma_f32_16x16x32_bf16 v[248:251], v[132:135], v[208:211], v[248:251]
    ds_read_b64 v[118:119], v36 offset:3336
    v_mfma_f32_16x16x32_bf16 v[248:251], v[144:147], v[196:199], v[248:251]
    ds_read_b128 v[184:187], v37 offset:256
    v_mfma_f32_16x16x32_bf16 v[244:247], v[124:127], v[212:215], v[244:247]
    ds_read_b64 v[120:121], v36 offset:3840
    v_mfma_f32_16x16x32_bf16 v[244:247], v[148:151], v[188:191], v[244:247]
    ds_read_b64 v[122:123], v36 offset:3848
    v_mfma_f32_16x16x32_bf16 v[248:251], v[128:131], v[212:215], v[248:251]
    v_mfma_f32_16x16x32_bf16 v[248:251], v[148:151], v[192:195], v[248:251]
    v_mfma_f32_16x16x32_bf16 v[248:251], v[124:127], v[216:219], v[248:251]
    v_mfma_f32_16x16x32_bf16 v[248:251], v[152:155], v[188:191], v[248:251]
    s_waitcnt lgkmcnt(15)
    v_mfma_f32_16x16x32_bf16 v[220:223], v[92:95], v[156:159], v[220:223]
    v_mfma_f32_16x16x32_bf16 v[224:227], v[92:95], v[160:163], v[224:227]
    v_mfma_f32_16x16x32_bf16 v[224:227], v[96:99], v[156:159], v[224:227]
    v_mfma_f32_16x16x32_bf16 v[228:231], v[96:99], v[160:163], v[228:231]
    v_mfma_f32_16x16x32_bf16 v[228:231], v[92:95], v[164:167], v[228:231]
    v_mfma_f32_16x16x32_bf16 v[228:231], v[100:103], v[156:159], v[228:231]
    v_mfma_f32_16x16x32_bf16 v[232:235], v[96:99], v[164:167], v[232:235]
    v_mfma_f32_16x16x32_bf16 v[232:235], v[100:103], v[160:163], v[232:235]
    v_mfma_f32_16x16x32_bf16 v[236:239], v[100:103], v[164:167], v[236:239]
    ds_read_b128 v[188:191], v37 offset:3904
    s_waitcnt lgkmcnt(15)
    v_mfma_f32_16x16x32_bf16 v[232:235], v[92:95], v[168:171], v[232:235]
    ds_read_b64 v[124:125], v36 offset:320
    s_waitcnt lgkmcnt(14)
    v_mfma_f32_16x16x32_bf16 v[232:235], v[104:107], v[156:159], v[232:235]
    ds_read_b64 v[126:127], v36 offset:328
    v_mfma_f32_16x16x32_bf16 v[236:239], v[96:99], v[168:171], v[236:239]
    ds_read_b128 v[192:195], v37 offset:3392
    v_mfma_f32_16x16x32_bf16 v[236:239], v[104:107], v[160:163], v[236:239]
    ds_read_b64 v[128:129], v36 offset:832
    v_mfma_f32_16x16x32_bf16 v[240:243], v[100:103], v[168:171], v[240:243]
    ds_read_b64 v[130:131], v36 offset:840
    v_mfma_f32_16x16x32_bf16 v[240:243], v[104:107], v[164:167], v[240:243]
    ds_read_b128 v[196:199], v37 offset:2880
    v_mfma_f32_16x16x32_bf16 v[244:247], v[104:107], v[168:171], v[244:247]
    ds_read_b64 v[132:133], v36 offset:1344
    s_waitcnt lgkmcnt(15)
    v_mfma_f32_16x16x32_bf16 v[236:239], v[92:95], v[172:175], v[236:239]
    ds_read_b64 v[134:135], v36 offset:1352
    v_mfma_f32_16x16x32_bf16 v[236:239], v[108:111], v[156:159], v[236:239]
    ds_read_b128 v[200:203], v37 offset:2368
    v_mfma_f32_16x16x32_bf16 v[240:243], v[96:99], v[172:175], v[240:243]
    ds_read_b64 v[136:137], v36 offset:1856
    v_mfma_f32_16x16x32_bf16 v[240:243], v[108:111], v[160:163], v[240:243]
    ds_read_b64 v[138:139], v36 offset:1864
    v_mfma_f32_16x16x32_bf16 v[244:247], v[100:103], v[172:175], v[244:247]
    ds_read_b128 v[204:207], v37 offset:1856
    v_mfma_f32_16x16x32_bf16 v[244:247], v[108:111], v[164:167], v[244:247]
    ds_read_b64 v[140:141], v36 offset:2368
    v_mfma_f32_16x16x32_bf16 v[248:251], v[104:107], v[172:175], v[248:251]
    ds_read_b64 v[142:143], v36 offset:2376
    v_mfma_f32_16x16x32_bf16 v[248:251], v[108:111], v[168:171], v[248:251]
    ds_read_b128 v[208:211], v37 offset:1344
    v_mfma_f32_16x16x32_bf16 v[240:243], v[92:95], v[176:179], v[240:243]
    ds_read_b64 v[144:145], v36 offset:2880
    s_waitcnt lgkmcnt(15)
    v_mfma_f32_16x16x32_bf16 v[240:243], v[112:115], v[156:159], v[240:243]
    ds_read_b64 v[146:147], v36 offset:2888
    v_mfma_f32_16x16x32_bf16 v[244:247], v[96:99], v[176:179], v[244:247]
    ds_read_b128 v[212:215], v37 offset:832
    v_mfma_f32_16x16x32_bf16 v[244:247], v[112:115], v[160:163], v[244:247]
    ds_read_b64 v[148:149], v36 offset:3392
    v_mfma_f32_16x16x32_bf16 v[248:251], v[100:103], v[176:179], v[248:251]
    ds_read_b64 v[150:151], v36 offset:3400
    v_mfma_f32_16x16x32_bf16 v[248:251], v[112:115], v[164:167], v[248:251]
    ds_read_b128 v[216:219], v37 offset:320
    v_mfma_f32_16x16x32_bf16 v[244:247], v[92:95], v[180:183], v[244:247]
    ds_read_b64 v[152:153], v36 offset:3904
    v_mfma_f32_16x16x32_bf16 v[244:247], v[116:119], v[156:159], v[244:247]
    ds_read_b64 v[154:155], v36 offset:3912
    v_mfma_f32_16x16x32_bf16 v[248:251], v[96:99], v[180:183], v[248:251]
    v_mfma_f32_16x16x32_bf16 v[248:251], v[116:119], v[160:163], v[248:251]
    v_mfma_f32_16x16x32_bf16 v[248:251], v[92:95], v[184:187], v[248:251]
    v_mfma_f32_16x16x32_bf16 v[248:251], v[120:123], v[156:159], v[248:251]
    s_waitcnt lgkmcnt(15)
    v_mfma_f32_16x16x32_bf16 v[220:223], v[124:127], v[188:191], v[220:223]
    v_mfma_f32_16x16x32_bf16 v[224:227], v[124:127], v[192:195], v[224:227]
    v_mfma_f32_16x16x32_bf16 v[224:227], v[128:131], v[188:191], v[224:227]
    v_mfma_f32_16x16x32_bf16 v[228:231], v[128:131], v[192:195], v[228:231]
    v_mfma_f32_16x16x32_bf16 v[228:231], v[124:127], v[196:199], v[228:231]
    v_mfma_f32_16x16x32_bf16 v[228:231], v[132:135], v[188:191], v[228:231]
    v_mfma_f32_16x16x32_bf16 v[232:235], v[128:131], v[196:199], v[232:235]
    v_mfma_f32_16x16x32_bf16 v[232:235], v[132:135], v[192:195], v[232:235]
    v_mfma_f32_16x16x32_bf16 v[236:239], v[132:135], v[196:199], v[236:239]
    ds_read_b128 v[156:159], v37 offset:3968
    s_waitcnt lgkmcnt(15)
    v_mfma_f32_16x16x32_bf16 v[232:235], v[124:127], v[200:203], v[232:235]
    ds_read_b64 v[92:93], v36 offset:384
    s_waitcnt lgkmcnt(14)
    v_mfma_f32_16x16x32_bf16 v[232:235], v[136:139], v[188:191], v[232:235]
    ds_read_b64 v[94:95], v36 offset:392
    v_mfma_f32_16x16x32_bf16 v[236:239], v[128:131], v[200:203], v[236:239]
    ds_read_b128 v[160:163], v37 offset:3456
    v_mfma_f32_16x16x32_bf16 v[236:239], v[136:139], v[192:195], v[236:239]
    ds_read_b64 v[96:97], v36 offset:896
    v_mfma_f32_16x16x32_bf16 v[240:243], v[132:135], v[200:203], v[240:243]
    ds_read_b64 v[98:99], v36 offset:904
    v_mfma_f32_16x16x32_bf16 v[240:243], v[136:139], v[196:199], v[240:243]
    ds_read_b128 v[164:167], v37 offset:2944
    v_mfma_f32_16x16x32_bf16 v[244:247], v[136:139], v[200:203], v[244:247]
    ds_read_b64 v[100:101], v36 offset:1408
    s_waitcnt lgkmcnt(15)
    v_mfma_f32_16x16x32_bf16 v[236:239], v[124:127], v[204:207], v[236:239]
    ds_read_b64 v[102:103], v36 offset:1416
    v_mfma_f32_16x16x32_bf16 v[236:239], v[140:143], v[188:191], v[236:239]
    ds_read_b128 v[168:171], v37 offset:2432
    s_mul_i32 s64, s54, 19456
    v_mfma_f32_16x16x32_bf16 v[240:243], v[128:131], v[204:207], v[240:243]
    ds_read_b64 v[104:105], v36 offset:1920
    s_lshr_b32 s65, s89, 1
    v_mfma_f32_16x16x32_bf16 v[240:243], v[140:143], v[192:195], v[240:243]
    ds_read_b64 v[106:107], v36 offset:1928
    s_add_u32 s64, s64, s65
    v_mfma_f32_16x16x32_bf16 v[244:247], v[132:135], v[204:207], v[244:247]
    ds_read_b128 v[172:175], v37 offset:1920
    s_add_u32 s64, s64, 14336
    v_mfma_f32_16x16x32_bf16 v[244:247], v[140:143], v[196:199], v[244:247]
    ds_read_b64 v[108:109], v36 offset:2432
    v_mul_u32_u24 v30, 160, v2
    v_mfma_f32_16x16x32_bf16 v[248:251], v[136:139], v[204:207], v[248:251]
    ds_read_b64 v[110:111], v36 offset:2440
    v_lshl_add_u32 v30, v3, 3, v30
    v_mfma_f32_16x16x32_bf16 v[248:251], v[140:143], v[200:203], v[248:251]
    ds_read_b128 v[176:179], v37 offset:1408
    v_add_u32 v30, s64, v30
    v_mfma_f32_16x16x32_bf16 v[240:243], v[124:127], v[208:211], v[240:243]
    ds_read_b64 v[112:113], v36 offset:2944
    s_waitcnt vmcnt(0)
    s_waitcnt lgkmcnt(15)
    v_mfma_f32_16x16x32_bf16 v[240:243], v[144:147], v[188:191], v[240:243]
    ds_read_b64 v[114:115], v36 offset:2952
    ds_read_b32 v6, v30 offset:0
    v_mfma_f32_16x16x32_bf16 v[244:247], v[128:131], v[208:211], v[244:247]
    ds_read_b128 v[180:183], v37 offset:896
    ds_read_b32 v7, v30 offset:32
    v_mfma_f32_16x16x32_bf16 v[244:247], v[144:147], v[192:195], v[244:247]
    ds_read_b64 v[116:117], v36 offset:3456
    ds_read_b32 v8, v30 offset:64
    v_mfma_f32_16x16x32_bf16 v[248:251], v[132:135], v[208:211], v[248:251]
    ds_read_b64 v[118:119], v36 offset:3464
    ds_read_b32 v9, v30 offset:96
    v_mfma_f32_16x16x32_bf16 v[248:251], v[144:147], v[196:199], v[248:251]
    ds_read_b128 v[184:187], v37 offset:384
    ds_read_b32 v10, v30 offset:128
    v_mfma_f32_16x16x32_bf16 v[244:247], v[124:127], v[212:215], v[244:247]
    ds_read_b64 v[120:121], v36 offset:3968
    ds_read_b32 v12, v30 offset:2560
    v_mfma_f32_16x16x32_bf16 v[244:247], v[148:151], v[188:191], v[244:247]
    ds_read_b64 v[122:123], v36 offset:3976
    ds_read_b32 v13, v30 offset:2592
    v_mfma_f32_16x16x32_bf16 v[248:251], v[128:131], v[212:215], v[248:251]
    ds_read_b32 v14, v30 offset:2624
    ds_read_b32 v15, v30 offset:2656
    v_mfma_f32_16x16x32_bf16 v[248:251], v[148:151], v[192:195], v[248:251]
    ds_read_b32 v16, v30 offset:2688
    v_mfma_f32_16x16x32_bf16 v[248:251], v[124:127], v[216:219], v[248:251]
    v_mfma_f32_16x16x32_bf16 v[248:251], v[152:155], v[188:191], v[248:251]
    s_waitcnt lgkmcnt(15)
    v_mfma_f32_16x16x32_bf16 v[220:223], v[92:95], v[156:159], v[220:223]
    v_mfma_f32_16x16x32_bf16 v[224:227], v[92:95], v[160:163], v[224:227]
    v_mfma_f32_16x16x32_bf16 v[224:227], v[96:99], v[156:159], v[224:227]
    v_mfma_f32_16x16x32_bf16 v[228:231], v[96:99], v[160:163], v[228:231]
    v_mfma_f32_16x16x32_bf16 v[228:231], v[92:95], v[164:167], v[228:231]
    v_lshlrev_b32 v38, 16, v6
    v_and_b32 v39, 0xffff0000, v6
    v_mfma_f32_16x16x32_bf16 v[228:231], v[100:103], v[156:159], v[228:231]
    s_waitcnt lgkmcnt(13)
    v_lshlrev_b32 v40, 16, v7
    v_and_b32 v41, 0xffff0000, v7
    v_mfma_f32_16x16x32_bf16 v[232:235], v[96:99], v[164:167], v[232:235]
    s_waitcnt lgkmcnt(11)
    v_lshlrev_b32 v42, 16, v8
    v_and_b32 v43, 0xffff0000, v8
    v_mfma_f32_16x16x32_bf16 v[232:235], v[100:103], v[160:163], v[232:235]
    s_waitcnt lgkmcnt(9)
    v_lshlrev_b32 v44, 16, v9
    v_and_b32 v45, 0xffff0000, v9
    v_mfma_f32_16x16x32_bf16 v[236:239], v[100:103], v[164:167], v[236:239]
    ds_read_b128 v[188:191], v37 offset:4032
    s_waitcnt lgkmcnt(8)
    v_lshlrev_b32 v46, 16, v10
    v_mfma_f32_16x16x32_bf16 v[232:235], v[92:95], v[168:171], v[232:235]
    ds_read_b64 v[124:125], v36 offset:448
    v_and_b32 v47, 0xffff0000, v10
    v_mfma_f32_16x16x32_bf16 v[232:235], v[104:107], v[156:159], v[232:235]
    ds_read_b64 v[126:127], v36 offset:456
    s_add_u32 s64, s86, 0
    v_mfma_f32_16x16x32_bf16 v[236:239], v[96:99], v[168:171], v[236:239]
    ds_read_b128 v[192:195], v37 offset:3520
    v_add_f32 v58, v38, v39
    v_mfma_f32_16x16x32_bf16 v[236:239], v[104:107], v[160:163], v[236:239]
    ds_read_b64 v[128:129], v36 offset:960
    v_mul_f32 v59, v38, v38
    v_mfma_f32_16x16x32_bf16 v[240:243], v[100:103], v[168:171], v[240:243]
    ds_read_b64 v[130:131], v36 offset:968
    v_mul_f32 v61, v39, v39
    v_mfma_f32_16x16x32_bf16 v[240:243], v[104:107], v[164:167], v[240:243]
    ds_read_b128 v[196:199], v37 offset:3008
    v_add_f32 v60, v40, v41
    v_mfma_f32_16x16x32_bf16 v[244:247], v[104:107], v[168:171], v[244:247]
    ds_read_b64 v[132:133], v36 offset:1472
    v_fmac_f32 v59, v40, v40
    v_mfma_f32_16x16x32_bf16 v[236:239], v[92:95], v[172:175], v[236:239]
    ds_read_b64 v[134:135], v36 offset:1480
    v_fmac_f32 v61, v41, v41
    v_mfma_f32_16x16x32_bf16 v[236:239], v[108:111], v[156:159], v[236:239]
    ds_read_b128 v[200:203], v37 offset:2496
    v_fmac_f32 v59, v42, v42
    v_mfma_f32_16x16x32_bf16 v[240:243], v[96:99], v[172:175], v[240:243]
    ds_read_b64 v[136:137], v36 offset:1984
    v_fmac_f32 v61, v43, v43
    v_mfma_f32_16x16x32_bf16 v[240:243], v[108:111], v[160:163], v[240:243]
    ds_read_b64 v[138:139], v36 offset:1992
    v_add_f32 v58, v58, v42
    v_mfma_f32_16x16x32_bf16 v[244:247], v[100:103], v[172:175], v[244:247]
    ds_read_b128 v[204:207], v37 offset:1984
    v_add_f32 v60, v60, v43
    v_mfma_f32_16x16x32_bf16 v[244:247], v[108:111], v[164:167], v[244:247]
    ds_read_b64 v[140:141], v36 offset:2496
    v_fmac_f32 v59, v44, v44
    v_mfma_f32_16x16x32_bf16 v[248:251], v[104:107], v[172:175], v[248:251]
    ds_read_b64 v[142:143], v36 offset:2504
    v_fmac_f32 v61, v45, v45
    v_mfma_f32_16x16x32_bf16 v[248:251], v[108:111], v[168:171], v[248:251]
    ds_read_b128 v[208:211], v37 offset:1472
    v_add_f32 v58, v58, v44
    v_mfma_f32_16x16x32_bf16 v[240:243], v[92:95], v[176:179], v[240:243]
    ds_read_b64 v[144:145], v36 offset:3008
    v_add_f32 v60, v60, v45
    v_mfma_f32_16x16x32_bf16 v[240:243], v[112:115], v[156:159], v[240:243]
    ds_read_b64 v[146:147], v36 offset:3016
    v_fmac_f32 v59, v46, v46
    v_mfma_f32_16x16x32_bf16 v[244:247], v[96:99], v[176:179], v[244:247]
    ds_read_b128 v[212:215], v37 offset:960
    v_fmac_f32 v61, v47, v47
    v_mfma_f32_16x16x32_bf16 v[244:247], v[112:115], v[160:163], v[244:247]
    ds_read_b64 v[148:149], v36 offset:3520
    v_add_f32 v58, v58, v46
    v_mfma_f32_16x16x32_bf16 v[248:251], v[100:103], v[176:179], v[248:251]
    ds_read_b64 v[150:151], v36 offset:3528
    v_add_f32 v60, v60, v47
    v_mfma_f32_16x16x32_bf16 v[248:251], v[112:115], v[164:167], v[248:251]
    ds_read_b128 v[216:219], v37 offset:448
    v_add_f32 v58, v58, v60
    v_mfma_f32_16x16x32_bf16 v[244:247], v[92:95], v[180:183], v[244:247]
    ds_read_b64 v[152:153], v36 offset:4032
    v_add_f32 v59, v59, v61
    v_mfma_f32_16x16x32_bf16 v[244:247], v[116:119], v[156:159], v[244:247]
    ds_read_b64 v[154:155], v36 offset:4040
    v_lshlrev_b32 v61, 4, v2
    v_mfma_f32_16x16x32_bf16 v[248:251], v[96:99], v[180:183], v[248:251]
    v_mov_b32 v60, s59
    v_permlane16_swap_b32 v58, v59
    v_mfma_f32_16x16x32_bf16 v[248:251], v[116:119], v[160:163], v[248:251]
    v_add_f32 v58, v58, v59
    v_mov_b32 v59, v58
    v_mfma_f32_16x16x32_bf16 v[248:251], v[92:95], v[184:187], v[248:251]
    s_nop 0
    v_permlane32_swap_b32 v58, v59
    v_add_f32 v58, v58, v59
    s_waitcnt lgkmcnt(15)
    v_mfma_f32_16x16x32_bf16 v[248:251], v[120:123], v[156:159], v[248:251]
    v_mov_b32 v59, v58
    s_nop 1
    v_permlane16_swap_b32 v58, v59
    v_mfma_f32_16x16x32_bf16 v[220:223], v[124:127], v[188:191], v[220:223]
    buffer_store_dwordx3 v[58:60], v61, s[32:35], s64 offen offset:0 sc1
    v_lshlrev_b32 v48, 16, v12
    v_mfma_f32_16x16x32_bf16 v[224:227], v[124:127], v[192:195], v[224:227]
    v_and_b32 v49, 0xffff0000, v12
    v_lshlrev_b32 v50, 16, v13
    v_mfma_f32_16x16x32_bf16 v[224:227], v[128:131], v[188:191], v[224:227]
    v_and_b32 v51, 0xffff0000, v13
    v_lshlrev_b32 v52, 16, v14
    v_mfma_f32_16x16x32_bf16 v[228:231], v[128:131], v[192:195], v[228:231]
    v_and_b32 v53, 0xffff0000, v14
    v_lshlrev_b32 v54, 16, v15
    v_mfma_f32_16x16x32_bf16 v[228:231], v[124:127], v[196:199], v[228:231]
    v_and_b32 v55, 0xffff0000, v15
    v_lshlrev_b32 v56, 16, v16
    v_mfma_f32_16x16x32_bf16 v[228:231], v[132:135], v[188:191], v[228:231]
    v_and_b32 v57, 0xffff0000, v16
    s_add_u32 s64, s86, 8192
    v_add_f32 v58, v48, v49
    v_mul_f32 v59, v48, v48
    v_mul_f32 v61, v49, v49
    v_add_f32 v60, v50, v51
    v_fmac_f32 v59, v50, v50
    v_fmac_f32 v61, v51, v51
    v_fmac_f32 v59, v52, v52
    v_fmac_f32 v61, v53, v53
    v_add_f32 v58, v58, v52
    v_add_f32 v60, v60, v53
    v_fmac_f32 v59, v54, v54
    v_fmac_f32 v61, v55, v55
    v_add_f32 v58, v58, v54
    v_add_f32 v60, v60, v55
    v_fmac_f32 v59, v56, v56
    v_fmac_f32 v61, v57, v57
    v_add_f32 v58, v58, v56
    v_add_f32 v60, v60, v57
    v_add_f32 v58, v58, v60
    v_add_f32 v59, v59, v61
    v_lshlrev_b32 v61, 4, v2
    v_mov_b32 v60, s59
    v_permlane16_swap_b32 v58, v59
    v_add_f32 v58, v58, v59
    v_mov_b32 v59, v58
    s_nop 1
    v_permlane32_swap_b32 v58, v59
    v_add_f32 v58, v58, v59
    v_mov_b32 v59, v58
    s_nop 1
    v_permlane16_swap_b32 v58, v59
    buffer_store_dwordx3 v[58:60], v61, s[32:35], s64 offen offset:0 sc1
    buffer_load_dword v34, v91, s[32:35], 0 offen sc1
    v_mfma_f32_16x16x32_bf16 v[232:235], v[128:131], v[196:199], v[232:235]
    s_mul_i32 s67, s54, 21312
    s_add_u32 s67, s67, 78592
    v_mfma_f32_16x16x32_bf16 v[232:235], v[132:135], v[192:195], v[232:235]
    v_lshlrev_b32 v108, 5, v2
    v_lshl_add_u32 v108, v3, 3, v108
    v_mfma_f32_16x16x32_bf16 v[236:239], v[132:135], v[196:199], v[236:239]
    v_add_u32 v108, s67, v108
    v_bfe_u32 v109, v0, 2, 2
    s_waitcnt lgkmcnt(14)
    v_mfma_f32_16x16x32_bf16 v[232:235], v[124:127], v[200:203], v[232:235]
    v_mul_u32_u24 v109, 21312, v109
    v_and_b32 v110, 3, v0
    s_waitcnt lgkmcnt(12)
    v_mfma_f32_16x16x32_bf16 v[232:235], v[136:139], v[188:191], v[232:235]
    v_lshl_add_u32 v109, v110, 3, v109
    v_lshl_add_u32 v109, v3, 5, v109
    v_mfma_f32_16x16x32_bf16 v[236:239], v[128:131], v[200:203], v[236:239]
    s_lshl_b32 s64, s54, 10
    s_add_u32 s64, s64, 78592
    v_mfma_f32_16x16x32_bf16 v[236:239], v[136:139], v[192:195], v[236:239]
    v_add_u32 v109, s64, v109
    v_mul_u32_u24 v110, 20480, v3
    v_mfma_f32_16x16x32_bf16 v[240:243], v[132:135], v[200:203], v[240:243]
    v_lshl_add_u32 v110, v2, 3, v110
    s_mul_i32 s68, s54, 655360
    v_mfma_f32_16x16x32_bf16 v[240:243], v[136:139], v[196:199], v[240:243]
    s_lshl_b32 s65, s3, 7
    s_add_u32 s68, s68, s65
    v_mfma_f32_16x16x32_bf16 v[244:247], v[136:139], v[200:203], v[244:247]
    s_add_u32 s68, s68, 6291456
    s_lshl_b32 s64, s3, 9
    s_waitcnt lgkmcnt(11)
    v_mfma_f32_16x16x32_bf16 v[236:239], v[124:127], v[204:207], v[236:239]
    s_lshl_b32 s65, s54, 7
    s_add_u32 s64, s64, s65
    s_waitcnt lgkmcnt(9)
    v_mfma_f32_16x16x32_bf16 v[236:239], v[140:143], v[188:191], v[236:239]
    s_add_u32 s64, s64, 262144
    v_mov_b32 v111, s64
    v_mfma_f32_16x16x32_bf16 v[240:243], v[128:131], v[204:207], v[240:243]
    s_lshl_b32 s64, s52, 5
    s_add_u32 s64, s64, s53
    v_mfma_f32_16x16x32_bf16 v[240:243], v[140:143], v[192:195], v[240:243]
    s_lshl_b32 s64, s64, 4
    s_lshr_b32 s65, s65, 5
    v_mfma_f32_16x16x32_bf16 v[244:247], v[132:135], v[204:207], v[244:247]
    s_add_u32 s64, s64, s65
    s_add_u32 s64, s64, 65536
    v_mfma_f32_16x16x32_bf16 v[244:247], v[140:143], v[196:199], v[244:247]
    v_mov_b32 v112, s64
    v_mov_b32 v113, s59
    v_mfma_f32_16x16x32_bf16 v[248:251], v[136:139], v[204:207], v[248:251]
    v_mfma_f32_16x16x32_bf16 v[248:251], v[140:143], v[200:203], v[248:251]
    s_waitcnt lgkmcnt(8)
    v_mfma_f32_16x16x32_bf16 v[240:243], v[124:127], v[208:211], v[240:243]
    s_waitcnt lgkmcnt(6)
    v_mfma_f32_16x16x32_bf16 v[240:243], v[144:147], v[188:191], v[240:243]
    v_mfma_f32_16x16x32_bf16 v[244:247], v[128:131], v[208:211], v[244:247]
    v_mfma_f32_16x16x32_bf16 v[244:247], v[144:147], v[192:195], v[244:247]
    v_mfma_f32_16x16x32_bf16 v[248:251], v[132:135], v[208:211], v[248:251]
    v_mfma_f32_16x16x32_bf16 v[248:251], v[144:147], v[196:199], v[248:251]
    s_waitcnt lgkmcnt(5)
    v_mfma_f32_16x16x32_bf16 v[244:247], v[124:127], v[212:215], v[244:247]
    s_waitcnt lgkmcnt(3)
    v_mfma_f32_16x16x32_bf16 v[244:247], v[148:151], v[188:191], v[244:247]
    v_mfma_f32_16x16x32_bf16 v[248:251], v[128:131], v[212:215], v[248:251]
    v_mfma_f32_16x16x32_bf16 v[248:251], v[148:151], v[192:195], v[248:251]
    s_waitcnt lgkmcnt(2)
    v_mfma_f32_16x16x32_bf16 v[248:251], v[124:127], v[216:219], v[248:251]
    s_waitcnt lgkmcnt(0)
    v_mfma_f32_16x16x32_bf16 v[248:251], v[152:155], v[188:191], v[248:251]
    v_cvt_pk_bf16_f32 v92, v220, v221
    v_cvt_pk_bf16_f32 v93, v222, v223
    ds_write_b64 v108, v[92:93] offset:0
    v_cvt_pk_bf16_f32 v94, v224, v225
    v_cvt_pk_bf16_f32 v95, v226, v227
    ds_write_b64 v108, v[94:95] offset:512
    v_cvt_pk_bf16_f32 v96, v228, v229
    v_cvt_pk_bf16_f32 v97, v230, v231
    ds_write_b64 v108, v[96:97] offset:1024
    v_cvt_pk_bf16_f32 v98, v232, v233
    v_cvt_pk_bf16_f32 v99, v234, v235
    ds_write_b64 v108, v[98:99] offset:1536
    v_cvt_pk_bf16_f32 v100, v236, v237
    v_cvt_pk_bf16_f32 v101, v238, v239
    ds_write_b64 v108, v[100:101] offset:2048
    v_cvt_pk_bf16_f32 v102, v240, v241
    v_cvt_pk_bf16_f32 v103, v242, v243
    ds_write_b64 v108, v[102:103] offset:2560
    v_cvt_pk_bf16_f32 v104, v244, v245
    v_cvt_pk_bf16_f32 v105, v246, v247
    ds_write_b64 v108, v[104:105] offset:3072
    v_cvt_pk_bf16_f32 v106, v248, v249
    v_cvt_pk_bf16_f32 v107, v250, v251
    ds_write_b64 v108, v[106:107] offset:3584
    s_waitcnt lgkmcnt(0)
    s_barrier
    ds_read_b64_tr_b16 v[156:157], v109 offset:0
    ds_read_b64_tr_b16 v[158:159], v109 offset:128
    ds_read_b64_tr_b16 v[160:161], v109 offset:256
    ds_read_b64_tr_b16 v[162:163], v109 offset:384
    ds_read_b64_tr_b16 v[164:165], v109 offset:512
    ds_read_b64_tr_b16 v[166:167], v109 offset:640
    ds_read_b64_tr_b16 v[168:169], v109 offset:768
    ds_read_b64_tr_b16 v[170:171], v109 offset:896
    s_waitcnt lgkmcnt(7)
    buffer_store_dwordx2 v[156:157], v110, s[32:35], s68 offen sc1
    s_add_u32 s68, s68, 81920
    s_waitcnt lgkmcnt(6)
    buffer_store_dwordx2 v[158:159], v110, s[32:35], s68 offen sc1
    s_add_u32 s68, s68, 81920
    s_waitcnt lgkmcnt(5)
    buffer_store_dwordx2 v[160:161], v110, s[32:35], s68 offen sc1
    s_add_u32 s68, s68, 81920
    s_waitcnt lgkmcnt(4)
    buffer_store_dwordx2 v[162:163], v110, s[32:35], s68 offen sc1
    s_add_u32 s68, s68, 81920
    s_waitcnt lgkmcnt(3)
    buffer_store_dwordx2 v[164:165], v110, s[32:35], s68 offen sc1
    s_add_u32 s68, s68, 81920
    s_waitcnt lgkmcnt(2)
    buffer_store_dwordx2 v[166:167], v110, s[32:35], s68 offen sc1
    s_add_u32 s68, s68, 81920
    s_waitcnt lgkmcnt(1)
    buffer_store_dwordx2 v[168:169], v110, s[32:35], s68 offen sc1
    s_add_u32 s68, s68, 81920
    s_waitcnt lgkmcnt(0)
    buffer_store_dwordx2 v[170:171], v110, s[32:35], s68 offen sc1
    buffer_store_dword v113, v112, s[32:35], 0 offen sc1
    s_mov_b32 s67, s87
    s_add_u32 s68, s87, 8192
    buffer_load_dwordx3 v[58:60], v1, s[32:35], s67 offen offset:0 sc1
    buffer_load_dwordx3 v[62:64], v1, s[32:35], s67 offen offset:1024 sc1
    buffer_load_dwordx3 v[66:68], v1, s[32:35], s67 offen offset:2048 sc1
    buffer_load_dwordx3 v[70:72], v1, s[32:35], s67 offen offset:3072 sc1
    buffer_load_dwordx3 v[74:76], v1, s[32:35], s68 offen offset:0 sc1
    buffer_load_dwordx3 v[78:80], v1, s[32:35], s68 offen offset:1024 sc1
    buffer_load_dwordx3 v[82:84], v1, s[32:35], s68 offen offset:2048 sc1
    buffer_load_dwordx3 v[86:88], v1, s[32:35], s68 offen offset:3072 sc1
    ds_read_b64_tr_b16 v[192:193], v26 offset:0
    ds_read_b64_tr_b16 v[194:195], v26 offset:2560
    ds_read_b64_tr_b16 v[196:197], v26 offset:32
    ds_read_b64_tr_b16 v[198:199], v26 offset:2592
    ds_read_b64_tr_b16 v[200:201], v26 offset:64
    ds_read_b64_tr_b16 v[202:203], v26 offset:2624
    ds_read_b64_tr_b16 v[204:205], v26 offset:96
    ds_read_b64_tr_b16 v[206:207], v26 offset:2656
    ds_read_b64_tr_b16 v[208:209], v26 offset:128
    ds_read_b64_tr_b16 v[210:211], v26 offset:2688
    s_waitcnt vmcnt(9)
    buffer_store_dword v113, v111, s[32:35], 0 offen sc1
    s_waitcnt lgkmcnt(8)
    buffer_store_dwordx4 v[192:195], v1, s[32:35], s98 offen offset:0 sc1
    s_waitcnt lgkmcnt(6)
    buffer_store_dwordx4 v[196:199], v1, s[32:35], s98 offen offset:1024 sc1
    s_waitcnt lgkmcnt(4)
    buffer_store_dwordx4 v[200:203], v1, s[32:35], s98 offen offset:2048 sc1
    s_waitcnt lgkmcnt(2)
    buffer_store_dwordx4 v[204:207], v1, s[32:35], s98 offen offset:3072 sc1
    s_add_u32 s98, s98, 4096
    s_waitcnt lgkmcnt(0)
    buffer_store_dwordx4 v[208:211], v1, s[32:35], s98 offen offset:0 sc1
    v_cmp_ne_u32 vcc, s59, v34
    s_cbranch_vccnz SPIN_150
BACK_151:
    s_mul_i32 s69, s54, 19456
    s_add_u32 m0, s69, 0
    s_add_u32 s66, s92, m0
    buffer_load_dwordx4 v1, s[32:35], s66 offen sc1 lds
    s_add_u32 m0, s69, 1024
    s_add_u32 s66, s92, m0
    buffer_load_dwordx4 v1, s[32:35], s66 offen sc1 lds
    s_add_u32 m0, s69, 2048
    s_add_u32 s66, s92, m0
    buffer_load_dwordx4 v1, s[32:35], s66 offen sc1 lds
    s_add_u32 m0, s69, 3072
    s_add_u32 s66, s92, m0
    buffer_load_dwordx4 v1, s[32:35], s66 offen sc1 lds
    s_add_u32 m0, s69, 4096
    s_add_u32 s66, s92, m0
    buffer_load_dwordx4 v1, s[32:35], s66 offen sc1 lds
    s_add_u32 m0, s69, 5120
    s_add_u32 s66, s92, m0
    buffer_load_dwordx4 v1, s[32:35], s66 offen sc1 lds
    s_add_u32 m0, s69, 6144
    s_add_u32 s66, s92, m0
    buffer_load_dwordx4 v1, s[32:35], s66 offen sc1 lds
    s_add_u32 m0, s69, 7168
    s_add_u32 s66, s92, m0
    buffer_load_dwordx4 v1, s[32:35], s66 offen sc1 lds
    s_add_u32 m0, s69, 8192
    s_add_u32 s66, s92, m0
    buffer_load_dwordx4 v1, s[32:35], s66 offen sc1 lds
    s_add_u32 m0, s69, 9216
    s_add_u32 s66, s92, m0
    buffer_load_dwordx4 v1, s[32:35], s66 offen sc1 lds
    s_add_u32 m0, s69, 10240
    s_add_u32 s66, s92, m0
    buffer_load_dwordx4 v1, s[32:35], s66 offen sc1 lds
    s_add_u32 m0, s69, 11264
    s_add_u32 s66, s92, m0
    buffer_load_dwordx4 v1, s[32:35], s66 offen sc1 lds
    s_waitcnt vmcnt(24)
    v_xor_b32 v60, v60, v64
    s_waitcnt vmcnt(22)
    v_xor_b32 v68, v68, v72
    v_xor_b32 v64, v64, v72
    v_xor_b32 v72, s59, v72
    v_or3_b32 v60, v60, v64, v68
    v_or_b32 v60, v60, v72
    v_cmp_ne_u32 vcc, 0, v60
    s_cbranch_vccnz SPIN_152
BACK_153:
    v_add_f32 v58, v58, v62
    v_add_f32 v59, v59, v63
    v_add_f32 v66, v66, v70
    v_add_f32 v67, v67, v71
    v_add_f32 v58, v58, v66
    v_add_f32 v59, v59, v67
    s_nop 1
    v_permlane16_swap_b32 v58, v59
    v_add_f32 v58, v58, v59
    v_mov_b32 v59, v58
    s_nop 1
    v_permlane32_swap_b32 v58, v59
    v_add_f32 v58, v58, v59
    v_mul_f32 v30, 0x3acccccd, v58
    v_mul_f32 v31, 0x3acccccd, v58
    s_nop 1
    v_permlane16_swap_b32 v30, v31
    v_fma_f32 v31, -v30, v30, v31
    v_max_f32 v31, 0, v31
    v_cvt_pk_bf16_f32 v31, v31, v30
    v_and_b32 v30, 0xffff0000, v31
    v_lshlrev_b32 v31, 16, v31
    v_add_f32 v31, 0x3727c5ac, v31
    v_cvt_pk_bf16_f32 v31, v31, v31
    v_lshlrev_b32 v31, 16, v31
    v_sqrt_f32 v31, v31
    s_nop 0
    v_cvt_pk_bf16_f32 v31, v31, v31
    v_lshlrev_b32 v31, 16, v31
    v_rcp_f32 v31, v31
    s_nop 0
    v_mul_f32 v32, -v30, v31
    v_fma_f32 v58, v38, v31, v32
    v_fma_f32 v59, v39, v31, v32
    v_fma_f32 v60, v40, v31, v32
    v_fma_f32 v61, v41, v31, v32
    v_fma_f32 v62, v42, v31, v32
    v_fma_f32 v63, v43, v31, v32
    v_fma_f32 v64, v44, v31, v32
    v_fma_f32 v65, v45, v31, v32
    v_fma_f32 v66, v46, v31, v32
    v_fma_f32 v67, v47, v31, v32
    s_waitcnt vmcnt(20)
    v_xor_b32 v76, v76, v80
    s_waitcnt vmcnt(18)
    v_xor_b32 v84, v84, v88
    v_xor_b32 v80, v80, v88
    v_xor_b32 v88, s59, v88
    v_or3_b32 v76, v76, v80, v84
    v_or_b32 v76, v76, v88
    v_cmp_ne_u32 vcc, 0, v76
    s_cbranch_vccnz SPIN_154
BACK_155:
    v_add_f32 v74, v74, v78
    v_add_f32 v75, v75, v79
    v_add_f32 v82, v82, v86
    v_add_f32 v83, v83, v87
    v_add_f32 v74, v74, v82
    v_add_f32 v75, v75, v83
    s_nop 1
    v_permlane16_swap_b32 v74, v75
    v_add_f32 v74, v74, v75
    v_mov_b32 v75, v74
    s_nop 1
    v_permlane32_swap_b32 v74, v75
    v_add_f32 v74, v74, v75
    v_mul_f32 v30, 0x3acccccd, v74
    v_mul_f32 v31, 0x3acccccd, v74
    s_nop 1
    v_permlane16_swap_b32 v30, v31
    v_fma_f32 v31, -v30, v30, v31
    v_max_f32 v31, 0, v31
    v_cvt_pk_bf16_f32 v31, v31, v30
    v_and_b32 v30, 0xffff0000, v31
    v_lshlrev_b32 v31, 16, v31
    v_add_f32 v31, 0x3727c5ac, v31
    v_cvt_pk_bf16_f32 v31, v31, v31
    v_lshlrev_b32 v31, 16, v31
    v_sqrt_f32 v31, v31
    s_nop 0
    v_cvt_pk_bf16_f32 v31, v31, v31
    v_lshlrev_b32 v31, 16, v31
    v_rcp_f32 v31, v31
    s_nop 0
    v_mul_f32 v32, -v30, v31
    v_fma_f32 v74, v48, v31, v32
    v_fma_f32 v75, v49, v31, v32
    v_fma_f32 v76, v50, v31, v32
    v_fma_f32 v77, v51, v31, v32
    v_fma_f32 v78, v52, v31, v32
    v_fma_f32 v79, v53, v31, v32
    v_fma_f32 v80, v54, v31, v32
    v_fma_f32 v81, v55, v31, v32
    v_fma_f32 v82, v56, v31, v32
    v_fma_f32 v83, v57, v31, v32
    s_branch S_W1DONE
S_W_PHASE:
    v_and_b32 v33, 31, v0
    s_mul_i32 s65, s54, 12
    v_add_u32 v90, s65, v33
    s_lshl_b32 s66, s54, 1
    s_add_u32 s66, s66, 36
    v_add_u32 v91, s66, v33
    v_cmp_gt_u32 vcc, 12, v33
    s_nop 1
    v_cndmask_b32 v90, v91, v90, vcc
    s_add_u32 s66, s66, 13
    s_min_u32 s66, s66, 53
    v_min_u32 v90, s66, v90
    s_mul_i32 s65, s56, 6912
    s_add_u32 s65, s65, 434176
    v_lshl_add_u32 v90, v90, 7, s65
    v_min_u32 v91, 19, v0
    s_mul_i32 s65, s58, 2560
    s_add_u32 s65, s65, 393216
    v_lshl_add_u32 v91, v91, 7, s65
    s_lshr_b32 s65, s89, 2
    v_xor_b32 v35, s65, v0
    v_lshlrev_b32 v35, 4, v35
    s_mul_i32 s92, s58, 143360
    s_add_u32 s92, s92, 31457280
    v_mul_u32_u24 v30, 205, v0
    v_lshrrev_b32 v30, 11, v30
    v_mul_u32_u24 v83, 1120, v30
    v_lshl_add_u32 v83, v0, 4, v83
    s_lshl_b32 s64, s55, 2
    s_and_b32 s65, s54, 1
    s_add_u32 s64, s64, s65
    s_mul_i32 s64, s64, 20480
    s_mul_i32 s65, s56, 160
    s_add_u32 s70, s64, s65
    s_mov_b32 s44, s4
    s_mov_b32 s45, s5
    s_mul_i32 s71, s54, 5120
    s_add_u32 m0, s71, 143360
    s_add_u32 s66, s70, 0
    s_mov_b32 exec_hi, 262143
    buffer_load_dwordx4 v83, s[44:47], s66 offen nt lds
    s_mov_b64 exec, -1
    s_add_u32 m0, s71, 144160
    s_add_u32 s66, s70, 6400
    s_mov_b32 exec_hi, 262143
    buffer_load_dwordx4 v83, s[44:47], s66 offen nt lds
    s_mov_b64 exec, -1
    s_add_u32 m0, s71, 144960
    s_add_u32 s66, s70, 12800
    s_mov_b32 exec_hi, 262143
    buffer_load_dwordx4 v83, s[44:47], s66 offen nt lds
    s_mov_b64 exec, -1
    s_add_u32 m0, s71, 145760
    s_add_u32 s66, s70, 19200
    s_mov_b32 exec_hi, 0
    s_mov_b32 exec_lo, 1023
    buffer_load_dwordx4 v83, s[44:47], s66 offen nt lds
    s_mov_b64 exec, -1
    s_add_u32 m0, s71, 145920
    s_add_u32 s66, s70, 40960
    s_mov_b32 exec_hi, 262143
    buffer_load_dwordx4 v83, s[44:47], s66 offen nt lds
    s_mov_b64 exec, -1
    s_add_u32 m0, s71, 146720
    s_add_u32 s66, s70, 47360
    s_mov_b32 exec_hi, 262143
    buffer_load_dwordx4 v83, s[44:47], s66 offen nt lds
    s_mov_b64 exec, -1
    s_add_u32 m0, s71, 147520
    s_add_u32 s66, s70, 53760
    s_mov_b32 exec_hi, 262143
    buffer_load_dwordx4 v83, s[44:47], s66 offen nt lds
    s_mov_b64 exec, -1
    s_add_u32 m0, s71, 148320
    s_add_u32 s66, s70, 60160
    s_mov_b32 exec_hi, 0
    s_mov_b32 exec_lo, 1023
    buffer_load_dwordx4 v83, s[44:47], s66 offen nt lds
    s_mov_b64 exec, -1
    s_cmp_lg_u32 s54, 0
    s_cbranch_scc1 S_NOWP
    s_mov_b32 s63, 0
    s_branch POLLB_158
POLL_157:
    s_sleep 6
    s_add_u32 s63, s63, 1
    s_cmp_gt_u32 s63, 400000
    s_cbranch_scc1 POLLX_159
POLLB_158:
    buffer_load_dword v34, v91, s[32:35], 0 offen sc1
    s_waitcnt vmcnt(0)
    v_cmp_ne_u32 vcc, s59, v34
    s_cbranch_vccnz POLL_157
POLLX_159:
S_NOWP:
    s_barrier
    s_mul_i32 s64, s54, 5120
    s_lshr_b32 s65, s89, 1
    s_add_u32 s64, s64, s65
    s_add_u32 s64, s64, 143360
    v_mul_u32_u24 v30, 160, v2
    v_lshl_add_u32 v30, v3, 3, v30
    v_add_u32 v30, s64, v30
    s_waitcnt vmcnt(0)
    ds_read_b32 v6, v30 offset:0
    ds_read_b32 v7, v30 offset:32
    ds_read_b32 v8, v30 offset:64
    ds_read_b32 v9, v30 offset:96
    ds_read_b32 v10, v30 offset:128
    ds_read_b32 v12, v30 offset:2560
    ds_read_b32 v13, v30 offset:2592
    ds_read_b32 v14, v30 offset:2624
    ds_read_b32 v15, v30 offset:2656
    ds_read_b32 v16, v30 offset:2688
    s_waitcnt lgkmcnt(9)
    v_lshlrev_b32 v38, 16, v6
    v_and_b32 v39, 0xffff0000, v6
    s_waitcnt lgkmcnt(8)
    v_lshlrev_b32 v40, 16, v7
    v_and_b32 v41, 0xffff0000, v7
    s_waitcnt lgkmcnt(7)
    v_lshlrev_b32 v42, 16, v8
    v_and_b32 v43, 0xffff0000, v8
    s_waitcnt lgkmcnt(6)
    v_lshlrev_b32 v44, 16, v9
    v_and_b32 v45, 0xffff0000, v9
    s_waitcnt lgkmcnt(5)
    v_lshlrev_b32 v46, 16, v10
    v_and_b32 v47, 0xffff0000, v10
    s_add_u32 s64, s86, 0
    v_add_f32 v58, v38, v39
    v_mul_f32 v59, v38, v38
    v_mul_f32 v61, v39, v39
    v_add_f32 v60, v40, v41
    v_fmac_f32 v59, v40, v40
    v_fmac_f32 v61, v41, v41
    v_fmac_f32 v59, v42, v42
    v_fmac_f32 v61, v43, v43
    v_add_f32 v58, v58, v42
    v_add_f32 v60, v60, v43
    v_fmac_f32 v59, v44, v44
    v_fmac_f32 v61, v45, v45
    v_add_f32 v58, v58, v44
    v_add_f32 v60, v60, v45
    v_fmac_f32 v59, v46, v46
    v_fmac_f32 v61, v47, v47
    v_add_f32 v58, v58, v46
    v_add_f32 v60, v60, v47
    v_add_f32 v58, v58, v60
    v_add_f32 v59, v59, v61
    v_lshlrev_b32 v61, 4, v2
    v_mov_b32 v60, s59
    v_permlane16_swap_b32 v58, v59
    v_add_f32 v58, v58, v59
    v_mov_b32 v59, v58
    s_nop 1
    v_permlane32_swap_b32 v58, v59
    v_add_f32 v58, v58, v59
    v_mov_b32 v59, v58
    s_nop 1
    v_permlane16_swap_b32 v58, v59
    buffer_store_dwordx3 v[58:60], v61, s[32:35], s64 offen offset:0 sc1
    s_waitcnt lgkmcnt(4)
    v_lshlrev_b32 v48, 16, v12
    v_and_b32 v49, 0xffff0000, v12
    s_waitcnt lgkmcnt(3)
    v_lshlrev_b32 v50, 16, v13
    v_and_b32 v51, 0xffff0000, v13
    s_waitcnt lgkmcnt(2)
    v_lshlrev_b32 v52, 16, v14
    v_and_b32 v53, 0xffff0000, v14
    s_waitcnt lgkmcnt(1)
    v_lshlrev_b32 v54, 16, v15
    v_and_b32 v55, 0xffff0000, v15
    s_waitcnt lgkmcnt(0)
    v_lshlrev_b32 v56, 16, v16
    v_and_b32 v57, 0xffff0000, v16
    s_add_u32 s64, s86, 8192
    v_add_f32 v58, v48, v49
    v_mul_f32 v59, v48, v48
    v_mul_f32 v61, v49, v49
    v_add_f32 v60, v50, v51
    v_fmac_f32 v59, v50, v50
    v_fmac_f32 v61, v51, v51
    v_fmac_f32 v59, v52, v52
    v_fmac_f32 v61, v53, v53
    v_add_f32 v58, v58, v52
    v_add_f32 v60, v60, v53
    v_fmac_f32 v59, v54, v54
    v_fmac_f32 v61, v55, v55
    v_add_f32 v58, v58, v54
    v_add_f32 v60, v60, v55
    v_fmac_f32 v59, v56, v56
    v_fmac_f32 v61, v57, v57
    v_add_f32 v58, v58, v56
    v_add_f32 v60, v60, v57
    v_add_f32 v58, v58, v60
    v_add_f32 v59, v59, v61
    v_lshlrev_b32 v61, 4, v2
    v_mov_b32 v60, s59
    v_permlane16_swap_b32 v58, v59
    v_add_f32 v58, v58, v59
    v_mov_b32 v59, v58
    s_nop 1
    v_permlane32_swap_b32 v58, v59
    v_add_f32 v58, v58, v59
    v_mov_b32 v59, v58
    s_nop 1
    v_permlane16_swap_b32 v58, v59
    buffer_store_dwordx3 v[58:60], v61, s[32:35], s64 offen offset:0 sc1
    s_mul_i32 s69, s54, 19456
    s_add_u32 m0, s69, 0
    s_add_u32 s66, s92, m0
    buffer_load_dwordx4 v1, s[32:35], s66 offen sc1 lds
    s_add_u32 m0, s69, 1024
    s_add_u32 s66, s92, m0
    buffer_load_dwordx4 v1, s[32:35], s66 offen sc1 lds
    s_add_u32 m0, s69, 2048
    s_add_u32 s66, s92, m0
    buffer_load_dwordx4 v1, s[32:35], s66 offen sc1 lds
    s_add_u32 m0, s69, 3072
    s_add_u32 s66, s92, m0
    buffer_load_dwordx4 v1, s[32:35], s66 offen sc1 lds
    s_add_u32 m0, s69, 4096
    s_add_u32 s66, s92, m0
    buffer_load_dwordx4 v1, s[32:35], s66 offen sc1 lds
    s_add_u32 m0, s69, 5120
    s_add_u32 s66, s92, m0
    buffer_load_dwordx4 v1, s[32:35], s66 offen sc1 lds
    s_add_u32 m0, s69, 6144
    s_add_u32 s66, s92, m0
    buffer_load_dwordx4 v1, s[32:35], s66 offen sc1 lds
    s_add_u32 m0, s69, 7168
    s_add_u32 s66, s92, m0
    buffer_load_dwordx4 v1, s[32:35], s66 offen sc1 lds
    s_add_u32 m0, s69, 8192
    s_add_u32 s66, s92, m0
    buffer_load_dwordx4 v1, s[32:35], s66 offen sc1 lds
    s_add_u32 m0, s69, 9216
    s_add_u32 s66, s92, m0
    buffer_load_dwordx4 v1, s[32:35], s66 offen sc1 lds
    s_add_u32 m0, s69, 10240
    s_add_u32 s66, s92, m0
    buffer_load_dwordx4 v1, s[32:35], s66 offen sc1 lds
    s_add_u32 m0, s69, 11264
    s_add_u32 s66, s92, m0
    buffer_load_dwordx4 v1, s[32:35], s66 offen sc1 lds
    s_sub_u32 s64, s53, 20
    s_lshl_b32 s64, s64, 2
    s_add_u32 s64, s64, s54
    s_mul_i32 s64, s64, 16384
    s_add_u32 s64, s64, 31457280
    s_cmp_lt_u32 s64, 32030720
    s_cselect_b32 s64, s64, 0x70000000
    s_add_u32 s65, s64, 8192
    v_lshlrev_b32 v30, 7, v0
    v_min_u32 v31, 79, v0
    v_lshlrev_b32 v31, 7, v31
    s_mov_b32 s66, 393216
    s_cmp_lg_u32 s53, 31
    s_cbranch_scc1 S_NOCB
    s_cmp_gt_u32 s54, 1
    s_cbranch_scc1 S_NOCB
    s_lshl_b32 s69, s52, 1
    s_add_u32 s69, s69, s54
    v_min_u32 v30, 19, v0
    s_mul_i32 s65, s69, 2560
    v_lshl_add_u32 v30, v30, 7, s65
    s_mov_b32 s64, 393216
    s_mul_i32 s66, s69, 7
    s_mul_i32 s67, s69, 6
    s_add_u32 s67, s67, 12
    s_cmp_ge_u32 s69, 12
    s_cselect_b32 s66, s67, s66
    s_lshl_b32 s66, s66, 5
    v_min_u32 v32, 27, v0
    v_lshl_add_u32 v33, v32, 3, s66
    v_min_u32 v33, 3448, v33
    global_load_dwordx2 v[92:93], v33, s[20:21]
    v_lshlrev_b32 v32, 4, v32
    s_mov_b32 s63, 0
    s_branch POLLB_161
POLL_160:
    s_sleep 6
    s_add_u32 s63, s63, 1
    s_cmp_gt_u32 s63, 400000
    s_cbranch_scc1 POLLX_162
POLLB_161:
    buffer_load_dword v31, v30, s[32:35], s64 offen sc1
    s_waitcnt vmcnt(0)
    v_cmp_ne_u32 vcc, s59, v31
    s_cbranch_vccnz POLL_160
POLLX_162:
    s_mul_i32 s64, s69, 8960
    s_add_u32 s64, s64, 73728
    buffer_load_dwordx4 v[100:103], v32, s[32:35], s64 offen offset:0 sc1
    buffer_load_dwordx4 v[104:107], v32, s[32:35], s64 offen offset:448 sc1
    buffer_load_dwordx4 v[108:111], v32, s[32:35], s64 offen offset:896 sc1
    buffer_load_dwordx4 v[112:115], v32, s[32:35], s64 offen offset:1344 sc1
    buffer_load_dwordx4 v[116:119], v32, s[32:35], s64 offen offset:1792 sc1
    buffer_load_dwordx4 v[120:123], v32, s[32:35], s64 offen offset:2240 sc1
    buffer_load_dwordx4 v[124:127], v32, s[32:35], s64 offen offset:2688 sc1
    buffer_load_dwordx4 v[128:131], v32, s[32:35], s64 offen offset:3136 sc1
    buffer_load_dwordx4 v[132:135], v32, s[32:35], s64 offen offset:3584 sc1
    s_add_u32 s64, s64, 4032
    buffer_load_dwordx4 v[136:139], v32, s[32:35], s64 offen offset:0 sc1
    buffer_load_dwordx4 v[140:143], v32, s[32:35], s64 offen offset:448 sc1
    buffer_load_dwordx4 v[144:147], v32, s[32:35], s64 offen offset:896 sc1
    buffer_load_dwordx4 v[148:151], v32, s[32:35], s64 offen offset:1344 sc1
    buffer_load_dwordx4 v[152:155], v32, s[32:35], s64 offen offset:1792 sc1
    buffer_load_dwordx4 v[156:159], v32, s[32:35], s64 offen offset:2240 sc1
    buffer_load_dwordx4 v[160:163], v32, s[32:35], s64 offen offset:2688 sc1
    buffer_load_dwordx4 v[164:167], v32, s[32:35], s64 offen offset:3136 sc1
    buffer_load_dwordx4 v[168:171], v32, s[32:35], s64 offen offset:3584 sc1
    s_add_u32 s64, s64, 4032
    buffer_load_dwordx4 v[172:175], v32, s[32:35], s64 offen offset:0 sc1
    buffer_load_dwordx4 v[176:179], v32, s[32:35], s64 offen offset:448 sc1
    s_waitcnt vmcnt(18)
    v_pk_add_f32 v[100:101], v[100:101], v[104:105]
    v_pk_add_f32 v[102:103], v[102:103], v[106:107]
    s_waitcnt vmcnt(17)
    v_pk_add_f32 v[100:101], v[100:101], v[108:109]
    v_pk_add_f32 v[102:103], v[102:103], v[110:111]
    s_waitcnt vmcnt(16)
    v_pk_add_f32 v[100:101], v[100:101], v[112:113]
    v_pk_add_f32 v[102:103], v[102:103], v[114:115]
    s_waitcnt vmcnt(15)
    v_pk_add_f32 v[100:101], v[100:101], v[116:117]
    v_pk_add_f32 v[102:103], v[102:103], v[118:119]
    s_waitcnt vmcnt(14)
    v_pk_add_f32 v[100:101], v[100:101], v[120:121]
    v_pk_add_f32 v[102:103], v[102:103], v[122:123]
    s_waitcnt vmcnt(13)
    v_pk_add_f32 v[100:101], v[100:101], v[124:125]
    v_pk_add_f32 v[102:103], v[102:103], v[126:127]
    s_waitcnt vmcnt(12)
    v_pk_add_f32 v[100:101], v[100:101], v[128:129]
    v_pk_add_f32 v[102:103], v[102:103], v[130:131]
    s_waitcnt vmcnt(11)
    v_pk_add_f32 v[100:101], v[100:101], v[132:133]
    v_pk_add_f32 v[102:103], v[102:103], v[134:135]
    s_waitcnt vmcnt(10)
    v_pk_add_f32 v[100:101], v[100:101], v[136:137]
    v_pk_add_f32 v[102:103], v[102:103], v[138:139]
    s_waitcnt vmcnt(9)
    v_pk_add_f32 v[100:101], v[100:101], v[140:141]
    v_pk_add_f32 v[102:103], v[102:103], v[142:143]
    s_waitcnt vmcnt(8)
    v_pk_add_f32 v[100:101], v[100:101], v[144:145]
    v_pk_add_f32 v[102:103], v[102:103], v[146:147]
    s_waitcnt vmcnt(7)
    v_pk_add_f32 v[100:101], v[100:101], v[148:149]
    v_pk_add_f32 v[102:103], v[102:103], v[150:151]
    s_waitcnt vmcnt(6)
    v_pk_add_f32 v[100:101], v[100:101], v[152:153]
    v_pk_add_f32 v[102:103], v[102:103], v[154:155]
    s_waitcnt vmcnt(5)
    v_pk_add_f32 v[100:101], v[100:101], v[156:157]
    v_pk_add_f32 v[102:103], v[102:103], v[158:159]
    s_waitcnt vmcnt(4)
    v_pk_add_f32 v[100:101], v[100:101], v[160:161]
    v_pk_add_f32 v[102:103], v[102:103], v[162:163]
    s_waitcnt vmcnt(3)
    v_pk_add_f32 v[100:101], v[100:101], v[164:165]
    v_pk_add_f32 v[102:103], v[102:103], v[166:167]
    s_waitcnt vmcnt(2)
    v_pk_add_f32 v[100:101], v[100:101], v[168:169]
    v_pk_add_f32 v[102:103], v[102:103], v[170:171]
    s_waitcnt vmcnt(1)
    v_pk_add_f32 v[100:101], v[100:101], v[172:173]
    v_pk_add_f32 v[102:103], v[102:103], v[174:175]
    s_waitcnt vmcnt(0)
    v_pk_add_f32 v[100:101], v[100:101], v[176:177]
    v_pk_add_f32 v[102:103], v[102:103], v[178:179]
    v_cvt_pk_bf16_f32 v104, v100, v100
    v_and_b32 v112, 0xffff0000, v104
    v_sub_f32 v100, v100, v112
    v_cvt_pk_bf16_f32 v113, v100, v100
    v_and_b32 v112, 0xffff0000, v113
    v_sub_f32 v100, v100, v112
    v_cvt_pk_bf16_f32 v113, v100, v100
    v_and_b32 v104, 0xffff, v104
    v_or_b32 v104, v104, v112
    v_and_b32 v113, 0xffff, v113
    v_lshlrev_b32 v112, 16, v92
    v_or_b32 v105, v113, v112
    v_cvt_pk_bf16_f32 v106, v101, v101
    v_and_b32 v112, 0xffff0000, v106
    v_sub_f32 v101, v101, v112
    v_cvt_pk_bf16_f32 v113, v101, v101
    v_and_b32 v112, 0xffff0000, v113
    v_sub_f32 v101, v101, v112
    v_cvt_pk_bf16_f32 v113, v101, v101
    v_and_b32 v106, 0xffff, v106
    v_or_b32 v106, v106, v112
    v_and_b32 v113, 0xffff, v113
    v_and_b32 v112, 0xffff0000, v92
    v_or_b32 v107, v113, v112
    v_cvt_pk_bf16_f32 v108, v102, v102
    v_and_b32 v112, 0xffff0000, v108
    v_sub_f32 v102, v102, v112
    v_cvt_pk_bf16_f32 v113, v102, v102
    v_and_b32 v112, 0xffff0000, v113
    v_sub_f32 v102, v102, v112
    v_cvt_pk_bf16_f32 v113, v102, v102
    v_and_b32 v108, 0xffff, v108
    v_or_b32 v108, v108, v112
    v_and_b32 v113, 0xffff, v113
    v_lshlrev_b32 v112, 16, v93
    v_or_b32 v109, v113, v112
    v_cvt_pk_bf16_f32 v110, v103, v103
    v_and_b32 v112, 0xffff0000, v110
    v_sub_f32 v103, v103, v112
    v_cvt_pk_bf16_f32 v113, v103, v103
    v_and_b32 v112, 0xffff0000, v113
    v_sub_f32 v103, v103, v112
    v_cvt_pk_bf16_f32 v113, v103, v103
    v_and_b32 v110, 0xffff, v110
    v_or_b32 v110, v110, v112
    v_and_b32 v113, 0xffff, v113
    v_and_b32 v112, 0xffff0000, v93
    v_or_b32 v111, v113, v112
    s_mul_i32 s64, s69, 896
    s_add_u32 s64, s64, 49152
    v_lshlrev_b32 v32, 1, v32
    buffer_store_dwordx4 v[104:107], v32, s[32:35], s64 offen sc1
    buffer_store_dwordx4 v[108:111], v32, s[32:35], s64 offen offset:16 sc1
    s_lshl_b32 s64, s69, 7
    s_add_u32 s64, s64, 8192
    v_mov_b32 v30, s59
    v_mov_b32 v31, 0
    s_waitcnt vmcnt(0)
    buffer_store_dword v30, v31, s[32:35], s64 offen sc1
S_NOCB:
    s_mov_b32 s67, s87
    s_add_u32 s68, s87, 8192
    buffer_load_dwordx3 v[58:60], v1, s[32:35], s67 offen offset:0 sc1
    buffer_load_dwordx3 v[62:64], v1, s[32:35], s67 offen offset:1024 sc1
    buffer_load_dwordx3 v[66:68], v1, s[32:35], s67 offen offset:2048 sc1
    buffer_load_dwordx3 v[70:72], v1, s[32:35], s67 offen offset:3072 sc1
    buffer_load_dwordx3 v[74:76], v1, s[32:35], s68 offen offset:0 sc1
    buffer_load_dwordx3 v[78:80], v1, s[32:35], s68 offen offset:1024 sc1
    buffer_load_dwordx3 v[82:84], v1, s[32:35], s68 offen offset:2048 sc1
    buffer_load_dwordx3 v[86:88], v1, s[32:35], s68 offen offset:3072 sc1
    s_waitcnt vmcnt(6)
    v_xor_b32 v60, v60, v64
    s_waitcnt vmcnt(4)
    v_xor_b32 v68, v68, v72
    v_xor_b32 v64, v64, v72
    v_xor_b32 v72, s59, v72
    v_or3_b32 v60, v60, v64, v68
    v_or_b32 v60, v60, v72
    v_cmp_ne_u32 vcc, 0, v60
    s_cbranch_vccnz SPIN_163
BACK_164:
    v_add_f32 v58, v58, v62
    v_add_f32 v59, v59, v63
    v_add_f32 v66, v66, v70
    v_add_f32 v67, v67, v71
    v_add_f32 v58, v58, v66
    v_add_f32 v59, v59, v67
    s_nop 1
    v_permlane16_swap_b32 v58, v59
    v_add_f32 v58, v58, v59
    v_mov_b32 v59, v58
    s_nop 1
    v_permlane32_swap_b32 v58, v59
    v_add_f32 v58, v58, v59
    v_mul_f32 v30, 0x3acccccd, v58
    v_mul_f32 v31, 0x3acccccd, v58
    s_nop 1
    v_permlane16_swap_b32 v30, v31
    v_fma_f32 v31, -v30, v30, v31
    v_max_f32 v31, 0, v31
    v_cvt_pk_bf16_f32 v31, v31, v30
    v_and_b32 v30, 0xffff0000, v31
    v_lshlrev_b32 v31, 16, v31
    v_add_f32 v31, 0x3727c5ac, v31
    v_cvt_pk_bf16_f32 v31, v31, v31
    v_lshlrev_b32 v31, 16, v31
    v_sqrt_f32 v31, v31
    s_nop 0
    v_cvt_pk_bf16_f32 v31, v31, v31
    v_lshlrev_b32 v31, 16, v31
    v_rcp_f32 v31, v31
    s_nop 0
    v_mul_f32 v32, -v30, v31
    v_fma_f32 v58, v38, v31, v32
    v_fma_f32 v59, v39, v31, v32
    v_fma_f32 v60, v40, v31, v32
    v_fma_f32 v61, v41, v31, v32
    v_fma_f32 v62, v42, v31, v32
    v_fma_f32 v63, v43, v31, v32
    v_fma_f32 v64, v44, v31, v32
    v_fma_f32 v65, v45, v31, v32
    v_fma_f32 v66, v46, v31, v32
    v_fma_f32 v67, v47, v31, v32
    s_waitcnt vmcnt(2)
    v_xor_b32 v76, v76, v80
    s_waitcnt vmcnt(0)
    v_xor_b32 v84, v84, v88
    v_xor_b32 v80, v80, v88
    v_xor_b32 v88, s59, v88
    v_or3_b32 v76, v76, v80, v84
    v_or_b32 v76, v76, v88
    v_cmp_ne_u32 vcc, 0, v76
    s_cbranch_vccnz SPIN_165
BACK_166:
    v_add_f32 v74, v74, v78
    v_add_f32 v75, v75, v79
    v_add_f32 v82, v82, v86
    v_add_f32 v83, v83, v87
    v_add_f32 v74, v74, v82
    v_add_f32 v75, v75, v83
    s_nop 1
    v_permlane16_swap_b32 v74, v75
    v_add_f32 v74, v74, v75
    v_mov_b32 v75, v74
    s_nop 1
    v_permlane32_swap_b32 v74, v75
    v_add_f32 v74, v74, v75
    v_mul_f32 v30, 0x3acccccd, v74
    v_mul_f32 v31, 0x3acccccd, v74
    s_nop 1
    v_permlane16_swap_b32 v30, v31
    v_fma_f32 v31, -v30, v30, v31
    v_max_f32 v31, 0, v31
    v_cvt_pk_bf16_f32 v31, v31, v30
    v_and_b32 v30, 0xffff0000, v31
    v_lshlrev_b32 v31, 16, v31
    v_add_f32 v31, 0x3727c5ac, v31
    v_cvt_pk_bf16_f32 v31, v31, v31
    v_lshlrev_b32 v31, 16, v31
    v_sqrt_f32 v31, v31
    s_nop 0
    v_cvt_pk_bf16_f32 v31, v31, v31
    v_lshlrev_b32 v31, 16, v31
    v_rcp_f32 v31, v31
    s_nop 0
    v_mul_f32 v32, -v30, v31
    v_fma_f32 v74, v48, v31, v32
    v_fma_f32 v75, v49, v31, v32
    v_fma_f32 v76, v50, v31, v32
    v_fma_f32 v77, v51, v31, v32
    v_fma_f32 v78, v52, v31, v32
    v_fma_f32 v79, v53, v31, v32
    v_fma_f32 v80, v54, v31, v32
    v_fma_f32 v81, v55, v31, v32
    v_fma_f32 v82, v56, v31, v32
    v_fma_f32 v83, v57, v31, v32
    s_lshl_b32 s64, s52, 9
    s_add_u32 s64, s64, 65536
    v_lshlrev_b32 v31, 2, v0
    s_mov_b32 s63, 0
    s_branch POLLB_168
POLL_167:
    s_sleep 4
    s_add_u32 s63, s63, 1
    s_cmp_gt_u32 s63, 400000
    s_cbranch_scc1 POLLX_169
POLLB_168:
    buffer_load_dword v30, v31, s[32:35], s64 offen sc1
    s_waitcnt vmcnt(0)
    v_cmp_ne_u32 vcc, s59, v30
    s_cbranch_vccnz POLL_167
POLLX_169:
S_W1DONE:
    s_xor_b32 s64, s54, 1
    s_and_b32 s64, s64, 1
    s_sub_u32 s96, s81, 55296
    s_add_u32 s65, s81, 55296
    s_cmp_eq_u32 s64, 1
    s_cselect_b32 s96, s65, s96
    s_mul_i32 s94, s54, 10240
    s_sub_u32 s94, 40960, s94
    s_cmp_eq_u32 s54, 3
    s_cselect_b32 s94, -8192, s94
    s_lshl_b32 s64, s55, 2
    s_and_b32 s65, s54, 1
    s_add_u32 s64, s64, s65
    s_lshl_b32 s64, s64, 3
    s_add_u32 s64, s64, s56
    s_mul_i32 s68, s64, 2560
    s_lshr_b32 s65, s89, 1
    s_add_u32 s68, s68, s65
    s_add_u32 s68, s68, 6291456
    s_add_u32 s69, s68, 40960
    v_min_u32 v31, 19, v0
    v_lshlrev_b32 v31, 9, v31
    s_mul_i32 s64, s56, 10240
    s_lshr_b32 s65, s55, 3
    s_lshl_b32 s65, s65, 7
    s_add_u32 s64, s64, s65
    s_add_u32 s64, s64, 262144
    s_mov_b32 s63, 0
    s_branch POLLB_171
POLL_170:
    s_sleep 2
    s_add_u32 s63, s63, 1
    s_cmp_gt_u32 s63, 400000
    s_cbranch_scc1 POLLX_172
POLLB_171:
    buffer_load_dword v30, v31, s[32:35], s64 offen sc1
    s_waitcnt vmcnt(0)
    v_cmp_ne_u32 vcc, s59, v30
    s_cbranch_vccnz POLL_170
POLLX_172:
    buffer_load_dword v17, v4, s[32:35], s68 offen offset:0 sc1
    buffer_load_dword v18, v4, s[32:35], s68 offen offset:512 sc1
    buffer_load_dword v19, v4, s[32:35], s68 offen offset:1024 sc1
    buffer_load_dword v20, v4, s[32:35], s68 offen offset:1536 sc1
    buffer_load_dword v21, v4, s[32:35], s68 offen offset:2048 sc1
    buffer_load_dword v22, v4, s[32:35], s69 offen offset:0 sc1
    buffer_load_dword v23, v4, s[32:35], s69 offen offset:512 sc1
    buffer_load_dword v24, v4, s[32:35], s69 offen offset:1024 sc1
    buffer_load_dword v25, v4, s[32:35], s69 offen offset:1536 sc1
    buffer_load_dword v26, v4, s[32:35], s69 offen offset:2048 sc1
    s_waitcnt vmcnt(9)
    v_lshlrev_b32 v102, 16, v17
    v_and_b32 v103, 0xffff0000, v17
    s_waitcnt vmcnt(8)
    v_lshlrev_b32 v104, 16, v18
    v_and_b32 v105, 0xffff0000, v18
    s_waitcnt vmcnt(7)
    v_lshlrev_b32 v106, 16, v19
    v_and_b32 v107, 0xffff0000, v19
    s_waitcnt vmcnt(6)
    v_lshlrev_b32 v108, 16, v20
    v_and_b32 v109, 0xffff0000, v20
    s_waitcnt vmcnt(5)
    v_lshlrev_b32 v110, 16, v21
    v_and_b32 v111, 0xffff0000, v21
    v_pk_fma_f32 v[38:39], v[58:59], v[102:103], v[38:39]
    v_pk_fma_f32 v[40:41], v[60:61], v[104:105], v[40:41]
    v_pk_fma_f32 v[42:43], v[62:63], v[106:107], v[42:43]
    v_pk_fma_f32 v[44:45], v[64:65], v[108:109], v[44:45]
    v_pk_fma_f32 v[46:47], v[66:67], v[110:111], v[46:47]
    v_cvt_pk_bf16_f32 v6, v38, v39
    v_cvt_pk_bf16_f32 v7, v40, v41
    v_cvt_pk_bf16_f32 v8, v42, v43
    v_cvt_pk_bf16_f32 v9, v44, v45
    v_cvt_pk_bf16_f32 v10, v46, v47
    s_add_u32 s64, s77, 0
    s_add_u32 s65, s78, 0
    buffer_store_dwordx4 v[6:9], v1, s[32:35], s64 offen sc1
    buffer_store_dword v10, v1, s[32:35], s65 offen sc1
    s_waitcnt vmcnt(6)
    v_lshlrev_b32 v142, 16, v22
    v_and_b32 v143, 0xffff0000, v22
    s_waitcnt vmcnt(5)
    v_lshlrev_b32 v144, 16, v23
    v_and_b32 v145, 0xffff0000, v23
    s_waitcnt vmcnt(4)
    v_lshlrev_b32 v146, 16, v24
    v_and_b32 v147, 0xffff0000, v24
    s_waitcnt vmcnt(3)
    v_lshlrev_b32 v148, 16, v25
    v_and_b32 v149, 0xffff0000, v25
    s_waitcnt vmcnt(2)
    v_lshlrev_b32 v150, 16, v26
    v_and_b32 v151, 0xffff0000, v26
    v_pk_fma_f32 v[48:49], v[74:75], v[142:143], v[48:49]
    v_pk_fma_f32 v[50:51], v[76:77], v[144:145], v[50:51]
    v_pk_fma_f32 v[52:53], v[78:79], v[146:147], v[52:53]
    v_pk_fma_f32 v[54:55], v[80:81], v[148:149], v[54:55]
    v_pk_fma_f32 v[56:57], v[82:83], v[150:151], v[56:57]
    v_cvt_pk_bf16_f32 v12, v48, v49
    v_cvt_pk_bf16_f32 v13, v50, v51
    v_cvt_pk_bf16_f32 v14, v52, v53
    v_cvt_pk_bf16_f32 v15, v54, v55
    v_cvt_pk_bf16_f32 v16, v56, v57
    s_add_u32 s64, s77, 40960
    s_add_u32 s65, s78, 40960
    buffer_store_dwordx4 v[12:15], v1, s[32:35], s64 offen sc1
    buffer_store_dword v16, v1, s[32:35], s65 offen sc1
    s_add_u32 s65, s86, 524288
    v_add_f32 v112, v38, v39
    v_mul_f32 v113, v38, v38
    v_mul_f32 v115, v39, v39
    v_add_f32 v114, v40, v41
    v_fmac_f32 v113, v40, v40
    v_fmac_f32 v115, v41, v41
    v_fmac_f32 v113, v42, v42
    v_fmac_f32 v115, v43, v43
    v_add_f32 v112, v112, v42
    v_add_f32 v114, v114, v43
    v_fmac_f32 v113, v44, v44
    v_fmac_f32 v115, v45, v45
    v_add_f32 v112, v112, v44
    v_add_f32 v114, v114, v45
    v_fmac_f32 v113, v46, v46
    v_fmac_f32 v115, v47, v47
    v_add_f32 v112, v112, v46
    v_add_f32 v114, v114, v47
    v_add_f32 v112, v112, v114
    v_add_f32 v113, v113, v115
    v_lshlrev_b32 v115, 4, v2
    v_mov_b32 v114, s59
    v_permlane16_swap_b32 v112, v113
    v_add_f32 v112, v112, v113
    v_mov_b32 v113, v112
    s_nop 1
    v_permlane32_swap_b32 v112, v113
    v_add_f32 v112, v112, v113
    v_mov_b32 v113, v112
    s_nop 1
    v_permlane16_swap_b32 v112, v113
    buffer_store_dwordx3 v[112:114], v115, s[32:35], s65 offen offset:0 sc1
    v_mov_b32 v32, s59
    v_mov_b32 v33, 0
    s_waitcnt vmcnt(3)
    buffer_store_dword v32, v33, s[32:35], s83 offen offset:0 sc1
    v_mov_b32 v32, s59
    v_mov_b32 v33, 0
    s_waitcnt vmcnt(2)
    buffer_store_dword v32, v33, s[32:35], s83 offen offset:128 sc1
    s_add_u32 s65, s86, 532480
    v_add_f32 v152, v48, v49
    v_mul_f32 v153, v48, v48
    v_mul_f32 v155, v49, v49
    v_add_f32 v154, v50, v51
    v_fmac_f32 v153, v50, v50
    v_fmac_f32 v155, v51, v51
    v_fmac_f32 v153, v52, v52
    v_fmac_f32 v155, v53, v53
    v_add_f32 v152, v152, v52
    v_add_f32 v154, v154, v53
    v_fmac_f32 v153, v54, v54
    v_fmac_f32 v155, v55, v55
    v_add_f32 v152, v152, v54
    v_add_f32 v154, v154, v55
    v_fmac_f32 v153, v56, v56
    v_fmac_f32 v155, v57, v57
    v_add_f32 v152, v152, v56
    v_add_f32 v154, v154, v57
    v_add_f32 v152, v152, v154
    v_add_f32 v153, v153, v155
    v_lshlrev_b32 v155, 4, v2
    v_mov_b32 v154, s59
    v_permlane16_swap_b32 v152, v153
    v_add_f32 v152, v152, v153
    v_mov_b32 v153, v152
    s_nop 1
    v_permlane32_swap_b32 v152, v153
    v_add_f32 v152, v152, v153
    v_mov_b32 v153, v152
    s_nop 1
    v_permlane16_swap_b32 v152, v153
    buffer_store_dwordx3 v[152:154], v155, s[32:35], s65 offen offset:0 sc1
    s_cmp_ge_u32 s53, 20
    s_cbranch_scc1 S_RESTI
    v_mov_b32 v30, s59
    v_mov_b32 v31, 0
    buffer_store_dword v30, v31, s[32:35], s99 offen sc1
    s_mul_i32 s69, s54, 19456
    s_add_u32 m0, s69, 12288
    s_add_u32 s66, s92, m0
    buffer_load_dwordx4 v1, s[32:35], s66 offen sc1 lds
    s_add_u32 m0, s69, 13312
    s_add_u32 s66, s92, m0
    buffer_load_dwordx4 v1, s[32:35], s66 offen sc1 lds
    s_add_u32 m0, s69, 14336
    s_add_u32 s66, s92, m0
    buffer_load_dwordx4 v1, s[32:35], s66 offen sc1 lds
    s_add_u32 m0, s69, 15360
    s_add_u32 s66, s92, m0
    buffer_load_dwordx4 v1, s[32:35], s66 offen sc1 lds
    s_add_u32 m0, s69, 16384
    s_add_u32 s66, s92, m0
    buffer_load_dwordx4 v1, s[32:35], s66 offen sc1 lds
    s_add_u32 m0, s69, 17408
    s_add_u32 s66, s92, m0
    buffer_load_dwordx4 v1, s[32:35], s66 offen sc1 lds
    s_add_u32 m0, s69, 18432
    s_add_u32 s66, s92, m0
    buffer_load_dwordx4 v1, s[32:35], s66 offen sc1 lds
    s_barrier
    s_mul_i32 s69, s54, 16384
    s_add_u32 s69, s69, 77824
    s_add_u32 m0, s69, 0
    s_add_u32 s66, s92, m0
    buffer_load_dwordx4 v1, s[32:35], s66 offen sc1 lds
    s_add_u32 m0, s69, 1024
    s_add_u32 s66, s92, m0
    buffer_load_dwordx4 v1, s[32:35], s66 offen sc1 lds
    s_add_u32 m0, s69, 2048
    s_add_u32 s66, s92, m0
    buffer_load_dwordx4 v1, s[32:35], s66 offen sc1 lds
    s_add_u32 m0, s69, 3072
    s_add_u32 s66, s92, m0
    buffer_load_dwordx4 v1, s[32:35], s66 offen sc1 lds
    s_add_u32 m0, s69, 4096
    s_add_u32 s66, s92, m0
    buffer_load_dwordx4 v1, s[32:35], s66 offen sc1 lds
    s_add_u32 m0, s69, 5120
    s_add_u32 s66, s92, m0
    buffer_load_dwordx4 v1, s[32:35], s66 offen sc1 lds
    s_add_u32 m0, s69, 6144
    s_add_u32 s66, s92, m0
    buffer_load_dwordx4 v1, s[32:35], s66 offen sc1 lds
    s_add_u32 m0, s69, 7168
    s_add_u32 s66, s92, m0
    buffer_load_dwordx4 v1, s[32:35], s66 offen sc1 lds
    s_add_u32 m0, s69, 8192
    s_add_u32 s66, s92, m0
    buffer_load_dwordx4 v1, s[32:35], s66 offen sc1 lds
    s_add_u32 m0, s69, 9216
    s_add_u32 s66, s92, m0
    buffer_load_dwordx4 v1, s[32:35], s66 offen sc1 lds
    s_add_u32 m0, s69, 10240
    s_add_u32 s66, s92, m0
    buffer_load_dwordx4 v1, s[32:35], s66 offen sc1 lds
    s_add_u32 m0, s69, 11264
    s_add_u32 s66, s92, m0
    buffer_load_dwordx4 v1, s[32:35], s66 offen sc1 lds
    s_add_u32 m0, s69, 12288
    s_add_u32 s66, s92, m0
    buffer_load_dwordx4 v1, s[32:35], s66 offen sc1 lds
    s_add_u32 m0, s69, 13312
    s_add_u32 s66, s92, m0
    buffer_load_dwordx4 v1, s[32:35], s66 offen sc1 lds
    s_add_u32 m0, s69, 14336
    s_add_u32 s66, s92, m0
    buffer_load_dwordx4 v1, s[32:35], s66 offen sc1 lds
    s_add_u32 m0, s69, 15360
    s_add_u32 s66, s92, m0
    buffer_load_dwordx4 v1, s[32:35], s66 offen sc1 lds
    s_branch S_HAVEB
S_RESTI:
    s_mul_i32 s69, s54, 19456
    s_add_u32 m0, s69, 12288
    s_add_u32 s66, s92, m0
    buffer_load_dwordx4 v1, s[32:35], s66 offen sc1 lds
    s_add_u32 m0, s69, 13312
    s_add_u32 s66, s92, m0
    buffer_load_dwordx4 v1, s[32:35], s66 offen sc1 lds
    s_add_u32 m0, s69, 14336
    s_add_u32 s66, s92, m0
    buffer_load_dwordx4 v1, s[32:35], s66 offen sc1 lds
    s_add_u32 m0, s69, 15360
    s_add_u32 s66, s92, m0
    buffer_load_dwordx4 v1, s[32:35], s66 offen sc1 lds
    s_add_u32 m0, s69, 16384
    s_add_u32 s66, s92, m0
    buffer_load_dwordx4 v1, s[32:35], s66 offen sc1 lds
    s_add_u32 m0, s69, 17408
    s_add_u32 s66, s92, m0
    buffer_load_dwordx4 v1, s[32:35], s66 offen sc1 lds
    s_add_u32 m0, s69, 18432
    s_add_u32 s66, s92, m0
    buffer_load_dwordx4 v1, s[32:35], s66 offen sc1 lds
    s_mul_i32 s69, s54, 16384
    s_add_u32 s69, s69, 77824
    s_add_u32 m0, s69, 0
    s_add_u32 s66, s92, m0
    buffer_load_dwordx4 v1, s[32:35], s66 offen sc1 lds
    s_add_u32 m0, s69, 1024
    s_add_u32 s66, s92, m0
    buffer_load_dwordx4 v1, s[32:35], s66 offen sc1 lds
    s_add_u32 m0, s69, 2048
    s_add_u32 s66, s92, m0
    buffer_load_dwordx4 v1, s[32:35], s66 offen sc1 lds
    s_add_u32 m0, s69, 3072
    s_add_u32 s66, s92, m0
    buffer_load_dwordx4 v1, s[32:35], s66 offen sc1 lds
    s_add_u32 m0, s69, 4096
    s_add_u32 s66, s92, m0
    buffer_load_dwordx4 v1, s[32:35], s66 offen sc1 lds
    s_add_u32 m0, s69, 5120
    s_add_u32 s66, s92, m0
    buffer_load_dwordx4 v1, s[32:35], s66 offen sc1 lds
    s_add_u32 m0, s69, 6144
    s_add_u32 s66, s92, m0
    buffer_load_dwordx4 v1, s[32:35], s66 offen sc1 lds
    s_add_u32 m0, s69, 7168
    s_add_u32 s66, s92, m0
    buffer_load_dwordx4 v1, s[32:35], s66 offen sc1 lds
    s_add_u32 m0, s69, 8192
    s_add_u32 s66, s92, m0
    buffer_load_dwordx4 v1, s[32:35], s66 offen sc1 lds
    s_add_u32 m0, s69, 9216
    s_add_u32 s66, s92, m0
    buffer_load_dwordx4 v1, s[32:35], s66 offen sc1 lds
    s_add_u32 m0, s69, 10240
    s_add_u32 s66, s92, m0
    buffer_load_dwordx4 v1, s[32:35], s66 offen sc1 lds
    s_add_u32 m0, s69, 11264
    s_add_u32 s66, s92, m0
    buffer_load_dwordx4 v1, s[32:35], s66 offen sc1 lds
    s_add_u32 m0, s69, 12288
    s_add_u32 s66, s92, m0
    buffer_load_dwordx4 v1, s[32:35], s66 offen sc1 lds
    s_add_u32 m0, s69, 13312
    s_add_u32 s66, s92, m0
    buffer_load_dwordx4 v1, s[32:35], s66 offen sc1 lds
    s_add_u32 m0, s69, 14336
    s_add_u32 s66, s92, m0
    buffer_load_dwordx4 v1, s[32:35], s66 offen sc1 lds
    s_add_u32 m0, s69, 15360
    s_add_u32 s66, s92, m0
    buffer_load_dwordx4 v1, s[32:35], s66 offen sc1 lds
S_HAVEB:
    s_waitcnt vmcnt(0)
    s_barrier
    v_mov_b32 v121, v90
    s_mov_b64 s[100:101], 0xffff
    ds_read_b128 v[160:163], v1 offset:0
    ds_read_b128 v[164:167], v1 offset:1024
    ds_read_b128 v[168:171], v1 offset:2048
    ds_read_b128 v[172:175], v1 offset:3072
    ds_read_b128 v[176:179], v1 offset:4096
    ds_read_b128 v[180:183], v1 offset:5120
    v_and_b32 v31, 16, v0
    v_lshlrev_b32 v31, 3, v31
    v_lshl_add_u32 v31, v2, 2, v31
    s_mov_b32 s66, s82
    s_lshl_b32 s67, s58, 7
    s_add_u32 s67, s67, 8192
    v_writelane_b32 v121, s67, 63
    s_mov_b32 s67, 0
    buffer_load_dword v120, v121, s[32:35], s67 offen sc1
    s_mov_b32 s63, 0
    s_branch POLLB_176
POLL_175:
    s_sleep 2
    s_add_u32 s63, s63, 1
    s_cmp_gt_u32 s63, 400000
    s_cbranch_scc1 POLLX_177
POLLB_176:
    buffer_load_dword v30, v31, s[32:35], s66 offen sc1
    s_waitcnt vmcnt(0)
    v_cmp_ne_u32 vcc, s59, v30
    s_cbranch_vccnz POLL_175
POLLX_177:
    s_add_u32 s98, s76, 40960
    buffer_load_dwordx4 v[184:187], v1, s[32:35], s98 offen offset:0 sc1
    s_add_u32 s93, s76, 0
    buffer_load_dwordx4 v[188:191], v1, s[32:35], s93 offen offset:0 sc1
    buffer_load_dwordx4 v[192:195], v1, s[32:35], s98 offen offset:1024 sc1
    buffer_load_dwordx4 v[196:199], v1, s[32:35], s93 offen offset:1024 sc1
    buffer_load_dwordx4 v[200:203], v1, s[32:35], s98 offen offset:2048 sc1
    buffer_load_dwordx4 v[204:207], v1, s[32:35], s93 offen offset:2048 sc1
    v_cmp_ne_u32 vcc, s59, v120
    s_cbranch_vccnz SPIN_178
BACK_179:
    s_or_b32 s64, s2, s54
    s_cmp_eq_u32 s64, 0
    s_cselect_b32 s64, 0, 0x70000000
    v_mov_b32 v33, s59
    v_mov_b32 v34, 0
    buffer_store_dword v33, v34, s[32:35], s64 offen sc1
    s_waitcnt vmcnt(6) lgkmcnt(5)
    v_mfma_f32_16x16x32_bf16 v[92:95], v[160:163], v[184:187], 0
    buffer_load_dwordx4 v[208:211], v1, s[32:35], s98 offen offset:3072 sc1
    s_waitcnt vmcnt(6)
    v_mfma_f32_16x16x32_bf16 v[132:135], v[160:163], v[188:191], 0
    ds_read_b128 v[160:163], v1 offset:6144
    s_waitcnt lgkmcnt(5)
    v_mfma_f32_16x16x32_bf16 v[96:99], v[164:167], v[184:187], 0
    v_mfma_f32_16x16x32_bf16 v[136:139], v[164:167], v[188:191], 0
    ds_read_b128 v[164:167], v1 offset:7168
    s_waitcnt lgkmcnt(4)
    buffer_load_dwordx4 v[212:215], v1, s[32:35], s93 offen offset:3072 sc1
    v_mfma_f32_16x16x32_bf16 v[100:103], v[168:171], v[184:187], 0
    v_mfma_f32_16x16x32_bf16 v[140:143], v[168:171], v[188:191], 0
    ds_read_b128 v[168:171], v1 offset:8192
    v_mfma_f32_16x16x32_bf16 v[104:107], v[172:175], v[184:187], 0
    s_add_u32 s98, s98, 4096
    buffer_load_dwordx4 v[216:219], v1, s[32:35], s98 offen offset:0 sc1
    v_mfma_f32_16x16x32_bf16 v[144:147], v[172:175], v[188:191], 0
    ds_read_b128 v[172:175], v1 offset:9216
    s_waitcnt lgkmcnt(4)
    v_mfma_f32_16x16x32_bf16 v[108:111], v[176:179], v[184:187], 0
    v_mfma_f32_16x16x32_bf16 v[148:151], v[176:179], v[188:191], 0
    ds_read_b128 v[176:179], v1 offset:10240
    s_add_u32 s93, s93, 4096
    buffer_load_dwordx4 v[220:223], v1, s[32:35], s93 offen offset:0 sc1
    v_mfma_f32_16x16x32_bf16 v[112:115], v[180:183], v[184:187], 0
    v_mfma_f32_16x16x32_bf16 v[152:155], v[180:183], v[188:191], 0
    ds_read_b128 v[180:183], v1 offset:11264
    s_waitcnt lgkmcnt(4)
    v_mfma_f32_16x16x32_bf16 v[116:119], v[160:163], v[184:187], 0
    buffer_load_dwordx4 v[224:227], v1, s[32:35], s98 offen offset:1024 sc1
    v_mfma_f32_16x16x32_bf16 v[156:159], v[160:163], v[188:191], 0
    ds_read_b128 v[160:163], v1 offset:12288
    buffer_load_dwordx4 v[228:231], v1, s[32:35], s93 offen offset:1024 sc1
    s_waitcnt vmcnt(10)
    v_mfma_f32_16x16x32_bf16 v[92:95], v[164:167], v[192:195], v[92:95]
    s_waitcnt vmcnt(9)
    v_mfma_f32_16x16x32_bf16 v[132:135], v[164:167], v[196:199], v[132:135]
    ds_read_b128 v[164:167], v1 offset:13312
    s_waitcnt lgkmcnt(4)
    buffer_load_dwordx4 v[56:59], v1, s[32:35], s98 offen offset:2048 sc1
    v_mfma_f32_16x16x32_bf16 v[96:99], v[168:171], v[192:195], v[96:99]
    buffer_load_dwordx4 a[0:3], v35, s[32:35], s90 offen offset:0 sc1
    v_mfma_f32_16x16x32_bf16 v[136:139], v[168:171], v[196:199], v[136:139]
    ds_read_b128 v[168:171], v1 offset:14336
    v_mfma_f32_16x16x32_bf16 v[100:103], v[172:175], v[192:195], v[100:103]
    buffer_load_dwordx4 v[60:63], v1, s[32:35], s93 offen offset:2048 sc1
    v_mfma_f32_16x16x32_bf16 v[140:143], v[172:175], v[196:199], v[140:143]
    ds_read_b128 v[172:175], v1 offset:15360
    s_waitcnt lgkmcnt(4)
    v_mfma_f32_16x16x32_bf16 v[104:107], v[176:179], v[192:195], v[104:107]
    v_mfma_f32_16x16x32_bf16 v[144:147], v[176:179], v[196:199], v[144:147]
    ds_read_b128 v[176:179], v1 offset:16384
    buffer_load_dwordx4 v[64:67], v1, s[32:35], s98 offen offset:3072 sc1
    v_mfma_f32_16x16x32_bf16 v[108:111], v[180:183], v[192:195], v[108:111]
    buffer_load_dwordx4 a[4:7], v35, s[32:35], s90 offen offset:1024 sc1
    v_mfma_f32_16x16x32_bf16 v[148:151], v[180:183], v[196:199], v[148:151]
    ds_read_b128 v[180:183], v1 offset:17408
    s_waitcnt lgkmcnt(4)
    v_mfma_f32_16x16x32_bf16 v[112:115], v[160:163], v[192:195], v[112:115]
    buffer_load_dwordx4 v[68:71], v1, s[32:35], s93 offen offset:3072 sc1
    v_mfma_f32_16x16x32_bf16 v[152:155], v[160:163], v[196:199], v[152:155]
    ds_read_b128 v[160:163], v1 offset:18432
    v_mfma_f32_16x16x32_bf16 v[116:119], v[164:167], v[192:195], v[116:119]
    s_add_u32 s98, s98, 4096
    buffer_load_dwordx4 v[72:75], v1, s[32:35], s98 offen offset:0 sc1
    v_mfma_f32_16x16x32_bf16 v[156:159], v[164:167], v[196:199], v[156:159]
    ds_read_b128 v[164:167], v1 offset:19456
    s_waitcnt lgkmcnt(4)
    s_add_u32 s93, s93, 4096
    buffer_load_dwordx4 v[184:187], v1, s[32:35], s93 offen offset:0 sc1
    s_waitcnt vmcnt(16)
    v_mfma_f32_16x16x32_bf16 v[92:95], v[168:171], v[200:203], v[92:95]
    buffer_load_dwordx4 a[8:11], v35, s[32:35], s90 offen offset:2048 sc1
    s_waitcnt vmcnt(16)
    v_mfma_f32_16x16x32_bf16 v[132:135], v[168:171], v[204:207], v[132:135]
    ds_read_b128 v[168:171], v1 offset:20480
    v_mfma_f32_16x16x32_bf16 v[96:99], v[172:175], v[200:203], v[96:99]
    buffer_load_dwordx4 v[188:191], v1, s[32:35], s98 offen offset:1024 sc1
    v_mfma_f32_16x16x32_bf16 v[136:139], v[172:175], v[204:207], v[136:139]
    ds_read_b128 v[172:175], v1 offset:21504
    s_waitcnt lgkmcnt(4)
    v_mfma_f32_16x16x32_bf16 v[100:103], v[176:179], v[200:203], v[100:103]
    v_mfma_f32_16x16x32_bf16 v[140:143], v[176:179], v[204:207], v[140:143]
    ds_read_b128 v[176:179], v1 offset:22528
    buffer_load_dwordx4 v[192:195], v1, s[32:35], s93 offen offset:1024 sc1
    v_mfma_f32_16x16x32_bf16 v[104:107], v[180:183], v[200:203], v[104:107]
    buffer_load_dwordx4 a[12:15], v35, s[32:35], s90 offen offset:3072 sc1
    v_mfma_f32_16x16x32_bf16 v[144:147], v[180:183], v[204:207], v[144:147]
    ds_read_b128 v[180:183], v1 offset:23552
    s_waitcnt lgkmcnt(4)
    v_mfma_f32_16x16x32_bf16 v[108:111], v[160:163], v[200:203], v[108:111]
    buffer_load_dwordx4 v[196:199], v1, s[32:35], s98 offen offset:2048 sc1
    v_mfma_f32_16x16x32_bf16 v[148:151], v[160:163], v[204:207], v[148:151]
    ds_read_b128 v[160:163], v1 offset:24576
    v_mfma_f32_16x16x32_bf16 v[112:115], v[164:167], v[200:203], v[112:115]
    v_mfma_f32_16x16x32_bf16 v[152:155], v[164:167], v[204:207], v[152:155]
    ds_read_b128 v[164:167], v1 offset:25600
    s_waitcnt lgkmcnt(4)
    v_mfma_f32_16x16x32_bf16 v[116:119], v[168:171], v[200:203], v[116:119]
    buffer_load_dwordx4 v[200:203], v1, s[32:35], s93 offen offset:2048 sc1
    s_add_u32 s90, s90, 4096
    buffer_load_dwordx4 a[16:19], v35, s[32:35], s90 offen offset:0 sc1
    v_mfma_f32_16x16x32_bf16 v[156:159], v[168:171], v[204:207], v[156:159]
    ds_read_b128 v[168:171], v1 offset:26624
    buffer_load_dwordx4 v[204:207], v1, s[32:35], s98 offen offset:3072 sc1
    s_waitcnt vmcnt(21)
    v_mfma_f32_16x16x32_bf16 v[92:95], v[172:175], v[208:211], v[92:95]
    s_add_u32 s69, s88, 524288
    s_waitcnt vmcnt(20)
    v_mfma_f32_16x16x32_bf16 v[132:135], v[172:175], v[212:215], v[132:135]
    ds_read_b128 v[172:175], v1 offset:27648
    s_waitcnt lgkmcnt(4)
    v_mfma_f32_16x16x32_bf16 v[96:99], v[176:179], v[208:211], v[96:99]
    buffer_load_dwordx3 v[76:78], v1, s[32:35], s69 offen offset:0 sc1
    buffer_load_dwordx3 v[80:82], v1, s[32:35], s69 offen offset:1024 sc1
    v_mfma_f32_16x16x32_bf16 v[136:139], v[176:179], v[212:215], v[136:139]
    ds_read_b128 v[176:179], v1 offset:28672
    buffer_load_dwordx3 v[84:86], v1, s[32:35], s69 offen offset:2048 sc1
    v_mfma_f32_16x16x32_bf16 v[100:103], v[180:183], v[208:211], v[100:103]
    buffer_load_dwordx4 a[20:23], v35, s[32:35], s90 offen offset:1024 sc1
    buffer_load_dwordx3 v[88:90], v1, s[32:35], s69 offen offset:3072 sc1
    v_mfma_f32_16x16x32_bf16 v[140:143], v[180:183], v[212:215], v[140:143]
    ds_read_b128 v[180:183], v1 offset:29696
    s_waitcnt lgkmcnt(4)
    v_mfma_f32_16x16x32_bf16 v[104:107], v[160:163], v[208:211], v[104:107]
    v_mfma_f32_16x16x32_bf16 v[144:147], v[160:163], v[212:215], v[144:147]
    ds_read_b128 v[160:163], v1 offset:30720
    v_mfma_f32_16x16x32_bf16 v[108:111], v[164:167], v[208:211], v[108:111]
    v_mfma_f32_16x16x32_bf16 v[148:151], v[164:167], v[212:215], v[148:151]
    ds_read_b128 v[164:167], v1 offset:31744
    s_waitcnt lgkmcnt(4)
    v_mfma_f32_16x16x32_bf16 v[112:115], v[168:171], v[208:211], v[112:115]
    buffer_load_dwordx4 a[24:27], v35, s[32:35], s90 offen offset:2048 sc1
    v_mfma_f32_16x16x32_bf16 v[152:155], v[168:171], v[212:215], v[152:155]
    ds_read_b128 v[168:171], v1 offset:32768
    v_mfma_f32_16x16x32_bf16 v[116:119], v[172:175], v[208:211], v[116:119]
    buffer_load_dwordx4 v[208:211], v1, s[32:35], s93 offen offset:3072 sc1
    v_mfma_f32_16x16x32_bf16 v[156:159], v[172:175], v[212:215], v[156:159]
    ds_read_b128 v[172:175], v1 offset:33792
    s_waitcnt lgkmcnt(4)
    s_add_u32 s98, s98, 4096
    buffer_load_dwordx4 v[212:215], v1, s[32:35], s98 offen offset:0 sc1
    s_waitcnt vmcnt(27)
    v_mfma_f32_16x16x32_bf16 v[92:95], v[176:179], v[216:219], v[92:95]
    s_waitcnt vmcnt(26)
    v_mfma_f32_16x16x32_bf16 v[132:135], v[176:179], v[220:223], v[132:135]
    ds_read_b128 v[176:179], v1 offset:34816
    v_mfma_f32_16x16x32_bf16 v[96:99], v[180:183], v[216:219], v[96:99]
    buffer_load_dwordx4 a[28:31], v35, s[32:35], s90 offen offset:3072 sc1
    v_mfma_f32_16x16x32_bf16 v[136:139], v[180:183], v[220:223], v[136:139]
    ds_read_b128 v[180:183], v1 offset:35840
    s_waitcnt lgkmcnt(4)
    v_mfma_f32_16x16x32_bf16 v[100:103], v[160:163], v[216:219], v[100:103]
    v_mfma_f32_16x16x32_bf16 v[140:143], v[160:163], v[220:223], v[140:143]
    ds_read_b128 v[160:163], v1 offset:36864
    v_mfma_f32_16x16x32_bf16 v[104:107], v[164:167], v[216:219], v[104:107]
    v_mfma_f32_16x16x32_bf16 v[144:147], v[164:167], v[220:223], v[144:147]
    ds_read_b128 v[164:167], v1 offset:37888
    s_waitcnt lgkmcnt(4)
    v_mfma_f32_16x16x32_bf16 v[108:111], v[168:171], v[216:219], v[108:111]
    s_add_u32 s90, s90, 4096
    buffer_load_dwordx4 a[32:35], v35, s[32:35], s90 offen offset:0 sc1
    v_mfma_f32_16x16x32_bf16 v[148:151], v[168:171], v[220:223], v[148:151]
    ds_read_b128 v[168:171], v1 offset:38912
    v_mfma_f32_16x16x32_bf16 v[112:115], v[172:175], v[216:219], v[112:115]
    v_mfma_f32_16x16x32_bf16 v[152:155], v[172:175], v[220:223], v[152:155]
    ds_read_b128 v[172:175], v1 offset:39936
    s_waitcnt lgkmcnt(4)
    v_mfma_f32_16x16x32_bf16 v[116:119], v[176:179], v[216:219], v[116:119]
    s_add_u32 s93, s93, 4096
    buffer_load_dwordx4 v[216:219], v1, s[32:35], s93 offen offset:0 sc1
    v_mfma_f32_16x16x32_bf16 v[156:159], v[176:179], v[220:223], v[156:159]
    ds_read_b128 v[176:179], v1 offset:40960
    buffer_load_dwordx4 v[220:223], v1, s[32:35], s98 offen offset:1024 sc1
    s_waitcnt vmcnt(29)
    v_mfma_f32_16x16x32_bf16 v[92:95], v[180:183], v[224:227], v[92:95]
    buffer_load_dwordx4 a[36:39], v35, s[32:35], s90 offen offset:1024 sc1
    s_waitcnt vmcnt(29)
    v_mfma_f32_16x16x32_bf16 v[132:135], v[180:183], v[228:231], v[132:135]
    ds_read_b128 v[180:183], v1 offset:41984
    s_waitcnt lgkmcnt(4)
    v_mfma_f32_16x16x32_bf16 v[96:99], v[160:163], v[224:227], v[96:99]
    v_mfma_f32_16x16x32_bf16 v[136:139], v[160:163], v[228:231], v[136:139]
    ds_read_b128 v[160:163], v1 offset:43008
    v_mfma_f32_16x16x32_bf16 v[100:103], v[164:167], v[224:227], v[100:103]
    v_mfma_f32_16x16x32_bf16 v[140:143], v[164:167], v[228:231], v[140:143]
    ds_read_b128 v[164:167], v1 offset:44032
    s_waitcnt lgkmcnt(4)
    v_mfma_f32_16x16x32_bf16 v[104:107], v[168:171], v[224:227], v[104:107]
    buffer_load_dwordx4 a[40:43], v35, s[32:35], s90 offen offset:2048 sc1
    v_mfma_f32_16x16x32_bf16 v[144:147], v[168:171], v[228:231], v[144:147]
    ds_read_b128 v[168:171], v1 offset:45056
    v_mfma_f32_16x16x32_bf16 v[108:111], v[172:175], v[224:227], v[108:111]
    v_mfma_f32_16x16x32_bf16 v[148:151], v[172:175], v[228:231], v[148:151]
    ds_read_b128 v[172:175], v1 offset:46080
    s_waitcnt lgkmcnt(4)
    v_mfma_f32_16x16x32_bf16 v[112:115], v[176:179], v[224:227], v[112:115]
    s_waitcnt vmcnt(12)
    v_xor_b32 v78, v78, v82
    s_waitcnt vmcnt(9)
    v_xor_b32 v86, v86, v90
    v_xor_b32 v82, v82, v90
    v_xor_b32 v90, s59, v90
    v_or3_b32 v78, v78, v82, v86
    v_or_b32 v78, v78, v90
    v_cmp_ne_u32 vcc, 0, v78
    s_cbranch_vccnz SPIN_181
BACK_182:
    v_mfma_f32_16x16x32_bf16 v[152:155], v[176:179], v[228:231], v[152:155]
    ds_read_b128 v[176:179], v1 offset:47104
    v_mfma_f32_16x16x32_bf16 v[116:119], v[180:183], v[224:227], v[116:119]
    buffer_load_dwordx4 v[224:227], v1, s[32:35], s93 offen offset:1024 sc1
    buffer_load_dwordx4 a[44:47], v35, s[32:35], s90 offen offset:3072 sc1
    v_mfma_f32_16x16x32_bf16 v[156:159], v[180:183], v[228:231], v[156:159]
    ds_read_b128 v[180:183], v1 offset:48128
    s_waitcnt lgkmcnt(4)
    buffer_load_dwordx4 v[228:231], v1, s[32:35], s98 offen offset:2048 sc1
    v_mfma_f32_16x16x32_bf16 v[92:95], v[160:163], v[56:59], v[92:95]
    v_mfma_f32_16x16x32_bf16 v[132:135], v[160:163], v[60:63], v[132:135]
    ds_read_b128 v[160:163], v1 offset:49152
    v_mfma_f32_16x16x32_bf16 v[96:99], v[164:167], v[56:59], v[96:99]
    v_mfma_f32_16x16x32_bf16 v[136:139], v[164:167], v[60:63], v[136:139]
    ds_read_b128 v[164:167], v1 offset:50176
    s_waitcnt lgkmcnt(4)
    v_mfma_f32_16x16x32_bf16 v[100:103], v[168:171], v[56:59], v[100:103]
    s_add_u32 s90, s90, 4096
    buffer_load_dwordx4 a[48:51], v35, s[32:35], s90 offen offset:0 sc1
    v_mfma_f32_16x16x32_bf16 v[140:143], v[168:171], v[60:63], v[140:143]
    ds_read_b128 v[168:171], v1 offset:51200
    v_mfma_f32_16x16x32_bf16 v[104:107], v[172:175], v[56:59], v[104:107]
    v_add_f32 v76, v76, v80
    v_add_f32 v77, v77, v81
    v_mfma_f32_16x16x32_bf16 v[144:147], v[172:175], v[60:63], v[144:147]
    ds_read_b128 v[172:175], v1 offset:52224
    s_waitcnt lgkmcnt(4)
    v_mfma_f32_16x16x32_bf16 v[108:111], v[176:179], v[56:59], v[108:111]
    v_add_f32 v84, v84, v88
    v_add_f32 v85, v85, v89
    v_mfma_f32_16x16x32_bf16 v[148:151], v[176:179], v[60:63], v[148:151]
    ds_read_b128 v[176:179], v1 offset:53248
    v_add_f32 v76, v76, v84
    v_mfma_f32_16x16x32_bf16 v[112:115], v[180:183], v[56:59], v[112:115]
    buffer_load_dwordx4 a[52:55], v35, s[32:35], s90 offen offset:1024 sc1
    v_add_f32 v77, v77, v85
    v_mfma_f32_16x16x32_bf16 v[152:155], v[180:183], v[60:63], v[152:155]
    ds_read_b128 v[180:183], v1 offset:54272
    s_waitcnt lgkmcnt(4)
    v_mfma_f32_16x16x32_bf16 v[116:119], v[160:163], v[56:59], v[116:119]
    buffer_load_dwordx4 v[56:59], v1, s[32:35], s93 offen offset:2048 sc1
    v_permlane16_swap_b32 v76, v77
    v_mfma_f32_16x16x32_bf16 v[156:159], v[160:163], v[60:63], v[156:159]
    ds_read_b128 v[160:163], v1 offset:55296
    buffer_load_dwordx4 v[60:63], v1, s[32:35], s98 offen offset:3072 sc1
    v_mfma_f32_16x16x32_bf16 v[92:95], v[164:167], v[64:67], v[92:95]
    v_add_f32 v76, v76, v77
    v_mov_b32 v77, v76
    v_mfma_f32_16x16x32_bf16 v[132:135], v[164:167], v[68:71], v[132:135]
    ds_read_b128 v[164:167], v1 offset:56320
    s_waitcnt lgkmcnt(4)
    v_mfma_f32_16x16x32_bf16 v[96:99], v[168:171], v[64:67], v[96:99]
    buffer_load_dwordx4 a[56:59], v35, s[32:35], s90 offen offset:2048 sc1
    v_permlane32_swap_b32 v76, v77
    v_mfma_f32_16x16x32_bf16 v[136:139], v[168:171], v[68:71], v[136:139]
    ds_read_b128 v[168:171], v28 offset:0
    v_add_f32 v76, v76, v77
    v_mfma_f32_16x16x32_bf16 v[100:103], v[172:175], v[64:67], v[100:103]
    v_mul_f32 v80, 0x3acccccd, v76
    v_mul_f32 v81, 0x3acccccd, v76
    v_mfma_f32_16x16x32_bf16 v[140:143], v[172:175], v[68:71], v[140:143]
    ds_read_b128 v[172:175], v28 offset:1024
    s_waitcnt lgkmcnt(4)
    v_mfma_f32_16x16x32_bf16 v[104:107], v[176:179], v[64:67], v[104:107]
    v_permlane16_swap_b32 v80, v81
    v_fma_f32 v81, -v80, v80, v81
    v_mfma_f32_16x16x32_bf16 v[144:147], v[176:179], v[68:71], v[144:147]
    ds_read_b128 v[176:179], v28 offset:2048
    v_max_f32 v81, 0, v81
    v_mfma_f32_16x16x32_bf16 v[108:111], v[180:183], v[64:67], v[108:111]
    buffer_load_dwordx4 a[60:63], v35, s[32:35], s90 offen offset:3072 sc1
    v_cvt_pk_bf16_f32 v81, v81, v80
    v_mfma_f32_16x16x32_bf16 v[148:151], v[180:183], v[68:71], v[148:151]
    ds_read_b128 v[180:183], v28 offset:3072
    s_waitcnt lgkmcnt(4)
    v_mfma_f32_16x16x32_bf16 v[112:115], v[160:163], v[64:67], v[112:115]
    v_and_b32 v80, 0xffff0000, v81
    v_lshlrev_b32 v81, 16, v81
    v_mfma_f32_16x16x32_bf16 v[152:155], v[160:163], v[68:71], v[152:155]
    ds_read_b128 v[160:163], v28 offset:4096
    v_add_f32 v81, 0x3727c5ac, v81
    v_mfma_f32_16x16x32_bf16 v[116:119], v[164:167], v[64:67], v[116:119]
    buffer_load_dwordx4 v[64:67], v1, s[32:35], s93 offen offset:3072 sc1
    v_cvt_pk_bf16_f32 v81, v81, v81
    v_mfma_f32_16x16x32_bf16 v[156:159], v[164:167], v[68:71], v[156:159]
    ds_read_b128 v[164:167], v28 offset:5120
    s_waitcnt lgkmcnt(4)
    s_add_u32 s98, s98, 4096
    buffer_load_dwordx4 v[68:71], v1, s[32:35], s98 offen offset:0 sc1
    v_mfma_f32_16x16x32_bf16 v[92:95], v[168:171], v[72:75], v[92:95]
    s_add_u32 s90, s90, 4096
    buffer_load_dwordx4 a[64:67], v35, s[32:35], s90 offen offset:0 sc1
    v_mfma_f32_16x16x32_bf16 v[132:135], v[168:171], v[184:187], v[132:135]
    ds_read_b128 v[168:171], v28 offset:6144
    v_mfma_f32_16x16x32_bf16 v[96:99], v[172:175], v[72:75], v[96:99]
    v_lshlrev_b32 v81, 16, v81
    v_mfma_f32_16x16x32_bf16 v[136:139], v[172:175], v[184:187], v[136:139]
    ds_read_b128 v[172:175], v28 offset:7168
    s_waitcnt lgkmcnt(4)
    v_mfma_f32_16x16x32_bf16 v[100:103], v[176:179], v[72:75], v[100:103]
    v_sqrt_f32 v81, v81
    v_mfma_f32_16x16x32_bf16 v[140:143], v[176:179], v[184:187], v[140:143]
    ds_read_b128 v[176:179], v28 offset:8192
    v_cvt_pk_bf16_f32 v81, v81, v81
    v_mfma_f32_16x16x32_bf16 v[104:107], v[180:183], v[72:75], v[104:107]
    buffer_load_dwordx4 a[68:71], v35, s[32:35], s90 offen offset:1024 sc1
    v_lshlrev_b32 v81, 16, v81
    v_mfma_f32_16x16x32_bf16 v[144:147], v[180:183], v[184:187], v[144:147]
    ds_read_b128 v[180:183], v28 offset:9216
    s_waitcnt lgkmcnt(4)
    v_mfma_f32_16x16x32_bf16 v[108:111], v[160:163], v[72:75], v[108:111]
    v_rcp_f32 v82, v81
    v_mfma_f32_16x16x32_bf16 v[148:151], v[160:163], v[184:187], v[148:151]
    ds_read_b128 v[160:163], v28 offset:10240
    v_xor_b32 v80, 0x80000000, v80
    v_mfma_f32_16x16x32_bf16 v[112:115], v[164:167], v[72:75], v[112:115]
    v_lshrrev_b32 v83, 16, v80
    v_or_b32 v80, v80, v83
    v_mfma_f32_16x16x32_bf16 v[152:155], v[164:167], v[184:187], v[152:155]
    ds_read_b128 v[164:167], v28 offset:11264
    s_waitcnt lgkmcnt(4)
    v_mfma_f32_16x16x32_bf16 v[116:119], v[168:171], v[72:75], v[116:119]
    s_add_u32 s93, s93, 4096
    buffer_load_dwordx4 v[72:75], v1, s[32:35], s93 offen offset:0 sc1
    buffer_load_dwordx4 a[72:75], v35, s[32:35], s90 offen offset:2048 sc1
    v_mfma_f32_16x16x32_bf16 v[156:159], v[168:171], v[184:187], v[156:159]
    ds_read_b128 v[168:171], v28 offset:12288
    buffer_load_dwordx4 v[184:187], v1, s[32:35], s98 offen offset:1024 sc1
    v_mfma_f32_16x16x32_bf16 v[92:95], v[172:175], v[188:191], v[92:95]
    v_or_b32 v81, v81, v83
    v_mfma_f32_16x16x32_bf16 v[132:135], v[172:175], v[192:195], v[132:135]
    ds_read_b128 v[172:175], v28 offset:13312
    s_waitcnt lgkmcnt(4)
    v_mfma_f32_16x16x32_bf16 v[96:99], v[176:179], v[188:191], v[96:99]
    v_mul_f32 v54, 0x3fb8aa3b, v82
    v_cndmask_b32 v50, 0, v80, s[100:101]
    v_mfma_f32_16x16x32_bf16 v[136:139], v[176:179], v[192:195], v[136:139]
    ds_read_b128 v[176:179], v28 offset:14336
    v_cndmask_b32 v51, 0, v81, s[100:101]
    v_mfma_f32_16x16x32_bf16 v[100:103], v[180:183], v[188:191], v[100:103]
    buffer_load_dwordx4 a[76:79], v35, s[32:35], s90 offen offset:3072 sc1
    s_add_u32 s69, s88, 532480
    v_mfma_f32_16x16x32_bf16 v[140:143], v[180:183], v[192:195], v[140:143]
    ds_read_b128 v[180:183], v28 offset:15360
    s_waitcnt lgkmcnt(4)
    v_mfma_f32_16x16x32_bf16 v[104:107], v[160:163], v[188:191], v[104:107]
    buffer_load_dwordx3 v[76:78], v1, s[32:35], s69 offen offset:0 sc1
    buffer_load_dwordx3 v[80:82], v1, s[32:35], s69 offen offset:1024 sc1
    v_mfma_f32_16x16x32_bf16 v[144:147], v[160:163], v[192:195], v[144:147]
    ds_read_b128 v[160:163], v28 offset:16384
    buffer_load_dwordx3 v[84:86], v1, s[32:35], s69 offen offset:2048 sc1
    v_mfma_f32_16x16x32_bf16 v[108:111], v[164:167], v[188:191], v[108:111]
    buffer_load_dwordx3 v[88:90], v1, s[32:35], s69 offen offset:3072 sc1
    v_mfma_f32_16x16x32_bf16 v[148:151], v[164:167], v[192:195], v[148:151]
    ds_read_b128 v[164:167], v28 offset:17408
    s_waitcnt lgkmcnt(4)
    v_mfma_f32_16x16x32_bf16 v[112:115], v[168:171], v[188:191], v[112:115]
    s_add_u32 s90, s90, 4096
    buffer_load_dwordx4 a[80:83], v35, s[32:35], s90 offen offset:0 sc1
    v_mfma_f32_16x16x32_bf16 v[152:155], v[168:171], v[192:195], v[152:155]
    ds_read_b128 v[168:171], v28 offset:18432
    v_mfma_f32_16x16x32_bf16 v[116:119], v[172:175], v[188:191], v[116:119]
    buffer_load_dwordx4 v[188:191], v1, s[32:35], s93 offen offset:1024 sc1
    v_mfma_f32_16x16x32_bf16 v[156:159], v[172:175], v[192:195], v[156:159]
    ds_read_b128 v[172:175], v28 offset:19456
    s_waitcnt lgkmcnt(4)
    buffer_load_dwordx4 v[192:195], v1, s[32:35], s98 offen offset:2048 sc1
    v_mfma_f32_16x16x32_bf16 v[92:95], v[176:179], v[196:199], v[92:95]
    v_mfma_f32_16x16x32_bf16 v[132:135], v[176:179], v[200:203], v[132:135]
    ds_read_b128 v[176:179], v28 offset:20480
    v_mfma_f32_16x16x32_bf16 v[96:99], v[180:183], v[196:199], v[96:99]
    buffer_load_dwordx4 a[84:87], v35, s[32:35], s90 offen offset:1024 sc1
    v_mfma_f32_16x16x32_bf16 v[136:139], v[180:183], v[200:203], v[136:139]
    ds_read_b128 v[180:183], v28 offset:21504
    s_waitcnt lgkmcnt(4)
    v_mfma_f32_16x16x32_bf16 v[100:103], v[160:163], v[196:199], v[100:103]
    v_mfma_f32_16x16x32_bf16 v[140:143], v[160:163], v[200:203], v[140:143]
    ds_read_b128 v[160:163], v28 offset:22528
    v_mfma_f32_16x16x32_bf16 v[104:107], v[164:167], v[196:199], v[104:107]
    v_mfma_f32_16x16x32_bf16 v[144:147], v[164:167], v[200:203], v[144:147]
    ds_read_b128 v[164:167], v28 offset:23552
    s_waitcnt lgkmcnt(4)
    v_mfma_f32_16x16x32_bf16 v[108:111], v[168:171], v[196:199], v[108:111]
    buffer_load_dwordx4 a[88:91], v35, s[32:35], s90 offen offset:2048 sc1
    v_mfma_f32_16x16x32_bf16 v[148:151], v[168:171], v[200:203], v[148:151]
    ds_read_b128 v[168:171], v28 offset:24576
    v_mfma_f32_16x16x32_bf16 v[112:115], v[172:175], v[196:199], v[112:115]
    v_mfma_f32_16x16x32_bf16 v[152:155], v[172:175], v[200:203], v[152:155]
    ds_read_b128 v[172:175], v28 offset:25600
    s_waitcnt lgkmcnt(4)
    v_mfma_f32_16x16x32_bf16 v[116:119], v[176:179], v[196:199], v[116:119]
    buffer_load_dwordx4 v[196:199], v1, s[32:35], s93 offen offset:2048 sc1
    v_mfma_f32_16x16x32_bf16 v[156:159], v[176:179], v[200:203], v[156:159]
    ds_read_b128 v[176:179], v28 offset:26624
    buffer_load_dwordx4 v[200:203], v1, s[32:35], s98 offen offset:3072 sc1
    v_mfma_f32_16x16x32_bf16 v[92:95], v[180:183], v[204:207], v[92:95]
    buffer_load_dwordx4 a[92:95], v35, s[32:35], s90 offen offset:3072 sc1
    s_waitcnt vmcnt(36)
    v_mfma_f32_16x16x32_bf16 v[132:135], v[180:183], v[208:211], v[132:135]
    ds_read_b128 v[180:183], v28 offset:27648
    s_waitcnt lgkmcnt(4)
    v_mfma_f32_16x16x32_bf16 v[96:99], v[160:163], v[204:207], v[96:99]
    v_mfma_f32_16x16x32_bf16 v[136:139], v[160:163], v[208:211], v[136:139]
    ds_read_b128 v[160:163], v28 offset:28672
    v_mfma_f32_16x16x32_bf16 v[100:103], v[164:167], v[204:207], v[100:103]
    v_mfma_f32_16x16x32_bf16 v[140:143], v[164:167], v[208:211], v[140:143]
    ds_read_b128 v[164:167], v28 offset:29696
    s_waitcnt lgkmcnt(4)
    v_mfma_f32_16x16x32_bf16 v[104:107], v[168:171], v[204:207], v[104:107]
    s_add_u32 s90, s90, 4096
    buffer_load_dwordx4 a[96:99], v35, s[32:35], s90 offen offset:0 sc1
    v_mfma_f32_16x16x32_bf16 v[144:147], v[168:171], v[208:211], v[144:147]
    ds_read_b128 v[168:171], v28 offset:30720
    v_mfma_f32_16x16x32_bf16 v[108:111], v[172:175], v[204:207], v[108:111]
    v_mfma_f32_16x16x32_bf16 v[148:151], v[172:175], v[208:211], v[148:151]
    ds_read_b128 v[172:175], v28 offset:31744
    s_waitcnt lgkmcnt(4)
    v_mfma_f32_16x16x32_bf16 v[112:115], v[176:179], v[204:207], v[112:115]
    v_mfma_f32_16x16x32_bf16 v[152:155], v[176:179], v[208:211], v[152:155]
    ds_read_b128 v[176:179], v28 offset:32768
    s_waitcnt vmcnt(11)
    v_xor_b32 v78, v78, v82
    s_waitcnt vmcnt(9)
    v_xor_b32 v86, v86, v90
    v_xor_b32 v82, v82, v90
    v_xor_b32 v90, s59, v90
    v_or3_b32 v78, v78, v82, v86
    v_or_b32 v78, v78, v90
    v_cmp_ne_u32 vcc, 0, v78
    s_cbranch_vccnz SPIN_183
BACK_184:
    v_mfma_f32_16x16x32_bf16 v[116:119], v[180:183], v[204:207], v[116:119]
    buffer_load_dwordx4 v[204:207], v1, s[32:35], s93 offen offset:3072 sc1
    buffer_load_dwordx4 a[100:103], v35, s[32:35], s90 offen offset:1024 sc1
    v_mfma_f32_16x16x32_bf16 v[156:159], v[180:183], v[208:211], v[156:159]
    ds_read_b128 v[180:183], v28 offset:33792
    s_waitcnt lgkmcnt(4)
    v_mfma_f32_16x16x32_bf16 v[92:95], v[160:163], v[212:215], v[92:95]
    v_mfma_f32_16x16x32_bf16 v[132:135], v[160:163], v[216:219], v[132:135]
    ds_read_b128 v[160:163], v28 offset:34816
    v_mfma_f32_16x16x32_bf16 v[96:99], v[164:167], v[212:215], v[96:99]
    v_mfma_f32_16x16x32_bf16 v[136:139], v[164:167], v[216:219], v[136:139]
    ds_read_b128 v[164:167], v28 offset:35840
    s_waitcnt lgkmcnt(4)
    v_mfma_f32_16x16x32_bf16 v[100:103], v[168:171], v[212:215], v[100:103]
    buffer_load_dwordx4 a[104:107], v35, s[32:35], s90 offen offset:2048 sc1
    v_mfma_f32_16x16x32_bf16 v[140:143], v[168:171], v[216:219], v[140:143]
    ds_read_b128 v[168:171], v28 offset:36864
    v_mfma_f32_16x16x32_bf16 v[104:107], v[172:175], v[212:215], v[104:107]
    v_add_f32 v76, v76, v80
    v_add_f32 v77, v77, v81
    v_mfma_f32_16x16x32_bf16 v[144:147], v[172:175], v[216:219], v[144:147]
    ds_read_b128 v[172:175], v28 offset:37888
    s_waitcnt lgkmcnt(4)
    v_mfma_f32_16x16x32_bf16 v[108:111], v[176:179], v[212:215], v[108:111]
    v_add_f32 v84, v84, v88
    v_add_f32 v85, v85, v89
    v_mfma_f32_16x16x32_bf16 v[148:151], v[176:179], v[216:219], v[148:151]
    ds_read_b128 v[176:179], v28 offset:38912
    v_add_f32 v76, v76, v84
    v_mfma_f32_16x16x32_bf16 v[112:115], v[180:183], v[212:215], v[112:115]
    buffer_load_dwordx4 a[108:111], v35, s[32:35], s90 offen offset:3072 sc1
    v_add_f32 v77, v77, v85
    v_mfma_f32_16x16x32_bf16 v[152:155], v[180:183], v[216:219], v[152:155]
    ds_read_b128 v[180:183], v28 offset:39936
    s_waitcnt lgkmcnt(4)
    v_mfma_f32_16x16x32_bf16 v[116:119], v[160:163], v[212:215], v[116:119]
    v_permlane16_swap_b32 v76, v77
    v_add_f32 v76, v76, v77
    v_mfma_f32_16x16x32_bf16 v[156:159], v[160:163], v[216:219], v[156:159]
    ds_read_b128 v[160:163], v28 offset:40960
    v_mov_b32 v77, v76
    v_mfma_f32_16x16x32_bf16 v[92:95], v[164:167], v[220:223], v[92:95]
    s_nop 0
    v_permlane32_swap_b32 v76, v77
    v_add_f32 v76, v76, v77
    v_mfma_f32_16x16x32_bf16 v[132:135], v[164:167], v[224:227], v[132:135]
    ds_read_b128 v[164:167], v28 offset:41984
    s_waitcnt lgkmcnt(4)
    v_mfma_f32_16x16x32_bf16 v[96:99], v[168:171], v[220:223], v[96:99]
    s_add_u32 s90, s90, 4096
    buffer_load_dwordx4 a[112:115], v35, s[32:35], s90 offen offset:0 sc1
    v_mfma_f32_16x16x32_bf16 v[136:139], v[168:171], v[224:227], v[136:139]
    ds_read_b128 v[168:171], v28 offset:43008
    v_mul_f32 v80, 0x3acccccd, v76
    v_mfma_f32_16x16x32_bf16 v[100:103], v[172:175], v[220:223], v[100:103]
    v_mul_f32 v81, 0x3acccccd, v76
    s_nop 1
    v_permlane16_swap_b32 v80, v81
    v_mfma_f32_16x16x32_bf16 v[140:143], v[172:175], v[224:227], v[140:143]
    ds_read_b128 v[172:175], v28 offset:44032
    s_waitcnt lgkmcnt(4)
    v_mfma_f32_16x16x32_bf16 v[104:107], v[176:179], v[220:223], v[104:107]
    v_fma_f32 v81, -v80, v80, v81
    v_max_f32 v81, 0, v81
    v_mfma_f32_16x16x32_bf16 v[144:147], v[176:179], v[224:227], v[144:147]
    ds_read_b128 v[176:179], v28 offset:45056
    v_cvt_pk_bf16_f32 v81, v81, v80
    v_mfma_f32_16x16x32_bf16 v[108:111], v[180:183], v[220:223], v[108:111]
    buffer_load_dwordx4 a[116:119], v35, s[32:35], s90 offen offset:1024 sc1
    v_and_b32 v80, 0xffff0000, v81
    v_mfma_f32_16x16x32_bf16 v[148:151], v[180:183], v[224:227], v[148:151]
    ds_read_b128 v[180:183], v28 offset:46080
    s_waitcnt lgkmcnt(4)
    v_mfma_f32_16x16x32_bf16 v[112:115], v[160:163], v[220:223], v[112:115]
    v_lshlrev_b32 v81, 16, v81
    v_add_f32 v81, 0x3727c5ac, v81
    v_mfma_f32_16x16x32_bf16 v[152:155], v[160:163], v[224:227], v[152:155]
    ds_read_b128 v[160:163], v28 offset:47104
    v_cvt_pk_bf16_f32 v81, v81, v81
    v_mfma_f32_16x16x32_bf16 v[116:119], v[164:167], v[220:223], v[116:119]
    v_lshlrev_b32 v81, 16, v81
    v_sqrt_f32 v81, v81
    v_mfma_f32_16x16x32_bf16 v[156:159], v[164:167], v[224:227], v[156:159]
    ds_read_b128 v[164:167], v28 offset:48128
    s_waitcnt lgkmcnt(4)
    v_mfma_f32_16x16x32_bf16 v[92:95], v[168:171], v[228:231], v[92:95]
    buffer_load_dwordx4 a[120:123], v35, s[32:35], s90 offen offset:2048 sc1
    v_mfma_f32_16x16x32_bf16 v[132:135], v[168:171], v[56:59], v[132:135]
    ds_read_b128 v[168:171], v28 offset:49152
    v_cvt_pk_bf16_f32 v81, v81, v81
    v_mfma_f32_16x16x32_bf16 v[96:99], v[172:175], v[228:231], v[96:99]
    v_lshlrev_b32 v81, 16, v81
    v_rcp_f32 v82, v81
    v_mfma_f32_16x16x32_bf16 v[136:139], v[172:175], v[56:59], v[136:139]
    ds_read_b128 v[172:175], v28 offset:50176
    s_waitcnt lgkmcnt(4)
    v_mfma_f32_16x16x32_bf16 v[100:103], v[176:179], v[228:231], v[100:103]
    v_xor_b32 v80, 0x80000000, v80
    v_mfma_f32_16x16x32_bf16 v[140:143], v[176:179], v[56:59], v[140:143]
    ds_read_b128 v[176:179], v28 offset:51200
    v_lshrrev_b32 v83, 16, v80
    v_mfma_f32_16x16x32_bf16 v[104:107], v[180:183], v[228:231], v[104:107]
    buffer_load_dwordx4 a[124:127], v35, s[32:35], s90 offen offset:3072 sc1
    v_or_b32 v80, v80, v83
    v_mfma_f32_16x16x32_bf16 v[144:147], v[180:183], v[56:59], v[144:147]
    ds_read_b128 v[180:183], v28 offset:52224
    s_waitcnt lgkmcnt(4)
    v_mfma_f32_16x16x32_bf16 v[108:111], v[160:163], v[228:231], v[108:111]
    v_or_b32 v81, v81, v83
    v_mul_f32 v55, 0x3fb8aa3b, v82
    v_mfma_f32_16x16x32_bf16 v[148:151], v[160:163], v[56:59], v[148:151]
    ds_read_b128 v[160:163], v28 offset:53248
    v_cndmask_b32 v52, 0, v80, s[100:101]
    v_mfma_f32_16x16x32_bf16 v[112:115], v[164:167], v[228:231], v[112:115]
    v_cndmask_b32 v53, 0, v81, s[100:101]
    s_mul_i32 s64, s58, 896
    v_mfma_f32_16x16x32_bf16 v[152:155], v[164:167], v[56:59], v[152:155]
    ds_read_b128 v[164:167], v28 offset:54272
    s_waitcnt lgkmcnt(4)
    v_mfma_f32_16x16x32_bf16 v[116:119], v[168:171], v[228:231], v[116:119]
    s_add_u32 s90, s90, 4096
    buffer_load_dwordx4 a[128:131], v35, s[32:35], s90 offen offset:0 sc1
    v_mfma_f32_16x16x32_bf16 v[156:159], v[168:171], v[56:59], v[156:159]
    ds_read_b128 v[168:171], v28 offset:55296
    s_add_u32 s64, s64, 49152
    v_mfma_f32_16x16x32_bf16 v[92:95], v[172:175], v[60:63], v[92:95]
    s_mul_i32 s65, s54, 5120
    s_add_u32 s65, s65, 143360
    v_mfma_f32_16x16x32_bf16 v[132:135], v[172:175], v[64:67], v[132:135]
    ds_read_b128 v[172:175], v28 offset:56320
    s_waitcnt lgkmcnt(4)
    v_mfma_f32_16x16x32_bf16 v[96:99], v[176:179], v[60:63], v[96:99]
    v_lshl_add_u32 v124, v2, 3, s65
    s_mov_b32 m0, s65
    s_mov_b32 exec_hi, 0xffffff
    buffer_load_dwordx4 v1, s[32:35], s64 offen sc1 lds
    s_mov_b64 exec, -1
    v_mfma_f32_16x16x32_bf16 v[136:139], v[176:179], v[64:67], v[136:139]
    ds_read_b128 v[176:179], v29 offset:0
    v_mfma_f32_16x16x32_bf16 v[100:103], v[180:183], v[60:63], v[100:103]
    buffer_load_dwordx4 a[132:135], v35, s[32:35], s90 offen offset:1024 sc1
    v_mfma_f32_16x16x32_bf16 v[140:143], v[180:183], v[64:67], v[140:143]
    ds_read_b128 v[180:183], v29 offset:1024
    s_waitcnt lgkmcnt(4)
    v_mfma_f32_16x16x32_bf16 v[104:107], v[160:163], v[60:63], v[104:107]
    v_mfma_f32_16x16x32_bf16 v[144:147], v[160:163], v[64:67], v[144:147]
    ds_read_b128 v[160:163], v29 offset:2048
    v_mfma_f32_16x16x32_bf16 v[108:111], v[164:167], v[60:63], v[108:111]
    v_mfma_f32_16x16x32_bf16 v[148:151], v[164:167], v[64:67], v[148:151]
    ds_read_b128 v[164:167], v29 offset:3072
    s_waitcnt lgkmcnt(4)
    v_mfma_f32_16x16x32_bf16 v[112:115], v[168:171], v[60:63], v[112:115]
    buffer_load_dwordx4 a[136:139], v35, s[32:35], s90 offen offset:2048 sc1
    v_mfma_f32_16x16x32_bf16 v[152:155], v[168:171], v[64:67], v[152:155]
    ds_read_b128 v[168:171], v29 offset:4096
    v_mfma_f32_16x16x32_bf16 v[116:119], v[172:175], v[60:63], v[116:119]
    v_mfma_f32_16x16x32_bf16 v[156:159], v[172:175], v[64:67], v[156:159]
    ds_read_b128 v[172:175], v29 offset:5120
    s_waitcnt lgkmcnt(4)
    v_mfma_f32_16x16x32_bf16 v[92:95], v[176:179], v[68:71], v[92:95]
    v_mfma_f32_16x16x32_bf16 v[132:135], v[176:179], v[72:75], v[132:135]
    ds_read_b128 v[176:179], v29 offset:6144
    v_mfma_f32_16x16x32_bf16 v[96:99], v[180:183], v[68:71], v[96:99]
    buffer_load_dwordx4 a[140:143], v35, s[32:35], s90 offen offset:3072 sc1
    v_mfma_f32_16x16x32_bf16 v[136:139], v[180:183], v[72:75], v[136:139]
    ds_read_b128 v[180:183], v29 offset:7168
    s_waitcnt lgkmcnt(4)
    v_mfma_f32_16x16x32_bf16 v[100:103], v[160:163], v[68:71], v[100:103]
    v_mfma_f32_16x16x32_bf16 v[140:143], v[160:163], v[72:75], v[140:143]
    ds_read_b128 v[160:163], v29 offset:8192
    v_mfma_f32_16x16x32_bf16 v[104:107], v[164:167], v[68:71], v[104:107]
    v_mfma_f32_16x16x32_bf16 v[144:147], v[164:167], v[72:75], v[144:147]
    ds_read_b128 v[164:167], v29 offset:9216
    s_waitcnt lgkmcnt(4)
    v_mfma_f32_16x16x32_bf16 v[108:111], v[168:171], v[68:71], v[108:111]
    s_add_u32 s90, s90, 4096
    buffer_load_dwordx4 a[144:147], v35, s[32:35], s90 offen offset:0 sc1
    v_mfma_f32_16x16x32_bf16 v[148:151], v[168:171], v[72:75], v[148:151]
    ds_read_b128 v[168:171], v29 offset:10240
    v_mfma_f32_16x16x32_bf16 v[112:115], v[172:175], v[68:71], v[112:115]
    v_mfma_f32_16x16x32_bf16 v[152:155], v[172:175], v[72:75], v[152:155]
    ds_read_b128 v[172:175], v29 offset:11264
    s_waitcnt lgkmcnt(4)
    v_mfma_f32_16x16x32_bf16 v[116:119], v[176:179], v[68:71], v[116:119]
    v_mfma_f32_16x16x32_bf16 v[156:159], v[176:179], v[72:75], v[156:159]
    ds_read_b128 v[176:179], v29 offset:12288
    v_mfma_f32_16x16x32_bf16 v[92:95], v[180:183], v[184:187], v[92:95]
    buffer_load_dwordx4 a[148:151], v35, s[32:35], s90 offen offset:1024 sc1
    s_waitcnt vmcnt(22)
    v_mfma_f32_16x16x32_bf16 v[132:135], v[180:183], v[188:191], v[132:135]
    ds_read_b128 v[180:183], v29 offset:13312
    s_waitcnt lgkmcnt(4)
    v_mfma_f32_16x16x32_bf16 v[96:99], v[160:163], v[184:187], v[96:99]
    v_mfma_f32_16x16x32_bf16 v[136:139], v[160:163], v[188:191], v[136:139]
    ds_read_b128 v[160:163], v29 offset:14336
    v_mfma_f32_16x16x32_bf16 v[100:103], v[164:167], v[184:187], v[100:103]
    v_mfma_f32_16x16x32_bf16 v[140:143], v[164:167], v[188:191], v[140:143]
    ds_read_b128 v[164:167], v29 offset:15360
    s_waitcnt lgkmcnt(4)
    v_mfma_f32_16x16x32_bf16 v[104:107], v[168:171], v[184:187], v[104:107]
    buffer_load_dwordx4 a[152:155], v35, s[32:35], s90 offen offset:2048 sc1
    v_mfma_f32_16x16x32_bf16 v[144:147], v[168:171], v[188:191], v[144:147]
    ds_read_b128 v[168:171], v29 offset:16384
    v_mfma_f32_16x16x32_bf16 v[108:111], v[172:175], v[184:187], v[108:111]
    v_mfma_f32_16x16x32_bf16 v[148:151], v[172:175], v[188:191], v[148:151]
    ds_read_b128 v[172:175], v29 offset:17408
    s_waitcnt lgkmcnt(4)
    v_mfma_f32_16x16x32_bf16 v[112:115], v[176:179], v[184:187], v[112:115]
    s_waitcnt vmcnt(6)
    ds_read_b64 v[36:37], v124 offset:0
    v_mfma_f32_16x16x32_bf16 v[152:155], v[176:179], v[188:191], v[152:155]
    ds_read_b128 v[176:179], v29 offset:18432
    ds_read_b64 v[38:39], v124 offset:128
    v_mfma_f32_16x16x32_bf16 v[116:119], v[180:183], v[184:187], v[116:119]
    buffer_load_dwordx4 a[156:159], v35, s[32:35], s90 offen offset:3072 sc1
    ds_read_b64 v[40:41], v124 offset:256
    v_mfma_f32_16x16x32_bf16 v[156:159], v[180:183], v[188:191], v[156:159]
    ds_read_b128 v[180:183], v29 offset:19456
    s_waitcnt lgkmcnt(7)
    v_mfma_f32_16x16x32_bf16 v[92:95], v[160:163], v[192:195], v[92:95]
    ds_read_b64 v[42:43], v124 offset:384
    ds_read_b64 v[44:45], v124 offset:512
    v_mfma_f32_16x16x32_bf16 v[132:135], v[160:163], v[196:199], v[132:135]
    ds_read_b128 v[160:163], v29 offset:20480
    ds_read_b64 v[46:47], v124 offset:640
    v_mfma_f32_16x16x32_bf16 v[96:99], v[164:167], v[192:195], v[96:99]
    ds_read_b64 v[48:49], v124 offset:768
    v_mfma_f32_16x16x32_bf16 v[136:139], v[164:167], v[196:199], v[136:139]
    ds_read_b128 v[164:167], v29 offset:21504
    s_waitcnt lgkmcnt(11)
    v_mfma_f32_16x16x32_bf16 v[100:103], v[168:171], v[192:195], v[100:103]
    s_add_u32 s90, s90, 4096
    buffer_load_dwordx4 a[160:163], v35, s[32:35], s90 offen offset:0 sc1
    v_mfma_f32_16x16x32_bf16 v[140:143], v[168:171], v[196:199], v[140:143]
    ds_read_b128 v[168:171], v29 offset:22528
    v_mfma_f32_16x16x32_bf16 v[104:107], v[172:175], v[192:195], v[104:107]
    v_mfma_f32_16x16x32_bf16 v[144:147], v[172:175], v[196:199], v[144:147]
    ds_read_b128 v[172:175], v29 offset:23552
    s_waitcnt lgkmcnt(8)
    v_mfma_f32_16x16x32_bf16 v[108:111], v[176:179], v[192:195], v[108:111]
    v_mfma_f32_16x16x32_bf16 v[148:151], v[176:179], v[196:199], v[148:151]
    ds_read_b128 v[176:179], v29 offset:24576
    v_mfma_f32_16x16x32_bf16 v[112:115], v[180:183], v[192:195], v[112:115]
    buffer_load_dwordx4 a[164:167], v35, s[32:35], s90 offen offset:1024 sc1
    v_mfma_f32_16x16x32_bf16 v[152:155], v[180:183], v[196:199], v[152:155]
    ds_read_b128 v[180:183], v29 offset:25600
    s_waitcnt lgkmcnt(4)
    v_mfma_f32_16x16x32_bf16 v[116:119], v[160:163], v[192:195], v[116:119]
    v_mfma_f32_16x16x32_bf16 v[156:159], v[160:163], v[196:199], v[156:159]
    ds_read_b128 v[160:163], v29 offset:26624
    v_mfma_f32_16x16x32_bf16 v[92:95], v[164:167], v[200:203], v[92:95]
    v_mfma_f32_16x16x32_bf16 v[132:135], v[164:167], v[204:207], v[132:135]
    ds_read_b128 v[164:167], v29 offset:27648
    s_waitcnt lgkmcnt(4)
    v_mfma_f32_16x16x32_bf16 v[96:99], v[168:171], v[200:203], v[96:99]
    buffer_load_dwordx4 a[168:171], v35, s[32:35], s90 offen offset:2048 sc1
    v_mfma_f32_16x16x32_bf16 v[136:139], v[168:171], v[204:207], v[136:139]
    v_mfma_f32_16x16x32_bf16 v[100:103], v[172:175], v[200:203], v[100:103]
    v_mfma_f32_16x16x32_bf16 v[140:143], v[172:175], v[204:207], v[140:143]
    s_waitcnt lgkmcnt(2)
    v_mfma_f32_16x16x32_bf16 v[104:107], v[176:179], v[200:203], v[104:107]
    v_mfma_f32_16x16x32_bf16 v[144:147], v[176:179], v[204:207], v[144:147]
    v_mfma_f32_16x16x32_bf16 v[108:111], v[180:183], v[200:203], v[108:111]
    buffer_load_dwordx4 a[172:175], v35, s[32:35], s90 offen offset:3072 sc1
    v_mfma_f32_16x16x32_bf16 v[148:151], v[180:183], v[204:207], v[148:151]
    s_waitcnt lgkmcnt(0)
    v_mfma_f32_16x16x32_bf16 v[112:115], v[160:163], v[200:203], v[112:115]
    v_mfma_f32_16x16x32_bf16 v[152:155], v[160:163], v[204:207], v[152:155]
    v_mfma_f32_16x16x32_bf16 v[116:119], v[164:167], v[200:203], v[116:119]
    v_mfma_f32_16x16x32_bf16 v[156:159], v[164:167], v[204:207], v[156:159]
    v_mfma_f32_16x16x16_bf16 v[92:95], v[36:37], v[52:53], v[92:95]
    v_mfma_f32_16x16x16_bf16 v[96:99], v[38:39], v[52:53], v[96:99]
    v_mfma_f32_16x16x16_bf16 v[100:103], v[40:41], v[52:53], v[100:103]
    v_mfma_f32_16x16x16_bf16 v[104:107], v[42:43], v[52:53], v[104:107]
    v_mfma_f32_16x16x16_bf16 v[108:111], v[44:45], v[52:53], v[108:111]
    v_mfma_f32_16x16x16_bf16 v[112:115], v[46:47], v[52:53], v[112:115]
    v_mfma_f32_16x16x16_bf16 v[116:119], v[48:49], v[52:53], v[116:119]
    v_mfma_f32_16x16x16_bf16 v[132:135], v[36:37], v[50:51], v[132:135]
    v_mfma_f32_16x16x16_bf16 v[136:139], v[38:39], v[50:51], v[136:139]
    v_mfma_f32_16x16x16_bf16 v[140:143], v[40:41], v[50:51], v[140:143]
    v_mfma_f32_16x16x16_bf16 v[144:147], v[42:43], v[50:51], v[144:147]
    v_mfma_f32_16x16x16_bf16 v[148:151], v[44:45], v[50:51], v[148:151]
    v_mfma_f32_16x16x16_bf16 v[152:155], v[46:47], v[50:51], v[152:155]
    v_mfma_f32_16x16x16_bf16 v[156:159], v[48:49], v[50:51], v[156:159]
    v_mov_b32 v208, 0x3f317218
    v_mov_b32 v210, 0xbfb17218
    s_add_u32 s64, s79, 0
    s_add_u32 s65, s80, 0
    v_pk_mul_f32 v[132:133], v[132:133], v[54:55] op_sel:[0,0] op_sel_hi:[1,0]
    v_pk_mul_f32 v[134:135], v[134:135], v[54:55] op_sel:[0,0] op_sel_hi:[1,0]
    v_pk_mul_f32 v[136:137], v[136:137], v[54:55] op_sel:[0,0] op_sel_hi:[1,0]
    v_pk_mul_f32 v[138:139], v[138:139], v[54:55] op_sel:[0,0] op_sel_hi:[1,0]
    v_exp_f32 v192, v132
    v_exp_f32 v193, v133
    v_exp_f32 v194, v134
    s_add_u32 s90, s90, 4096
    buffer_load_dwordx4 a[176:179], v35, s[32:35], s90 offen offset:0 sc1
    v_exp_f32 v195, v135
    v_exp_f32 v196, v136
    v_exp_f32 v197, v137
    v_exp_f32 v198, v138
    v_exp_f32 v199, v139
    v_pk_add_f32 v[192:193], v[192:193], 1.0 op_sel_hi:[1,0]
    v_pk_add_f32 v[194:195], v[194:195], 1.0 op_sel_hi:[1,0]
    buffer_load_dwordx4 a[180:183], v35, s[32:35], s90 offen offset:1024 sc1
    v_pk_add_f32 v[196:197], v[196:197], 1.0 op_sel_hi:[1,0]
    v_pk_add_f32 v[198:199], v[198:199], 1.0 op_sel_hi:[1,0]
    v_pk_fma_f32 v[192:193], v[192:193], v[192:193], 1.0 op_sel_hi:[1,1,0]
    v_pk_fma_f32 v[194:195], v[194:195], v[194:195], 1.0 op_sel_hi:[1,1,0]
    v_pk_fma_f32 v[196:197], v[196:197], v[196:197], 1.0 op_sel_hi:[1,1,0]
    v_pk_fma_f32 v[198:199], v[198:199], v[198:199], 1.0 op_sel_hi:[1,1,0]
    v_rcp_f32 v192, v192
    buffer_load_dwordx4 a[184:187], v35, s[32:35], s90 offen offset:2048 sc1
    v_rcp_f32 v193, v193
    v_rcp_f32 v194, v194
    v_rcp_f32 v195, v195
    v_rcp_f32 v196, v196
    v_rcp_f32 v197, v197
    v_rcp_f32 v198, v198
    v_rcp_f32 v199, v199
    buffer_load_dwordx4 a[188:191], v35, s[32:35], s90 offen offset:3072 sc1
    v_pk_fma_f32 v[192:193], v[192:193], v[210:211], v[208:209] op_sel_hi:[1,0,0]
    v_pk_fma_f32 v[194:195], v[194:195], v[210:211], v[208:209] op_sel_hi:[1,0,0]
    v_pk_fma_f32 v[196:197], v[196:197], v[210:211], v[208:209] op_sel_hi:[1,0,0]
    v_pk_fma_f32 v[198:199], v[198:199], v[210:211], v[208:209] op_sel_hi:[1,0,0]
    v_pk_mul_f32 v[132:133], v[132:133], v[192:193]
    v_pk_mul_f32 v[134:135], v[134:135], v[194:195]
    v_pk_mul_f32 v[136:137], v[136:137], v[196:197]
    s_add_u32 s90, s90, 4096
    buffer_load_dwordx4 a[192:195], v35, s[32:35], s90 offen offset:0 sc1
    v_pk_mul_f32 v[138:139], v[138:139], v[198:199]
    v_cvt_pk_bf16_f32 v200, v132, v133
    v_cvt_pk_bf16_f32 v201, v134, v135
    v_cvt_pk_bf16_f32 v202, v136, v137
    v_cvt_pk_bf16_f32 v203, v138, v139
    buffer_store_dwordx4 v[200:203], v1, s[32:35], s64 offen offset:0 sc1
    v_pk_mul_f32 v[140:141], v[140:141], v[54:55] op_sel:[0,0] op_sel_hi:[1,0]
    v_pk_mul_f32 v[142:143], v[142:143], v[54:55] op_sel:[0,0] op_sel_hi:[1,0]
    v_pk_mul_f32 v[144:145], v[144:145], v[54:55] op_sel:[0,0] op_sel_hi:[1,0]
    v_pk_mul_f32 v[146:147], v[146:147], v[54:55] op_sel:[0,0] op_sel_hi:[1,0]
    v_exp_f32 v192, v140
    v_exp_f32 v193, v141
    buffer_load_dwordx4 a[196:199], v35, s[32:35], s90 offen offset:1024 sc1
    v_exp_f32 v194, v142
    v_exp_f32 v195, v143
    v_exp_f32 v196, v144
    v_exp_f32 v197, v145
    v_exp_f32 v198, v146
    v_exp_f32 v199, v147
    v_pk_add_f32 v[192:193], v[192:193], 1.0 op_sel_hi:[1,0]
    buffer_load_dwordx4 a[200:203], v35, s[32:35], s90 offen offset:2048 sc1
    v_pk_add_f32 v[194:195], v[194:195], 1.0 op_sel_hi:[1,0]
    v_pk_add_f32 v[196:197], v[196:197], 1.0 op_sel_hi:[1,0]
    v_pk_add_f32 v[198:199], v[198:199], 1.0 op_sel_hi:[1,0]
    v_pk_fma_f32 v[192:193], v[192:193], v[192:193], 1.0 op_sel_hi:[1,1,0]
    v_pk_fma_f32 v[194:195], v[194:195], v[194:195], 1.0 op_sel_hi:[1,1,0]
    v_pk_fma_f32 v[196:197], v[196:197], v[196:197], 1.0 op_sel_hi:[1,1,0]
    v_pk_fma_f32 v[198:199], v[198:199], v[198:199], 1.0 op_sel_hi:[1,1,0]
    buffer_load_dwordx4 a[204:207], v35, s[32:35], s90 offen offset:3072 sc1
    v_rcp_f32 v192, v192
    v_rcp_f32 v193, v193
    v_rcp_f32 v194, v194
    v_rcp_f32 v195, v195
    v_rcp_f32 v196, v196
    v_rcp_f32 v197, v197
    v_rcp_f32 v198, v198
    s_add_u32 s90, s90, 4096
    buffer_load_dwordx4 a[208:211], v35, s[32:35], s90 offen offset:0 sc1
    v_rcp_f32 v199, v199
    v_pk_fma_f32 v[192:193], v[192:193], v[210:211], v[208:209] op_sel_hi:[1,0,0]
    v_pk_fma_f32 v[194:195], v[194:195], v[210:211], v[208:209] op_sel_hi:[1,0,0]
    v_pk_fma_f32 v[196:197], v[196:197], v[210:211], v[208:209] op_sel_hi:[1,0,0]
    v_pk_fma_f32 v[198:199], v[198:199], v[210:211], v[208:209] op_sel_hi:[1,0,0]
    v_pk_mul_f32 v[140:141], v[140:141], v[192:193]
    v_pk_mul_f32 v[142:143], v[142:143], v[194:195]
    buffer_load_dwordx4 a[212:215], v35, s[32:35], s90 offen offset:1024 sc1
    v_pk_mul_f32 v[144:145], v[144:145], v[196:197]
    v_pk_mul_f32 v[146:147], v[146:147], v[198:199]
    v_cvt_pk_bf16_f32 v204, v140, v141
    v_cvt_pk_bf16_f32 v205, v142, v143
    v_cvt_pk_bf16_f32 v206, v144, v145
    v_cvt_pk_bf16_f32 v207, v146, v147
    buffer_store_dwordx4 v[204:207], v1, s[32:35], s64 offen offset:1024 sc1
    v_pk_mul_f32 v[148:149], v[148:149], v[54:55] op_sel:[0,0] op_sel_hi:[1,0]
    v_pk_mul_f32 v[150:151], v[150:151], v[54:55] op_sel:[0,0] op_sel_hi:[1,0]
    v_pk_mul_f32 v[152:153], v[152:153], v[54:55] op_sel:[0,0] op_sel_hi:[1,0]
    v_pk_mul_f32 v[154:155], v[154:155], v[54:55] op_sel:[0,0] op_sel_hi:[1,0]
    v_exp_f32 v192, v148
    buffer_load_dwordx4 a[216:219], v35, s[32:35], s90 offen offset:2048 sc1
    v_exp_f32 v193, v149
    v_exp_f32 v194, v150
    v_exp_f32 v195, v151
    v_exp_f32 v196, v152
    v_exp_f32 v197, v153
    v_exp_f32 v198, v154
    v_exp_f32 v199, v155
    buffer_load_dwordx4 a[220:223], v35, s[32:35], s90 offen offset:3072 sc1
    v_pk_add_f32 v[192:193], v[192:193], 1.0 op_sel_hi:[1,0]
    v_pk_add_f32 v[194:195], v[194:195], 1.0 op_sel_hi:[1,0]
    v_pk_add_f32 v[196:197], v[196:197], 1.0 op_sel_hi:[1,0]
    v_pk_add_f32 v[198:199], v[198:199], 1.0 op_sel_hi:[1,0]
    v_pk_fma_f32 v[192:193], v[192:193], v[192:193], 1.0 op_sel_hi:[1,1,0]
    v_pk_fma_f32 v[194:195], v[194:195], v[194:195], 1.0 op_sel_hi:[1,1,0]
    v_pk_fma_f32 v[196:197], v[196:197], v[196:197], 1.0 op_sel_hi:[1,1,0]
    s_add_u32 s90, s90, 4096
    buffer_load_dwordx4 a[224:227], v35, s[32:35], s90 offen offset:0 sc1
    v_pk_fma_f32 v[198:199], v[198:199], v[198:199], 1.0 op_sel_hi:[1,1,0]
    v_rcp_f32 v192, v192
    v_rcp_f32 v193, v193
    v_rcp_f32 v194, v194
    v_rcp_f32 v195, v195
    v_rcp_f32 v196, v196
    v_rcp_f32 v197, v197
    buffer_load_dwordx4 a[228:231], v35, s[32:35], s90 offen offset:1024 sc1
    v_rcp_f32 v198, v198
    v_rcp_f32 v199, v199
    v_pk_fma_f32 v[192:193], v[192:193], v[210:211], v[208:209] op_sel_hi:[1,0,0]
    v_pk_fma_f32 v[194:195], v[194:195], v[210:211], v[208:209] op_sel_hi:[1,0,0]
    v_pk_fma_f32 v[196:197], v[196:197], v[210:211], v[208:209] op_sel_hi:[1,0,0]
    v_pk_fma_f32 v[198:199], v[198:199], v[210:211], v[208:209] op_sel_hi:[1,0,0]
    v_pk_mul_f32 v[148:149], v[148:149], v[192:193]
    buffer_load_dwordx4 a[232:235], v35, s[32:35], s90 offen offset:2048 sc1
    v_pk_mul_f32 v[150:151], v[150:151], v[194:195]
    v_pk_mul_f32 v[152:153], v[152:153], v[196:197]
    v_pk_mul_f32 v[154:155], v[154:155], v[198:199]
    v_cvt_pk_bf16_f32 v200, v148, v149
    v_cvt_pk_bf16_f32 v201, v150, v151
    v_cvt_pk_bf16_f32 v202, v152, v153
    v_cvt_pk_bf16_f32 v203, v154, v155
    buffer_store_dwordx4 v[200:203], v1, s[32:35], s64 offen offset:2048 sc1
    v_pk_mul_f32 v[156:157], v[156:157], v[54:55] op_sel:[0,0] op_sel_hi:[1,0]
    v_pk_mul_f32 v[158:159], v[158:159], v[54:55] op_sel:[0,0] op_sel_hi:[1,0]
    v_exp_f32 v192, v156
    v_exp_f32 v193, v157
    buffer_load_dwordx4 a[236:239], v35, s[32:35], s90 offen offset:3072 sc1
    v_exp_f32 v194, v158
    v_exp_f32 v195, v159
    v_pk_add_f32 v[192:193], v[192:193], 1.0 op_sel_hi:[1,0]
    v_pk_add_f32 v[194:195], v[194:195], 1.0 op_sel_hi:[1,0]
    v_pk_fma_f32 v[192:193], v[192:193], v[192:193], 1.0 op_sel_hi:[1,1,0]
    v_pk_fma_f32 v[194:195], v[194:195], v[194:195], 1.0 op_sel_hi:[1,1,0]
    v_rcp_f32 v192, v192
    v_rcp_f32 v193, v193
    v_rcp_f32 v194, v194
    v_rcp_f32 v195, v195
    v_pk_fma_f32 v[192:193], v[192:193], v[210:211], v[208:209] op_sel_hi:[1,0,0]
    v_pk_fma_f32 v[194:195], v[194:195], v[210:211], v[208:209] op_sel_hi:[1,0,0]
    v_pk_mul_f32 v[156:157], v[156:157], v[192:193]
    v_pk_mul_f32 v[158:159], v[158:159], v[194:195]
    v_cvt_pk_bf16_f32 v204, v156, v157
    v_cvt_pk_bf16_f32 v205, v158, v159
    s_cmp_ge_u32 s58, 12
    s_cselect_b32 s80, 0x70000000, s80
    s_cselect_b32 s65, 0x70000000, s65
    buffer_store_dwordx2 v[204:205], v4, s[32:35], s65 offen sc1
    s_add_u32 s68, s85, 0
    v_bfe_u32 v121, v0, 1, 2
    v_lshlrev_b32 v121, 4, v121
    v_and_b32 v120, 1, v0
    v_lshl_add_u32 v121, v120, 2, v121
    s_add_u32 s67, s84, 0
    v_mov_b32 v208, 0x3f317218
    v_mov_b32 v210, 0xbfb17218
    s_add_u32 s64, s79, 110592
    s_add_u32 s65, s80, 110592
    v_pk_mul_f32 v[92:93], v[92:93], v[54:55] op_sel:[0,1] op_sel_hi:[1,1]
    v_pk_mul_f32 v[94:95], v[94:95], v[54:55] op_sel:[0,1] op_sel_hi:[1,1]
    v_pk_mul_f32 v[96:97], v[96:97], v[54:55] op_sel:[0,1] op_sel_hi:[1,1]
    v_pk_mul_f32 v[98:99], v[98:99], v[54:55] op_sel:[0,1] op_sel_hi:[1,1]
    v_exp_f32 v192, v92
    v_exp_f32 v193, v93
    v_exp_f32 v194, v94
    v_exp_f32 v195, v95
    v_exp_f32 v196, v96
    v_exp_f32 v197, v97
    v_exp_f32 v198, v98
    v_exp_f32 v199, v99
    v_mov_b32 v124, s59
    v_mov_b32 v125, 0
    s_waitcnt vmcnt(0)
    buffer_store_dword v124, v125, s[32:35], s68 offen offset:0 sc1
    v_pk_add_f32 v[192:193], v[192:193], 1.0 op_sel_hi:[1,0]
    v_pk_add_f32 v[194:195], v[194:195], 1.0 op_sel_hi:[1,0]
    v_pk_add_f32 v[196:197], v[196:197], 1.0 op_sel_hi:[1,0]
    v_pk_add_f32 v[198:199], v[198:199], 1.0 op_sel_hi:[1,0]
    v_pk_fma_f32 v[192:193], v[192:193], v[192:193], 1.0 op_sel_hi:[1,1,0]
    v_pk_fma_f32 v[194:195], v[194:195], v[194:195], 1.0 op_sel_hi:[1,1,0]
    v_pk_fma_f32 v[196:197], v[196:197], v[196:197], 1.0 op_sel_hi:[1,1,0]
    v_pk_fma_f32 v[198:199], v[198:199], v[198:199], 1.0 op_sel_hi:[1,1,0]
    v_rcp_f32 v192, v192
    v_rcp_f32 v193, v193
    v_rcp_f32 v194, v194
    v_rcp_f32 v195, v195
    v_rcp_f32 v196, v196
    buffer_load_dwordx4 a[240:243], v35, s[32:35], s91 offen offset:0 sc1
    v_rcp_f32 v197, v197
    v_rcp_f32 v198, v198
    v_rcp_f32 v199, v199
    v_pk_fma_f32 v[192:193], v[192:193], v[210:211], v[208:209] op_sel_hi:[1,0,0]
    v_pk_fma_f32 v[194:195], v[194:195], v[210:211], v[208:209] op_sel_hi:[1,0,0]
    buffer_load_dwordx4 a[244:247], v35, s[32:35], s91 offen offset:1024 sc1
    v_pk_fma_f32 v[196:197], v[196:197], v[210:211], v[208:209] op_sel_hi:[1,0,0]
    v_pk_fma_f32 v[198:199], v[198:199], v[210:211], v[208:209] op_sel_hi:[1,0,0]
    v_pk_mul_f32 v[92:93], v[92:93], v[192:193]
    v_pk_mul_f32 v[94:95], v[94:95], v[194:195]
    v_pk_mul_f32 v[96:97], v[96:97], v[196:197]
    buffer_load_dwordx4 a[248:251], v35, s[32:35], s91 offen offset:2048 sc1
    v_pk_mul_f32 v[98:99], v[98:99], v[198:199]
    v_cvt_pk_bf16_f32 v200, v92, v93
    v_cvt_pk_bf16_f32 v201, v94, v95
    v_cvt_pk_bf16_f32 v202, v96, v97
    v_cvt_pk_bf16_f32 v203, v98, v99
    buffer_store_dwordx4 v[200:203], v1, s[32:35], s64 offen offset:0 sc1
    v_pk_mul_f32 v[100:101], v[100:101], v[54:55] op_sel:[0,1] op_sel_hi:[1,1]
    v_pk_mul_f32 v[102:103], v[102:103], v[54:55] op_sel:[0,1] op_sel_hi:[1,1]
    v_pk_mul_f32 v[104:105], v[104:105], v[54:55] op_sel:[0,1] op_sel_hi:[1,1]
    v_pk_mul_f32 v[106:107], v[106:107], v[54:55] op_sel:[0,1] op_sel_hi:[1,1]
    buffer_load_dwordx4 a[252:255], v35, s[32:35], s91 offen offset:3072 sc1
    v_exp_f32 v192, v100
    v_exp_f32 v193, v101
    v_exp_f32 v194, v102
    v_exp_f32 v195, v103
    v_exp_f32 v196, v104
    s_add_u32 s91, s91, 4096
    buffer_load_dwordx4 v[232:235], v35, s[32:35], s91 offen offset:0 sc1
    v_exp_f32 v197, v105
    v_exp_f32 v198, v106
    v_exp_f32 v199, v107
    v_pk_add_f32 v[192:193], v[192:193], 1.0 op_sel_hi:[1,0]
    v_pk_add_f32 v[194:195], v[194:195], 1.0 op_sel_hi:[1,0]
    buffer_load_dwordx4 v[236:239], v35, s[32:35], s91 offen offset:1024 sc1
    v_pk_add_f32 v[196:197], v[196:197], 1.0 op_sel_hi:[1,0]
    v_pk_add_f32 v[198:199], v[198:199], 1.0 op_sel_hi:[1,0]
    v_pk_fma_f32 v[192:193], v[192:193], v[192:193], 1.0 op_sel_hi:[1,1,0]
    v_pk_fma_f32 v[194:195], v[194:195], v[194:195], 1.0 op_sel_hi:[1,1,0]
    v_pk_fma_f32 v[196:197], v[196:197], v[196:197], 1.0 op_sel_hi:[1,1,0]
    buffer_load_dwordx4 v[240:243], v35, s[32:35], s91 offen offset:2048 sc1
    v_pk_fma_f32 v[198:199], v[198:199], v[198:199], 1.0 op_sel_hi:[1,1,0]
    v_rcp_f32 v192, v192
    v_rcp_f32 v193, v193
    v_rcp_f32 v194, v194
    v_rcp_f32 v195, v195
    buffer_load_dwordx4 v[244:247], v35, s[32:35], s91 offen offset:3072 sc1
    v_rcp_f32 v196, v196
    v_rcp_f32 v197, v197
    v_rcp_f32 v198, v198
    v_rcp_f32 v199, v199
    v_pk_fma_f32 v[192:193], v[192:193], v[210:211], v[208:209] op_sel_hi:[1,0,0]
    s_add_u32 s91, s91, 4096
    buffer_load_dwordx4 v[248:251], v35, s[32:35], s91 offen offset:0 sc1
    v_pk_fma_f32 v[194:195], v[194:195], v[210:211], v[208:209] op_sel_hi:[1,0,0]
    v_pk_fma_f32 v[196:197], v[196:197], v[210:211], v[208:209] op_sel_hi:[1,0,0]
    v_pk_fma_f32 v[198:199], v[198:199], v[210:211], v[208:209] op_sel_hi:[1,0,0]
    v_pk_mul_f32 v[100:101], v[100:101], v[192:193]
    v_pk_mul_f32 v[102:103], v[102:103], v[194:195]
    buffer_load_dwordx4 v[252:255], v35, s[32:35], s91 offen offset:1024 sc1
    v_pk_mul_f32 v[104:105], v[104:105], v[196:197]
    v_pk_mul_f32 v[106:107], v[106:107], v[198:199]
    v_cvt_pk_bf16_f32 v204, v100, v101
    v_cvt_pk_bf16_f32 v205, v102, v103
    v_cvt_pk_bf16_f32 v206, v104, v105
    v_cvt_pk_bf16_f32 v207, v106, v107
    buffer_store_dwordx4 v[204:207], v1, s[32:35], s64 offen offset:1024 sc1
    buffer_load_dword v120, v121, s[32:35], s67 offen sc1
    v_pk_mul_f32 v[108:109], v[108:109], v[54:55] op_sel:[0,1] op_sel_hi:[1,1]
    v_pk_mul_f32 v[110:111], v[110:111], v[54:55] op_sel:[0,1] op_sel_hi:[1,1]
    v_pk_mul_f32 v[112:113], v[112:113], v[54:55] op_sel:[0,1] op_sel_hi:[1,1]
    v_pk_mul_f32 v[114:115], v[114:115], v[54:55] op_sel:[0,1] op_sel_hi:[1,1]
    v_exp_f32 v192, v108
    v_exp_f32 v193, v109
    v_exp_f32 v194, v110
    v_exp_f32 v195, v111
    v_exp_f32 v196, v112
    v_exp_f32 v197, v113
    v_exp_f32 v198, v114
    v_exp_f32 v199, v115
    v_pk_add_f32 v[192:193], v[192:193], 1.0 op_sel_hi:[1,0]
    v_pk_add_f32 v[194:195], v[194:195], 1.0 op_sel_hi:[1,0]
    v_pk_add_f32 v[196:197], v[196:197], 1.0 op_sel_hi:[1,0]
    v_pk_add_f32 v[198:199], v[198:199], 1.0 op_sel_hi:[1,0]
    v_pk_fma_f32 v[192:193], v[192:193], v[192:193], 1.0 op_sel_hi:[1,1,0]
    v_pk_fma_f32 v[194:195], v[194:195], v[194:195], 1.0 op_sel_hi:[1,1,0]
    v_pk_fma_f32 v[196:197], v[196:197], v[196:197], 1.0 op_sel_hi:[1,1,0]
    v_pk_fma_f32 v[198:199], v[198:199], v[198:199], 1.0 op_sel_hi:[1,1,0]
    v_rcp_f32 v192, v192
    v_rcp_f32 v193, v193
    v_rcp_f32 v194, v194
    v_rcp_f32 v195, v195
    v_rcp_f32 v196, v196
    v_rcp_f32 v197, v197
    v_rcp_f32 v198, v198
    v_rcp_f32 v199, v199
    v_pk_fma_f32 v[192:193], v[192:193], v[210:211], v[208:209] op_sel_hi:[1,0,0]
    v_pk_fma_f32 v[194:195], v[194:195], v[210:211], v[208:209] op_sel_hi:[1,0,0]
    v_pk_fma_f32 v[196:197], v[196:197], v[210:211], v[208:209] op_sel_hi:[1,0,0]
    v_pk_fma_f32 v[198:199], v[198:199], v[210:211], v[208:209] op_sel_hi:[1,0,0]
    v_pk_mul_f32 v[108:109], v[108:109], v[192:193]
    v_pk_mul_f32 v[110:111], v[110:111], v[194:195]
    v_pk_mul_f32 v[112:113], v[112:113], v[196:197]
    v_pk_mul_f32 v[114:115], v[114:115], v[198:199]
    v_cvt_pk_bf16_f32 v200, v108, v109
    v_cvt_pk_bf16_f32 v201, v110, v111
    v_cvt_pk_bf16_f32 v202, v112, v113
    v_cvt_pk_bf16_f32 v203, v114, v115
    buffer_store_dwordx4 v[200:203], v1, s[32:35], s64 offen offset:2048 sc1
    s_waitcnt vmcnt(1)
    v_cmp_ne_u32 vcc, s59, v120
    s_cbranch_vccnz SPIN_187
BACK_188:
    v_pk_mul_f32 v[116:117], v[116:117], v[54:55] op_sel:[0,1] op_sel_hi:[1,1]
    v_pk_mul_f32 v[118:119], v[118:119], v[54:55] op_sel:[0,1] op_sel_hi:[1,1]
    v_exp_f32 v192, v116
    s_add_u32 s95, s96, 0
    buffer_load_dwordx4 v[132:135], v1, s[32:35], s95 offen offset:0 sc1
    v_exp_f32 v193, v117
    v_exp_f32 v194, v118
    v_exp_f32 v195, v119
    buffer_load_dwordx4 v[136:139], v1, s[32:35], s95 offen offset:1024 sc1
    v_pk_add_f32 v[192:193], v[192:193], 1.0 op_sel_hi:[1,0]
    v_pk_add_f32 v[194:195], v[194:195], 1.0 op_sel_hi:[1,0]
    v_pk_fma_f32 v[192:193], v[192:193], v[192:193], 1.0 op_sel_hi:[1,1,0]
    buffer_load_dwordx4 v[140:143], v1, s[32:35], s95 offen offset:2048 sc1
    v_pk_fma_f32 v[194:195], v[194:195], v[194:195], 1.0 op_sel_hi:[1,1,0]
    v_rcp_f32 v192, v192
    v_rcp_f32 v193, v193
    buffer_load_dwordx4 v[144:147], v1, s[32:35], s95 offen offset:3072 sc1
    v_rcp_f32 v194, v194
    v_rcp_f32 v195, v195
    v_pk_fma_f32 v[192:193], v[192:193], v[210:211], v[208:209] op_sel_hi:[1,0,0]
    s_add_u32 s95, s95, 4096
    buffer_load_dwordx4 v[148:151], v1, s[32:35], s95 offen offset:0 sc1
    v_pk_fma_f32 v[194:195], v[194:195], v[210:211], v[208:209] op_sel_hi:[1,0,0]
    v_pk_mul_f32 v[116:117], v[116:117], v[192:193]
    v_pk_mul_f32 v[118:119], v[118:119], v[194:195]
    buffer_load_dwordx4 v[152:155], v1, s[32:35], s95 offen offset:1024 sc1
    v_cvt_pk_bf16_f32 v204, v116, v117
    v_cvt_pk_bf16_f32 v205, v118, v119
    buffer_store_dwordx2 v[204:205], v4, s[32:35], s65 offen sc1
    s_waitcnt vmcnt(6)
    v_mfma_f32_16x16x32_bf16 v[192:195], a[0:3], v[132:135], 0
    buffer_load_dwordx4 v[156:159], v1, s[32:35], s95 offen offset:2048 sc1
    v_mfma_f32_16x16x32_bf16 v[196:199], a[4:7], v[132:135], 0
    v_mfma_f32_16x16x32_bf16 v[200:203], a[8:11], v[132:135], 0
    v_mfma_f32_16x16x32_bf16 v[204:207], a[12:15], v[132:135], 0
    buffer_load_dwordx4 v[160:163], v1, s[32:35], s95 offen offset:3072 sc1
    v_mfma_f32_16x16x32_bf16 v[208:211], a[16:19], v[132:135], 0
    s_add_u32 s95, s95, 4096
    buffer_load_dwordx4 v[164:167], v1, s[32:35], s95 offen offset:0 sc1
    s_waitcnt vmcnt(8)
    v_mfma_f32_16x16x32_bf16 v[192:195], a[20:23], v[136:139], v[192:195]
    v_mfma_f32_16x16x32_bf16 v[196:199], a[24:27], v[136:139], v[196:199]
    buffer_load_dwordx4 v[168:171], v1, s[32:35], s95 offen offset:1024 sc1
    v_mfma_f32_16x16x32_bf16 v[200:203], a[28:31], v[136:139], v[200:203]
    v_mfma_f32_16x16x32_bf16 v[204:207], a[32:35], v[136:139], v[204:207]
    v_mfma_f32_16x16x32_bf16 v[208:211], a[36:39], v[136:139], v[208:211]
    buffer_load_dwordx4 v[172:175], v1, s[32:35], s95 offen offset:2048 sc1
    s_waitcnt vmcnt(9)
    v_mfma_f32_16x16x32_bf16 v[192:195], a[40:43], v[140:143], v[192:195]
    v_mfma_f32_16x16x32_bf16 v[196:199], a[44:47], v[140:143], v[196:199]
    s_add_u32 s68, s85, 4096
    v_mov_b32 v32, s59
    v_mfma_f32_16x16x32_bf16 v[200:203], a[48:51], v[140:143], v[200:203]
    buffer_load_dwordx4 v[176:179], v1, s[32:35], s95 offen offset:3072 sc1
    v_mov_b32 v33, 0
    v_mfma_f32_16x16x32_bf16 v[204:207], a[52:55], v[140:143], v[204:207]
    s_waitcnt vmcnt(6)
    buffer_store_dword v32, v33, s[32:35], s68 offen offset:0 sc1
    v_mfma_f32_16x16x32_bf16 v[208:211], a[56:59], v[140:143], v[208:211]
    s_add_u32 s95, s95, s94
    buffer_load_dwordx2 v[180:181], v4, s[32:35], s95 offen offset:0 sc1
    buffer_load_dwordx2 v[182:183], v4, s[32:35], s95 offen offset:512 sc1
    v_mfma_f32_16x16x32_bf16 v[192:195], a[60:63], v[144:147], v[192:195]
    buffer_load_dwordx2 v[184:185], v4, s[32:35], s95 offen offset:1024 sc1
    buffer_load_dwordx2 v[186:187], v4, s[32:35], s95 offen offset:1536 sc1
    v_mfma_f32_16x16x32_bf16 v[196:199], a[64:67], v[144:147], v[196:199]
    v_bfe_u32 v121, v0, 1, 2
    v_mfma_f32_16x16x32_bf16 v[200:203], a[68:71], v[144:147], v[200:203]
    v_lshlrev_b32 v121, 4, v121
    v_and_b32 v120, 1, v0
    v_mfma_f32_16x16x32_bf16 v[204:207], a[72:75], v[144:147], v[204:207]
    s_add_u32 s99, s81, 0
    buffer_load_dwordx4 v[188:191], v1, s[32:35], s99 offen offset:0 sc1
    v_mfma_f32_16x16x32_bf16 v[208:211], a[76:79], v[144:147], v[208:211]
    buffer_load_dwordx4 v[132:135], v1, s[32:35], s99 offen offset:1024 sc1
    v_lshl_add_u32 v121, v120, 2, v121
    v_mfma_f32_16x16x32_bf16 v[192:195], a[80:83], v[148:151], v[192:195]
    s_add_u32 s67, s84, 4096
    v_mfma_f32_16x16x32_bf16 v[196:199], a[84:87], v[148:151], v[196:199]
    buffer_load_dwordx4 v[136:139], v1, s[32:35], s99 offen offset:2048 sc1
    v_mfma_f32_16x16x32_bf16 v[200:203], a[88:91], v[148:151], v[200:203]
    v_mfma_f32_16x16x32_bf16 v[204:207], a[92:95], v[148:151], v[204:207]
    v_mfma_f32_16x16x32_bf16 v[208:211], a[96:99], v[148:151], v[208:211]
    buffer_load_dwordx4 v[140:143], v1, s[32:35], s99 offen offset:3072 sc1
    v_mfma_f32_16x16x32_bf16 v[192:195], a[100:103], v[152:155], v[192:195]
    v_mfma_f32_16x16x32_bf16 v[196:199], a[104:107], v[152:155], v[196:199]
    v_mfma_f32_16x16x32_bf16 v[200:203], a[108:111], v[152:155], v[200:203]
    s_add_u32 s99, s99, 4096
    buffer_load_dwordx4 v[144:147], v1, s[32:35], s99 offen offset:0 sc1
    v_mfma_f32_16x16x32_bf16 v[204:207], a[112:115], v[152:155], v[204:207]
    v_mfma_f32_16x16x32_bf16 v[208:211], a[116:119], v[152:155], v[208:211]
    buffer_load_dwordx4 v[148:151], v1, s[32:35], s99 offen offset:1024 sc1
    s_waitcnt vmcnt(16)
    v_mfma_f32_16x16x32_bf16 v[192:195], a[120:123], v[156:159], v[192:195]
    buffer_load_dwordx4 v[152:155], v1, s[32:35], s99 offen offset:2048 sc1
    v_mfma_f32_16x16x32_bf16 v[196:199], a[124:127], v[156:159], v[196:199]
    v_mfma_f32_16x16x32_bf16 v[200:203], a[128:131], v[156:159], v[200:203]
    v_mfma_f32_16x16x32_bf16 v[204:207], a[132:135], v[156:159], v[204:207]
    v_mfma_f32_16x16x32_bf16 v[208:211], a[136:139], v[156:159], v[208:211]
    buffer_load_dwordx4 v[156:159], v1, s[32:35], s99 offen offset:3072 sc1
    s_waitcnt vmcnt(17)
    v_mfma_f32_16x16x32_bf16 v[192:195], a[140:143], v[160:163], v[192:195]
    v_mfma_f32_16x16x32_bf16 v[196:199], a[144:147], v[160:163], v[196:199]
    v_mfma_f32_16x16x32_bf16 v[200:203], a[148:151], v[160:163], v[200:203]
    v_mfma_f32_16x16x32_bf16 v[204:207], a[152:155], v[160:163], v[204:207]
    v_mfma_f32_16x16x32_bf16 v[208:211], a[156:159], v[160:163], v[208:211]
    s_add_u32 s99, s99, 4096
    buffer_load_dwordx4 v[160:163], v1, s[32:35], s99 offen offset:0 sc1
    s_waitcnt vmcnt(17)
    v_mfma_f32_16x16x32_bf16 v[192:195], a[160:163], v[164:167], v[192:195]
    v_mfma_f32_16x16x32_bf16 v[196:199], a[164:167], v[164:167], v[196:199]
    v_mfma_f32_16x16x32_bf16 v[200:203], a[168:171], v[164:167], v[200:203]
    v_mfma_f32_16x16x32_bf16 v[204:207], a[172:175], v[164:167], v[204:207]
    v_mfma_f32_16x16x32_bf16 v[208:211], a[176:179], v[164:167], v[208:211]
    buffer_load_dwordx4 v[164:167], v1, s[32:35], s99 offen offset:1024 sc1
    s_waitcnt vmcnt(17)
    v_mfma_f32_16x16x32_bf16 v[192:195], a[180:183], v[168:171], v[192:195]
    v_mfma_f32_16x16x32_bf16 v[196:199], a[184:187], v[168:171], v[196:199]
    v_mfma_f32_16x16x32_bf16 v[200:203], a[188:191], v[168:171], v[200:203]
    v_mfma_f32_16x16x32_bf16 v[204:207], a[192:195], v[168:171], v[204:207]
    v_mfma_f32_16x16x32_bf16 v[208:211], a[196:199], v[168:171], v[208:211]
    buffer_load_dwordx4 v[168:171], v1, s[32:35], s99 offen offset:2048 sc1
    s_waitcnt vmcnt(17)
    v_mfma_f32_16x16x32_bf16 v[192:195], a[200:203], v[172:175], v[192:195]
    v_mfma_f32_16x16x32_bf16 v[196:199], a[204:207], v[172:175], v[196:199]
    v_mfma_f32_16x16x32_bf16 v[200:203], a[208:211], v[172:175], v[200:203]
    v_mfma_f32_16x16x32_bf16 v[204:207], a[212:215], v[172:175], v[204:207]
    v_mfma_f32_16x16x32_bf16 v[208:211], a[216:219], v[172:175], v[208:211]
    buffer_load_dwordx4 v[172:175], v1, s[32:35], s99 offen offset:3072 sc1
    s_waitcnt vmcnt(17)
    v_mfma_f32_16x16x32_bf16 v[192:195], a[220:223], v[176:179], v[192:195]
    v_mfma_f32_16x16x32_bf16 v[196:199], a[224:227], v[176:179], v[196:199]
    v_mfma_f32_16x16x32_bf16 v[200:203], a[228:231], v[176:179], v[200:203]
    v_mfma_f32_16x16x32_bf16 v[204:207], a[232:235], v[176:179], v[204:207]
    v_mfma_f32_16x16x32_bf16 v[208:211], a[236:239], v[176:179], v[208:211]
    s_add_u32 s99, s99, s94
    buffer_load_dwordx2 v[176:177], v4, s[32:35], s99 offen offset:0 sc1
    buffer_load_dwordx2 v[178:179], v4, s[32:35], s99 offen offset:512 sc1
    s_waitcnt vmcnt(16)
    v_mfma_f32_16x16x32_bf16 v[192:195], a[240:243], v[180:183], v[192:195]
    v_mfma_f32_16x16x32_bf16 v[196:199], a[244:247], v[180:183], v[196:199]
    v_mfma_f32_16x16x32_bf16 v[200:203], a[248:251], v[180:183], v[200:203]
    v_mfma_f32_16x16x32_bf16 v[204:207], a[252:255], v[180:183], v[204:207]
    buffer_load_dword v120, v121, s[32:35], s67 offen sc1
    v_mfma_f32_16x16x32_bf16 v[208:211], v[232:235], v[180:183], v[208:211]
    buffer_load_dwordx2 v[180:181], v4, s[32:35], s99 offen offset:1024 sc1
    buffer_load_dwordx2 v[182:183], v4, s[32:35], s99 offen offset:1536 sc1
    s_waitcnt vmcnt(17)
    v_mfma_f32_16x16x32_bf16 v[192:195], v[236:239], v[184:187], v[192:195]
    v_mfma_f32_16x16x32_bf16 v[196:199], v[240:243], v[184:187], v[196:199]
    v_mfma_f32_16x16x32_bf16 v[200:203], v[244:247], v[184:187], v[200:203]
    v_mfma_f32_16x16x32_bf16 v[204:207], v[248:251], v[184:187], v[204:207]
    v_mfma_f32_16x16x32_bf16 v[208:211], v[252:255], v[184:187], v[208:211]
    s_waitcnt vmcnt(16)
    v_mfma_f32_16x16x32_bf16 v[212:215], a[0:3], v[188:191], 0
    v_mfma_f32_16x16x32_bf16 v[216:219], a[4:7], v[188:191], 0
    v_mfma_f32_16x16x32_bf16 v[220:223], a[8:11], v[188:191], 0
    s_xor_b32 s68, s54, 0
    s_mul_i32 s68, s68, 5120
    v_mfma_f32_16x16x32_bf16 v[224:227], a[12:15], v[188:191], 0
    s_add_u32 s68, s68, 143360
    v_add_u32 v33, s68, v1
    v_mfma_f32_16x16x32_bf16 v[228:231], a[16:19], v[188:191], 0
    ds_write_b128 v33, v[192:195] offset:0
    ds_write_b128 v33, v[196:199] offset:1024
    s_waitcnt vmcnt(15)
    v_mfma_f32_16x16x32_bf16 v[212:215], a[20:23], v[132:135], v[212:215]
    ds_write_b128 v33, v[200:203] offset:2048
    ds_write_b128 v33, v[204:207] offset:3072
    v_mfma_f32_16x16x32_bf16 v[216:219], a[24:27], v[132:135], v[216:219]
    ds_write_b128 v33, v[208:211] offset:4096
    s_xor_b32 s68, s54, 1
    v_mfma_f32_16x16x32_bf16 v[220:223], a[28:31], v[132:135], v[220:223]
    s_mul_i32 s68, s68, 5120
    s_add_u32 s68, s68, 143360
    v_mfma_f32_16x16x32_bf16 v[224:227], a[32:35], v[132:135], v[224:227]
    v_add_u32 v33, s68, v1
    s_xor_b32 s68, s54, 3
    v_mfma_f32_16x16x32_bf16 v[228:231], a[36:39], v[132:135], v[228:231]
    s_mul_i32 s68, s68, 5120
    s_add_u32 s68, s68, 143368
    s_waitcnt vmcnt(14)
    v_mfma_f32_16x16x32_bf16 v[212:215], a[40:43], v[136:139], v[212:215]
    s_waitcnt vmcnt(2)
    v_cmp_ne_u32 vcc, s59, v120
    s_cbranch_vccnz SPIN_190
BACK_191:
    v_add_u32 v34, s68, v1
    v_mfma_f32_16x16x32_bf16 v[216:219], a[44:47], v[136:139], v[216:219]
    s_add_u32 s95, s96, 110592
    buffer_load_dwordx4 v[184:187], v1, s[32:35], s95 offen offset:0 sc1
    v_mfma_f32_16x16x32_bf16 v[220:223], a[48:51], v[136:139], v[220:223]
    v_mfma_f32_16x16x32_bf16 v[224:227], a[52:55], v[136:139], v[224:227]
    v_mfma_f32_16x16x32_bf16 v[228:231], a[56:59], v[136:139], v[228:231]
    buffer_load_dwordx4 v[188:191], v1, s[32:35], s95 offen offset:1024 sc1
    v_mfma_f32_16x16x32_bf16 v[212:215], a[60:63], v[140:143], v[212:215]
    v_mfma_f32_16x16x32_bf16 v[216:219], a[64:67], v[140:143], v[216:219]
    v_mfma_f32_16x16x32_bf16 v[220:223], a[68:71], v[140:143], v[220:223]
    buffer_load_dwordx4 v[132:135], v1, s[32:35], s95 offen offset:2048 sc1
    v_mfma_f32_16x16x32_bf16 v[224:227], a[72:75], v[140:143], v[224:227]
    v_mfma_f32_16x16x32_bf16 v[228:231], a[76:79], v[140:143], v[228:231]
    buffer_load_dwordx4 v[136:139], v1, s[32:35], s95 offen offset:3072 sc1
    s_waitcnt lgkmcnt(0)
    v_mfma_f32_16x16x32_bf16 v[212:215], a[80:83], v[144:147], v[212:215]
    s_add_u32 s95, s95, 4096
    buffer_load_dwordx4 v[140:143], v1, s[32:35], s95 offen offset:0 sc1
    v_mfma_f32_16x16x32_bf16 v[216:219], a[84:87], v[144:147], v[216:219]
    s_barrier
    ds_read_b64 v[192:193], v33 offset:0
    v_mfma_f32_16x16x32_bf16 v[220:223], a[88:91], v[144:147], v[220:223]
    ds_read_b64 v[194:195], v33 offset:1024
    ds_read_b64 v[196:197], v33 offset:2048
    v_mfma_f32_16x16x32_bf16 v[224:227], a[92:95], v[144:147], v[224:227]
    ds_read_b64 v[198:199], v33 offset:3072
    ds_read_b64 v[200:201], v33 offset:4096
    v_mfma_f32_16x16x32_bf16 v[228:231], a[96:99], v[144:147], v[228:231]
    buffer_load_dwordx4 v[144:147], v1, s[32:35], s95 offen offset:1024 sc1
    ds_read_b64 v[202:203], v34 offset:0
    v_mfma_f32_16x16x32_bf16 v[212:215], a[100:103], v[148:151], v[212:215]
    ds_read_b64 v[204:205], v34 offset:1024
    ds_read_b64 v[206:207], v34 offset:2048
    v_mfma_f32_16x16x32_bf16 v[216:219], a[104:107], v[148:151], v[216:219]
    ds_read_b64 v[208:209], v34 offset:3072
    ds_read_b64 v[210:211], v34 offset:4096
    v_mfma_f32_16x16x32_bf16 v[220:223], a[108:111], v[148:151], v[220:223]
    v_mfma_f32_16x16x32_bf16 v[224:227], a[112:115], v[148:151], v[224:227]
    v_mfma_f32_16x16x32_bf16 v[228:231], a[116:119], v[148:151], v[228:231]
    buffer_load_dwordx4 v[148:151], v1, s[32:35], s95 offen offset:2048 sc1
    v_mfma_f32_16x16x32_bf16 v[212:215], a[120:123], v[152:155], v[212:215]
    v_mfma_f32_16x16x32_bf16 v[216:219], a[124:127], v[152:155], v[216:219]
    v_mfma_f32_16x16x32_bf16 v[220:223], a[128:131], v[152:155], v[220:223]
    v_mfma_f32_16x16x32_bf16 v[224:227], a[132:135], v[152:155], v[224:227]
    v_mfma_f32_16x16x32_bf16 v[228:231], a[136:139], v[152:155], v[228:231]
    buffer_load_dwordx4 v[152:155], v1, s[32:35], s95 offen offset:3072 sc1
    v_mfma_f32_16x16x32_bf16 v[212:215], a[140:143], v[156:159], v[212:215]
    v_mfma_f32_16x16x32_bf16 v[216:219], a[144:147], v[156:159], v[216:219]
    s_waitcnt lgkmcnt(4)
    v_add_f32 v192, v192, v202
    v_add_f32 v193, v193, v203
    v_mfma_f32_16x16x32_bf16 v[220:223], a[148:151], v[156:159], v[220:223]
    s_waitcnt lgkmcnt(3)
    v_add_f32 v194, v194, v204
    v_add_f32 v195, v195, v205
    v_mfma_f32_16x16x32_bf16 v[224:227], a[152:155], v[156:159], v[224:227]
    s_waitcnt lgkmcnt(2)
    v_add_f32 v196, v196, v206
    v_add_f32 v197, v197, v207
    v_mfma_f32_16x16x32_bf16 v[228:231], a[156:159], v[156:159], v[228:231]
    s_add_u32 s95, s95, 4096
    buffer_load_dwordx4 v[156:159], v1, s[32:35], s95 offen offset:0 sc1
    v_mfma_f32_16x16x32_bf16 v[212:215], a[160:163], v[160:163], v[212:215]
    s_waitcnt lgkmcnt(1)
    v_add_f32 v198, v198, v208
    v_add_f32 v199, v199, v209
    v_mfma_f32_16x16x32_bf16 v[216:219], a[164:167], v[160:163], v[216:219]
    s_waitcnt lgkmcnt(0)
    v_add_f32 v200, v200, v210
    v_add_f32 v201, v201, v211
    v_mfma_f32_16x16x32_bf16 v[220:223], a[168:171], v[160:163], v[220:223]
    v_lshlrev_b32 v202, 16, v6
    v_and_b32 v203, 0xffff0000, v6
    v_mfma_f32_16x16x32_bf16 v[224:227], a[172:175], v[160:163], v[224:227]
    v_lshlrev_b32 v204, 16, v7
    v_and_b32 v205, 0xffff0000, v7
    v_mfma_f32_16x16x32_bf16 v[228:231], a[176:179], v[160:163], v[228:231]
    buffer_load_dwordx4 v[160:163], v1, s[32:35], s95 offen offset:1024 sc1
    v_lshlrev_b32 v206, 16, v8
    v_mfma_f32_16x16x32_bf16 v[212:215], a[180:183], v[164:167], v[212:215]
    v_and_b32 v207, 0xffff0000, v8
    v_lshlrev_b32 v208, 16, v9
    v_mfma_f32_16x16x32_bf16 v[216:219], a[184:187], v[164:167], v[216:219]
    v_and_b32 v209, 0xffff0000, v9
    v_lshlrev_b32 v210, 16, v10
    v_mfma_f32_16x16x32_bf16 v[220:223], a[188:191], v[164:167], v[220:223]
    v_and_b32 v211, 0xffff0000, v10
    v_add_f32 v192, v192, v202
    v_mfma_f32_16x16x32_bf16 v[224:227], a[192:195], v[164:167], v[224:227]
    v_add_f32 v193, v193, v203
    v_add_f32 v194, v194, v204
    v_mfma_f32_16x16x32_bf16 v[228:231], a[196:199], v[164:167], v[228:231]
    buffer_load_dwordx4 v[164:167], v1, s[32:35], s95 offen offset:2048 sc1
    v_add_f32 v195, v195, v205
    v_mfma_f32_16x16x32_bf16 v[212:215], a[200:203], v[168:171], v[212:215]
    v_add_f32 v196, v196, v206
    v_add_f32 v197, v197, v207
    v_mfma_f32_16x16x32_bf16 v[216:219], a[204:207], v[168:171], v[216:219]
    v_add_f32 v198, v198, v208
    v_add_f32 v199, v199, v209
    v_mfma_f32_16x16x32_bf16 v[220:223], a[208:211], v[168:171], v[220:223]
    v_add_f32 v200, v200, v210
    v_add_f32 v201, v201, v211
    v_mfma_f32_16x16x32_bf16 v[224:227], a[212:215], v[168:171], v[224:227]
    v_subrev_u32 v35, 8, v34
    v_mov_b32 v34, v33
    v_mfma_f32_16x16x32_bf16 v[228:231], a[216:219], v[168:171], v[228:231]
    buffer_load_dwordx4 v[168:171], v1, s[32:35], s95 offen offset:3072 sc1
    v_mfma_f32_16x16x32_bf16 v[212:215], a[220:223], v[172:175], v[212:215]
    v_mfma_f32_16x16x32_bf16 v[216:219], a[224:227], v[172:175], v[216:219]
    v_mfma_f32_16x16x32_bf16 v[220:223], a[228:231], v[172:175], v[220:223]
    v_mfma_f32_16x16x32_bf16 v[224:227], a[232:235], v[172:175], v[224:227]
    v_mfma_f32_16x16x32_bf16 v[228:231], a[236:239], v[172:175], v[228:231]
    s_add_u32 s95, s95, s94
    buffer_load_dwordx2 v[172:173], v4, s[32:35], s95 offen offset:0 sc1
    buffer_load_dwordx2 v[174:175], v4, s[32:35], s95 offen offset:512 sc1
    v_mfma_f32_16x16x32_bf16 v[212:215], a[240:243], v[176:179], v[212:215]
    v_mfma_f32_16x16x32_bf16 v[216:219], a[244:247], v[176:179], v[216:219]
    v_mfma_f32_16x16x32_bf16 v[220:223], a[248:251], v[176:179], v[220:223]
    v_mfma_f32_16x16x32_bf16 v[224:227], a[252:255], v[176:179], v[224:227]
    v_mfma_f32_16x16x32_bf16 v[228:231], v[232:235], v[176:179], v[228:231]
    buffer_load_dwordx2 v[176:177], v4, s[32:35], s95 offen offset:1024 sc1
    buffer_load_dwordx2 v[178:179], v4, s[32:35], s95 offen offset:1536 sc1
    s_waitcnt vmcnt(16)
    v_mfma_f32_16x16x32_bf16 v[212:215], v[236:239], v[180:183], v[212:215]
    v_mfma_f32_16x16x32_bf16 v[216:219], v[240:243], v[180:183], v[216:219]
    v_mfma_f32_16x16x32_bf16 v[220:223], v[244:247], v[180:183], v[220:223]
    v_mfma_f32_16x16x32_bf16 v[224:227], v[248:251], v[180:183], v[224:227]
    v_mfma_f32_16x16x32_bf16 v[228:231], v[252:255], v[180:183], v[228:231]
    s_add_u32 s99, s81, 110592
    buffer_load_dwordx4 v[180:183], v1, s[32:35], s99 offen offset:0 sc1
    s_waitcnt vmcnt(16)
    v_mfma_f32_16x16x32_bf16 v[92:95], a[0:3], v[184:187], 0
    v_mfma_f32_16x16x32_bf16 v[96:99], a[4:7], v[184:187], 0
    v_mfma_f32_16x16x32_bf16 v[100:103], a[8:11], v[184:187], 0
    ds_write_b64 v34, v[214:215] offset:0
    ds_write_b64 v34, v[218:219] offset:1024
    v_mfma_f32_16x16x32_bf16 v[104:107], a[12:15], v[184:187], 0
    ds_write_b64 v34, v[222:223] offset:2048
    ds_write_b64 v34, v[226:227] offset:3072
    v_mfma_f32_16x16x32_bf16 v[108:111], a[16:19], v[184:187], 0
    buffer_load_dwordx4 v[184:187], v1, s[32:35], s99 offen offset:1024 sc1
    ds_write_b64 v34, v[230:231] offset:4096
    s_waitcnt vmcnt(16)
    v_mfma_f32_16x16x32_bf16 v[92:95], a[20:23], v[188:191], v[92:95]
    v_add_f32 v192, v192, v212
    v_add_f32 v193, v193, v213
    v_mfma_f32_16x16x32_bf16 v[96:99], a[24:27], v[188:191], v[96:99]
    v_add_f32 v194, v194, v216
    v_add_f32 v195, v195, v217
    v_mfma_f32_16x16x32_bf16 v[100:103], a[28:31], v[188:191], v[100:103]
    v_add_f32 v196, v196, v220
    v_add_f32 v197, v197, v221
    v_mfma_f32_16x16x32_bf16 v[104:107], a[32:35], v[188:191], v[104:107]
    v_add_f32 v198, v198, v224
    v_add_f32 v199, v199, v225
    v_mfma_f32_16x16x32_bf16 v[108:111], a[36:39], v[188:191], v[108:111]
    buffer_load_dwordx4 v[188:191], v1, s[32:35], s99 offen offset:2048 sc1
    v_add_f32 v200, v200, v228
    s_waitcnt vmcnt(16)
    v_mfma_f32_16x16x32_bf16 v[92:95], a[40:43], v[132:135], v[92:95]
    v_add_f32 v201, v201, v229
    v_mfma_f32_16x16x32_bf16 v[96:99], a[44:47], v[132:135], v[96:99]
    v_mfma_f32_16x16x32_bf16 v[100:103], a[48:51], v[132:135], v[100:103]
    v_mfma_f32_16x16x32_bf16 v[104:107], a[52:55], v[132:135], v[104:107]
    s_waitcnt lgkmcnt(0)
    s_barrier
    v_mfma_f32_16x16x32_bf16 v[108:111], a[56:59], v[132:135], v[108:111]
    buffer_load_dwordx4 v[132:135], v1, s[32:35], s99 offen offset:3072 sc1
    ds_read_b64 v[202:203], v35 offset:0
    s_waitcnt vmcnt(16)
    v_mfma_f32_16x16x32_bf16 v[92:95], a[60:63], v[136:139], v[92:95]
    ds_read_b64 v[204:205], v35 offset:1024
    ds_read_b64 v[206:207], v35 offset:2048
    v_mfma_f32_16x16x32_bf16 v[96:99], a[64:67], v[136:139], v[96:99]
    ds_read_b64 v[208:209], v35 offset:3072
    ds_read_b64 v[210:211], v35 offset:4096
    v_mfma_f32_16x16x32_bf16 v[100:103], a[68:71], v[136:139], v[100:103]
    v_mfma_f32_16x16x32_bf16 v[104:107], a[72:75], v[136:139], v[104:107]
    v_mfma_f32_16x16x32_bf16 v[108:111], a[76:79], v[136:139], v[108:111]
    s_add_u32 s99, s99, 4096
    buffer_load_dwordx4 v[136:139], v1, s[32:35], s99 offen offset:0 sc1
    s_waitcnt vmcnt(16)
    v_mfma_f32_16x16x32_bf16 v[92:95], a[80:83], v[140:143], v[92:95]
    v_mfma_f32_16x16x32_bf16 v[96:99], a[84:87], v[140:143], v[96:99]
    v_mfma_f32_16x16x32_bf16 v[100:103], a[88:91], v[140:143], v[100:103]
    s_waitcnt lgkmcnt(4)
    v_add_f32 v192, v192, v202
    v_add_f32 v193, v193, v203
    v_mfma_f32_16x16x32_bf16 v[104:107], a[92:95], v[140:143], v[104:107]
    s_waitcnt lgkmcnt(3)
    v_add_f32 v194, v194, v204
    v_add_f32 v195, v195, v205
    v_mfma_f32_16x16x32_bf16 v[108:111], a[96:99], v[140:143], v[108:111]
    buffer_load_dwordx4 v[140:143], v1, s[32:35], s99 offen offset:1024 sc1
    s_waitcnt lgkmcnt(2)
    v_add_f32 v196, v196, v206
    s_waitcnt vmcnt(16)
    v_mfma_f32_16x16x32_bf16 v[92:95], a[100:103], v[144:147], v[92:95]
    v_add_f32 v197, v197, v207
    s_waitcnt lgkmcnt(1)
    v_add_f32 v198, v198, v208
    v_mfma_f32_16x16x32_bf16 v[96:99], a[104:107], v[144:147], v[96:99]
    v_add_f32 v199, v199, v209
    s_waitcnt lgkmcnt(0)
    v_add_f32 v200, v200, v210
    v_mfma_f32_16x16x32_bf16 v[100:103], a[108:111], v[144:147], v[100:103]
    v_add_f32 v201, v201, v211
    s_add_u32 s64, s86, 1048576
    v_mfma_f32_16x16x32_bf16 v[104:107], a[112:115], v[144:147], v[104:107]
    v_add_f32 v212, v192, v193
    v_mul_f32 v213, v192, v192
    v_mfma_f32_16x16x32_bf16 v[108:111], a[116:119], v[144:147], v[108:111]
    buffer_load_dwordx4 v[144:147], v1, s[32:35], s99 offen offset:2048 sc1
    v_mul_f32 v215, v193, v193
    s_waitcnt vmcnt(16)
    v_mfma_f32_16x16x32_bf16 v[92:95], a[120:123], v[148:151], v[92:95]
    v_add_f32 v214, v194, v195
    v_fmac_f32 v213, v194, v194
    v_mfma_f32_16x16x32_bf16 v[96:99], a[124:127], v[148:151], v[96:99]
    v_fmac_f32 v215, v195, v195
    v_fmac_f32 v213, v196, v196
    v_mfma_f32_16x16x32_bf16 v[100:103], a[128:131], v[148:151], v[100:103]
    v_fmac_f32 v215, v197, v197
    v_add_f32 v212, v212, v196
    v_mfma_f32_16x16x32_bf16 v[104:107], a[132:135], v[148:151], v[104:107]
    v_add_f32 v214, v214, v197
    v_fmac_f32 v213, v198, v198
    v_mfma_f32_16x16x32_bf16 v[108:111], a[136:139], v[148:151], v[108:111]
    buffer_load_dwordx4 v[148:151], v1, s[32:35], s99 offen offset:3072 sc1
    v_fmac_f32 v215, v199, v199
    s_waitcnt vmcnt(16)
    v_mfma_f32_16x16x32_bf16 v[92:95], a[140:143], v[152:155], v[92:95]
    v_add_f32 v212, v212, v198
    v_add_f32 v214, v214, v199
    v_mfma_f32_16x16x32_bf16 v[96:99], a[144:147], v[152:155], v[96:99]
    v_fmac_f32 v213, v200, v200
    v_fmac_f32 v215, v201, v201
    v_mfma_f32_16x16x32_bf16 v[100:103], a[148:151], v[152:155], v[100:103]
    v_add_f32 v212, v212, v200
    v_add_f32 v214, v214, v201
    v_mfma_f32_16x16x32_bf16 v[104:107], a[152:155], v[152:155], v[104:107]
    v_add_f32 v212, v212, v214
    v_add_f32 v213, v213, v215
    v_mfma_f32_16x16x32_bf16 v[108:111], a[156:159], v[152:155], v[108:111]
    s_add_u32 s99, s99, 4096
    buffer_load_dwordx4 v[152:155], v1, s[32:35], s99 offen offset:0 sc1
    s_waitcnt vmcnt(16)
    v_mfma_f32_16x16x32_bf16 v[92:95], a[160:163], v[156:159], v[92:95]
    v_lshlrev_b32 v215, 4, v2
    v_mov_b32 v214, s97
    v_mfma_f32_16x16x32_bf16 v[96:99], a[164:167], v[156:159], v[96:99]
    v_permlane16_swap_b32 v212, v213
    v_add_f32 v212, v212, v213
    v_mfma_f32_16x16x32_bf16 v[100:103], a[168:171], v[156:159], v[100:103]
    v_mov_b32 v213, v212
    s_nop 1
    v_permlane32_swap_b32 v212, v213
    v_mfma_f32_16x16x32_bf16 v[104:107], a[172:175], v[156:159], v[104:107]
    v_add_f32 v212, v212, v213
    v_mov_b32 v213, v212
    v_mfma_f32_16x16x32_bf16 v[108:111], a[176:179], v[156:159], v[108:111]
    buffer_load_dwordx4 v[156:159], v1, s[32:35], s99 offen offset:1024 sc1
    v_permlane16_swap_b32 v212, v213
    s_waitcnt vmcnt(16)
    v_mfma_f32_16x16x32_bf16 v[92:95], a[180:183], v[160:163], v[92:95]
    buffer_store_dwordx3 v[212:214], v215, s[32:35], s64 offen offset:0 sc1
    s_barrier
    v_mfma_f32_16x16x32_bf16 v[96:99], a[184:187], v[160:163], v[96:99]
    s_add_u32 s69, s87, 1048576
    buffer_load_dwordx3 v[212:214], v1, s[32:35], s69 offen offset:0 sc1
    v_mfma_f32_16x16x32_bf16 v[100:103], a[188:191], v[160:163], v[100:103]
    buffer_load_dwordx3 v[216:218], v1, s[32:35], s69 offen offset:1024 sc1
    buffer_load_dwordx3 v[220:222], v1, s[32:35], s69 offen offset:2048 sc1
    v_mfma_f32_16x16x32_bf16 v[104:107], a[192:195], v[160:163], v[104:107]
    buffer_load_dwordx3 v[224:226], v1, s[32:35], s69 offen offset:3072 sc1
    v_mfma_f32_16x16x32_bf16 v[108:111], a[196:199], v[160:163], v[108:111]
    buffer_load_dwordx4 v[160:163], v1, s[32:35], s99 offen offset:2048 sc1
    s_waitcnt vmcnt(21)
    v_mfma_f32_16x16x32_bf16 v[92:95], a[200:203], v[164:167], v[92:95]
    v_mfma_f32_16x16x32_bf16 v[96:99], a[204:207], v[164:167], v[96:99]
    v_mfma_f32_16x16x32_bf16 v[100:103], a[208:211], v[164:167], v[100:103]
    v_mfma_f32_16x16x32_bf16 v[104:107], a[212:215], v[164:167], v[104:107]
    v_mfma_f32_16x16x32_bf16 v[108:111], a[216:219], v[164:167], v[108:111]
    buffer_load_dwordx4 v[164:167], v1, s[32:35], s99 offen offset:3072 sc1
    s_waitcnt vmcnt(21)
    v_mfma_f32_16x16x32_bf16 v[92:95], a[220:223], v[168:171], v[92:95]
    v_mfma_f32_16x16x32_bf16 v[96:99], a[224:227], v[168:171], v[96:99]
    v_mfma_f32_16x16x32_bf16 v[100:103], a[228:231], v[168:171], v[100:103]
    v_mfma_f32_16x16x32_bf16 v[104:107], a[232:235], v[168:171], v[104:107]
    v_mfma_f32_16x16x32_bf16 v[108:111], a[236:239], v[168:171], v[108:111]
    s_add_u32 s99, s99, s94
    buffer_load_dwordx2 v[168:169], v4, s[32:35], s99 offen offset:0 sc1
    buffer_load_dwordx2 v[170:171], v4, s[32:35], s99 offen offset:512 sc1
    s_waitcnt vmcnt(21)
    v_mfma_f32_16x16x32_bf16 v[92:95], a[240:243], v[172:175], v[92:95]
    s_waitcnt vmcnt(6)
    v_xor_b32 v214, v214, v218
    s_waitcnt vmcnt(4)
    v_xor_b32 v222, v222, v226
    v_xor_b32 v218, v218, v226
    v_xor_b32 v226, s97, v226
    v_or3_b32 v214, v214, v218, v222
    v_or_b32 v214, v214, v226
    v_cmp_ne_u32 vcc, 0, v214
    s_cbranch_vccnz SPIN_195
BACK_196:
    v_mfma_f32_16x16x32_bf16 v[96:99], a[244:247], v[172:175], v[96:99]
    v_mfma_f32_16x16x32_bf16 v[100:103], a[248:251], v[172:175], v[100:103]
    v_mfma_f32_16x16x32_bf16 v[104:107], a[252:255], v[172:175], v[104:107]
    v_add_f32 v212, v212, v216
    v_mfma_f32_16x16x32_bf16 v[108:111], v[232:235], v[172:175], v[108:111]
    buffer_load_dwordx2 v[172:173], v4, s[32:35], s99 offen offset:1024 sc1
    buffer_load_dwordx2 v[174:175], v4, s[32:35], s99 offen offset:1536 sc1
    v_mfma_f32_16x16x32_bf16 v[92:95], v[236:239], v[176:179], v[92:95]
    v_add_f32 v213, v213, v217
    v_add_f32 v220, v220, v224
    v_mfma_f32_16x16x32_bf16 v[96:99], v[240:243], v[176:179], v[96:99]
    v_add_f32 v221, v221, v225
    v_add_f32 v212, v212, v220
    v_mfma_f32_16x16x32_bf16 v[100:103], v[244:247], v[176:179], v[100:103]
    v_add_f32 v213, v213, v221
    s_nop 1
    v_permlane16_swap_b32 v212, v213
    v_mfma_f32_16x16x32_bf16 v[104:107], v[248:251], v[176:179], v[104:107]
    v_add_f32 v212, v212, v213
    v_mov_b32 v213, v212
    v_mfma_f32_16x16x32_bf16 v[108:111], v[252:255], v[176:179], v[108:111]
    s_nop 0
    v_permlane32_swap_b32 v212, v213
    v_add_f32 v212, v212, v213
    v_mfma_f32_16x16x32_bf16 v[112:115], a[0:3], v[180:183], 0
    v_mul_f32 v30, 0x3acccccd, v212
    v_mul_f32 v31, 0x3acccccd, v212
    v_mfma_f32_16x16x32_bf16 v[116:119], a[4:7], v[180:183], 0
    s_nop 0
    v_permlane16_swap_b32 v30, v31
    v_fma_f32 v31, -v30, v30, v31
    v_mfma_f32_16x16x32_bf16 v[120:123], a[8:11], v[180:183], 0
    v_max_f32 v31, 0, v31
    v_cvt_pk_bf16_f32 v31, v31, v30
    v_mfma_f32_16x16x32_bf16 v[124:127], a[12:15], v[180:183], 0
    v_and_b32 v30, 0xffff0000, v31
    v_lshlrev_b32 v31, 16, v31
    v_mfma_f32_16x16x32_bf16 v[128:131], a[16:19], v[180:183], 0
    v_add_f32 v31, 0x3727c5ac, v31
    v_cvt_pk_bf16_f32 v31, v31, v31
    v_mfma_f32_16x16x32_bf16 v[112:115], a[20:23], v[184:187], v[112:115]
    v_lshlrev_b32 v31, 16, v31
    v_sqrt_f32 v31, v31
    v_mfma_f32_16x16x32_bf16 v[116:119], a[24:27], v[184:187], v[116:119]
    v_cvt_pk_bf16_f32 v31, v31, v31
    v_lshlrev_b32 v31, 16, v31
    v_mfma_f32_16x16x32_bf16 v[120:123], a[28:31], v[184:187], v[120:123]
    v_rcp_f32 v31, v31
    v_mfma_f32_16x16x32_bf16 v[124:127], a[32:35], v[184:187], v[124:127]
    v_mul_f32 v32, -v30, v31
    v_lshlrev_b32 v202, 16, v17
    v_mfma_f32_16x16x32_bf16 v[128:131], a[36:39], v[184:187], v[128:131]
    v_and_b32 v203, 0xffff0000, v17
    v_lshlrev_b32 v204, 16, v18
    v_mfma_f32_16x16x32_bf16 v[112:115], a[40:43], v[188:191], v[112:115]
    v_and_b32 v205, 0xffff0000, v18
    v_lshlrev_b32 v206, 16, v19
    v_mfma_f32_16x16x32_bf16 v[116:119], a[44:47], v[188:191], v[116:119]
    v_and_b32 v207, 0xffff0000, v19
    v_lshlrev_b32 v208, 16, v20
    v_mfma_f32_16x16x32_bf16 v[120:123], a[48:51], v[188:191], v[120:123]
    v_and_b32 v209, 0xffff0000, v20
    v_lshlrev_b32 v210, 16, v21
    v_mfma_f32_16x16x32_bf16 v[124:127], a[52:55], v[188:191], v[124:127]
    v_and_b32 v211, 0xffff0000, v21
    v_fma_f32 v212, v192, v31, v32
    v_mfma_f32_16x16x32_bf16 v[128:131], a[56:59], v[188:191], v[128:131]
    v_fma_f32 v213, v193, v31, v32
    v_fma_f32 v214, v194, v31, v32
    v_mfma_f32_16x16x32_bf16 v[112:115], a[60:63], v[132:135], v[112:115]
    v_fma_f32 v215, v195, v31, v32
    v_fma_f32 v216, v196, v31, v32
    v_mfma_f32_16x16x32_bf16 v[116:119], a[64:67], v[132:135], v[116:119]
    v_fma_f32 v217, v197, v31, v32
    v_fma_f32 v218, v198, v31, v32
    v_mfma_f32_16x16x32_bf16 v[120:123], a[68:71], v[132:135], v[120:123]
    v_fma_f32 v219, v199, v31, v32
    v_fma_f32 v220, v200, v31, v32
    v_mfma_f32_16x16x32_bf16 v[124:127], a[72:75], v[132:135], v[124:127]
    v_fma_f32 v221, v201, v31, v32
    v_fmac_f32 v192, v212, v202
    v_mfma_f32_16x16x32_bf16 v[128:131], a[76:79], v[132:135], v[128:131]
    v_fmac_f32 v193, v213, v203
    v_fmac_f32 v194, v214, v204
    v_mfma_f32_16x16x32_bf16 v[112:115], a[80:83], v[136:139], v[112:115]
    v_fmac_f32 v195, v215, v205
    v_fmac_f32 v196, v216, v206
    v_mfma_f32_16x16x32_bf16 v[116:119], a[84:87], v[136:139], v[116:119]
    v_fmac_f32 v197, v217, v207
    v_fmac_f32 v198, v218, v208
    v_mfma_f32_16x16x32_bf16 v[120:123], a[88:91], v[136:139], v[120:123]
    v_fmac_f32 v199, v219, v209
    v_fmac_f32 v200, v220, v210
    v_mfma_f32_16x16x32_bf16 v[124:127], a[92:95], v[136:139], v[124:127]
    v_fmac_f32 v201, v221, v211
    v_cvt_pk_bf16_f32 v6, v192, v193
    v_mfma_f32_16x16x32_bf16 v[128:131], a[96:99], v[136:139], v[128:131]
    v_cvt_pk_bf16_f32 v7, v194, v195
    v_cvt_pk_bf16_f32 v8, v196, v197
    v_mfma_f32_16x16x32_bf16 v[112:115], a[100:103], v[140:143], v[112:115]
    v_cvt_pk_bf16_f32 v9, v198, v199
    v_cvt_pk_bf16_f32 v10, v200, v201
    v_mfma_f32_16x16x32_bf16 v[116:119], a[104:107], v[140:143], v[116:119]
    s_add_u32 s64, s77, 2621440
    s_add_u32 s65, s78, 2621440
    v_mfma_f32_16x16x32_bf16 v[120:123], a[108:111], v[140:143], v[120:123]
    buffer_store_dwordx4 v[6:9], v1, s[32:35], s64 offen sc1
    buffer_store_dword v10, v1, s[32:35], s65 offen sc1
    v_mfma_f32_16x16x32_bf16 v[124:127], a[112:115], v[140:143], v[124:127]
    s_add_u32 s65, s86, 1572864
    v_add_f32 v212, v192, v193
    v_mfma_f32_16x16x32_bf16 v[128:131], a[116:119], v[140:143], v[128:131]
    v_mul_f32 v213, v192, v192
    v_mul_f32 v215, v193, v193
    v_mfma_f32_16x16x32_bf16 v[112:115], a[120:123], v[144:147], v[112:115]
    v_add_f32 v214, v194, v195
    v_fmac_f32 v213, v194, v194
    v_mfma_f32_16x16x32_bf16 v[116:119], a[124:127], v[144:147], v[116:119]
    v_fmac_f32 v215, v195, v195
    v_fmac_f32 v213, v196, v196
    v_mfma_f32_16x16x32_bf16 v[120:123], a[128:131], v[144:147], v[120:123]
    v_fmac_f32 v215, v197, v197
    v_add_f32 v212, v212, v196
    v_mfma_f32_16x16x32_bf16 v[124:127], a[132:135], v[144:147], v[124:127]
    v_add_f32 v214, v214, v197
    v_fmac_f32 v213, v198, v198
    v_mfma_f32_16x16x32_bf16 v[128:131], a[136:139], v[144:147], v[128:131]
    v_fmac_f32 v215, v199, v199
    v_add_f32 v212, v212, v198
    v_mfma_f32_16x16x32_bf16 v[112:115], a[140:143], v[148:151], v[112:115]
    v_add_f32 v214, v214, v199
    v_fmac_f32 v213, v200, v200
    v_mfma_f32_16x16x32_bf16 v[116:119], a[144:147], v[148:151], v[116:119]
    v_fmac_f32 v215, v201, v201
    v_add_f32 v212, v212, v200
    v_mfma_f32_16x16x32_bf16 v[120:123], a[148:151], v[148:151], v[120:123]
    v_add_f32 v214, v214, v201
    v_add_f32 v212, v212, v214
    v_mfma_f32_16x16x32_bf16 v[124:127], a[152:155], v[148:151], v[124:127]
    v_add_f32 v213, v213, v215
    v_lshlrev_b32 v215, 4, v2
    v_mfma_f32_16x16x32_bf16 v[128:131], a[156:159], v[148:151], v[128:131]
    v_mov_b32 v214, s97
    v_permlane16_swap_b32 v212, v213
    v_mfma_f32_16x16x32_bf16 v[112:115], a[160:163], v[152:155], v[112:115]
    v_add_f32 v212, v212, v213
    v_mov_b32 v213, v212
    v_mfma_f32_16x16x32_bf16 v[116:119], a[164:167], v[152:155], v[116:119]
    s_nop 0
    v_permlane32_swap_b32 v212, v213
    v_add_f32 v212, v212, v213
    v_mfma_f32_16x16x32_bf16 v[120:123], a[168:171], v[152:155], v[120:123]
    v_mov_b32 v213, v212
    s_nop 1
    v_permlane16_swap_b32 v212, v213
    v_mfma_f32_16x16x32_bf16 v[124:127], a[172:175], v[152:155], v[124:127]
    s_add_u32 s64, s83, 8192
    v_mov_b32 v30, s97
    v_mfma_f32_16x16x32_bf16 v[128:131], a[176:179], v[152:155], v[128:131]
    v_mov_b32 v31, 0
    s_waitcnt vmcnt(0)
    v_mfma_f32_16x16x32_bf16 v[112:115], a[180:183], v[156:159], v[112:115]
    buffer_store_dword v30, v31, s[32:35], s64 offen offset:0 sc1
    buffer_store_dwordx3 v[212:214], v215, s[32:35], s65 offen offset:0 sc1
    v_mfma_f32_16x16x32_bf16 v[116:119], a[184:187], v[156:159], v[116:119]
    s_xor_b32 s68, s54, 0
    s_mul_i32 s68, s68, 5120
    v_mfma_f32_16x16x32_bf16 v[120:123], a[188:191], v[156:159], v[120:123]
    s_add_u32 s68, s68, 143360
    v_add_u32 v33, s68, v1
    v_mfma_f32_16x16x32_bf16 v[124:127], a[192:195], v[156:159], v[124:127]
    ds_write_b128 v33, v[92:95] offset:0
    ds_write_b128 v33, v[96:99] offset:1024
    v_mfma_f32_16x16x32_bf16 v[128:131], a[196:199], v[156:159], v[128:131]
    ds_write_b128 v33, v[100:103] offset:2048
    ds_write_b128 v33, v[104:107] offset:3072
    v_mfma_f32_16x16x32_bf16 v[112:115], a[200:203], v[160:163], v[112:115]
    ds_write_b128 v33, v[108:111] offset:4096
    s_xor_b32 s68, s54, 1
    v_mfma_f32_16x16x32_bf16 v[116:119], a[204:207], v[160:163], v[116:119]
    s_mul_i32 s68, s68, 5120
    s_add_u32 s68, s68, 143360
    v_mfma_f32_16x16x32_bf16 v[120:123], a[208:211], v[160:163], v[120:123]
    v_add_u32 v33, s68, v1
    s_xor_b32 s68, s54, 3
    v_mfma_f32_16x16x32_bf16 v[124:127], a[212:215], v[160:163], v[124:127]
    s_mul_i32 s68, s68, 5120
    s_add_u32 s68, s68, 143368
    v_mfma_f32_16x16x32_bf16 v[128:131], a[216:219], v[160:163], v[128:131]
    v_add_u32 v34, s68, v1
    v_mfma_f32_16x16x32_bf16 v[112:115], a[220:223], v[164:167], v[112:115]
    v_mfma_f32_16x16x32_bf16 v[116:119], a[224:227], v[164:167], v[116:119]
    v_mfma_f32_16x16x32_bf16 v[120:123], a[228:231], v[164:167], v[120:123]
    v_mfma_f32_16x16x32_bf16 v[124:127], a[232:235], v[164:167], v[124:127]
    v_mfma_f32_16x16x32_bf16 v[128:131], a[236:239], v[164:167], v[128:131]
    v_mfma_f32_16x16x32_bf16 v[112:115], a[240:243], v[168:171], v[112:115]
    v_mfma_f32_16x16x32_bf16 v[116:119], a[244:247], v[168:171], v[116:119]
    s_waitcnt lgkmcnt(0)
    s_barrier
    v_mfma_f32_16x16x32_bf16 v[120:123], a[248:251], v[168:171], v[120:123]
    ds_read_b64 v[92:93], v33 offset:0
    ds_read_b64 v[94:95], v33 offset:1024
    v_mfma_f32_16x16x32_bf16 v[124:127], a[252:255], v[168:171], v[124:127]
    ds_read_b64 v[96:97], v33 offset:2048
    ds_read_b64 v[98:99], v33 offset:3072
    v_mfma_f32_16x16x32_bf16 v[128:131], v[232:235], v[168:171], v[128:131]
    ds_read_b64 v[100:101], v33 offset:4096
    ds_read_b64 v[102:103], v34 offset:0
    v_mfma_f32_16x16x32_bf16 v[112:115], v[236:239], v[172:175], v[112:115]
    ds_read_b64 v[104:105], v34 offset:1024
    ds_read_b64 v[106:107], v34 offset:2048
    v_mfma_f32_16x16x32_bf16 v[116:119], v[240:243], v[172:175], v[116:119]
    ds_read_b64 v[108:109], v34 offset:3072
    ds_read_b64 v[110:111], v34 offset:4096
    v_mfma_f32_16x16x32_bf16 v[120:123], v[244:247], v[172:175], v[120:123]
    v_mfma_f32_16x16x32_bf16 v[124:127], v[248:251], v[172:175], v[124:127]
    v_mfma_f32_16x16x32_bf16 v[128:131], v[252:255], v[172:175], v[128:131]
    s_waitcnt lgkmcnt(4)
    v_add_f32 v92, v92, v102
    v_add_f32 v93, v93, v103
    s_waitcnt lgkmcnt(3)
    v_add_f32 v94, v94, v104
    v_add_f32 v95, v95, v105
    s_waitcnt lgkmcnt(2)
    v_add_f32 v96, v96, v106
    v_add_f32 v97, v97, v107
    s_waitcnt lgkmcnt(1)
    v_add_f32 v98, v98, v108
    v_add_f32 v99, v99, v109
    s_waitcnt lgkmcnt(0)
    v_add_f32 v100, v100, v110
    v_add_f32 v101, v101, v111
    v_lshlrev_b32 v102, 16, v12
    v_and_b32 v103, 0xffff0000, v12
    v_lshlrev_b32 v104, 16, v13
    v_and_b32 v105, 0xffff0000, v13
    v_lshlrev_b32 v106, 16, v14
    v_and_b32 v107, 0xffff0000, v14
    v_lshlrev_b32 v108, 16, v15
    v_and_b32 v109, 0xffff0000, v15
    v_lshlrev_b32 v110, 16, v16
    v_and_b32 v111, 0xffff0000, v16
    v_add_f32 v92, v92, v102
    v_add_f32 v93, v93, v103
    v_add_f32 v94, v94, v104
    v_add_f32 v95, v95, v105
    v_add_f32 v96, v96, v106
    v_add_f32 v97, v97, v107
    v_add_f32 v98, v98, v108
    v_add_f32 v99, v99, v109
    v_add_f32 v100, v100, v110
    v_add_f32 v101, v101, v111
    v_subrev_u32 v35, 8, v34
    v_mov_b32 v34, v33
    v_lshlrev_b32 v31, 2, v2
    s_add_u32 s66, s82, 8192
    buffer_load_dword v30, v31, s[32:35], s66 offen sc1
    ds_read_b128 v[160:163], v1 offset:0
    ds_read_b128 v[164:167], v1 offset:1024
    ds_read_b128 v[168:171], v1 offset:2048
    ds_read_b128 v[172:175], v1 offset:3072
    ds_read_b128 v[176:179], v1 offset:4096
    ds_read_b128 v[180:183], v1 offset:5120
    ds_read_b128 v[184:187], v1 offset:6144
    ds_read_b128 v[188:191], v1 offset:7168
    ds_read_b128 v[192:195], v1 offset:8192
    ds_read_b128 v[196:199], v1 offset:9216
    ds_read_b128 v[200:203], v1 offset:10240
    ds_read_b128 v[204:207], v1 offset:11264
    ds_write_b64 v34, v[114:115] offset:0
    ds_write_b64 v34, v[118:119] offset:1024
    ds_write_b64 v34, v[122:123] offset:2048
    ds_write_b64 v34, v[126:127] offset:3072
    ds_write_b64 v34, v[130:131] offset:4096
    v_pk_add_f32 v[92:93], v[92:93], v[112:113]
    v_pk_add_f32 v[94:95], v[94:95], v[116:117]
    v_pk_add_f32 v[96:97], v[96:97], v[120:121]
    v_pk_add_f32 v[98:99], v[98:99], v[124:125]
    v_pk_add_f32 v[100:101], v[100:101], v[128:129]
    s_waitcnt vmcnt(0)
    v_cmp_ne_u32 vcc, s97, v30
    s_cbranch_vccnz SPIN_198
BACK_199:
    s_add_u32 s93, s76, 2621440
    buffer_load_dwordx4 v[208:211], v1, s[32:35], s93 offen offset:0 sc1
    buffer_load_dwordx4 v[212:215], v1, s[32:35], s93 offen offset:1024 sc1
    buffer_load_dwordx4 v[216:219], v1, s[32:35], s93 offen offset:2048 sc1
    buffer_load_dwordx4 v[220:223], v1, s[32:35], s93 offen offset:3072 sc1
    s_add_u32 s93, s93, 4096
    buffer_load_dwordx4 v[224:227], v1, s[32:35], s93 offen offset:0 sc1
    buffer_load_dwordx4 v[228:231], v1, s[32:35], s93 offen offset:1024 sc1
    s_waitcnt lgkmcnt(0)
    s_barrier
    ds_read_b64 v[102:103], v35 offset:0
    ds_read_b64 v[104:105], v35 offset:1024
    ds_read_b64 v[106:107], v35 offset:2048
    ds_read_b64 v[108:109], v35 offset:3072
    ds_read_b64 v[110:111], v35 offset:4096
    s_waitcnt lgkmcnt(4)
    v_pk_add_f32 v[92:93], v[92:93], v[102:103]
    s_waitcnt lgkmcnt(3)
    v_pk_add_f32 v[94:95], v[94:95], v[104:105]
    s_waitcnt lgkmcnt(2)
    v_pk_add_f32 v[96:97], v[96:97], v[106:107]
    s_waitcnt lgkmcnt(1)
    v_pk_add_f32 v[98:99], v[98:99], v[108:109]
    s_waitcnt lgkmcnt(0)
    v_pk_add_f32 v[100:101], v[100:101], v[110:111]
    s_add_u32 s67, s88, 1572864
    buffer_load_dwordx3 v[116:118], v1, s[32:35], s67 offen offset:0 sc1
    buffer_load_dwordx3 v[120:122], v1, s[32:35], s67 offen offset:1024 sc1
    buffer_load_dwordx3 v[124:126], v1, s[32:35], s67 offen offset:2048 sc1
    buffer_load_dwordx3 v[128:130], v1, s[32:35], s67 offen offset:3072 sc1
    s_add_u32 s64, s86, 1056768
    v_add_f32 v112, v92, v93
    v_mul_f32 v113, v92, v92
    v_mul_f32 v115, v93, v93
    v_add_f32 v114, v94, v95
    v_fmac_f32 v113, v94, v94
    v_fmac_f32 v115, v95, v95
    v_fmac_f32 v113, v96, v96
    v_fmac_f32 v115, v97, v97
    v_add_f32 v112, v112, v96
    v_add_f32 v114, v114, v97
    v_fmac_f32 v113, v98, v98
    v_fmac_f32 v115, v99, v99
    v_add_f32 v112, v112, v98
    v_add_f32 v114, v114, v99
    v_fmac_f32 v113, v100, v100
    v_fmac_f32 v115, v101, v101
    v_add_f32 v112, v112, v100
    v_add_f32 v114, v114, v101
    v_add_f32 v112, v112, v114
    v_add_f32 v113, v113, v115
    v_lshlrev_b32 v115, 4, v2
    v_mov_b32 v114, s97
    v_permlane16_swap_b32 v112, v113
    v_add_f32 v112, v112, v113
    v_mov_b32 v113, v112
    s_nop 1
    v_permlane32_swap_b32 v112, v113
    v_add_f32 v112, v112, v113
    v_mov_b32 v113, v112
    s_nop 1
    v_permlane16_swap_b32 v112, v113
    buffer_store_dwordx3 v[112:114], v115, s[32:35], s64 offen offset:0 sc1
    s_waitcnt vmcnt(10)
    v_mfma_f32_16x16x32_bf16 v[132:135], v[160:163], v[208:211], 0
    ds_read_b128 v[160:163], v1 offset:12288
    s_barrier
    v_mfma_f32_16x16x32_bf16 v[136:139], v[164:167], v[208:211], 0
    ds_read_b128 v[164:167], v1 offset:13312
    v_mfma_f32_16x16x32_bf16 v[140:143], v[168:171], v[208:211], 0
    ds_read_b128 v[168:171], v1 offset:14336
    v_mfma_f32_16x16x32_bf16 v[144:147], v[172:175], v[208:211], 0
    ds_read_b128 v[172:175], v1 offset:15360
    v_mfma_f32_16x16x32_bf16 v[148:151], v[176:179], v[208:211], 0
    ds_read_b128 v[176:179], v1 offset:16384
    v_mfma_f32_16x16x32_bf16 v[152:155], v[180:183], v[208:211], 0
    ds_read_b128 v[180:183], v1 offset:17408
    s_waitcnt vmcnt(3)
    v_xor_b32 v118, v118, v122
    s_waitcnt vmcnt(1)
    v_xor_b32 v126, v126, v130
    v_xor_b32 v122, v122, v130
    v_xor_b32 v130, s97, v130
    v_or3_b32 v118, v118, v122, v126
    v_or_b32 v118, v118, v130
    v_cmp_ne_u32 vcc, 0, v118
    s_cbranch_vccnz SPIN_200
BACK_201:
    v_mfma_f32_16x16x32_bf16 v[156:159], v[184:187], v[208:211], 0
    ds_read_b128 v[184:187], v1 offset:18432
    buffer_load_dwordx4 v[208:211], v1, s[32:35], s93 offen offset:2048 sc1
    v_mfma_f32_16x16x32_bf16 v[132:135], v[188:191], v[212:215], v[132:135]
    ds_read_b128 v[188:191], v1 offset:19456
    v_mfma_f32_16x16x32_bf16 v[136:139], v[192:195], v[212:215], v[136:139]
    ds_read_b128 v[192:195], v1 offset:20480
    v_mfma_f32_16x16x32_bf16 v[140:143], v[196:199], v[212:215], v[140:143]
    ds_read_b128 v[196:199], v1 offset:21504
    v_mfma_f32_16x16x32_bf16 v[144:147], v[200:203], v[212:215], v[144:147]
    ds_read_b128 v[200:203], v1 offset:22528
    v_add_f32 v116, v116, v120
    v_add_f32 v117, v117, v121
    v_mfma_f32_16x16x32_bf16 v[148:151], v[204:207], v[212:215], v[148:151]
    ds_read_b128 v[204:207], v1 offset:23552
    s_waitcnt lgkmcnt(8)
    v_add_f32 v124, v124, v128
    v_mfma_f32_16x16x32_bf16 v[152:155], v[160:163], v[212:215], v[152:155]
    ds_read_b128 v[160:163], v1 offset:24576
    v_add_f32 v125, v125, v129
    v_add_f32 v116, v116, v124
    v_mfma_f32_16x16x32_bf16 v[156:159], v[164:167], v[212:215], v[156:159]
    ds_read_b128 v[164:167], v1 offset:25600
    buffer_load_dwordx4 v[212:215], v1, s[32:35], s93 offen offset:3072 sc1
    v_add_f32 v117, v117, v125
    v_mfma_f32_16x16x32_bf16 v[132:135], v[168:171], v[216:219], v[132:135]
    ds_read_b128 v[168:171], v1 offset:26624
    v_permlane16_swap_b32 v116, v117
    v_add_f32 v116, v116, v117
    v_mfma_f32_16x16x32_bf16 v[136:139], v[172:175], v[216:219], v[136:139]
    ds_read_b128 v[172:175], v1 offset:27648
    s_waitcnt lgkmcnt(8)
    v_mov_b32 v117, v116
    v_mfma_f32_16x16x32_bf16 v[140:143], v[176:179], v[216:219], v[140:143]
    ds_read_b128 v[176:179], v1 offset:28672
    v_permlane32_swap_b32 v116, v117
    v_add_f32 v116, v116, v117
    v_mfma_f32_16x16x32_bf16 v[144:147], v[180:183], v[216:219], v[144:147]
    ds_read_b128 v[180:183], v1 offset:29696
    v_mul_f32 v120, 0x3acccccd, v116
    v_mul_f32 v121, 0x3acccccd, v116
    v_mfma_f32_16x16x32_bf16 v[148:151], v[184:187], v[216:219], v[148:151]
    ds_read_b128 v[184:187], v1 offset:30720
    v_permlane16_swap_b32 v120, v121
    v_fma_f32 v121, -v120, v120, v121
    v_mfma_f32_16x16x32_bf16 v[152:155], v[188:191], v[216:219], v[152:155]
    ds_read_b128 v[188:191], v1 offset:31744
    s_waitcnt lgkmcnt(8)
    v_max_f32 v121, 0, v121
    v_mfma_f32_16x16x32_bf16 v[156:159], v[192:195], v[216:219], v[156:159]
    ds_read_b128 v[192:195], v1 offset:32768
    s_add_u32 s93, s93, 4096
    buffer_load_dwordx4 v[216:219], v1, s[32:35], s93 offen offset:0 sc1
    v_mfma_f32_16x16x32_bf16 v[132:135], v[196:199], v[220:223], v[132:135]
    ds_read_b128 v[196:199], v1 offset:33792
    v_cvt_pk_bf16_f32 v121, v121, v120
    v_and_b32 v120, 0xffff0000, v121
    v_mfma_f32_16x16x32_bf16 v[136:139], v[200:203], v[220:223], v[136:139]
    ds_read_b128 v[200:203], v1 offset:34816
    v_lshlrev_b32 v121, 16, v121
    v_add_f32 v121, 0x3727c5ac, v121
    v_mfma_f32_16x16x32_bf16 v[140:143], v[204:207], v[220:223], v[140:143]
    ds_read_b128 v[204:207], v1 offset:35840
    s_waitcnt lgkmcnt(8)
    v_cvt_pk_bf16_f32 v121, v121, v121
    v_mfma_f32_16x16x32_bf16 v[144:147], v[160:163], v[220:223], v[144:147]
    ds_read_b128 v[160:163], v1 offset:36864
    v_lshlrev_b32 v121, 16, v121
    v_sqrt_f32 v121, v121
    v_mfma_f32_16x16x32_bf16 v[148:151], v[164:167], v[220:223], v[148:151]
    ds_read_b128 v[164:167], v1 offset:37888
    v_cvt_pk_bf16_f32 v121, v121, v121
    v_mfma_f32_16x16x32_bf16 v[152:155], v[168:171], v[220:223], v[152:155]
    ds_read_b128 v[168:171], v1 offset:38912
    v_lshlrev_b32 v121, 16, v121
    v_rcp_f32 v122, v121
    v_mfma_f32_16x16x32_bf16 v[156:159], v[172:175], v[220:223], v[156:159]
    ds_read_b128 v[172:175], v1 offset:39936
    s_waitcnt lgkmcnt(8)
    buffer_load_dwordx4 v[220:223], v1, s[32:35], s93 offen offset:1024 sc1
    v_mfma_f32_16x16x32_bf16 v[132:135], v[176:179], v[224:227], v[132:135]
    ds_read_b128 v[176:179], v1 offset:40960
    v_xor_b32 v120, 0x80000000, v120
    v_mfma_f32_16x16x32_bf16 v[136:139], v[180:183], v[224:227], v[136:139]
    ds_read_b128 v[180:183], v1 offset:41984
    v_lshrrev_b32 v123, 16, v120
    v_or_b32 v120, v120, v123
    v_mfma_f32_16x16x32_bf16 v[140:143], v[184:187], v[224:227], v[140:143]
    ds_read_b128 v[184:187], v1 offset:43008
    v_or_b32 v121, v121, v123
    v_mul_f32 v54, 0x3fb8aa3b, v122
    v_mfma_f32_16x16x32_bf16 v[144:147], v[188:191], v[224:227], v[144:147]
    ds_read_b128 v[188:191], v1 offset:44032
    s_waitcnt lgkmcnt(8)
    v_cndmask_b32 v50, 0, v120, s[100:101]
    v_mfma_f32_16x16x32_bf16 v[148:151], v[192:195], v[224:227], v[148:151]
    ds_read_b128 v[192:195], v1 offset:45056
    v_cndmask_b32 v51, 0, v121, s[100:101]
    s_add_u32 s69, s87, 1056768
    v_mfma_f32_16x16x32_bf16 v[152:155], v[196:199], v[224:227], v[152:155]
    ds_read_b128 v[196:199], v1 offset:46080
    buffer_load_dwordx3 v[112:114], v1, s[32:35], s69 offen offset:0 sc1
    buffer_load_dwordx3 v[116:118], v1, s[32:35], s69 offen offset:1024 sc1
    v_mfma_f32_16x16x32_bf16 v[156:159], v[200:203], v[224:227], v[156:159]
    ds_read_b128 v[200:203], v1 offset:47104
    buffer_load_dwordx4 v[224:227], v1, s[32:35], s93 offen offset:2048 sc1
    buffer_load_dwordx3 v[120:122], v1, s[32:35], s69 offen offset:2048 sc1
    v_mfma_f32_16x16x32_bf16 v[132:135], v[204:207], v[228:231], v[132:135]
    ds_read_b128 v[204:207], v1 offset:48128
    s_waitcnt lgkmcnt(8)
    buffer_load_dwordx3 v[124:126], v1, s[32:35], s69 offen offset:3072 sc1
    v_mfma_f32_16x16x32_bf16 v[136:139], v[160:163], v[228:231], v[136:139]
    ds_read_b128 v[160:163], v1 offset:49152
    v_mfma_f32_16x16x32_bf16 v[140:143], v[164:167], v[228:231], v[140:143]
    ds_read_b128 v[164:167], v1 offset:50176
    v_mfma_f32_16x16x32_bf16 v[144:147], v[168:171], v[228:231], v[144:147]
    ds_read_b128 v[168:171], v1 offset:51200
    v_mfma_f32_16x16x32_bf16 v[148:151], v[172:175], v[228:231], v[148:151]
    ds_read_b128 v[172:175], v1 offset:52224
    s_waitcnt lgkmcnt(8)
    s_waitcnt vmcnt(3)
    v_xor_b32 v114, v114, v118
    s_waitcnt vmcnt(0)
    v_xor_b32 v122, v122, v126
    v_xor_b32 v118, v118, v126
    v_xor_b32 v126, s97, v126
    v_or3_b32 v114, v114, v118, v122
    v_or_b32 v114, v114, v126
    v_cmp_ne_u32 vcc, 0, v114
    s_cbranch_vccnz SPIN_202
BACK_203:
    v_add_f32 v112, v112, v116
    v_add_f32 v113, v113, v117
    v_add_f32 v120, v120, v124
    v_add_f32 v121, v121, v125
    v_add_f32 v112, v112, v120
    v_add_f32 v113, v113, v121
    s_nop 1
    v_permlane16_swap_b32 v112, v113
    v_add_f32 v112, v112, v113
    v_mov_b32 v113, v112
    s_nop 1
    v_permlane32_swap_b32 v112, v113
    v_add_f32 v112, v112, v113
    v_mul_f32 v30, 0x3acccccd, v112
    v_mul_f32 v31, 0x3acccccd, v112
    s_nop 1
    v_permlane16_swap_b32 v30, v31
    v_fma_f32 v31, -v30, v30, v31
    v_max_f32 v31, 0, v31
    v_cvt_pk_bf16_f32 v31, v31, v30
    v_and_b32 v30, 0xffff0000, v31
    v_lshlrev_b32 v31, 16, v31
    v_add_f32 v31, 0x3727c5ac, v31
    v_cvt_pk_bf16_f32 v31, v31, v31
    v_lshlrev_b32 v31, 16, v31
    v_sqrt_f32 v31, v31
    s_nop 0
    v_cvt_pk_bf16_f32 v31, v31, v31
    v_lshlrev_b32 v31, 16, v31
    v_rcp_f32 v31, v31
    s_nop 0
    v_mul_f32 v32, -v30, v31
    v_lshlrev_b32 v102, 16, v22
    v_and_b32 v103, 0xffff0000, v22
    v_lshlrev_b32 v104, 16, v23
    v_and_b32 v105, 0xffff0000, v23
    v_lshlrev_b32 v106, 16, v24
    v_and_b32 v107, 0xffff0000, v24
    v_lshlrev_b32 v108, 16, v25
    v_and_b32 v109, 0xffff0000, v25
    v_lshlrev_b32 v110, 16, v26
    v_and_b32 v111, 0xffff0000, v26
    v_pk_fma_f32 v[112:113], v[92:93], v[30:31], v[32:33] op_sel:[0,1,0] op_sel_hi:[1,1,0]
    v_pk_fma_f32 v[114:115], v[94:95], v[30:31], v[32:33] op_sel:[0,1,0] op_sel_hi:[1,1,0]
    v_pk_fma_f32 v[116:117], v[96:97], v[30:31], v[32:33] op_sel:[0,1,0] op_sel_hi:[1,1,0]
    v_pk_fma_f32 v[118:119], v[98:99], v[30:31], v[32:33] op_sel:[0,1,0] op_sel_hi:[1,1,0]
    v_pk_fma_f32 v[120:121], v[100:101], v[30:31], v[32:33] op_sel:[0,1,0] op_sel_hi:[1,1,0]
    v_pk_fma_f32 v[92:93], v[112:113], v[102:103], v[92:93]
    v_pk_fma_f32 v[94:95], v[114:115], v[104:105], v[94:95]
    v_pk_fma_f32 v[96:97], v[116:117], v[106:107], v[96:97]
    v_pk_fma_f32 v[98:99], v[118:119], v[108:109], v[98:99]
    v_pk_fma_f32 v[100:101], v[120:121], v[110:111], v[100:101]
    v_cvt_pk_bf16_f32 v12, v92, v93
    v_cvt_pk_bf16_f32 v13, v94, v95
    v_cvt_pk_bf16_f32 v14, v96, v97
    v_cvt_pk_bf16_f32 v15, v98, v99
    v_cvt_pk_bf16_f32 v16, v100, v101
    s_add_u32 s64, s77, 2662400
    s_add_u32 s65, s78, 2662400
    buffer_store_dwordx4 v[12:15], v1, s[32:35], s64 offen sc1
    buffer_store_dword v16, v1, s[32:35], s65 offen sc1
    v_mfma_f32_16x16x32_bf16 v[152:155], v[176:179], v[228:231], v[152:155]
    ds_read_b128 v[176:179], v1 offset:53248
    v_mfma_f32_16x16x32_bf16 v[156:159], v[180:183], v[228:231], v[156:159]
    ds_read_b128 v[180:183], v1 offset:54272
    buffer_load_dwordx4 v[228:231], v1, s[32:35], s93 offen offset:3072 sc1
    v_mfma_f32_16x16x32_bf16 v[132:135], v[184:187], v[208:211], v[132:135]
    ds_read_b128 v[184:187], v1 offset:55296
    v_mfma_f32_16x16x32_bf16 v[136:139], v[188:191], v[208:211], v[136:139]
    ds_read_b128 v[188:191], v1 offset:56320
    s_waitcnt lgkmcnt(8)
    v_mfma_f32_16x16x32_bf16 v[140:143], v[192:195], v[208:211], v[140:143]
    ds_read_b128 v[192:195], v28 offset:0
    v_mfma_f32_16x16x32_bf16 v[144:147], v[196:199], v[208:211], v[144:147]
    ds_read_b128 v[196:199], v28 offset:1024
    v_mfma_f32_16x16x32_bf16 v[148:151], v[200:203], v[208:211], v[148:151]
    ds_read_b128 v[200:203], v28 offset:2048
    v_mfma_f32_16x16x32_bf16 v[152:155], v[204:207], v[208:211], v[152:155]
    ds_read_b128 v[204:207], v28 offset:3072
    s_waitcnt lgkmcnt(8)
    v_mfma_f32_16x16x32_bf16 v[156:159], v[160:163], v[208:211], v[156:159]
    ds_read_b128 v[160:163], v28 offset:4096
    s_add_u32 s93, s93, 4096
    buffer_load_dwordx4 v[208:211], v1, s[32:35], s93 offen offset:0 sc1
    v_mfma_f32_16x16x32_bf16 v[132:135], v[164:167], v[212:215], v[132:135]
    ds_read_b128 v[164:167], v28 offset:5120
    v_mfma_f32_16x16x32_bf16 v[136:139], v[168:171], v[212:215], v[136:139]
    ds_read_b128 v[168:171], v28 offset:6144
    s_add_u32 s64, s83, 8320
    v_mfma_f32_16x16x32_bf16 v[140:143], v[172:175], v[212:215], v[140:143]
    ds_read_b128 v[172:175], v28 offset:7168
    s_waitcnt lgkmcnt(8)
    v_mfma_f32_16x16x32_bf16 v[144:147], v[176:179], v[212:215], v[144:147]
    ds_read_b128 v[176:179], v28 offset:8192
    v_mov_b32 v30, s97
    v_mfma_f32_16x16x32_bf16 v[148:151], v[180:183], v[212:215], v[148:151]
    ds_read_b128 v[180:183], v28 offset:9216
    v_mov_b32 v31, 0
    v_mfma_f32_16x16x32_bf16 v[152:155], v[184:187], v[212:215], v[152:155]
    ds_read_b128 v[184:187], v28 offset:10240
    s_waitcnt vmcnt(2)
    v_mfma_f32_16x16x32_bf16 v[156:159], v[188:191], v[212:215], v[156:159]
    ds_read_b128 v[188:191], v28 offset:11264
    s_waitcnt lgkmcnt(8)
    buffer_load_dwordx4 v[212:215], v1, s[32:35], s93 offen offset:1024 sc1
    v_mfma_f32_16x16x32_bf16 v[132:135], v[192:195], v[216:219], v[132:135]
    ds_read_b128 v[192:195], v28 offset:12288
    v_mfma_f32_16x16x32_bf16 v[136:139], v[196:199], v[216:219], v[136:139]
    ds_read_b128 v[196:199], v28 offset:13312
    buffer_store_dword v30, v31, s[32:35], s64 offen offset:0 sc1
    v_mfma_f32_16x16x32_bf16 v[140:143], v[200:203], v[216:219], v[140:143]
    ds_read_b128 v[200:203], v28 offset:14336
    s_add_u32 s65, s86, 1581056
    v_mfma_f32_16x16x32_bf16 v[144:147], v[204:207], v[216:219], v[144:147]
    ds_read_b128 v[204:207], v28 offset:15360
    s_waitcnt lgkmcnt(8)
    v_mfma_f32_16x16x32_bf16 v[148:151], v[160:163], v[216:219], v[148:151]
    ds_read_b128 v[160:163], v28 offset:16384
    v_add_f32 v112, v92, v93
    v_mfma_f32_16x16x32_bf16 v[152:155], v[164:167], v[216:219], v[152:155]
    ds_read_b128 v[164:167], v28 offset:17408
    v_mul_f32 v113, v92, v92
    v_mfma_f32_16x16x32_bf16 v[156:159], v[168:171], v[216:219], v[156:159]
    ds_read_b128 v[168:171], v28 offset:18432
    buffer_load_dwordx4 v[216:219], v1, s[32:35], s93 offen offset:2048 sc1
    v_mfma_f32_16x16x32_bf16 v[132:135], v[172:175], v[220:223], v[132:135]
    ds_read_b128 v[172:175], v28 offset:19456
    s_waitcnt lgkmcnt(8)
    v_mfma_f32_16x16x32_bf16 v[136:139], v[176:179], v[220:223], v[136:139]
    ds_read_b128 v[176:179], v28 offset:20480
    v_mul_f32 v115, v93, v93
    v_mfma_f32_16x16x32_bf16 v[140:143], v[180:183], v[220:223], v[140:143]
    ds_read_b128 v[180:183], v28 offset:21504
    v_add_f32 v114, v94, v95
    v_mfma_f32_16x16x32_bf16 v[144:147], v[184:187], v[220:223], v[144:147]
    ds_read_b128 v[184:187], v28 offset:22528
    v_fmac_f32 v113, v94, v94
    v_mfma_f32_16x16x32_bf16 v[148:151], v[188:191], v[220:223], v[148:151]
    ds_read_b128 v[188:191], v28 offset:23552
    s_waitcnt lgkmcnt(8)
    v_mfma_f32_16x16x32_bf16 v[152:155], v[192:195], v[220:223], v[152:155]
    ds_read_b128 v[192:195], v28 offset:24576
    v_fmac_f32 v115, v95, v95
    v_mfma_f32_16x16x32_bf16 v[156:159], v[196:199], v[220:223], v[156:159]
    ds_read_b128 v[196:199], v28 offset:25600
    buffer_load_dwordx4 v[220:223], v1, s[32:35], s93 offen offset:3072 sc1
    v_mfma_f32_16x16x32_bf16 v[132:135], v[200:203], v[224:227], v[132:135]
    ds_read_b128 v[200:203], v28 offset:26624
    v_fmac_f32 v113, v96, v96
    v_mfma_f32_16x16x32_bf16 v[136:139], v[204:207], v[224:227], v[136:139]
    ds_read_b128 v[204:207], v28 offset:27648
    s_waitcnt lgkmcnt(8)
    v_mfma_f32_16x16x32_bf16 v[140:143], v[160:163], v[224:227], v[140:143]
    ds_read_b128 v[160:163], v28 offset:28672
    v_fmac_f32 v115, v97, v97
    v_mfma_f32_16x16x32_bf16 v[144:147], v[164:167], v[224:227], v[144:147]
    ds_read_b128 v[164:167], v28 offset:29696
    v_add_f32 v112, v112, v96
    v_mfma_f32_16x16x32_bf16 v[148:151], v[168:171], v[224:227], v[148:151]
    ds_read_b128 v[168:171], v28 offset:30720
    v_add_f32 v114, v114, v97
    v_mfma_f32_16x16x32_bf16 v[152:155], v[172:175], v[224:227], v[152:155]
    ds_read_b128 v[172:175], v28 offset:31744
    s_waitcnt lgkmcnt(8)
    v_mfma_f32_16x16x32_bf16 v[156:159], v[176:179], v[224:227], v[156:159]
    ds_read_b128 v[176:179], v28 offset:32768
    s_add_u32 s93, s93, 4096
    buffer_load_dwordx4 v[224:227], v1, s[32:35], s93 offen offset:0 sc1
    s_waitcnt vmcnt(6)
    v_mfma_f32_16x16x32_bf16 v[132:135], v[180:183], v[228:231], v[132:135]
    ds_read_b128 v[180:183], v28 offset:33792
    v_mfma_f32_16x16x32_bf16 v[136:139], v[184:187], v[228:231], v[136:139]
    ds_read_b128 v[184:187], v28 offset:34816
    v_fmac_f32 v113, v98, v98
    v_mfma_f32_16x16x32_bf16 v[140:143], v[188:191], v[228:231], v[140:143]
    ds_read_b128 v[188:191], v28 offset:35840
    s_waitcnt lgkmcnt(8)
    v_mfma_f32_16x16x32_bf16 v[144:147], v[192:195], v[228:231], v[144:147]
    ds_read_b128 v[192:195], v28 offset:36864
    v_fmac_f32 v115, v99, v99
    v_mfma_f32_16x16x32_bf16 v[148:151], v[196:199], v[228:231], v[148:151]
    ds_read_b128 v[196:199], v28 offset:37888
    v_add_f32 v112, v112, v98
    v_mfma_f32_16x16x32_bf16 v[152:155], v[200:203], v[228:231], v[152:155]
    ds_read_b128 v[200:203], v28 offset:38912
    v_add_f32 v114, v114, v99
    v_mfma_f32_16x16x32_bf16 v[156:159], v[204:207], v[228:231], v[156:159]
    ds_read_b128 v[204:207], v28 offset:39936
    s_waitcnt lgkmcnt(8)
    buffer_load_dwordx4 v[228:231], v1, s[32:35], s93 offen offset:1024 sc1
    s_waitcnt vmcnt(6)
    v_mfma_f32_16x16x32_bf16 v[132:135], v[160:163], v[208:211], v[132:135]
    ds_read_b128 v[160:163], v28 offset:40960
    v_mfma_f32_16x16x32_bf16 v[136:139], v[164:167], v[208:211], v[136:139]
    ds_read_b128 v[164:167], v28 offset:41984
    v_fmac_f32 v113, v100, v100
    v_mfma_f32_16x16x32_bf16 v[140:143], v[168:171], v[208:211], v[140:143]
    ds_read_b128 v[168:171], v28 offset:43008
    v_fmac_f32 v115, v101, v101
    v_mfma_f32_16x16x32_bf16 v[144:147], v[172:175], v[208:211], v[144:147]
    ds_read_b128 v[172:175], v28 offset:44032
    s_waitcnt lgkmcnt(8)
    v_mfma_f32_16x16x32_bf16 v[148:151], v[176:179], v[208:211], v[148:151]
    ds_read_b128 v[176:179], v28 offset:45056
    v_add_f32 v112, v112, v100
    v_mfma_f32_16x16x32_bf16 v[152:155], v[180:183], v[208:211], v[152:155]
    ds_read_b128 v[180:183], v28 offset:46080
    v_add_f32 v114, v114, v101
    v_mfma_f32_16x16x32_bf16 v[156:159], v[184:187], v[208:211], v[156:159]
    ds_read_b128 v[184:187], v28 offset:47104
    buffer_load_dwordx4 v[208:211], v1, s[32:35], s93 offen offset:2048 sc1
    s_waitcnt vmcnt(6)
    v_mfma_f32_16x16x32_bf16 v[132:135], v[188:191], v[212:215], v[132:135]
    ds_read_b128 v[188:191], v28 offset:48128
    s_waitcnt lgkmcnt(8)
    v_mfma_f32_16x16x32_bf16 v[136:139], v[192:195], v[212:215], v[136:139]
    ds_read_b128 v[192:195], v28 offset:49152
    v_add_f32 v112, v112, v114
    v_mfma_f32_16x16x32_bf16 v[140:143], v[196:199], v[212:215], v[140:143]
    ds_read_b128 v[196:199], v28 offset:50176
    v_add_f32 v113, v113, v115
    v_mfma_f32_16x16x32_bf16 v[144:147], v[200:203], v[212:215], v[144:147]
    ds_read_b128 v[200:203], v28 offset:51200
    v_lshlrev_b32 v115, 4, v2
    v_mfma_f32_16x16x32_bf16 v[148:151], v[204:207], v[212:215], v[148:151]
    ds_read_b128 v[204:207], v28 offset:52224
    s_waitcnt lgkmcnt(8)
    v_mfma_f32_16x16x32_bf16 v[152:155], v[160:163], v[212:215], v[152:155]
    ds_read_b128 v[160:163], v28 offset:53248
    v_mov_b32 v114, s97
    v_mfma_f32_16x16x32_bf16 v[156:159], v[164:167], v[212:215], v[156:159]
    ds_read_b128 v[164:167], v28 offset:54272
    buffer_load_dwordx4 v[212:215], v1, s[32:35], s93 offen offset:3072 sc1
    s_waitcnt vmcnt(5)
    v_mfma_f32_16x16x32_bf16 v[132:135], v[168:171], v[216:219], v[132:135]
    ds_read_b128 v[168:171], v28 offset:55296
    v_permlane16_swap_b32 v112, v113
    v_mfma_f32_16x16x32_bf16 v[136:139], v[172:175], v[216:219], v[136:139]
    ds_read_b128 v[172:175], v28 offset:56320
    s_waitcnt lgkmcnt(8)
    v_mfma_f32_16x16x32_bf16 v[140:143], v[176:179], v[216:219], v[140:143]
    ds_read_b128 v[176:179], v29 offset:0
    v_add_f32 v112, v112, v113
    v_mfma_f32_16x16x32_bf16 v[144:147], v[180:183], v[216:219], v[144:147]
    ds_read_b128 v[180:183], v29 offset:1024
    v_mov_b32 v113, v112
    v_mfma_f32_16x16x32_bf16 v[148:151], v[184:187], v[216:219], v[148:151]
    ds_read_b128 v[184:187], v29 offset:2048
    v_permlane32_swap_b32 v112, v113
    v_mfma_f32_16x16x32_bf16 v[152:155], v[188:191], v[216:219], v[152:155]
    ds_read_b128 v[188:191], v29 offset:3072
    s_waitcnt lgkmcnt(8)
    v_mfma_f32_16x16x32_bf16 v[156:159], v[192:195], v[216:219], v[156:159]
    ds_read_b128 v[192:195], v29 offset:4096
    v_add_f32 v112, v112, v113
    s_waitcnt vmcnt(4)
    v_mfma_f32_16x16x32_bf16 v[132:135], v[196:199], v[220:223], v[132:135]
    ds_read_b128 v[196:199], v29 offset:5120
    v_mov_b32 v113, v112
    v_mfma_f32_16x16x32_bf16 v[136:139], v[200:203], v[220:223], v[136:139]
    ds_read_b128 v[200:203], v29 offset:6144
    v_permlane16_swap_b32 v112, v113
    v_mfma_f32_16x16x32_bf16 v[140:143], v[204:207], v[220:223], v[140:143]
    ds_read_b128 v[204:207], v29 offset:7168
    s_waitcnt lgkmcnt(8)
    v_mfma_f32_16x16x32_bf16 v[144:147], v[160:163], v[220:223], v[144:147]
    ds_read_b128 v[160:163], v29 offset:8192
    buffer_store_dwordx3 v[112:114], v115, s[32:35], s65 offen offset:0 sc1
    v_mfma_f32_16x16x32_bf16 v[148:151], v[164:167], v[220:223], v[148:151]
    ds_read_b128 v[164:167], v29 offset:9216
    v_mfma_f32_16x16x32_bf16 v[152:155], v[168:171], v[220:223], v[152:155]
    ds_read_b128 v[168:171], v29 offset:10240
    v_mfma_f32_16x16x32_bf16 v[156:159], v[172:175], v[220:223], v[156:159]
    ds_read_b128 v[172:175], v29 offset:11264
    s_waitcnt lgkmcnt(8)
    s_waitcnt vmcnt(4)
    v_mfma_f32_16x16x32_bf16 v[132:135], v[176:179], v[224:227], v[132:135]
    ds_read_b128 v[176:179], v29 offset:12288
    v_mfma_f32_16x16x32_bf16 v[136:139], v[180:183], v[224:227], v[136:139]
    ds_read_b128 v[180:183], v29 offset:13312
    v_mfma_f32_16x16x32_bf16 v[140:143], v[184:187], v[224:227], v[140:143]
    ds_read_b128 v[184:187], v29 offset:14336
    v_mfma_f32_16x16x32_bf16 v[144:147], v[188:191], v[224:227], v[144:147]
    ds_read_b128 v[188:191], v29 offset:15360
    s_waitcnt lgkmcnt(8)
    v_mfma_f32_16x16x32_bf16 v[148:151], v[192:195], v[224:227], v[148:151]
    ds_read_b128 v[192:195], v29 offset:16384
    v_mfma_f32_16x16x32_bf16 v[152:155], v[196:199], v[224:227], v[152:155]
    ds_read_b128 v[196:199], v29 offset:17408
    v_mfma_f32_16x16x32_bf16 v[156:159], v[200:203], v[224:227], v[156:159]
    ds_read_b128 v[200:203], v29 offset:18432
    s_waitcnt vmcnt(3)
    v_mfma_f32_16x16x32_bf16 v[132:135], v[204:207], v[228:231], v[132:135]
    ds_read_b128 v[204:207], v29 offset:19456
    s_waitcnt lgkmcnt(8)
    v_mfma_f32_16x16x32_bf16 v[136:139], v[160:163], v[228:231], v[136:139]
    ds_read_b128 v[160:163], v29 offset:20480
    v_mfma_f32_16x16x32_bf16 v[140:143], v[164:167], v[228:231], v[140:143]
    ds_read_b128 v[164:167], v29 offset:21504
    v_mfma_f32_16x16x32_bf16 v[144:147], v[168:171], v[228:231], v[144:147]
    ds_read_b128 v[168:171], v29 offset:22528
    v_mfma_f32_16x16x32_bf16 v[148:151], v[172:175], v[228:231], v[148:151]
    ds_read_b128 v[172:175], v29 offset:23552
    s_waitcnt lgkmcnt(8)
    v_mfma_f32_16x16x32_bf16 v[152:155], v[176:179], v[228:231], v[152:155]
    ds_read_b128 v[176:179], v29 offset:24576
    v_mfma_f32_16x16x32_bf16 v[156:159], v[180:183], v[228:231], v[156:159]
    ds_read_b128 v[180:183], v29 offset:25600
    s_waitcnt vmcnt(2)
    v_mfma_f32_16x16x32_bf16 v[132:135], v[184:187], v[208:211], v[132:135]
    ds_read_b128 v[184:187], v29 offset:26624
    v_mfma_f32_16x16x32_bf16 v[136:139], v[188:191], v[208:211], v[136:139]
    ds_read_b128 v[188:191], v29 offset:27648
    s_waitcnt lgkmcnt(8)
    v_mfma_f32_16x16x32_bf16 v[140:143], v[192:195], v[208:211], v[140:143]
    ds_read_b128 v[192:195], v1 offset:0
    v_mfma_f32_16x16x32_bf16 v[144:147], v[196:199], v[208:211], v[144:147]
    ds_read_b128 v[196:199], v1 offset:1024
    v_mfma_f32_16x16x32_bf16 v[148:151], v[200:203], v[208:211], v[148:151]
    ds_read_b128 v[200:203], v1 offset:2048
    v_mfma_f32_16x16x32_bf16 v[152:155], v[204:207], v[208:211], v[152:155]
    ds_read_b128 v[204:207], v1 offset:3072
    s_waitcnt lgkmcnt(8)
    v_mfma_f32_16x16x32_bf16 v[156:159], v[160:163], v[208:211], v[156:159]
    ds_read_b128 v[160:163], v1 offset:4096
    s_waitcnt vmcnt(1)
    v_mfma_f32_16x16x32_bf16 v[132:135], v[164:167], v[212:215], v[132:135]
    ds_read_b128 v[164:167], v1 offset:5120
    v_mfma_f32_16x16x32_bf16 v[136:139], v[168:171], v[212:215], v[136:139]
    ds_read_b128 v[168:171], v1 offset:6144
    v_mfma_f32_16x16x32_bf16 v[140:143], v[172:175], v[212:215], v[140:143]
    ds_read_b128 v[172:175], v1 offset:7168
    s_waitcnt lgkmcnt(8)
    v_mfma_f32_16x16x32_bf16 v[144:147], v[176:179], v[212:215], v[144:147]
    ds_read_b128 v[176:179], v1 offset:8192
    v_mfma_f32_16x16x32_bf16 v[148:151], v[180:183], v[212:215], v[148:151]
    ds_read_b128 v[180:183], v1 offset:9216
    v_mfma_f32_16x16x32_bf16 v[152:155], v[184:187], v[212:215], v[152:155]
    ds_read_b128 v[184:187], v1 offset:10240
    v_mfma_f32_16x16x32_bf16 v[156:159], v[188:191], v[212:215], v[156:159]
    ds_read_b128 v[188:191], v1 offset:11264
    s_waitcnt lgkmcnt(8)
    v_mfma_f32_16x16x16_bf16 v[132:135], v[36:37], v[50:51], v[132:135]
    v_mfma_f32_16x16x16_bf16 v[136:139], v[38:39], v[50:51], v[136:139]
    v_mfma_f32_16x16x16_bf16 v[140:143], v[40:41], v[50:51], v[140:143]
    v_mfma_f32_16x16x16_bf16 v[144:147], v[42:43], v[50:51], v[144:147]
    v_mfma_f32_16x16x16_bf16 v[148:151], v[44:45], v[50:51], v[148:151]
    v_mfma_f32_16x16x16_bf16 v[152:155], v[46:47], v[50:51], v[152:155]
    v_mfma_f32_16x16x16_bf16 v[156:159], v[48:49], v[50:51], v[156:159]
    v_lshlrev_b32 v121, 2, v2
    s_add_u32 s66, s82, 8320
    buffer_load_dword v120, v121, s[32:35], s66 offen sc1
    v_mov_b32 v108, 0x3f317218
    v_mov_b32 v110, 0xbfb17218
    s_add_u32 s64, s79, 7077888
    s_add_u32 s65, s80, 7077888
    v_pk_mul_f32 v[132:133], v[132:133], v[54:55] op_sel:[0,0] op_sel_hi:[1,0]
    v_pk_mul_f32 v[134:135], v[134:135], v[54:55] op_sel:[0,0] op_sel_hi:[1,0]
    v_pk_mul_f32 v[136:137], v[136:137], v[54:55] op_sel:[0,0] op_sel_hi:[1,0]
    v_pk_mul_f32 v[138:139], v[138:139], v[54:55] op_sel:[0,0] op_sel_hi:[1,0]
    v_exp_f32 v92, v132
    v_exp_f32 v93, v133
    v_exp_f32 v94, v134
    v_exp_f32 v95, v135
    v_exp_f32 v96, v136
    v_exp_f32 v97, v137
    v_exp_f32 v98, v138
    v_exp_f32 v99, v139
    v_pk_add_f32 v[92:93], v[92:93], 1.0 op_sel_hi:[1,0]
    v_pk_add_f32 v[94:95], v[94:95], 1.0 op_sel_hi:[1,0]
    v_pk_add_f32 v[96:97], v[96:97], 1.0 op_sel_hi:[1,0]
    v_pk_add_f32 v[98:99], v[98:99], 1.0 op_sel_hi:[1,0]
    v_pk_fma_f32 v[92:93], v[92:93], v[92:93], 1.0 op_sel_hi:[1,1,0]
    v_pk_fma_f32 v[94:95], v[94:95], v[94:95], 1.0 op_sel_hi:[1,1,0]
    v_pk_fma_f32 v[96:97], v[96:97], v[96:97], 1.0 op_sel_hi:[1,1,0]
    v_pk_fma_f32 v[98:99], v[98:99], v[98:99], 1.0 op_sel_hi:[1,1,0]
    v_rcp_f32 v92, v92
    v_rcp_f32 v93, v93
    v_rcp_f32 v94, v94
    v_rcp_f32 v95, v95
    v_rcp_f32 v96, v96
    v_rcp_f32 v97, v97
    v_rcp_f32 v98, v98
    v_rcp_f32 v99, v99
    v_pk_fma_f32 v[92:93], v[92:93], v[110:111], v[108:109] op_sel_hi:[1,0,0]
    v_pk_fma_f32 v[94:95], v[94:95], v[110:111], v[108:109] op_sel_hi:[1,0,0]
    v_pk_fma_f32 v[96:97], v[96:97], v[110:111], v[108:109] op_sel_hi:[1,0,0]
    v_pk_fma_f32 v[98:99], v[98:99], v[110:111], v[108:109] op_sel_hi:[1,0,0]
    v_pk_mul_f32 v[132:133], v[132:133], v[92:93]
    v_pk_mul_f32 v[134:135], v[134:135], v[94:95]
    v_pk_mul_f32 v[136:137], v[136:137], v[96:97]
    v_pk_mul_f32 v[138:139], v[138:139], v[98:99]
    v_cvt_pk_bf16_f32 v100, v132, v133
    v_cvt_pk_bf16_f32 v101, v134, v135
    v_cvt_pk_bf16_f32 v102, v136, v137
    v_cvt_pk_bf16_f32 v103, v138, v139
    buffer_store_dwordx4 v[100:103], v1, s[32:35], s64 offen offset:0 sc1
    v_pk_mul_f32 v[140:141], v[140:141], v[54:55] op_sel:[0,0] op_sel_hi:[1,0]
    v_pk_mul_f32 v[142:143], v[142:143], v[54:55] op_sel:[0,0] op_sel_hi:[1,0]
    v_pk_mul_f32 v[144:145], v[144:145], v[54:55] op_sel:[0,0] op_sel_hi:[1,0]
    v_pk_mul_f32 v[146:147], v[146:147], v[54:55] op_sel:[0,0] op_sel_hi:[1,0]
    v_exp_f32 v92, v140
    v_exp_f32 v93, v141
    v_exp_f32 v94, v142
    v_exp_f32 v95, v143
    v_exp_f32 v96, v144
    v_exp_f32 v97, v145
    v_exp_f32 v98, v146
    v_exp_f32 v99, v147
    v_pk_add_f32 v[92:93], v[92:93], 1.0 op_sel_hi:[1,0]
    v_pk_add_f32 v[94:95], v[94:95], 1.0 op_sel_hi:[1,0]
    v_pk_add_f32 v[96:97], v[96:97], 1.0 op_sel_hi:[1,0]
    v_pk_add_f32 v[98:99], v[98:99], 1.0 op_sel_hi:[1,0]
    v_pk_fma_f32 v[92:93], v[92:93], v[92:93], 1.0 op_sel_hi:[1,1,0]
    v_pk_fma_f32 v[94:95], v[94:95], v[94:95], 1.0 op_sel_hi:[1,1,0]
    v_pk_fma_f32 v[96:97], v[96:97], v[96:97], 1.0 op_sel_hi:[1,1,0]
    v_pk_fma_f32 v[98:99], v[98:99], v[98:99], 1.0 op_sel_hi:[1,1,0]
    v_rcp_f32 v92, v92
    v_rcp_f32 v93, v93
    v_rcp_f32 v94, v94
    v_rcp_f32 v95, v95
    v_rcp_f32 v96, v96
    v_rcp_f32 v97, v97
    v_rcp_f32 v98, v98
    v_rcp_f32 v99, v99
    v_pk_fma_f32 v[92:93], v[92:93], v[110:111], v[108:109] op_sel_hi:[1,0,0]
    v_pk_fma_f32 v[94:95], v[94:95], v[110:111], v[108:109] op_sel_hi:[1,0,0]
    v_pk_fma_f32 v[96:97], v[96:97], v[110:111], v[108:109] op_sel_hi:[1,0,0]
    v_pk_fma_f32 v[98:99], v[98:99], v[110:111], v[108:109] op_sel_hi:[1,0,0]
    v_pk_mul_f32 v[140:141], v[140:141], v[92:93]
    v_pk_mul_f32 v[142:143], v[142:143], v[94:95]
    v_pk_mul_f32 v[144:145], v[144:145], v[96:97]
    v_pk_mul_f32 v[146:147], v[146:147], v[98:99]
    v_cvt_pk_bf16_f32 v104, v140, v141
    v_cvt_pk_bf16_f32 v105, v142, v143
    v_cvt_pk_bf16_f32 v106, v144, v145
    v_cvt_pk_bf16_f32 v107, v146, v147
    buffer_store_dwordx4 v[104:107], v1, s[32:35], s64 offen offset:1024 sc1
    s_waitcnt vmcnt(2)
    v_cmp_ne_u32 vcc, s97, v120
    s_cbranch_vccnz SPIN_206
BACK_207:
    v_pk_mul_f32 v[148:149], v[148:149], v[54:55] op_sel:[0,0] op_sel_hi:[1,0]
    v_pk_mul_f32 v[150:151], v[150:151], v[54:55] op_sel:[0,0] op_sel_hi:[1,0]
    v_pk_mul_f32 v[152:153], v[152:153], v[54:55] op_sel:[0,0] op_sel_hi:[1,0]
    s_add_u32 s98, s76, 2662400
    buffer_load_dwordx4 v[216:219], v1, s[32:35], s98 offen offset:0 sc1
    v_pk_mul_f32 v[154:155], v[154:155], v[54:55] op_sel:[0,0] op_sel_hi:[1,0]
    v_exp_f32 v92, v148
    v_exp_f32 v93, v149
    v_exp_f32 v94, v150
    v_exp_f32 v95, v151
    buffer_load_dwordx4 v[220:223], v1, s[32:35], s98 offen offset:1024 sc1
    v_exp_f32 v96, v152
    v_exp_f32 v97, v153
    v_exp_f32 v98, v154
    v_exp_f32 v99, v155
    v_pk_add_f32 v[92:93], v[92:93], 1.0 op_sel_hi:[1,0]
    buffer_load_dwordx4 v[224:227], v1, s[32:35], s98 offen offset:2048 sc1
    v_pk_add_f32 v[94:95], v[94:95], 1.0 op_sel_hi:[1,0]
    v_pk_add_f32 v[96:97], v[96:97], 1.0 op_sel_hi:[1,0]
    v_pk_add_f32 v[98:99], v[98:99], 1.0 op_sel_hi:[1,0]
    v_pk_fma_f32 v[92:93], v[92:93], v[92:93], 1.0 op_sel_hi:[1,1,0]
    v_pk_fma_f32 v[94:95], v[94:95], v[94:95], 1.0 op_sel_hi:[1,1,0]
    buffer_load_dwordx4 v[228:231], v1, s[32:35], s98 offen offset:3072 sc1
    v_pk_fma_f32 v[96:97], v[96:97], v[96:97], 1.0 op_sel_hi:[1,1,0]
    v_pk_fma_f32 v[98:99], v[98:99], v[98:99], 1.0 op_sel_hi:[1,1,0]
    v_rcp_f32 v92, v92
    v_rcp_f32 v93, v93
    v_rcp_f32 v94, v94
    s_add_u32 s98, s98, 4096
    buffer_load_dwordx4 v[208:211], v1, s[32:35], s98 offen offset:0 sc1
    v_rcp_f32 v95, v95
    v_rcp_f32 v96, v96
    v_rcp_f32 v97, v97
    v_rcp_f32 v98, v98
    v_rcp_f32 v99, v99
    buffer_load_dwordx4 v[212:215], v1, s[32:35], s98 offen offset:1024 sc1
    v_pk_fma_f32 v[92:93], v[92:93], v[110:111], v[108:109] op_sel_hi:[1,0,0]
    v_pk_fma_f32 v[94:95], v[94:95], v[110:111], v[108:109] op_sel_hi:[1,0,0]
    v_pk_fma_f32 v[96:97], v[96:97], v[110:111], v[108:109] op_sel_hi:[1,0,0]
    v_pk_fma_f32 v[98:99], v[98:99], v[110:111], v[108:109] op_sel_hi:[1,0,0]
    v_pk_mul_f32 v[148:149], v[148:149], v[92:93]
    v_pk_mul_f32 v[150:151], v[150:151], v[94:95]
    v_pk_mul_f32 v[152:153], v[152:153], v[96:97]
    v_pk_mul_f32 v[154:155], v[154:155], v[98:99]
    v_cvt_pk_bf16_f32 v100, v148, v149
    v_cvt_pk_bf16_f32 v101, v150, v151
    v_cvt_pk_bf16_f32 v102, v152, v153
    v_cvt_pk_bf16_f32 v103, v154, v155
    buffer_store_dwordx4 v[100:103], v1, s[32:35], s64 offen offset:2048 sc1
    v_pk_mul_f32 v[156:157], v[156:157], v[54:55] op_sel:[0,0] op_sel_hi:[1,0]
    v_pk_mul_f32 v[158:159], v[158:159], v[54:55] op_sel:[0,0] op_sel_hi:[1,0]
    v_exp_f32 v92, v156
    v_exp_f32 v93, v157
    v_exp_f32 v94, v158
    v_exp_f32 v95, v159
    v_pk_add_f32 v[92:93], v[92:93], 1.0 op_sel_hi:[1,0]
    v_pk_add_f32 v[94:95], v[94:95], 1.0 op_sel_hi:[1,0]
    v_pk_fma_f32 v[92:93], v[92:93], v[92:93], 1.0 op_sel_hi:[1,1,0]
    v_pk_fma_f32 v[94:95], v[94:95], v[94:95], 1.0 op_sel_hi:[1,1,0]
    v_rcp_f32 v92, v92
    v_rcp_f32 v93, v93
    v_rcp_f32 v94, v94
    v_rcp_f32 v95, v95
    v_pk_fma_f32 v[92:93], v[92:93], v[110:111], v[108:109] op_sel_hi:[1,0,0]
    v_pk_fma_f32 v[94:95], v[94:95], v[110:111], v[108:109] op_sel_hi:[1,0,0]
    v_pk_mul_f32 v[156:157], v[156:157], v[92:93]
    v_pk_mul_f32 v[158:159], v[158:159], v[94:95]
    v_cvt_pk_bf16_f32 v104, v156, v157
    v_cvt_pk_bf16_f32 v105, v158, v159
    buffer_store_dwordx2 v[104:105], v4, s[32:35], s65 offen sc1
    s_waitcnt vmcnt(7)
    v_mfma_f32_16x16x32_bf16 v[92:95], v[192:195], v[216:219], 0
    ds_read_b128 v[192:195], v1 offset:12288
    v_mfma_f32_16x16x32_bf16 v[96:99], v[196:199], v[216:219], 0
    ds_read_b128 v[196:199], v1 offset:13312
    v_mfma_f32_16x16x32_bf16 v[100:103], v[200:203], v[216:219], 0
    ds_read_b128 v[200:203], v1 offset:14336
    v_mfma_f32_16x16x32_bf16 v[104:107], v[204:207], v[216:219], 0
    ds_read_b128 v[204:207], v1 offset:15360
    s_waitcnt lgkmcnt(8)
    v_mfma_f32_16x16x32_bf16 v[108:111], v[160:163], v[216:219], 0
    ds_read_b128 v[160:163], v1 offset:16384
    v_mfma_f32_16x16x32_bf16 v[112:115], v[164:167], v[216:219], 0
    ds_read_b128 v[164:167], v1 offset:17408
    v_mfma_f32_16x16x32_bf16 v[116:119], v[168:171], v[216:219], 0
    ds_read_b128 v[168:171], v1 offset:18432
    buffer_load_dwordx4 v[216:219], v1, s[32:35], s98 offen offset:2048 sc1
    s_waitcnt vmcnt(7)
    v_mfma_f32_16x16x32_bf16 v[92:95], v[172:175], v[220:223], v[92:95]
    ds_read_b128 v[172:175], v1 offset:19456
    s_waitcnt lgkmcnt(8)
    v_mfma_f32_16x16x32_bf16 v[96:99], v[176:179], v[220:223], v[96:99]
    ds_read_b128 v[176:179], v1 offset:20480
    v_mfma_f32_16x16x32_bf16 v[100:103], v[180:183], v[220:223], v[100:103]
    ds_read_b128 v[180:183], v1 offset:21504
    v_mfma_f32_16x16x32_bf16 v[104:107], v[184:187], v[220:223], v[104:107]
    ds_read_b128 v[184:187], v1 offset:22528
    v_mfma_f32_16x16x32_bf16 v[108:111], v[188:191], v[220:223], v[108:111]
    ds_read_b128 v[188:191], v1 offset:23552
    s_waitcnt lgkmcnt(8)
    v_mfma_f32_16x16x32_bf16 v[112:115], v[192:195], v[220:223], v[112:115]
    ds_read_b128 v[192:195], v1 offset:24576
    v_mfma_f32_16x16x32_bf16 v[116:119], v[196:199], v[220:223], v[116:119]
    ds_read_b128 v[196:199], v1 offset:25600
    buffer_load_dwordx4 v[220:223], v1, s[32:35], s98 offen offset:3072 sc1
    s_waitcnt vmcnt(7)
    v_mfma_f32_16x16x32_bf16 v[92:95], v[200:203], v[224:227], v[92:95]
    ds_read_b128 v[200:203], v1 offset:26624
    v_mfma_f32_16x16x32_bf16 v[96:99], v[204:207], v[224:227], v[96:99]
    ds_read_b128 v[204:207], v1 offset:27648
    s_waitcnt lgkmcnt(8)
    v_mfma_f32_16x16x32_bf16 v[100:103], v[160:163], v[224:227], v[100:103]
    ds_read_b128 v[160:163], v1 offset:28672
    v_mfma_f32_16x16x32_bf16 v[104:107], v[164:167], v[224:227], v[104:107]
    ds_read_b128 v[164:167], v1 offset:29696
    v_mfma_f32_16x16x32_bf16 v[108:111], v[168:171], v[224:227], v[108:111]
    ds_read_b128 v[168:171], v1 offset:30720
    v_mfma_f32_16x16x32_bf16 v[112:115], v[172:175], v[224:227], v[112:115]
    ds_read_b128 v[172:175], v1 offset:31744
    s_waitcnt lgkmcnt(8)
    v_mfma_f32_16x16x32_bf16 v[116:119], v[176:179], v[224:227], v[116:119]
    ds_read_b128 v[176:179], v1 offset:32768
    s_add_u32 s98, s98, 4096
    buffer_load_dwordx4 v[224:227], v1, s[32:35], s98 offen offset:0 sc1
    s_waitcnt vmcnt(7)
    v_mfma_f32_16x16x32_bf16 v[92:95], v[180:183], v[228:231], v[92:95]
    ds_read_b128 v[180:183], v1 offset:33792
    v_mfma_f32_16x16x32_bf16 v[96:99], v[184:187], v[228:231], v[96:99]
    ds_read_b128 v[184:187], v1 offset:34816
    s_add_u32 s68, s85, 8192
    v_mfma_f32_16x16x32_bf16 v[100:103], v[188:191], v[228:231], v[100:103]
    ds_read_b128 v[188:191], v1 offset:35840
    s_waitcnt lgkmcnt(8)
    v_mfma_f32_16x16x32_bf16 v[104:107], v[192:195], v[228:231], v[104:107]
    ds_read_b128 v[192:195], v1 offset:36864
    v_mov_b32 v32, s97
    v_mfma_f32_16x16x32_bf16 v[108:111], v[196:199], v[228:231], v[108:111]
    ds_read_b128 v[196:199], v1 offset:37888
    v_mov_b32 v33, 0
    v_mfma_f32_16x16x32_bf16 v[112:115], v[200:203], v[228:231], v[112:115]
    ds_read_b128 v[200:203], v1 offset:38912
    s_waitcnt vmcnt(3)
    v_mfma_f32_16x16x32_bf16 v[116:119], v[204:207], v[228:231], v[116:119]
    ds_read_b128 v[204:207], v1 offset:39936
    s_waitcnt lgkmcnt(8)
    buffer_load_dwordx4 v[228:231], v1, s[32:35], s98 offen offset:1024 sc1
    v_mfma_f32_16x16x32_bf16 v[92:95], v[160:163], v[208:211], v[92:95]
    ds_read_b128 v[160:163], v1 offset:40960
    v_mfma_f32_16x16x32_bf16 v[96:99], v[164:167], v[208:211], v[96:99]
    ds_read_b128 v[164:167], v1 offset:41984
    buffer_store_dword v32, v33, s[32:35], s68 offen offset:0 sc1
    v_mfma_f32_16x16x32_bf16 v[100:103], v[168:171], v[208:211], v[100:103]
    ds_read_b128 v[168:171], v1 offset:43008
    s_add_u32 s69, s88, 1581056
    v_mfma_f32_16x16x32_bf16 v[104:107], v[172:175], v[208:211], v[104:107]
    ds_read_b128 v[172:175], v1 offset:44032
    s_waitcnt lgkmcnt(8)
    v_mfma_f32_16x16x32_bf16 v[108:111], v[176:179], v[208:211], v[108:111]
    ds_read_b128 v[176:179], v1 offset:45056
    buffer_load_dwordx3 v[120:122], v1, s[32:35], s69 offen offset:0 sc1
    v_mfma_f32_16x16x32_bf16 v[112:115], v[180:183], v[208:211], v[112:115]
    ds_read_b128 v[180:183], v1 offset:46080
    buffer_load_dwordx3 v[124:126], v1, s[32:35], s69 offen offset:1024 sc1
    v_mfma_f32_16x16x32_bf16 v[116:119], v[184:187], v[208:211], v[116:119]
    ds_read_b128 v[184:187], v1 offset:47104
    buffer_load_dwordx4 v[208:211], v1, s[32:35], s98 offen offset:2048 sc1
    v_mfma_f32_16x16x32_bf16 v[92:95], v[188:191], v[212:215], v[92:95]
    ds_read_b128 v[188:191], v1 offset:48128
    s_waitcnt lgkmcnt(8)
    v_mfma_f32_16x16x32_bf16 v[96:99], v[192:195], v[212:215], v[96:99]
    ds_read_b128 v[192:195], v1 offset:49152
    buffer_load_dwordx3 v[128:130], v1, s[32:35], s69 offen offset:2048 sc1
    v_mfma_f32_16x16x32_bf16 v[100:103], v[196:199], v[212:215], v[100:103]
    ds_read_b128 v[196:199], v1 offset:50176
    buffer_load_dwordx3 v[132:134], v1, s[32:35], s69 offen offset:3072 sc1
    v_mfma_f32_16x16x32_bf16 v[104:107], v[200:203], v[212:215], v[104:107]
    ds_read_b128 v[200:203], v1 offset:51200
    v_mfma_f32_16x16x32_bf16 v[108:111], v[204:207], v[212:215], v[108:111]
    ds_read_b128 v[204:207], v1 offset:52224
    s_waitcnt lgkmcnt(8)
    v_mfma_f32_16x16x32_bf16 v[112:115], v[160:163], v[212:215], v[112:115]
    ds_read_b128 v[160:163], v1 offset:53248
    v_mfma_f32_16x16x32_bf16 v[116:119], v[164:167], v[212:215], v[116:119]
    ds_read_b128 v[164:167], v1 offset:54272
    buffer_load_dwordx4 v[212:215], v1, s[32:35], s98 offen offset:3072 sc1
    s_waitcnt vmcnt(10)
    v_mfma_f32_16x16x32_bf16 v[92:95], v[168:171], v[216:219], v[92:95]
    ds_read_b128 v[168:171], v1 offset:55296
    v_mfma_f32_16x16x32_bf16 v[96:99], v[172:175], v[216:219], v[96:99]
    ds_read_b128 v[172:175], v1 offset:56320
    s_waitcnt lgkmcnt(8)
    v_mfma_f32_16x16x32_bf16 v[100:103], v[176:179], v[216:219], v[100:103]
    ds_read_b128 v[176:179], v28 offset:0
    v_mfma_f32_16x16x32_bf16 v[104:107], v[180:183], v[216:219], v[104:107]
    ds_read_b128 v[180:183], v28 offset:1024
    v_mfma_f32_16x16x32_bf16 v[108:111], v[184:187], v[216:219], v[108:111]
    ds_read_b128 v[184:187], v28 offset:2048
    v_mfma_f32_16x16x32_bf16 v[112:115], v[188:191], v[216:219], v[112:115]
    ds_read_b128 v[188:191], v28 offset:3072
    s_waitcnt lgkmcnt(8)
    v_mfma_f32_16x16x32_bf16 v[116:119], v[192:195], v[216:219], v[116:119]
    ds_read_b128 v[192:195], v28 offset:4096
    s_add_u32 s98, s98, 4096
    buffer_load_dwordx4 v[216:219], v1, s[32:35], s98 offen offset:0 sc1
    s_waitcnt vmcnt(10)
    v_mfma_f32_16x16x32_bf16 v[92:95], v[196:199], v[220:223], v[92:95]
    ds_read_b128 v[196:199], v28 offset:5120
    v_mfma_f32_16x16x32_bf16 v[96:99], v[200:203], v[220:223], v[96:99]
    ds_read_b128 v[200:203], v28 offset:6144
    v_mfma_f32_16x16x32_bf16 v[100:103], v[204:207], v[220:223], v[100:103]
    ds_read_b128 v[204:207], v28 offset:7168
    s_waitcnt lgkmcnt(8)
    v_mfma_f32_16x16x32_bf16 v[104:107], v[160:163], v[220:223], v[104:107]
    ds_read_b128 v[160:163], v28 offset:8192
    v_mfma_f32_16x16x32_bf16 v[108:111], v[164:167], v[220:223], v[108:111]
    ds_read_b128 v[164:167], v28 offset:9216
    v_mfma_f32_16x16x32_bf16 v[112:115], v[168:171], v[220:223], v[112:115]
    ds_read_b128 v[168:171], v28 offset:10240
    v_mfma_f32_16x16x32_bf16 v[116:119], v[172:175], v[220:223], v[116:119]
    ds_read_b128 v[172:175], v28 offset:11264
    s_waitcnt lgkmcnt(8)
    buffer_load_dwordx4 v[220:223], v1, s[32:35], s98 offen offset:1024 sc1
    s_waitcnt vmcnt(10)
    v_mfma_f32_16x16x32_bf16 v[92:95], v[176:179], v[224:227], v[92:95]
    ds_read_b128 v[176:179], v28 offset:12288
    v_mfma_f32_16x16x32_bf16 v[96:99], v[180:183], v[224:227], v[96:99]
    ds_read_b128 v[180:183], v28 offset:13312
    v_mfma_f32_16x16x32_bf16 v[100:103], v[184:187], v[224:227], v[100:103]
    ds_read_b128 v[184:187], v28 offset:14336
    v_mfma_f32_16x16x32_bf16 v[104:107], v[188:191], v[224:227], v[104:107]
    ds_read_b128 v[188:191], v28 offset:15360
    s_waitcnt lgkmcnt(8)
    v_mfma_f32_16x16x32_bf16 v[108:111], v[192:195], v[224:227], v[108:111]
    ds_read_b128 v[192:195], v28 offset:16384
    v_mfma_f32_16x16x32_bf16 v[112:115], v[196:199], v[224:227], v[112:115]
    ds_read_b128 v[196:199], v28 offset:17408
    v_mfma_f32_16x16x32_bf16 v[116:119], v[200:203], v[224:227], v[116:119]
    ds_read_b128 v[200:203], v28 offset:18432
    buffer_load_dwordx4 v[224:227], v1, s[32:35], s98 offen offset:2048 sc1
    s_waitcnt vmcnt(10)
    v_mfma_f32_16x16x32_bf16 v[92:95], v[204:207], v[228:231], v[92:95]
    ds_read_b128 v[204:207], v28 offset:19456
    s_waitcnt lgkmcnt(8)
    v_mfma_f32_16x16x32_bf16 v[96:99], v[160:163], v[228:231], v[96:99]
    ds_read_b128 v[160:163], v28 offset:20480
    v_mfma_f32_16x16x32_bf16 v[100:103], v[164:167], v[228:231], v[100:103]
    ds_read_b128 v[164:167], v28 offset:21504
    v_mfma_f32_16x16x32_bf16 v[104:107], v[168:171], v[228:231], v[104:107]
    ds_read_b128 v[168:171], v28 offset:22528
    v_mfma_f32_16x16x32_bf16 v[108:111], v[172:175], v[228:231], v[108:111]
    ds_read_b128 v[172:175], v28 offset:23552
    s_waitcnt lgkmcnt(8)
    v_mfma_f32_16x16x32_bf16 v[112:115], v[176:179], v[228:231], v[112:115]
    ds_read_b128 v[176:179], v28 offset:24576
    v_mfma_f32_16x16x32_bf16 v[116:119], v[180:183], v[228:231], v[116:119]
    ds_read_b128 v[180:183], v28 offset:25600
    buffer_load_dwordx4 v[228:231], v1, s[32:35], s98 offen offset:3072 sc1
    s_waitcnt vmcnt(7)
    v_mfma_f32_16x16x32_bf16 v[92:95], v[184:187], v[208:211], v[92:95]
    ds_read_b128 v[184:187], v28 offset:26624
    v_xor_b32 v122, v122, v126
    s_waitcnt vmcnt(5)
    v_xor_b32 v130, v130, v134
    v_xor_b32 v126, v126, v134
    v_xor_b32 v134, s97, v134
    v_or3_b32 v122, v122, v126, v130
    v_or_b32 v122, v122, v134
    v_cmp_ne_u32 vcc, 0, v122
    s_cbranch_vccnz SPIN_208
BACK_209:
    v_mfma_f32_16x16x32_bf16 v[96:99], v[188:191], v[208:211], v[96:99]
    ds_read_b128 v[188:191], v28 offset:27648
    s_waitcnt lgkmcnt(8)
    v_mfma_f32_16x16x32_bf16 v[100:103], v[192:195], v[208:211], v[100:103]
    ds_read_b128 v[192:195], v28 offset:28672
    v_mfma_f32_16x16x32_bf16 v[104:107], v[196:199], v[208:211], v[104:107]
    ds_read_b128 v[196:199], v28 offset:29696
    v_mfma_f32_16x16x32_bf16 v[108:111], v[200:203], v[208:211], v[108:111]
    ds_read_b128 v[200:203], v28 offset:30720
    v_mfma_f32_16x16x32_bf16 v[112:115], v[204:207], v[208:211], v[112:115]
    ds_read_b128 v[204:207], v28 offset:31744
    s_waitcnt lgkmcnt(8)
    v_mfma_f32_16x16x32_bf16 v[116:119], v[160:163], v[208:211], v[116:119]
    ds_read_b128 v[160:163], v28 offset:32768
    s_add_u32 s98, s98, 4096
    buffer_load_dwordx4 v[208:211], v1, s[32:35], s98 offen offset:0 sc1
    s_waitcnt vmcnt(5)
    v_mfma_f32_16x16x32_bf16 v[92:95], v[164:167], v[212:215], v[92:95]
    ds_read_b128 v[164:167], v28 offset:33792
    v_mfma_f32_16x16x32_bf16 v[96:99], v[168:171], v[212:215], v[96:99]
    ds_read_b128 v[168:171], v28 offset:34816
    v_mfma_f32_16x16x32_bf16 v[100:103], v[172:175], v[212:215], v[100:103]
    ds_read_b128 v[172:175], v28 offset:35840
    s_waitcnt lgkmcnt(8)
    v_mfma_f32_16x16x32_bf16 v[104:107], v[176:179], v[212:215], v[104:107]
    ds_read_b128 v[176:179], v28 offset:36864
    v_mfma_f32_16x16x32_bf16 v[108:111], v[180:183], v[212:215], v[108:111]
    ds_read_b128 v[180:183], v28 offset:37888
    v_mfma_f32_16x16x32_bf16 v[112:115], v[184:187], v[212:215], v[112:115]
    ds_read_b128 v[184:187], v28 offset:38912
    v_mfma_f32_16x16x32_bf16 v[116:119], v[188:191], v[212:215], v[116:119]
    ds_read_b128 v[188:191], v28 offset:39936
    s_waitcnt lgkmcnt(8)
    buffer_load_dwordx4 v[212:215], v1, s[32:35], s98 offen offset:1024 sc1
    s_waitcnt vmcnt(5)
    v_mfma_f32_16x16x32_bf16 v[92:95], v[192:195], v[216:219], v[92:95]
    ds_read_b128 v[192:195], v28 offset:40960
    v_mfma_f32_16x16x32_bf16 v[96:99], v[196:199], v[216:219], v[96:99]
    ds_read_b128 v[196:199], v28 offset:41984
    v_add_f32 v120, v120, v124
    v_mfma_f32_16x16x32_bf16 v[100:103], v[200:203], v[216:219], v[100:103]
    ds_read_b128 v[200:203], v28 offset:43008
    v_add_f32 v121, v121, v125
    v_mfma_f32_16x16x32_bf16 v[104:107], v[204:207], v[216:219], v[104:107]
    ds_read_b128 v[204:207], v28 offset:44032
    s_waitcnt lgkmcnt(8)
    v_mfma_f32_16x16x32_bf16 v[108:111], v[160:163], v[216:219], v[108:111]
    ds_read_b128 v[160:163], v28 offset:45056
    v_add_f32 v128, v128, v132
    v_mfma_f32_16x16x32_bf16 v[112:115], v[164:167], v[216:219], v[112:115]
    ds_read_b128 v[164:167], v28 offset:46080
    v_add_f32 v129, v129, v133
    v_mfma_f32_16x16x32_bf16 v[116:119], v[168:171], v[216:219], v[116:119]
    ds_read_b128 v[168:171], v28 offset:47104
    buffer_load_dwordx4 v[216:219], v1, s[32:35], s98 offen offset:2048 sc1
    s_waitcnt vmcnt(5)
    v_mfma_f32_16x16x32_bf16 v[92:95], v[172:175], v[220:223], v[92:95]
    ds_read_b128 v[172:175], v28 offset:48128
    s_waitcnt lgkmcnt(8)
    v_mfma_f32_16x16x32_bf16 v[96:99], v[176:179], v[220:223], v[96:99]
    ds_read_b128 v[176:179], v28 offset:49152
    v_add_f32 v120, v120, v128
    v_mfma_f32_16x16x32_bf16 v[100:103], v[180:183], v[220:223], v[100:103]
    ds_read_b128 v[180:183], v28 offset:50176
    v_add_f32 v121, v121, v129
    v_mfma_f32_16x16x32_bf16 v[104:107], v[184:187], v[220:223], v[104:107]
    ds_read_b128 v[184:187], v28 offset:51200
    v_permlane16_swap_b32 v120, v121
    v_mfma_f32_16x16x32_bf16 v[108:111], v[188:191], v[220:223], v[108:111]
    ds_read_b128 v[188:191], v28 offset:52224
    s_waitcnt lgkmcnt(8)
    v_mfma_f32_16x16x32_bf16 v[112:115], v[192:195], v[220:223], v[112:115]
    ds_read_b128 v[192:195], v28 offset:53248
    v_add_f32 v120, v120, v121
    v_mfma_f32_16x16x32_bf16 v[116:119], v[196:199], v[220:223], v[116:119]
    ds_read_b128 v[196:199], v28 offset:54272
    buffer_load_dwordx4 v[220:223], v1, s[32:35], s98 offen offset:3072 sc1
    s_waitcnt vmcnt(5)
    v_mfma_f32_16x16x32_bf16 v[92:95], v[200:203], v[224:227], v[92:95]
    ds_read_b128 v[200:203], v28 offset:55296
    v_mov_b32 v121, v120
    v_mfma_f32_16x16x32_bf16 v[96:99], v[204:207], v[224:227], v[96:99]
    ds_read_b128 v[204:207], v28 offset:56320
    s_waitcnt lgkmcnt(8)
    v_mfma_f32_16x16x32_bf16 v[100:103], v[160:163], v[224:227], v[100:103]
    ds_read_b128 v[160:163], v29 offset:0
    v_permlane32_swap_b32 v120, v121
    v_mfma_f32_16x16x32_bf16 v[104:107], v[164:167], v[224:227], v[104:107]
    ds_read_b128 v[164:167], v29 offset:1024
    v_add_f32 v120, v120, v121
    v_mfma_f32_16x16x32_bf16 v[108:111], v[168:171], v[224:227], v[108:111]
    ds_read_b128 v[168:171], v29 offset:2048
    v_mul_f32 v124, 0x3acccccd, v120
    v_mfma_f32_16x16x32_bf16 v[112:115], v[172:175], v[224:227], v[112:115]
    ds_read_b128 v[172:175], v29 offset:3072
    s_waitcnt lgkmcnt(8)
    v_mfma_f32_16x16x32_bf16 v[116:119], v[176:179], v[224:227], v[116:119]
    ds_read_b128 v[176:179], v29 offset:4096
    v_mul_f32 v125, 0x3acccccd, v120
    s_waitcnt vmcnt(4)
    v_mfma_f32_16x16x32_bf16 v[92:95], v[180:183], v[228:231], v[92:95]
    ds_read_b128 v[180:183], v29 offset:5120
    v_permlane16_swap_b32 v124, v125
    v_mfma_f32_16x16x32_bf16 v[96:99], v[184:187], v[228:231], v[96:99]
    ds_read_b128 v[184:187], v29 offset:6144
    v_fma_f32 v125, -v124, v124, v125
    v_mfma_f32_16x16x32_bf16 v[100:103], v[188:191], v[228:231], v[100:103]
    ds_read_b128 v[188:191], v29 offset:7168
    s_waitcnt lgkmcnt(8)
    v_mfma_f32_16x16x32_bf16 v[104:107], v[192:195], v[228:231], v[104:107]
    ds_read_b128 v[192:195], v29 offset:8192
    v_max_f32 v125, 0, v125
    v_mfma_f32_16x16x32_bf16 v[108:111], v[196:199], v[228:231], v[108:111]
    ds_read_b128 v[196:199], v29 offset:9216
    v_cvt_pk_bf16_f32 v125, v125, v124
    v_mfma_f32_16x16x32_bf16 v[112:115], v[200:203], v[228:231], v[112:115]
    ds_read_b128 v[200:203], v29 offset:10240
    v_and_b32 v124, 0xffff0000, v125
    v_mfma_f32_16x16x32_bf16 v[116:119], v[204:207], v[228:231], v[116:119]
    ds_read_b128 v[204:207], v29 offset:11264
    s_waitcnt lgkmcnt(8)
    s_waitcnt vmcnt(3)
    v_mfma_f32_16x16x32_bf16 v[92:95], v[160:163], v[208:211], v[92:95]
    ds_read_b128 v[160:163], v29 offset:12288
    v_lshlrev_b32 v125, 16, v125
    v_mfma_f32_16x16x32_bf16 v[96:99], v[164:167], v[208:211], v[96:99]
    ds_read_b128 v[164:167], v29 offset:13312
    v_add_f32 v125, 0x3727c5ac, v125
    v_mfma_f32_16x16x32_bf16 v[100:103], v[168:171], v[208:211], v[100:103]
    ds_read_b128 v[168:171], v29 offset:14336
    v_cvt_pk_bf16_f32 v125, v125, v125
    v_mfma_f32_16x16x32_bf16 v[104:107], v[172:175], v[208:211], v[104:107]
    ds_read_b128 v[172:175], v29 offset:15360
    s_waitcnt lgkmcnt(8)
    v_mfma_f32_16x16x32_bf16 v[108:111], v[176:179], v[208:211], v[108:111]
    ds_read_b128 v[176:179], v29 offset:16384
    v_lshlrev_b32 v125, 16, v125
    v_mfma_f32_16x16x32_bf16 v[112:115], v[180:183], v[208:211], v[112:115]
    ds_read_b128 v[180:183], v29 offset:17408
    v_sqrt_f32 v125, v125
    v_mfma_f32_16x16x32_bf16 v[116:119], v[184:187], v[208:211], v[116:119]
    ds_read_b128 v[184:187], v29 offset:18432
    s_waitcnt vmcnt(2)
    v_mfma_f32_16x16x32_bf16 v[92:95], v[188:191], v[212:215], v[92:95]
    ds_read_b128 v[188:191], v29 offset:19456
    s_waitcnt lgkmcnt(8)
    v_mfma_f32_16x16x32_bf16 v[96:99], v[192:195], v[212:215], v[96:99]
    ds_read_b128 v[192:195], v29 offset:20480
    v_cvt_pk_bf16_f32 v125, v125, v125
    v_mfma_f32_16x16x32_bf16 v[100:103], v[196:199], v[212:215], v[100:103]
    ds_read_b128 v[196:199], v29 offset:21504
    v_lshlrev_b32 v125, 16, v125
    v_mfma_f32_16x16x32_bf16 v[104:107], v[200:203], v[212:215], v[104:107]
    ds_read_b128 v[200:203], v29 offset:22528
    v_rcp_f32 v126, v125
    v_mfma_f32_16x16x32_bf16 v[108:111], v[204:207], v[212:215], v[108:111]
    ds_read_b128 v[204:207], v29 offset:23552
    s_waitcnt lgkmcnt(8)
    v_mfma_f32_16x16x32_bf16 v[112:115], v[160:163], v[212:215], v[112:115]
    ds_read_b128 v[160:163], v29 offset:24576
    v_mfma_f32_16x16x32_bf16 v[116:119], v[164:167], v[212:215], v[116:119]
    ds_read_b128 v[164:167], v29 offset:25600
    v_xor_b32 v124, 0x80000000, v124
    s_waitcnt vmcnt(1)
    v_mfma_f32_16x16x32_bf16 v[92:95], v[168:171], v[216:219], v[92:95]
    ds_read_b128 v[168:171], v29 offset:26624
    v_lshrrev_b32 v127, 16, v124
    v_mfma_f32_16x16x32_bf16 v[96:99], v[172:175], v[216:219], v[96:99]
    ds_read_b128 v[172:175], v29 offset:27648
    s_waitcnt lgkmcnt(8)
    v_mfma_f32_16x16x32_bf16 v[100:103], v[176:179], v[216:219], v[100:103]
    v_or_b32 v124, v124, v127
    v_or_b32 v125, v125, v127
    v_mfma_f32_16x16x32_bf16 v[104:107], v[180:183], v[216:219], v[104:107]
    v_mul_f32 v55, 0x3fb8aa3b, v126
    v_cndmask_b32 v52, 0, v124, s[100:101]
    v_mfma_f32_16x16x32_bf16 v[108:111], v[184:187], v[216:219], v[108:111]
    v_cndmask_b32 v53, 0, v125, s[100:101]
    v_bfe_u32 v121, v0, 1, 2
    v_mfma_f32_16x16x32_bf16 v[112:115], v[188:191], v[216:219], v[112:115]
    s_waitcnt lgkmcnt(4)
    v_lshlrev_b32 v121, 4, v121
    v_mfma_f32_16x16x32_bf16 v[116:119], v[192:195], v[216:219], v[116:119]
    v_and_b32 v120, 1, v0
    v_lshl_add_u32 v121, v120, 2, v121
    s_waitcnt vmcnt(0)
    v_mfma_f32_16x16x32_bf16 v[92:95], v[196:199], v[220:223], v[92:95]
    s_add_u32 s67, s84, 8192
    buffer_load_dword v120, v121, s[32:35], s67 offen sc1
    v_mfma_f32_16x16x32_bf16 v[96:99], v[200:203], v[220:223], v[96:99]
    v_mfma_f32_16x16x32_bf16 v[100:103], v[204:207], v[220:223], v[100:103]
    s_waitcnt lgkmcnt(0)
    v_mfma_f32_16x16x32_bf16 v[104:107], v[160:163], v[220:223], v[104:107]
    v_mfma_f32_16x16x32_bf16 v[108:111], v[164:167], v[220:223], v[108:111]
    v_mfma_f32_16x16x32_bf16 v[112:115], v[168:171], v[220:223], v[112:115]
    v_mfma_f32_16x16x32_bf16 v[116:119], v[172:175], v[220:223], v[116:119]
    v_mfma_f32_16x16x16_bf16 v[92:95], v[36:37], v[52:53], v[92:95]
    v_mfma_f32_16x16x16_bf16 v[96:99], v[38:39], v[52:53], v[96:99]
    v_mfma_f32_16x16x16_bf16 v[100:103], v[40:41], v[52:53], v[100:103]
    v_mfma_f32_16x16x16_bf16 v[104:107], v[42:43], v[52:53], v[104:107]
    v_mfma_f32_16x16x16_bf16 v[108:111], v[44:45], v[52:53], v[108:111]
    v_mfma_f32_16x16x16_bf16 v[112:115], v[46:47], v[52:53], v[112:115]
    v_mfma_f32_16x16x16_bf16 v[116:119], v[48:49], v[52:53], v[116:119]
    s_waitcnt vmcnt(0)
    v_cmp_ne_u32 vcc, s97, v120
    s_cbranch_vccnz SPIN_210
BACK_211:
    v_mov_b32 v208, 0x3f317218
    v_mov_b32 v210, 0xbfb17218
    s_add_u32 s64, s79, 7188480
    s_add_u32 s65, s80, 7188480
    v_pk_mul_f32 v[92:93], v[92:93], v[54:55] op_sel:[0,1] op_sel_hi:[1,1]
    v_pk_mul_f32 v[94:95], v[94:95], v[54:55] op_sel:[0,1] op_sel_hi:[1,1]
    v_pk_mul_f32 v[96:97], v[96:97], v[54:55] op_sel:[0,1] op_sel_hi:[1,1]
    v_pk_mul_f32 v[98:99], v[98:99], v[54:55] op_sel:[0,1] op_sel_hi:[1,1]
    v_exp_f32 v192, v92
    v_exp_f32 v193, v93
    v_exp_f32 v194, v94
    s_add_u32 s95, s96, 7077888
    buffer_load_dwordx4 v[132:135], v1, s[32:35], s95 offen offset:0 sc1
    v_exp_f32 v195, v95
    v_exp_f32 v196, v96
    v_exp_f32 v197, v97
    v_exp_f32 v198, v98
    v_exp_f32 v199, v99
    v_pk_add_f32 v[192:193], v[192:193], 1.0 op_sel_hi:[1,0]
    v_pk_add_f32 v[194:195], v[194:195], 1.0 op_sel_hi:[1,0]
    buffer_load_dwordx4 v[136:139], v1, s[32:35], s95 offen offset:1024 sc1
    v_pk_add_f32 v[196:197], v[196:197], 1.0 op_sel_hi:[1,0]
    v_pk_add_f32 v[198:199], v[198:199], 1.0 op_sel_hi:[1,0]
    v_pk_fma_f32 v[192:193], v[192:193], v[192:193], 1.0 op_sel_hi:[1,1,0]
    v_pk_fma_f32 v[194:195], v[194:195], v[194:195], 1.0 op_sel_hi:[1,1,0]
    v_pk_fma_f32 v[196:197], v[196:197], v[196:197], 1.0 op_sel_hi:[1,1,0]
    v_pk_fma_f32 v[198:199], v[198:199], v[198:199], 1.0 op_sel_hi:[1,1,0]
    v_rcp_f32 v192, v192
    buffer_load_dwordx4 v[140:143], v1, s[32:35], s95 offen offset:2048 sc1
    v_rcp_f32 v193, v193
    v_rcp_f32 v194, v194
    v_rcp_f32 v195, v195
    v_rcp_f32 v196, v196
    v_rcp_f32 v197, v197
    v_rcp_f32 v198, v198
    v_rcp_f32 v199, v199
    buffer_load_dwordx4 v[144:147], v1, s[32:35], s95 offen offset:3072 sc1
    v_pk_fma_f32 v[192:193], v[192:193], v[210:211], v[208:209] op_sel_hi:[1,0,0]
    v_pk_fma_f32 v[194:195], v[194:195], v[210:211], v[208:209] op_sel_hi:[1,0,0]
    v_pk_fma_f32 v[196:197], v[196:197], v[210:211], v[208:209] op_sel_hi:[1,0,0]
    v_pk_fma_f32 v[198:199], v[198:199], v[210:211], v[208:209] op_sel_hi:[1,0,0]
    v_pk_mul_f32 v[92:93], v[92:93], v[192:193]
    v_pk_mul_f32 v[94:95], v[94:95], v[194:195]
    v_pk_mul_f32 v[96:97], v[96:97], v[196:197]
    s_add_u32 s95, s95, 4096
    buffer_load_dwordx4 v[148:151], v1, s[32:35], s95 offen offset:0 sc1
    v_pk_mul_f32 v[98:99], v[98:99], v[198:199]
    v_cvt_pk_bf16_f32 v200, v92, v93
    v_cvt_pk_bf16_f32 v201, v94, v95
    v_cvt_pk_bf16_f32 v202, v96, v97
    v_cvt_pk_bf16_f32 v203, v98, v99
    buffer_store_dwordx4 v[200:203], v1, s[32:35], s64 offen offset:0 sc1
    v_pk_mul_f32 v[100:101], v[100:101], v[54:55] op_sel:[0,1] op_sel_hi:[1,1]
    v_pk_mul_f32 v[102:103], v[102:103], v[54:55] op_sel:[0,1] op_sel_hi:[1,1]
    v_pk_mul_f32 v[104:105], v[104:105], v[54:55] op_sel:[0,1] op_sel_hi:[1,1]
    v_pk_mul_f32 v[106:107], v[106:107], v[54:55] op_sel:[0,1] op_sel_hi:[1,1]
    v_exp_f32 v192, v100
    v_exp_f32 v193, v101
    buffer_load_dwordx4 v[152:155], v1, s[32:35], s95 offen offset:1024 sc1
    v_exp_f32 v194, v102
    v_exp_f32 v195, v103
    v_exp_f32 v196, v104
    v_exp_f32 v197, v105
    v_exp_f32 v198, v106
    v_exp_f32 v199, v107
    v_pk_add_f32 v[192:193], v[192:193], 1.0 op_sel_hi:[1,0]
    buffer_load_dwordx4 v[156:159], v1, s[32:35], s95 offen offset:2048 sc1
    v_pk_add_f32 v[194:195], v[194:195], 1.0 op_sel_hi:[1,0]
    v_pk_add_f32 v[196:197], v[196:197], 1.0 op_sel_hi:[1,0]
    v_pk_add_f32 v[198:199], v[198:199], 1.0 op_sel_hi:[1,0]
    v_pk_fma_f32 v[192:193], v[192:193], v[192:193], 1.0 op_sel_hi:[1,1,0]
    v_pk_fma_f32 v[194:195], v[194:195], v[194:195], 1.0 op_sel_hi:[1,1,0]
    v_pk_fma_f32 v[196:197], v[196:197], v[196:197], 1.0 op_sel_hi:[1,1,0]
    v_pk_fma_f32 v[198:199], v[198:199], v[198:199], 1.0 op_sel_hi:[1,1,0]
    buffer_load_dwordx4 v[160:163], v1, s[32:35], s95 offen offset:3072 sc1
    v_rcp_f32 v192, v192
    v_rcp_f32 v193, v193
    v_rcp_f32 v194, v194
    v_rcp_f32 v195, v195
    v_rcp_f32 v196, v196
    v_rcp_f32 v197, v197
    v_rcp_f32 v198, v198
    s_add_u32 s95, s95, 4096
    buffer_load_dwordx4 v[164:167], v1, s[32:35], s95 offen offset:0 sc1
    v_rcp_f32 v199, v199
    v_pk_fma_f32 v[192:193], v[192:193], v[210:211], v[208:209] op_sel_hi:[1,0,0]
    v_pk_fma_f32 v[194:195], v[194:195], v[210:211], v[208:209] op_sel_hi:[1,0,0]
    v_pk_fma_f32 v[196:197], v[196:197], v[210:211], v[208:209] op_sel_hi:[1,0,0]
    v_pk_fma_f32 v[198:199], v[198:199], v[210:211], v[208:209] op_sel_hi:[1,0,0]
    v_pk_mul_f32 v[100:101], v[100:101], v[192:193]
    v_pk_mul_f32 v[102:103], v[102:103], v[194:195]
    buffer_load_dwordx4 v[168:171], v1, s[32:35], s95 offen offset:1024 sc1
    v_pk_mul_f32 v[104:105], v[104:105], v[196:197]
    v_pk_mul_f32 v[106:107], v[106:107], v[198:199]
    v_cvt_pk_bf16_f32 v204, v100, v101
    v_cvt_pk_bf16_f32 v205, v102, v103
    v_cvt_pk_bf16_f32 v206, v104, v105
    v_cvt_pk_bf16_f32 v207, v106, v107
    buffer_store_dwordx4 v[204:207], v1, s[32:35], s64 offen offset:1024 sc1
    v_pk_mul_f32 v[108:109], v[108:109], v[54:55] op_sel:[0,1] op_sel_hi:[1,1]
    v_pk_mul_f32 v[110:111], v[110:111], v[54:55] op_sel:[0,1] op_sel_hi:[1,1]
    v_pk_mul_f32 v[112:113], v[112:113], v[54:55] op_sel:[0,1] op_sel_hi:[1,1]
    v_pk_mul_f32 v[114:115], v[114:115], v[54:55] op_sel:[0,1] op_sel_hi:[1,1]
    v_exp_f32 v192, v108
    buffer_load_dwordx4 v[172:175], v1, s[32:35], s95 offen offset:2048 sc1
    v_exp_f32 v193, v109
    v_exp_f32 v194, v110
    v_exp_f32 v195, v111
    v_exp_f32 v196, v112
    v_exp_f32 v197, v113
    v_exp_f32 v198, v114
    v_exp_f32 v199, v115
    buffer_load_dwordx4 v[176:179], v1, s[32:35], s95 offen offset:3072 sc1
    v_pk_add_f32 v[192:193], v[192:193], 1.0 op_sel_hi:[1,0]
    v_pk_add_f32 v[194:195], v[194:195], 1.0 op_sel_hi:[1,0]
    v_pk_add_f32 v[196:197], v[196:197], 1.0 op_sel_hi:[1,0]
    v_pk_add_f32 v[198:199], v[198:199], 1.0 op_sel_hi:[1,0]
    v_pk_fma_f32 v[192:193], v[192:193], v[192:193], 1.0 op_sel_hi:[1,1,0]
    v_pk_fma_f32 v[194:195], v[194:195], v[194:195], 1.0 op_sel_hi:[1,1,0]
    v_pk_fma_f32 v[196:197], v[196:197], v[196:197], 1.0 op_sel_hi:[1,1,0]
    s_add_u32 s95, s95, s94
    buffer_load_dwordx2 v[180:181], v4, s[32:35], s95 offen offset:0 sc1
    buffer_load_dwordx2 v[182:183], v4, s[32:35], s95 offen offset:512 sc1
    v_pk_fma_f32 v[198:199], v[198:199], v[198:199], 1.0 op_sel_hi:[1,1,0]
    v_rcp_f32 v192, v192
    v_rcp_f32 v193, v193
    v_rcp_f32 v194, v194
    v_rcp_f32 v195, v195
    v_rcp_f32 v196, v196
    v_rcp_f32 v197, v197
    buffer_load_dwordx2 v[184:185], v4, s[32:35], s95 offen offset:1024 sc1
    buffer_load_dwordx2 v[186:187], v4, s[32:35], s95 offen offset:1536 sc1
    v_rcp_f32 v198, v198
    v_rcp_f32 v199, v199
    v_pk_fma_f32 v[192:193], v[192:193], v[210:211], v[208:209] op_sel_hi:[1,0,0]
    v_pk_fma_f32 v[194:195], v[194:195], v[210:211], v[208:209] op_sel_hi:[1,0,0]
    v_pk_fma_f32 v[196:197], v[196:197], v[210:211], v[208:209] op_sel_hi:[1,0,0]
    v_pk_fma_f32 v[198:199], v[198:199], v[210:211], v[208:209] op_sel_hi:[1,0,0]
    v_pk_mul_f32 v[108:109], v[108:109], v[192:193]
    s_add_u32 s99, s81, 7077888
    buffer_load_dwordx4 v[188:191], v1, s[32:35], s99 offen offset:0 sc1
    v_pk_mul_f32 v[110:111], v[110:111], v[194:195]
    v_pk_mul_f32 v[112:113], v[112:113], v[196:197]
    v_pk_mul_f32 v[114:115], v[114:115], v[198:199]
    v_cvt_pk_bf16_f32 v200, v108, v109
    v_cvt_pk_bf16_f32 v201, v110, v111
    v_cvt_pk_bf16_f32 v202, v112, v113
    v_cvt_pk_bf16_f32 v203, v114, v115
    buffer_store_dwordx4 v[200:203], v1, s[32:35], s64 offen offset:2048 sc1
    v_pk_mul_f32 v[116:117], v[116:117], v[54:55] op_sel:[0,1] op_sel_hi:[1,1]
    v_pk_mul_f32 v[118:119], v[118:119], v[54:55] op_sel:[0,1] op_sel_hi:[1,1]
    v_exp_f32 v192, v116
    v_exp_f32 v193, v117
    v_exp_f32 v194, v118
    v_exp_f32 v195, v119
    v_pk_add_f32 v[192:193], v[192:193], 1.0 op_sel_hi:[1,0]
    v_pk_add_f32 v[194:195], v[194:195], 1.0 op_sel_hi:[1,0]
    v_pk_fma_f32 v[192:193], v[192:193], v[192:193], 1.0 op_sel_hi:[1,1,0]
    v_pk_fma_f32 v[194:195], v[194:195], v[194:195], 1.0 op_sel_hi:[1,1,0]
    v_rcp_f32 v192, v192
    v_rcp_f32 v193, v193
    v_rcp_f32 v194, v194
    v_rcp_f32 v195, v195
    v_pk_fma_f32 v[192:193], v[192:193], v[210:211], v[208:209] op_sel_hi:[1,0,0]
    v_pk_fma_f32 v[194:195], v[194:195], v[210:211], v[208:209] op_sel_hi:[1,0,0]
    v_pk_mul_f32 v[116:117], v[116:117], v[192:193]
    v_pk_mul_f32 v[118:119], v[118:119], v[194:195]
    v_cvt_pk_bf16_f32 v204, v116, v117
    v_cvt_pk_bf16_f32 v205, v118, v119
    buffer_store_dwordx2 v[204:205], v4, s[32:35], s65 offen sc1
    s_waitcnt vmcnt(20)
    v_mfma_f32_16x16x32_bf16 v[192:195], a[0:3], v[132:135], 0
    v_mfma_f32_16x16x32_bf16 v[196:199], a[4:7], v[132:135], 0
    v_mfma_f32_16x16x32_bf16 v[200:203], a[8:11], v[132:135], 0
    v_mfma_f32_16x16x32_bf16 v[204:207], a[12:15], v[132:135], 0
    v_mfma_f32_16x16x32_bf16 v[208:211], a[16:19], v[132:135], 0
    buffer_load_dwordx4 v[132:135], v1, s[32:35], s99 offen offset:1024 sc1
    s_waitcnt vmcnt(20)
    v_mfma_f32_16x16x32_bf16 v[192:195], a[20:23], v[136:139], v[192:195]
    v_mfma_f32_16x16x32_bf16 v[196:199], a[24:27], v[136:139], v[196:199]
    v_mfma_f32_16x16x32_bf16 v[200:203], a[28:31], v[136:139], v[200:203]
    v_mfma_f32_16x16x32_bf16 v[204:207], a[32:35], v[136:139], v[204:207]
    v_mfma_f32_16x16x32_bf16 v[208:211], a[36:39], v[136:139], v[208:211]
    buffer_load_dwordx4 v[136:139], v1, s[32:35], s99 offen offset:2048 sc1
    s_waitcnt vmcnt(20)
    v_mfma_f32_16x16x32_bf16 v[192:195], a[40:43], v[140:143], v[192:195]
    v_mfma_f32_16x16x32_bf16 v[196:199], a[44:47], v[140:143], v[196:199]
    s_add_u32 s68, s85, 12288
    v_mov_b32 v32, s97
    v_mfma_f32_16x16x32_bf16 v[200:203], a[48:51], v[140:143], v[200:203]
    v_mov_b32 v33, 0
    s_waitcnt vmcnt(2)
    v_mfma_f32_16x16x32_bf16 v[204:207], a[52:55], v[140:143], v[204:207]
    buffer_store_dword v32, v33, s[32:35], s68 offen offset:0 sc1
    v_bfe_u32 v121, v0, 1, 2
    v_mfma_f32_16x16x32_bf16 v[208:211], a[56:59], v[140:143], v[208:211]
    buffer_load_dwordx4 v[140:143], v1, s[32:35], s99 offen offset:3072 sc1
    v_lshlrev_b32 v121, 4, v121
    v_mfma_f32_16x16x32_bf16 v[192:195], a[60:63], v[144:147], v[192:195]
    v_and_b32 v120, 1, v0
    v_lshl_add_u32 v121, v120, 2, v121
    v_mfma_f32_16x16x32_bf16 v[196:199], a[64:67], v[144:147], v[196:199]
    s_add_u32 s67, s84, 12288
    v_mfma_f32_16x16x32_bf16 v[200:203], a[68:71], v[144:147], v[200:203]
    v_mfma_f32_16x16x32_bf16 v[204:207], a[72:75], v[144:147], v[204:207]
    v_mfma_f32_16x16x32_bf16 v[208:211], a[76:79], v[144:147], v[208:211]
    s_add_u32 s99, s99, 4096
    buffer_load_dwordx4 v[144:147], v1, s[32:35], s99 offen offset:0 sc1
    v_mfma_f32_16x16x32_bf16 v[192:195], a[80:83], v[148:151], v[192:195]
    v_mfma_f32_16x16x32_bf16 v[196:199], a[84:87], v[148:151], v[196:199]
    v_mfma_f32_16x16x32_bf16 v[200:203], a[88:91], v[148:151], v[200:203]
    v_mfma_f32_16x16x32_bf16 v[204:207], a[92:95], v[148:151], v[204:207]
    v_mfma_f32_16x16x32_bf16 v[208:211], a[96:99], v[148:151], v[208:211]
    buffer_load_dwordx4 v[148:151], v1, s[32:35], s99 offen offset:1024 sc1
    v_mfma_f32_16x16x32_bf16 v[192:195], a[100:103], v[152:155], v[192:195]
    v_mfma_f32_16x16x32_bf16 v[196:199], a[104:107], v[152:155], v[196:199]
    v_mfma_f32_16x16x32_bf16 v[200:203], a[108:111], v[152:155], v[200:203]
    v_mfma_f32_16x16x32_bf16 v[204:207], a[112:115], v[152:155], v[204:207]
    v_mfma_f32_16x16x32_bf16 v[208:211], a[116:119], v[152:155], v[208:211]
    buffer_load_dwordx4 v[152:155], v1, s[32:35], s99 offen offset:2048 sc1
    v_mfma_f32_16x16x32_bf16 v[192:195], a[120:123], v[156:159], v[192:195]
    v_mfma_f32_16x16x32_bf16 v[196:199], a[124:127], v[156:159], v[196:199]
    v_mfma_f32_16x16x32_bf16 v[200:203], a[128:131], v[156:159], v[200:203]
    v_mfma_f32_16x16x32_bf16 v[204:207], a[132:135], v[156:159], v[204:207]
    v_mfma_f32_16x16x32_bf16 v[208:211], a[136:139], v[156:159], v[208:211]
    buffer_load_dwordx4 v[156:159], v1, s[32:35], s99 offen offset:3072 sc1
    v_mfma_f32_16x16x32_bf16 v[192:195], a[140:143], v[160:163], v[192:195]
    v_mfma_f32_16x16x32_bf16 v[196:199], a[144:147], v[160:163], v[196:199]
    v_mfma_f32_16x16x32_bf16 v[200:203], a[148:151], v[160:163], v[200:203]
    v_mfma_f32_16x16x32_bf16 v[204:207], a[152:155], v[160:163], v[204:207]
    v_mfma_f32_16x16x32_bf16 v[208:211], a[156:159], v[160:163], v[208:211]
    s_add_u32 s99, s99, 4096
    buffer_load_dwordx4 v[160:163], v1, s[32:35], s99 offen offset:0 sc1
    v_mfma_f32_16x16x32_bf16 v[192:195], a[160:163], v[164:167], v[192:195]
    v_mfma_f32_16x16x32_bf16 v[196:199], a[164:167], v[164:167], v[196:199]
    v_mfma_f32_16x16x32_bf16 v[200:203], a[168:171], v[164:167], v[200:203]
    v_mfma_f32_16x16x32_bf16 v[204:207], a[172:175], v[164:167], v[204:207]
    v_mfma_f32_16x16x32_bf16 v[208:211], a[176:179], v[164:167], v[208:211]
    buffer_load_dwordx4 v[164:167], v1, s[32:35], s99 offen offset:1024 sc1
    v_mfma_f32_16x16x32_bf16 v[192:195], a[180:183], v[168:171], v[192:195]
    v_mfma_f32_16x16x32_bf16 v[196:199], a[184:187], v[168:171], v[196:199]
    v_mfma_f32_16x16x32_bf16 v[200:203], a[188:191], v[168:171], v[200:203]
    v_mfma_f32_16x16x32_bf16 v[204:207], a[192:195], v[168:171], v[204:207]
    v_mfma_f32_16x16x32_bf16 v[208:211], a[196:199], v[168:171], v[208:211]
    buffer_load_dwordx4 v[168:171], v1, s[32:35], s99 offen offset:2048 sc1
    v_mfma_f32_16x16x32_bf16 v[192:195], a[200:203], v[172:175], v[192:195]
    v_mfma_f32_16x16x32_bf16 v[196:199], a[204:207], v[172:175], v[196:199]
    v_mfma_f32_16x16x32_bf16 v[200:203], a[208:211], v[172:175], v[200:203]
    v_mfma_f32_16x16x32_bf16 v[204:207], a[212:215], v[172:175], v[204:207]
    v_mfma_f32_16x16x32_bf16 v[208:211], a[216:219], v[172:175], v[208:211]
    buffer_load_dwordx4 v[172:175], v1, s[32:35], s99 offen offset:3072 sc1
    v_mfma_f32_16x16x32_bf16 v[192:195], a[220:223], v[176:179], v[192:195]
    v_mfma_f32_16x16x32_bf16 v[196:199], a[224:227], v[176:179], v[196:199]
    v_mfma_f32_16x16x32_bf16 v[200:203], a[228:231], v[176:179], v[200:203]
    v_mfma_f32_16x16x32_bf16 v[204:207], a[232:235], v[176:179], v[204:207]
    v_mfma_f32_16x16x32_bf16 v[208:211], a[236:239], v[176:179], v[208:211]
    s_add_u32 s99, s99, s94
    buffer_load_dwordx2 v[176:177], v4, s[32:35], s99 offen offset:0 sc1
    buffer_load_dwordx2 v[178:179], v4, s[32:35], s99 offen offset:512 sc1
    v_mfma_f32_16x16x32_bf16 v[192:195], a[240:243], v[180:183], v[192:195]
    buffer_load_dword v120, v121, s[32:35], s67 offen sc1
    v_mfma_f32_16x16x32_bf16 v[196:199], a[244:247], v[180:183], v[196:199]
    v_mfma_f32_16x16x32_bf16 v[200:203], a[248:251], v[180:183], v[200:203]
    v_mfma_f32_16x16x32_bf16 v[204:207], a[252:255], v[180:183], v[204:207]
    v_mfma_f32_16x16x32_bf16 v[208:211], v[232:235], v[180:183], v[208:211]
    buffer_load_dwordx2 v[180:181], v4, s[32:35], s99 offen offset:1024 sc1
    buffer_load_dwordx2 v[182:183], v4, s[32:35], s99 offen offset:1536 sc1
    v_mfma_f32_16x16x32_bf16 v[192:195], v[236:239], v[184:187], v[192:195]
    v_mfma_f32_16x16x32_bf16 v[196:199], v[240:243], v[184:187], v[196:199]
    v_mfma_f32_16x16x32_bf16 v[200:203], v[244:247], v[184:187], v[200:203]
    v_mfma_f32_16x16x32_bf16 v[204:207], v[248:251], v[184:187], v[204:207]
    v_mfma_f32_16x16x32_bf16 v[208:211], v[252:255], v[184:187], v[208:211]
    v_mfma_f32_16x16x32_bf16 v[212:215], a[0:3], v[188:191], 0
    v_mfma_f32_16x16x32_bf16 v[216:219], a[4:7], v[188:191], 0
    v_mfma_f32_16x16x32_bf16 v[220:223], a[8:11], v[188:191], 0
    s_xor_b32 s68, s54, 0
    s_mul_i32 s68, s68, 5120
    v_mfma_f32_16x16x32_bf16 v[224:227], a[12:15], v[188:191], 0
    s_add_u32 s68, s68, 143360
    v_add_u32 v33, s68, v1
    v_mfma_f32_16x16x32_bf16 v[228:231], a[16:19], v[188:191], 0
    ds_write_b128 v33, v[192:195] offset:0
    ds_write_b128 v33, v[196:199] offset:1024
    s_waitcnt vmcnt(16)
    v_mfma_f32_16x16x32_bf16 v[212:215], a[20:23], v[132:135], v[212:215]
    ds_write_b128 v33, v[200:203] offset:2048
    ds_write_b128 v33, v[204:207] offset:3072
    v_mfma_f32_16x16x32_bf16 v[216:219], a[24:27], v[132:135], v[216:219]
    ds_write_b128 v33, v[208:211] offset:4096
    s_xor_b32 s68, s54, 1
    v_mfma_f32_16x16x32_bf16 v[220:223], a[28:31], v[132:135], v[220:223]
    s_mul_i32 s68, s68, 5120
    s_add_u32 s68, s68, 143360
    v_mfma_f32_16x16x32_bf16 v[224:227], a[32:35], v[132:135], v[224:227]
    v_add_u32 v33, s68, v1
    s_xor_b32 s68, s54, 3
    v_mfma_f32_16x16x32_bf16 v[228:231], a[36:39], v[132:135], v[228:231]
    s_mul_i32 s68, s68, 5120
    s_add_u32 s68, s68, 143368
    s_waitcnt vmcnt(15)
    v_mfma_f32_16x16x32_bf16 v[212:215], a[40:43], v[136:139], v[212:215]
    s_waitcnt vmcnt(2)
    v_cmp_ne_u32 vcc, s97, v120
    s_cbranch_vccnz SPIN_214
BACK_215:
    v_add_u32 v34, s68, v1
    v_mfma_f32_16x16x32_bf16 v[216:219], a[44:47], v[136:139], v[216:219]
    s_add_u32 s95, s96, 7188480
    buffer_load_dwordx4 v[184:187], v1, s[32:35], s95 offen offset:0 sc1
    v_mfma_f32_16x16x32_bf16 v[220:223], a[48:51], v[136:139], v[220:223]
    v_mfma_f32_16x16x32_bf16 v[224:227], a[52:55], v[136:139], v[224:227]
    v_mfma_f32_16x16x32_bf16 v[228:231], a[56:59], v[136:139], v[228:231]
    buffer_load_dwordx4 v[188:191], v1, s[32:35], s95 offen offset:1024 sc1
    v_mfma_f32_16x16x32_bf16 v[212:215], a[60:63], v[140:143], v[212:215]
    v_mfma_f32_16x16x32_bf16 v[216:219], a[64:67], v[140:143], v[216:219]
    v_mfma_f32_16x16x32_bf16 v[220:223], a[68:71], v[140:143], v[220:223]
    buffer_load_dwordx4 v[132:135], v1, s[32:35], s95 offen offset:2048 sc1
    v_mfma_f32_16x16x32_bf16 v[224:227], a[72:75], v[140:143], v[224:227]
    v_mfma_f32_16x16x32_bf16 v[228:231], a[76:79], v[140:143], v[228:231]
    buffer_load_dwordx4 v[136:139], v1, s[32:35], s95 offen offset:3072 sc1
    s_waitcnt lgkmcnt(0)
    v_mfma_f32_16x16x32_bf16 v[212:215], a[80:83], v[144:147], v[212:215]
    s_add_u32 s95, s95, 4096
    buffer_load_dwordx4 v[140:143], v1, s[32:35], s95 offen offset:0 sc1
    v_mfma_f32_16x16x32_bf16 v[216:219], a[84:87], v[144:147], v[216:219]
    s_barrier
    ds_read_b64 v[192:193], v33 offset:0
    v_mfma_f32_16x16x32_bf16 v[220:223], a[88:91], v[144:147], v[220:223]
    ds_read_b64 v[194:195], v33 offset:1024
    ds_read_b64 v[196:197], v33 offset:2048
    v_mfma_f32_16x16x32_bf16 v[224:227], a[92:95], v[144:147], v[224:227]
    ds_read_b64 v[198:199], v33 offset:3072
    ds_read_b64 v[200:201], v33 offset:4096
    v_mfma_f32_16x16x32_bf16 v[228:231], a[96:99], v[144:147], v[228:231]
    buffer_load_dwordx4 v[144:147], v1, s[32:35], s95 offen offset:1024 sc1
    ds_read_b64 v[202:203], v34 offset:0
    v_mfma_f32_16x16x32_bf16 v[212:215], a[100:103], v[148:151], v[212:215]
    ds_read_b64 v[204:205], v34 offset:1024
    ds_read_b64 v[206:207], v34 offset:2048
    v_mfma_f32_16x16x32_bf16 v[216:219], a[104:107], v[148:151], v[216:219]
    ds_read_b64 v[208:209], v34 offset:3072
    ds_read_b64 v[210:211], v34 offset:4096
    v_mfma_f32_16x16x32_bf16 v[220:223], a[108:111], v[148:151], v[220:223]
    v_mfma_f32_16x16x32_bf16 v[224:227], a[112:115], v[148:151], v[224:227]
    v_mfma_f32_16x16x32_bf16 v[228:231], a[116:119], v[148:151], v[228:231]
    buffer_load_dwordx4 v[148:151], v1, s[32:35], s95 offen offset:2048 sc1
    v_mfma_f32_16x16x32_bf16 v[212:215], a[120:123], v[152:155], v[212:215]
    v_mfma_f32_16x16x32_bf16 v[216:219], a[124:127], v[152:155], v[216:219]
    v_mfma_f32_16x16x32_bf16 v[220:223], a[128:131], v[152:155], v[220:223]
    v_mfma_f32_16x16x32_bf16 v[224:227], a[132:135], v[152:155], v[224:227]
    v_mfma_f32_16x16x32_bf16 v[228:231], a[136:139], v[152:155], v[228:231]
    buffer_load_dwordx4 v[152:155], v1, s[32:35], s95 offen offset:3072 sc1
    v_mfma_f32_16x16x32_bf16 v[212:215], a[140:143], v[156:159], v[212:215]
    v_mfma_f32_16x16x32_bf16 v[216:219], a[144:147], v[156:159], v[216:219]
    s_waitcnt lgkmcnt(4)
    v_add_f32 v192, v192, v202
    v_add_f32 v193, v193, v203
    v_mfma_f32_16x16x32_bf16 v[220:223], a[148:151], v[156:159], v[220:223]
    s_waitcnt lgkmcnt(3)
    v_add_f32 v194, v194, v204
    v_add_f32 v195, v195, v205
    v_mfma_f32_16x16x32_bf16 v[224:227], a[152:155], v[156:159], v[224:227]
    s_waitcnt lgkmcnt(2)
    v_add_f32 v196, v196, v206
    v_add_f32 v197, v197, v207
    v_mfma_f32_16x16x32_bf16 v[228:231], a[156:159], v[156:159], v[228:231]
    s_add_u32 s95, s95, 4096
    buffer_load_dwordx4 v[156:159], v1, s[32:35], s95 offen offset:0 sc1
    v_mfma_f32_16x16x32_bf16 v[212:215], a[160:163], v[160:163], v[212:215]
    s_waitcnt lgkmcnt(1)
    v_add_f32 v198, v198, v208
    v_add_f32 v199, v199, v209
    v_mfma_f32_16x16x32_bf16 v[216:219], a[164:167], v[160:163], v[216:219]
    s_waitcnt lgkmcnt(0)
    v_add_f32 v200, v200, v210
    v_add_f32 v201, v201, v211
    v_mfma_f32_16x16x32_bf16 v[220:223], a[168:171], v[160:163], v[220:223]
    v_lshlrev_b32 v202, 16, v6
    v_and_b32 v203, 0xffff0000, v6
    v_mfma_f32_16x16x32_bf16 v[224:227], a[172:175], v[160:163], v[224:227]
    v_lshlrev_b32 v204, 16, v7
    v_and_b32 v205, 0xffff0000, v7
    v_mfma_f32_16x16x32_bf16 v[228:231], a[176:179], v[160:163], v[228:231]
    buffer_load_dwordx4 v[160:163], v1, s[32:35], s95 offen offset:1024 sc1
    v_lshlrev_b32 v206, 16, v8
    v_mfma_f32_16x16x32_bf16 v[212:215], a[180:183], v[164:167], v[212:215]
    v_and_b32 v207, 0xffff0000, v8
    v_lshlrev_b32 v208, 16, v9
    v_mfma_f32_16x16x32_bf16 v[216:219], a[184:187], v[164:167], v[216:219]
    v_and_b32 v209, 0xffff0000, v9
    v_lshlrev_b32 v210, 16, v10
    v_mfma_f32_16x16x32_bf16 v[220:223], a[188:191], v[164:167], v[220:223]
    v_and_b32 v211, 0xffff0000, v10
    v_add_f32 v192, v192, v202
    v_mfma_f32_16x16x32_bf16 v[224:227], a[192:195], v[164:167], v[224:227]
    v_add_f32 v193, v193, v203
    v_add_f32 v194, v194, v204
    v_mfma_f32_16x16x32_bf16 v[228:231], a[196:199], v[164:167], v[228:231]
    buffer_load_dwordx4 v[164:167], v1, s[32:35], s95 offen offset:2048 sc1
    v_add_f32 v195, v195, v205
    v_mfma_f32_16x16x32_bf16 v[212:215], a[200:203], v[168:171], v[212:215]
    v_add_f32 v196, v196, v206
    v_add_f32 v197, v197, v207
    v_mfma_f32_16x16x32_bf16 v[216:219], a[204:207], v[168:171], v[216:219]
    v_add_f32 v198, v198, v208
    v_add_f32 v199, v199, v209
    v_mfma_f32_16x16x32_bf16 v[220:223], a[208:211], v[168:171], v[220:223]
    v_add_f32 v200, v200, v210
    v_add_f32 v201, v201, v211
    v_mfma_f32_16x16x32_bf16 v[224:227], a[212:215], v[168:171], v[224:227]
    v_subrev_u32 v35, 8, v34
    v_mov_b32 v34, v33
    v_mfma_f32_16x16x32_bf16 v[228:231], a[216:219], v[168:171], v[228:231]
    buffer_load_dwordx4 v[168:171], v1, s[32:35], s95 offen offset:3072 sc1
    v_mfma_f32_16x16x32_bf16 v[212:215], a[220:223], v[172:175], v[212:215]
    v_mfma_f32_16x16x32_bf16 v[216:219], a[224:227], v[172:175], v[216:219]
    v_mfma_f32_16x16x32_bf16 v[220:223], a[228:231], v[172:175], v[220:223]
    v_mfma_f32_16x16x32_bf16 v[224:227], a[232:235], v[172:175], v[224:227]
    v_mfma_f32_16x16x32_bf16 v[228:231], a[236:239], v[172:175], v[228:231]
    s_add_u32 s95, s95, s94
    buffer_load_dwordx2 v[172:173], v4, s[32:35], s95 offen offset:0 sc1
    buffer_load_dwordx2 v[174:175], v4, s[32:35], s95 offen offset:512 sc1
    v_mfma_f32_16x16x32_bf16 v[212:215], a[240:243], v[176:179], v[212:215]
    v_mfma_f32_16x16x32_bf16 v[216:219], a[244:247], v[176:179], v[216:219]
    v_mfma_f32_16x16x32_bf16 v[220:223], a[248:251], v[176:179], v[220:223]
    v_mfma_f32_16x16x32_bf16 v[224:227], a[252:255], v[176:179], v[224:227]
    v_mfma_f32_16x16x32_bf16 v[228:231], v[232:235], v[176:179], v[228:231]
    buffer_load_dwordx2 v[176:177], v4, s[32:35], s95 offen offset:1024 sc1
    buffer_load_dwordx2 v[178:179], v4, s[32:35], s95 offen offset:1536 sc1
    s_waitcnt vmcnt(16)
    v_mfma_f32_16x16x32_bf16 v[212:215], v[236:239], v[180:183], v[212:215]
    v_mfma_f32_16x16x32_bf16 v[216:219], v[240:243], v[180:183], v[216:219]
    v_mfma_f32_16x16x32_bf16 v[220:223], v[244:247], v[180:183], v[220:223]
    v_mfma_f32_16x16x32_bf16 v[224:227], v[248:251], v[180:183], v[224:227]
    v_mfma_f32_16x16x32_bf16 v[228:231], v[252:255], v[180:183], v[228:231]
    s_add_u32 s99, s81, 7188480
    buffer_load_dwordx4 v[180:183], v1, s[32:35], s99 offen offset:0 sc1
    s_waitcnt vmcnt(16)
    v_mfma_f32_16x16x32_bf16 v[92:95], a[0:3], v[184:187], 0
    v_mfma_f32_16x16x32_bf16 v[96:99], a[4:7], v[184:187], 0
    v_mfma_f32_16x16x32_bf16 v[100:103], a[8:11], v[184:187], 0
    ds_write_b64 v34, v[214:215] offset:0
    ds_write_b64 v34, v[218:219] offset:1024
    v_mfma_f32_16x16x32_bf16 v[104:107], a[12:15], v[184:187], 0
    ds_write_b64 v34, v[222:223] offset:2048
    ds_write_b64 v34, v[226:227] offset:3072
    v_mfma_f32_16x16x32_bf16 v[108:111], a[16:19], v[184:187], 0
    buffer_load_dwordx4 v[184:187], v1, s[32:35], s99 offen offset:1024 sc1
    ds_write_b64 v34, v[230:231] offset:4096
    s_waitcnt vmcnt(16)
    v_mfma_f32_16x16x32_bf16 v[92:95], a[20:23], v[188:191], v[92:95]
    v_add_f32 v192, v192, v212
    v_add_f32 v193, v193, v213
    v_mfma_f32_16x16x32_bf16 v[96:99], a[24:27], v[188:191], v[96:99]
    v_add_f32 v194, v194, v216
    v_add_f32 v195, v195, v217
    v_mfma_f32_16x16x32_bf16 v[100:103], a[28:31], v[188:191], v[100:103]
    v_add_f32 v196, v196, v220
    v_add_f32 v197, v197, v221
    v_mfma_f32_16x16x32_bf16 v[104:107], a[32:35], v[188:191], v[104:107]
    v_add_f32 v198, v198, v224
    v_add_f32 v199, v199, v225
    v_mfma_f32_16x16x32_bf16 v[108:111], a[36:39], v[188:191], v[108:111]
    buffer_load_dwordx4 v[188:191], v1, s[32:35], s99 offen offset:2048 sc1
    v_add_f32 v200, v200, v228
    s_waitcnt vmcnt(16)
    v_mfma_f32_16x16x32_bf16 v[92:95], a[40:43], v[132:135], v[92:95]
    v_add_f32 v201, v201, v229
    v_mfma_f32_16x16x32_bf16 v[96:99], a[44:47], v[132:135], v[96:99]
    v_mfma_f32_16x16x32_bf16 v[100:103], a[48:51], v[132:135], v[100:103]
    v_mfma_f32_16x16x32_bf16 v[104:107], a[52:55], v[132:135], v[104:107]
    s_waitcnt lgkmcnt(0)
    s_barrier
    v_mfma_f32_16x16x32_bf16 v[108:111], a[56:59], v[132:135], v[108:111]
    buffer_load_dwordx4 v[132:135], v1, s[32:35], s99 offen offset:3072 sc1
    ds_read_b64 v[202:203], v35 offset:0
    s_waitcnt vmcnt(16)
    v_mfma_f32_16x16x32_bf16 v[92:95], a[60:63], v[136:139], v[92:95]
    ds_read_b64 v[204:205], v35 offset:1024
    ds_read_b64 v[206:207], v35 offset:2048
    v_mfma_f32_16x16x32_bf16 v[96:99], a[64:67], v[136:139], v[96:99]
    ds_read_b64 v[208:209], v35 offset:3072
    ds_read_b64 v[210:211], v35 offset:4096
    v_mfma_f32_16x16x32_bf16 v[100:103], a[68:71], v[136:139], v[100:103]
    v_mfma_f32_16x16x32_bf16 v[104:107], a[72:75], v[136:139], v[104:107]
    v_mfma_f32_16x16x32_bf16 v[108:111], a[76:79], v[136:139], v[108:111]
    s_add_u32 s99, s99, 4096
    buffer_load_dwordx4 v[136:139], v1, s[32:35], s99 offen offset:0 sc1
    s_waitcnt vmcnt(16)
    v_mfma_f32_16x16x32_bf16 v[92:95], a[80:83], v[140:143], v[92:95]
    v_mfma_f32_16x16x32_bf16 v[96:99], a[84:87], v[140:143], v[96:99]
    v_mfma_f32_16x16x32_bf16 v[100:103], a[88:91], v[140:143], v[100:103]
    v_mfma_f32_16x16x32_bf16 v[104:107], a[92:95], v[140:143], v[104:107]
    s_waitcnt lgkmcnt(4)
    v_add_f32 v192, v192, v202
    v_add_f32 v193, v193, v203
    v_mfma_f32_16x16x32_bf16 v[108:111], a[96:99], v[140:143], v[108:111]
    buffer_load_dwordx4 v[140:143], v1, s[32:35], s99 offen offset:1024 sc1
    s_waitcnt lgkmcnt(3)
    v_add_f32 v194, v194, v204
    s_waitcnt vmcnt(16)
    v_mfma_f32_16x16x32_bf16 v[92:95], a[100:103], v[144:147], v[92:95]
    v_add_f32 v195, v195, v205
    s_waitcnt lgkmcnt(2)
    v_add_f32 v196, v196, v206
    v_mfma_f32_16x16x32_bf16 v[96:99], a[104:107], v[144:147], v[96:99]
    v_add_f32 v197, v197, v207
    s_waitcnt lgkmcnt(1)
    v_add_f32 v198, v198, v208
    v_mfma_f32_16x16x32_bf16 v[100:103], a[108:111], v[144:147], v[100:103]
    v_add_f32 v199, v199, v209
    s_waitcnt lgkmcnt(0)
    v_add_f32 v200, v200, v210
    v_mfma_f32_16x16x32_bf16 v[104:107], a[112:115], v[144:147], v[104:107]
    v_add_f32 v201, v201, v211
    s_barrier
    v_mfma_f32_16x16x32_bf16 v[108:111], a[116:119], v[144:147], v[108:111]
    buffer_load_dwordx4 v[144:147], v1, s[32:35], s99 offen offset:2048 sc1
    s_and_b32 s65, s54, 1
    s_lshl_b32 s64, s55, 2
    s_add_u32 s64, s64, s65
    s_mul_i32 s64, s64, 20480
    s_mul_i32 s65, s56, 160
    s_add_u32 s64, s64, s65
    s_lshr_b32 s65, s54, 1
    s_lshl_b32 s65, s65, 2
    s_add_u32 s64, s64, s65
    v_mul_u32_u24 v30, 1280, v2
    v_lshl_add_u32 v30, v3, 3, v30
    v_add_u32 v30, s64, v30
    v_add_u32 v31, 40960, v30
    s_waitcnt vmcnt(16)
    v_mfma_f32_16x16x32_bf16 v[92:95], a[120:123], v[148:151], v[92:95]
    v_mfma_f32_16x16x32_bf16 v[96:99], a[124:127], v[148:151], v[96:99]
    v_mfma_f32_16x16x32_bf16 v[100:103], a[128:131], v[148:151], v[100:103]
    v_mfma_f32_16x16x32_bf16 v[104:107], a[132:135], v[148:151], v[104:107]
    v_mfma_f32_16x16x32_bf16 v[108:111], a[136:139], v[148:151], v[108:111]
    buffer_load_dwordx4 v[148:151], v1, s[32:35], s99 offen offset:3072 sc1
    s_waitcnt vmcnt(16)
    v_mfma_f32_16x16x32_bf16 v[92:95], a[140:143], v[152:155], v[92:95]
    v_mfma_f32_16x16x32_bf16 v[96:99], a[144:147], v[152:155], v[96:99]
    v_mfma_f32_16x16x32_bf16 v[100:103], a[148:151], v[152:155], v[100:103]
    v_mfma_f32_16x16x32_bf16 v[104:107], a[152:155], v[152:155], v[104:107]
    v_mfma_f32_16x16x32_bf16 v[108:111], a[156:159], v[152:155], v[108:111]
    s_add_u32 s99, s99, 4096
    buffer_load_dwordx4 v[152:155], v1, s[32:35], s99 offen offset:0 sc1
    s_waitcnt vmcnt(16)
    v_mfma_f32_16x16x32_bf16 v[92:95], a[160:163], v[156:159], v[92:95]
    v_mfma_f32_16x16x32_bf16 v[96:99], a[164:167], v[156:159], v[96:99]
    v_mfma_f32_16x16x32_bf16 v[100:103], a[168:171], v[156:159], v[100:103]
    v_mfma_f32_16x16x32_bf16 v[104:107], a[172:175], v[156:159], v[104:107]
    v_mfma_f32_16x16x32_bf16 v[108:111], a[176:179], v[156:159], v[108:111]
    buffer_load_dwordx4 v[156:159], v1, s[32:35], s99 offen offset:1024 sc1
    s_waitcnt vmcnt(16)
    v_mfma_f32_16x16x32_bf16 v[92:95], a[180:183], v[160:163], v[92:95]
    v_mfma_f32_16x16x32_bf16 v[96:99], a[184:187], v[160:163], v[96:99]
    v_mfma_f32_16x16x32_bf16 v[100:103], a[188:191], v[160:163], v[100:103]
    v_mfma_f32_16x16x32_bf16 v[104:107], a[192:195], v[160:163], v[104:107]
    v_mfma_f32_16x16x32_bf16 v[108:111], a[196:199], v[160:163], v[108:111]
    buffer_load_dwordx4 v[160:163], v1, s[32:35], s99 offen offset:2048 sc1
    s_waitcnt vmcnt(16)
    v_mfma_f32_16x16x32_bf16 v[92:95], a[200:203], v[164:167], v[92:95]
    v_mfma_f32_16x16x32_bf16 v[96:99], a[204:207], v[164:167], v[96:99]
    v_mfma_f32_16x16x32_bf16 v[100:103], a[208:211], v[164:167], v[100:103]
    v_mfma_f32_16x16x32_bf16 v[104:107], a[212:215], v[164:167], v[104:107]
    v_mfma_f32_16x16x32_bf16 v[108:111], a[216:219], v[164:167], v[108:111]
    buffer_load_dwordx4 v[164:167], v1, s[32:35], s99 offen offset:3072 sc1
    s_waitcnt vmcnt(16)
    v_mfma_f32_16x16x32_bf16 v[92:95], a[220:223], v[168:171], v[92:95]
    v_mfma_f32_16x16x32_bf16 v[96:99], a[224:227], v[168:171], v[96:99]
    v_mfma_f32_16x16x32_bf16 v[100:103], a[228:231], v[168:171], v[100:103]
    v_mfma_f32_16x16x32_bf16 v[104:107], a[232:235], v[168:171], v[104:107]
    v_mfma_f32_16x16x32_bf16 v[108:111], a[236:239], v[168:171], v[108:111]
    s_add_u32 s99, s99, s94
    buffer_load_dwordx2 v[168:169], v4, s[32:35], s99 offen offset:0 sc1
    buffer_load_dwordx2 v[170:171], v4, s[32:35], s99 offen offset:512 sc1
    s_waitcnt vmcnt(16)
    v_mfma_f32_16x16x32_bf16 v[92:95], a[240:243], v[172:175], v[92:95]
    v_mfma_f32_16x16x32_bf16 v[96:99], a[244:247], v[172:175], v[96:99]
    v_mfma_f32_16x16x32_bf16 v[100:103], a[248:251], v[172:175], v[100:103]
    v_mfma_f32_16x16x32_bf16 v[104:107], a[252:255], v[172:175], v[104:107]
    v_mfma_f32_16x16x32_bf16 v[108:111], v[232:235], v[172:175], v[108:111]
    buffer_load_dwordx2 v[172:173], v4, s[32:35], s99 offen offset:1024 sc1
    buffer_load_dwordx2 v[174:175], v4, s[32:35], s99 offen offset:1536 sc1
    s_waitcnt vmcnt(16)
    v_mfma_f32_16x16x32_bf16 v[92:95], v[236:239], v[176:179], v[92:95]
    v_mfma_f32_16x16x32_bf16 v[96:99], v[240:243], v[176:179], v[96:99]
    v_mfma_f32_16x16x32_bf16 v[100:103], v[244:247], v[176:179], v[100:103]
    v_mfma_f32_16x16x32_bf16 v[104:107], v[248:251], v[176:179], v[104:107]
    v_mfma_f32_16x16x32_bf16 v[108:111], v[252:255], v[176:179], v[108:111]
    s_waitcnt vmcnt(15)
    v_mfma_f32_16x16x32_bf16 v[112:115], a[0:3], v[180:183], 0
    v_mfma_f32_16x16x32_bf16 v[116:119], a[4:7], v[180:183], 0
    v_mfma_f32_16x16x32_bf16 v[120:123], a[8:11], v[180:183], 0
    s_xor_b32 s68, s54, 0
    s_mul_i32 s68, s68, 5120
    v_mfma_f32_16x16x32_bf16 v[124:127], a[12:15], v[180:183], 0
    s_add_u32 s68, s68, 143360
    v_add_u32 v33, s68, v1
    v_mfma_f32_16x16x32_bf16 v[128:131], a[16:19], v[180:183], 0
    ds_write_b128 v33, v[92:95] offset:0
    ds_write_b128 v33, v[96:99] offset:1024
    s_waitcnt vmcnt(14)
    v_mfma_f32_16x16x32_bf16 v[112:115], a[20:23], v[184:187], v[112:115]
    ds_write_b128 v33, v[100:103] offset:2048
    ds_write_b128 v33, v[104:107] offset:3072
    v_mfma_f32_16x16x32_bf16 v[116:119], a[24:27], v[184:187], v[116:119]
    ds_write_b128 v33, v[108:111] offset:4096
    s_xor_b32 s68, s54, 1
    v_mfma_f32_16x16x32_bf16 v[120:123], a[28:31], v[184:187], v[120:123]
    s_mul_i32 s68, s68, 5120
    s_add_u32 s68, s68, 143360
    v_mfma_f32_16x16x32_bf16 v[124:127], a[32:35], v[184:187], v[124:127]
    v_add_u32 v33, s68, v1
    s_xor_b32 s68, s54, 3
    v_mfma_f32_16x16x32_bf16 v[128:131], a[36:39], v[184:187], v[128:131]
    s_mul_i32 s68, s68, 5120
    s_add_u32 s68, s68, 143368
    s_waitcnt vmcnt(13)
    v_mfma_f32_16x16x32_bf16 v[112:115], a[40:43], v[188:191], v[112:115]
    v_add_u32 v34, s68, v1
    v_mfma_f32_16x16x32_bf16 v[116:119], a[44:47], v[188:191], v[116:119]
    v_mfma_f32_16x16x32_bf16 v[120:123], a[48:51], v[188:191], v[120:123]
    v_mfma_f32_16x16x32_bf16 v[124:127], a[52:55], v[188:191], v[124:127]
    v_mfma_f32_16x16x32_bf16 v[128:131], a[56:59], v[188:191], v[128:131]
    s_waitcnt vmcnt(12)
    v_mfma_f32_16x16x32_bf16 v[112:115], a[60:63], v[132:135], v[112:115]
    v_mfma_f32_16x16x32_bf16 v[116:119], a[64:67], v[132:135], v[116:119]
    v_mfma_f32_16x16x32_bf16 v[120:123], a[68:71], v[132:135], v[120:123]
    s_waitcnt lgkmcnt(0)
    s_barrier
    v_mfma_f32_16x16x32_bf16 v[124:127], a[72:75], v[132:135], v[124:127]
    ds_read_b64 v[92:93], v33 offset:0
    ds_read_b64 v[94:95], v33 offset:1024
    v_mfma_f32_16x16x32_bf16 v[128:131], a[76:79], v[132:135], v[128:131]
    ds_read_b64 v[96:97], v33 offset:2048
    ds_read_b64 v[98:99], v33 offset:3072
    s_waitcnt vmcnt(11)
    v_mfma_f32_16x16x32_bf16 v[112:115], a[80:83], v[136:139], v[112:115]
    ds_read_b64 v[100:101], v33 offset:4096
    ds_read_b64 v[102:103], v34 offset:0
    v_mfma_f32_16x16x32_bf16 v[116:119], a[84:87], v[136:139], v[116:119]
    ds_read_b64 v[104:105], v34 offset:1024
    ds_read_b64 v[106:107], v34 offset:2048
    v_mfma_f32_16x16x32_bf16 v[120:123], a[88:91], v[136:139], v[120:123]
    ds_read_b64 v[108:109], v34 offset:3072
    ds_read_b64 v[110:111], v34 offset:4096
    v_mfma_f32_16x16x32_bf16 v[124:127], a[92:95], v[136:139], v[124:127]
    v_mfma_f32_16x16x32_bf16 v[128:131], a[96:99], v[136:139], v[128:131]
    s_waitcnt vmcnt(10)
    v_mfma_f32_16x16x32_bf16 v[112:115], a[100:103], v[140:143], v[112:115]
    v_mfma_f32_16x16x32_bf16 v[116:119], a[104:107], v[140:143], v[116:119]
    v_mfma_f32_16x16x32_bf16 v[120:123], a[108:111], v[140:143], v[120:123]
    v_mfma_f32_16x16x32_bf16 v[124:127], a[112:115], v[140:143], v[124:127]
    v_mfma_f32_16x16x32_bf16 v[128:131], a[116:119], v[140:143], v[128:131]
    s_waitcnt vmcnt(9)
    v_mfma_f32_16x16x32_bf16 v[112:115], a[120:123], v[144:147], v[112:115]
    v_mfma_f32_16x16x32_bf16 v[116:119], a[124:127], v[144:147], v[116:119]
    v_mfma_f32_16x16x32_bf16 v[120:123], a[128:131], v[144:147], v[120:123]
    s_waitcnt lgkmcnt(4)
    v_add_f32 v92, v92, v102
    v_add_f32 v93, v93, v103
    v_mfma_f32_16x16x32_bf16 v[124:127], a[132:135], v[144:147], v[124:127]
    s_waitcnt lgkmcnt(3)
    v_add_f32 v94, v94, v104
    v_add_f32 v95, v95, v105
    v_mfma_f32_16x16x32_bf16 v[128:131], a[136:139], v[144:147], v[128:131]
    s_waitcnt lgkmcnt(2)
    v_add_f32 v96, v96, v106
    v_add_f32 v97, v97, v107
    s_waitcnt vmcnt(8)
    v_mfma_f32_16x16x32_bf16 v[112:115], a[140:143], v[148:151], v[112:115]
    s_waitcnt lgkmcnt(1)
    v_add_f32 v98, v98, v108
    v_add_f32 v99, v99, v109
    v_mfma_f32_16x16x32_bf16 v[116:119], a[144:147], v[148:151], v[116:119]
    s_waitcnt lgkmcnt(0)
    v_add_f32 v100, v100, v110
    v_add_f32 v101, v101, v111
    v_mfma_f32_16x16x32_bf16 v[120:123], a[148:151], v[148:151], v[120:123]
    v_lshlrev_b32 v102, 16, v12
    v_and_b32 v103, 0xffff0000, v12
    v_mfma_f32_16x16x32_bf16 v[124:127], a[152:155], v[148:151], v[124:127]
    v_lshlrev_b32 v104, 16, v13
    v_and_b32 v105, 0xffff0000, v13
    v_mfma_f32_16x16x32_bf16 v[128:131], a[156:159], v[148:151], v[128:131]
    v_lshlrev_b32 v106, 16, v14
    v_and_b32 v107, 0xffff0000, v14
    s_waitcnt vmcnt(7)
    v_mfma_f32_16x16x32_bf16 v[112:115], a[160:163], v[152:155], v[112:115]
    v_lshlrev_b32 v108, 16, v15
    v_and_b32 v109, 0xffff0000, v15
    v_mfma_f32_16x16x32_bf16 v[116:119], a[164:167], v[152:155], v[116:119]
    v_lshlrev_b32 v110, 16, v16
    v_and_b32 v111, 0xffff0000, v16
    v_mfma_f32_16x16x32_bf16 v[120:123], a[168:171], v[152:155], v[120:123]
    v_add_f32 v92, v92, v102
    v_add_f32 v93, v93, v103
    v_mfma_f32_16x16x32_bf16 v[124:127], a[172:175], v[152:155], v[124:127]
    v_add_f32 v94, v94, v104
    v_add_f32 v95, v95, v105
    v_mfma_f32_16x16x32_bf16 v[128:131], a[176:179], v[152:155], v[128:131]
    v_add_f32 v96, v96, v106
    v_add_f32 v97, v97, v107
    s_waitcnt vmcnt(6)
    v_mfma_f32_16x16x32_bf16 v[112:115], a[180:183], v[156:159], v[112:115]
    v_add_f32 v98, v98, v108
    v_add_f32 v99, v99, v109
    v_mfma_f32_16x16x32_bf16 v[116:119], a[184:187], v[156:159], v[116:119]
    v_add_f32 v100, v100, v110
    v_add_f32 v101, v101, v111
    v_mfma_f32_16x16x32_bf16 v[120:123], a[188:191], v[156:159], v[120:123]
    v_subrev_u32 v35, 8, v34
    v_mov_b32 v34, v33
    v_mfma_f32_16x16x32_bf16 v[124:127], a[192:195], v[156:159], v[124:127]
    v_cvt_pk_bf16_f32 v202, v192, v193
    v_cvt_pk_bf16_f32 v203, v194, v195
    v_mfma_f32_16x16x32_bf16 v[128:131], a[196:199], v[156:159], v[128:131]
    v_cvt_pk_bf16_f32 v204, v196, v197
    v_cvt_pk_bf16_f32 v205, v198, v199
    s_waitcnt vmcnt(5)
    v_mfma_f32_16x16x32_bf16 v[112:115], a[200:203], v[160:163], v[112:115]
    v_cvt_pk_bf16_f32 v206, v200, v201
    global_store_dword v30, v202, s[24:25] offset:0
    v_mfma_f32_16x16x32_bf16 v[116:119], a[204:207], v[160:163], v[116:119]
    global_store_dword v30, v203, s[24:25] offset:32
    global_store_dword v30, v204, s[24:25] offset:64
    v_mfma_f32_16x16x32_bf16 v[120:123], a[208:211], v[160:163], v[120:123]
    global_store_dword v30, v205, s[24:25] offset:96
    global_store_dword v30, v206, s[24:25] offset:128
    v_mfma_f32_16x16x32_bf16 v[124:127], a[212:215], v[160:163], v[124:127]
    v_mfma_f32_16x16x32_bf16 v[128:131], a[216:219], v[160:163], v[128:131]
    s_waitcnt vmcnt(9)
    v_mfma_f32_16x16x32_bf16 v[112:115], a[220:223], v[164:167], v[112:115]
    v_mfma_f32_16x16x32_bf16 v[116:119], a[224:227], v[164:167], v[116:119]
    v_mfma_f32_16x16x32_bf16 v[120:123], a[228:231], v[164:167], v[120:123]
    v_mfma_f32_16x16x32_bf16 v[124:127], a[232:235], v[164:167], v[124:127]
    v_mfma_f32_16x16x32_bf16 v[128:131], a[236:239], v[164:167], v[128:131]
    s_waitcnt vmcnt(7)
    v_mfma_f32_16x16x32_bf16 v[112:115], a[240:243], v[168:171], v[112:115]
    v_mfma_f32_16x16x32_bf16 v[116:119], a[244:247], v[168:171], v[116:119]
    v_mfma_f32_16x16x32_bf16 v[120:123], a[248:251], v[168:171], v[120:123]
    v_mfma_f32_16x16x32_bf16 v[124:127], a[252:255], v[168:171], v[124:127]
    v_mfma_f32_16x16x32_bf16 v[128:131], v[232:235], v[168:171], v[128:131]
    s_waitcnt vmcnt(5)
    v_mfma_f32_16x16x32_bf16 v[112:115], v[236:239], v[172:175], v[112:115]
    v_mfma_f32_16x16x32_bf16 v[116:119], v[240:243], v[172:175], v[116:119]
    v_mfma_f32_16x16x32_bf16 v[120:123], v[244:247], v[172:175], v[120:123]
    v_mfma_f32_16x16x32_bf16 v[124:127], v[248:251], v[172:175], v[124:127]
    v_mfma_f32_16x16x32_bf16 v[128:131], v[252:255], v[172:175], v[128:131]
    s_nop 3
    ds_write_b64 v34, v[114:115] offset:0
    ds_write_b64 v34, v[118:119] offset:1024
    ds_write_b64 v34, v[122:123] offset:2048
    ds_write_b64 v34, v[126:127] offset:3072
    ds_write_b64 v34, v[130:131] offset:4096
    v_pk_add_f32 v[92:93], v[92:93], v[112:113]
    v_pk_add_f32 v[94:95], v[94:95], v[116:117]
    v_pk_add_f32 v[96:97], v[96:97], v[120:121]
    v_pk_add_f32 v[98:99], v[98:99], v[124:125]
    v_pk_add_f32 v[100:101], v[100:101], v[128:129]
    s_waitcnt lgkmcnt(0)
    s_barrier
    ds_read_b64 v[102:103], v35 offset:0
    ds_read_b64 v[104:105], v35 offset:1024
    ds_read_b64 v[106:107], v35 offset:2048
    ds_read_b64 v[108:109], v35 offset:3072
    ds_read_b64 v[110:111], v35 offset:4096
    s_waitcnt lgkmcnt(4)
    v_pk_add_f32 v[92:93], v[92:93], v[102:103]
    s_waitcnt lgkmcnt(3)
    v_pk_add_f32 v[94:95], v[94:95], v[104:105]
    s_waitcnt lgkmcnt(2)
    v_pk_add_f32 v[96:97], v[96:97], v[106:107]
    s_waitcnt lgkmcnt(1)
    v_pk_add_f32 v[98:99], v[98:99], v[108:109]
    s_waitcnt lgkmcnt(0)
    v_pk_add_f32 v[100:101], v[100:101], v[110:111]
    v_cvt_pk_bf16_f32 v102, v92, v93
    v_cvt_pk_bf16_f32 v103, v94, v95
    v_cvt_pk_bf16_f32 v104, v96, v97
    v_cvt_pk_bf16_f32 v105, v98, v99
    v_cvt_pk_bf16_f32 v106, v100, v101
    global_store_dword v31, v102, s[24:25] offset:0
    global_store_dword v31, v103, s[24:25] offset:32
    global_store_dword v31, v104, s[24:25] offset:64
    global_store_dword v31, v105, s[24:25] offset:96
    global_store_dword v31, v106, s[24:25] offset:128
    s_endpgm
SPIN_150:
    s_mov_b32 s63, 0
    s_branch POLLB_220
POLL_219:
    s_sleep 2
    s_add_u32 s63, s63, 1
    s_cmp_gt_u32 s63, 400000
    s_cbranch_scc1 POLLX_221
POLLB_220:
    buffer_load_dword v34, v91, s[32:35], 0 offen sc1
    s_waitcnt vmcnt(0)
    v_cmp_ne_u32 vcc, s59, v34
    s_cbranch_vccnz POLL_219
POLLX_221:
    s_branch BACK_151
SPIN_152:
    s_mov_b32 s63, 0
    s_branch POLLB_223
POLL_222:
    s_sleep 2
    s_add_u32 s63, s63, 1
    s_cmp_gt_u32 s63, 400000
    s_cbranch_scc1 POLLX_224
POLLB_223:
    buffer_load_dwordx3 v[58:60], v1, s[32:35], s67 offen offset:0 sc1
    buffer_load_dwordx3 v[62:64], v1, s[32:35], s67 offen offset:1024 sc1
    buffer_load_dwordx3 v[66:68], v1, s[32:35], s67 offen offset:2048 sc1
    buffer_load_dwordx3 v[70:72], v1, s[32:35], s67 offen offset:3072 sc1
    s_waitcnt vmcnt(0)
    v_cmp_ne_u32 vcc, s59, v60
    s_cbranch_vccnz POLL_222
    v_cmp_ne_u32 vcc, s59, v64
    s_cbranch_vccnz POLL_222
    v_cmp_ne_u32 vcc, s59, v68
    s_cbranch_vccnz POLL_222
    v_cmp_ne_u32 vcc, s59, v72
    s_cbranch_vccnz POLL_222
POLLX_224:
    s_branch BACK_153
SPIN_154:
    s_mov_b32 s63, 0
    s_branch POLLB_226
POLL_225:
    s_sleep 2
    s_add_u32 s63, s63, 1
    s_cmp_gt_u32 s63, 400000
    s_cbranch_scc1 POLLX_227
POLLB_226:
    buffer_load_dwordx3 v[74:76], v1, s[32:35], s68 offen offset:0 sc1
    buffer_load_dwordx3 v[78:80], v1, s[32:35], s68 offen offset:1024 sc1
    buffer_load_dwordx3 v[82:84], v1, s[32:35], s68 offen offset:2048 sc1
    buffer_load_dwordx3 v[86:88], v1, s[32:35], s68 offen offset:3072 sc1
    s_waitcnt vmcnt(0)
    v_cmp_ne_u32 vcc, s59, v76
    s_cbranch_vccnz POLL_225
    v_cmp_ne_u32 vcc, s59, v80
    s_cbranch_vccnz POLL_225
    v_cmp_ne_u32 vcc, s59, v84
    s_cbranch_vccnz POLL_225
    v_cmp_ne_u32 vcc, s59, v88
    s_cbranch_vccnz POLL_225
POLLX_227:
    s_branch BACK_155
SPIN_163:
    s_mov_b32 s63, 0
    s_branch POLLB_229
POLL_228:
    s_sleep 2
    s_add_u32 s63, s63, 1
    s_cmp_gt_u32 s63, 400000
    s_cbranch_scc1 POLLX_230
POLLB_229:
    buffer_load_dwordx3 v[58:60], v1, s[32:35], s67 offen offset:0 sc1
    buffer_load_dwordx3 v[62:64], v1, s[32:35], s67 offen offset:1024 sc1
    buffer_load_dwordx3 v[66:68], v1, s[32:35], s67 offen offset:2048 sc1
    buffer_load_dwordx3 v[70:72], v1, s[32:35], s67 offen offset:3072 sc1
    s_waitcnt vmcnt(0)
    v_cmp_ne_u32 vcc, s59, v60
    s_cbranch_vccnz POLL_228
    v_cmp_ne_u32 vcc, s59, v64
    s_cbranch_vccnz POLL_228
    v_cmp_ne_u32 vcc, s59, v68
    s_cbranch_vccnz POLL_228
    v_cmp_ne_u32 vcc, s59, v72
    s_cbranch_vccnz POLL_228
POLLX_230:
    s_branch BACK_164
SPIN_165:
    s_mov_b32 s63, 0
    s_branch POLLB_232
POLL_231:
    s_sleep 2
    s_add_u32 s63, s63, 1
    s_cmp_gt_u32 s63, 400000
    s_cbranch_scc1 POLLX_233
POLLB_232:
    buffer_load_dwordx3 v[74:76], v1, s[32:35], s68 offen offset:0 sc1
    buffer_load_dwordx3 v[78:80], v1, s[32:35], s68 offen offset:1024 sc1
    buffer_load_dwordx3 v[82:84], v1, s[32:35], s68 offen offset:2048 sc1
    buffer_load_dwordx3 v[86:88], v1, s[32:35], s68 offen offset:3072 sc1
    s_waitcnt vmcnt(0)
    v_cmp_ne_u32 vcc, s59, v76
    s_cbranch_vccnz POLL_231
    v_cmp_ne_u32 vcc, s59, v80
    s_cbranch_vccnz POLL_231
    v_cmp_ne_u32 vcc, s59, v84
    s_cbranch_vccnz POLL_231
    v_cmp_ne_u32 vcc, s59, v88
    s_cbranch_vccnz POLL_231
POLLX_233:
    s_branch BACK_166
SPIN_178:
    s_mov_b32 s63, 0
    s_branch POLLB_235
POLL_234:
    s_sleep 2
    s_add_u32 s63, s63, 1
    s_cmp_gt_u32 s63, 400000
    s_cbranch_scc1 POLLX_236
POLLB_235:
    buffer_load_dword v120, v121, s[32:35], s67 offen sc1
    s_waitcnt vmcnt(0)
    v_cmp_ne_u32 vcc, s59, v120
    s_cbranch_vccnz POLL_234
POLLX_236:
    s_branch BACK_179
SPIN_181:
    s_mov_b32 s63, 0
    s_branch POLLB_238
POLL_237:
    s_sleep 2
    s_add_u32 s63, s63, 1
    s_cmp_gt_u32 s63, 400000
    s_cbranch_scc1 POLLX_239
POLLB_238:
    buffer_load_dwordx3 v[76:78], v1, s[32:35], s69 offen offset:0 sc1
    buffer_load_dwordx3 v[80:82], v1, s[32:35], s69 offen offset:1024 sc1
    buffer_load_dwordx3 v[84:86], v1, s[32:35], s69 offen offset:2048 sc1
    buffer_load_dwordx3 v[88:90], v1, s[32:35], s69 offen offset:3072 sc1
    s_waitcnt vmcnt(0)
    v_cmp_ne_u32 vcc, s59, v78
    s_cbranch_vccnz POLL_237
    v_cmp_ne_u32 vcc, s59, v82
    s_cbranch_vccnz POLL_237
    v_cmp_ne_u32 vcc, s59, v86
    s_cbranch_vccnz POLL_237
    v_cmp_ne_u32 vcc, s59, v90
    s_cbranch_vccnz POLL_237
POLLX_239:
    s_branch BACK_182
SPIN_183:
    s_mov_b32 s63, 0
    s_branch POLLB_241
POLL_240:
    s_sleep 2
    s_add_u32 s63, s63, 1
    s_cmp_gt_u32 s63, 400000
    s_cbranch_scc1 POLLX_242
POLLB_241:
    buffer_load_dwordx3 v[76:78], v1, s[32:35], s69 offen offset:0 sc1
    buffer_load_dwordx3 v[80:82], v1, s[32:35], s69 offen offset:1024 sc1
    buffer_load_dwordx3 v[84:86], v1, s[32:35], s69 offen offset:2048 sc1
    buffer_load_dwordx3 v[88:90], v1, s[32:35], s69 offen offset:3072 sc1
    s_waitcnt vmcnt(0)
    v_cmp_ne_u32 vcc, s59, v78
    s_cbranch_vccnz POLL_240
    v_cmp_ne_u32 vcc, s59, v82
    s_cbranch_vccnz POLL_240
    v_cmp_ne_u32 vcc, s59, v86
    s_cbranch_vccnz POLL_240
    v_cmp_ne_u32 vcc, s59, v90
    s_cbranch_vccnz POLL_240
POLLX_242:
    s_branch BACK_184
SPIN_187:
    s_mov_b32 s63, 0
    s_branch POLLB_244
POLL_243:
    s_sleep 2
    s_add_u32 s63, s63, 1
    s_cmp_gt_u32 s63, 400000
    s_cbranch_scc1 POLLX_245
POLLB_244:
    buffer_load_dword v120, v121, s[32:35], s67 offen sc1
    s_waitcnt vmcnt(0)
    v_cmp_ne_u32 vcc, s59, v120
    s_cbranch_vccnz POLL_243
POLLX_245:
    s_branch BACK_188
SPIN_190:
    s_mov_b32 s63, 0
    s_branch POLLB_247
POLL_246:
    s_sleep 2
    s_add_u32 s63, s63, 1
    s_cmp_gt_u32 s63, 400000
    s_cbranch_scc1 POLLX_248
POLLB_247:
    buffer_load_dword v120, v121, s[32:35], s67 offen sc1
    s_waitcnt vmcnt(0)
    v_cmp_ne_u32 vcc, s59, v120
    s_cbranch_vccnz POLL_246
POLLX_248:
    s_branch BACK_191
SPIN_195:
    s_mov_b32 s63, 0
    s_branch POLLB_250
POLL_249:
    s_sleep 2
    s_add_u32 s63, s63, 1
    s_cmp_gt_u32 s63, 400000
    s_cbranch_scc1 POLLX_251
POLLB_250:
    buffer_load_dwordx3 v[212:214], v1, s[32:35], s69 offen offset:0 sc1
    buffer_load_dwordx3 v[216:218], v1, s[32:35], s69 offen offset:1024 sc1
    buffer_load_dwordx3 v[220:222], v1, s[32:35], s69 offen offset:2048 sc1
    buffer_load_dwordx3 v[224:226], v1, s[32:35], s69 offen offset:3072 sc1
    s_waitcnt vmcnt(0)
    v_cmp_ne_u32 vcc, s97, v214
    s_cbranch_vccnz POLL_249
    v_cmp_ne_u32 vcc, s97, v218
    s_cbranch_vccnz POLL_249
    v_cmp_ne_u32 vcc, s97, v222
    s_cbranch_vccnz POLL_249
    v_cmp_ne_u32 vcc, s97, v226
    s_cbranch_vccnz POLL_249
POLLX_251:
    s_branch BACK_196
SPIN_198:
    s_mov_b32 s63, 0
    s_branch POLLB_253
POLL_252:
    s_sleep 2
    s_add_u32 s63, s63, 1
    s_cmp_gt_u32 s63, 400000
    s_cbranch_scc1 POLLX_254
POLLB_253:
    buffer_load_dword v30, v31, s[32:35], s66 offen sc1
    s_waitcnt vmcnt(0)
    v_cmp_ne_u32 vcc, s97, v30
    s_cbranch_vccnz POLL_252
POLLX_254:
    s_branch BACK_199
SPIN_200:
    s_mov_b32 s63, 0
    s_branch POLLB_256
POLL_255:
    s_sleep 2
    s_add_u32 s63, s63, 1
    s_cmp_gt_u32 s63, 400000
    s_cbranch_scc1 POLLX_257
POLLB_256:
    buffer_load_dwordx3 v[116:118], v1, s[32:35], s67 offen offset:0 sc1
    buffer_load_dwordx3 v[120:122], v1, s[32:35], s67 offen offset:1024 sc1
    buffer_load_dwordx3 v[124:126], v1, s[32:35], s67 offen offset:2048 sc1
    buffer_load_dwordx3 v[128:130], v1, s[32:35], s67 offen offset:3072 sc1
    s_waitcnt vmcnt(0)
    v_cmp_ne_u32 vcc, s97, v118
    s_cbranch_vccnz POLL_255
    v_cmp_ne_u32 vcc, s97, v122
    s_cbranch_vccnz POLL_255
    v_cmp_ne_u32 vcc, s97, v126
    s_cbranch_vccnz POLL_255
    v_cmp_ne_u32 vcc, s97, v130
    s_cbranch_vccnz POLL_255
POLLX_257:
    s_branch BACK_201
SPIN_202:
    s_mov_b32 s63, 0
    s_branch POLLB_259
POLL_258:
    s_sleep 2
    s_add_u32 s63, s63, 1
    s_cmp_gt_u32 s63, 400000
    s_cbranch_scc1 POLLX_260
POLLB_259:
    buffer_load_dwordx3 v[112:114], v1, s[32:35], s69 offen offset:0 sc1
    buffer_load_dwordx3 v[116:118], v1, s[32:35], s69 offen offset:1024 sc1
    buffer_load_dwordx3 v[120:122], v1, s[32:35], s69 offen offset:2048 sc1
    buffer_load_dwordx3 v[124:126], v1, s[32:35], s69 offen offset:3072 sc1
    s_waitcnt vmcnt(0)
    v_cmp_ne_u32 vcc, s97, v114
    s_cbranch_vccnz POLL_258
    v_cmp_ne_u32 vcc, s97, v118
    s_cbranch_vccnz POLL_258
    v_cmp_ne_u32 vcc, s97, v122
    s_cbranch_vccnz POLL_258
    v_cmp_ne_u32 vcc, s97, v126
    s_cbranch_vccnz POLL_258
POLLX_260:
    s_branch BACK_203
SPIN_206:
    s_mov_b32 s63, 0
    s_branch POLLB_262
POLL_261:
    s_sleep 2
    s_add_u32 s63, s63, 1
    s_cmp_gt_u32 s63, 400000
    s_cbranch_scc1 POLLX_263
POLLB_262:
    buffer_load_dword v120, v121, s[32:35], s66 offen sc1
    s_waitcnt vmcnt(0)
    v_cmp_ne_u32 vcc, s97, v120
    s_cbranch_vccnz POLL_261
POLLX_263:
    s_branch BACK_207
SPIN_208:
    s_mov_b32 s63, 0
    s_branch POLLB_265
POLL_264:
    s_sleep 2
    s_add_u32 s63, s63, 1
    s_cmp_gt_u32 s63, 400000
    s_cbranch_scc1 POLLX_266
POLLB_265:
    buffer_load_dwordx3 v[120:122], v1, s[32:35], s69 offen offset:0 sc1
    buffer_load_dwordx3 v[124:126], v1, s[32:35], s69 offen offset:1024 sc1
    buffer_load_dwordx3 v[128:130], v1, s[32:35], s69 offen offset:2048 sc1
    buffer_load_dwordx3 v[132:134], v1, s[32:35], s69 offen offset:3072 sc1
    s_waitcnt vmcnt(0)
    v_cmp_ne_u32 vcc, s97, v122
    s_cbranch_vccnz POLL_264
    v_cmp_ne_u32 vcc, s97, v126
    s_cbranch_vccnz POLL_264
    v_cmp_ne_u32 vcc, s97, v130
    s_cbranch_vccnz POLL_264
    v_cmp_ne_u32 vcc, s97, v134
    s_cbranch_vccnz POLL_264
POLLX_266:
    s_branch BACK_209
SPIN_210:
    s_mov_b32 s63, 0
    s_branch POLLB_268
POLL_267:
    s_sleep 2
    s_add_u32 s63, s63, 1
    s_cmp_gt_u32 s63, 400000
    s_cbranch_scc1 POLLX_269
POLLB_268:
    buffer_load_dword v120, v121, s[32:35], s67 offen sc1
    s_waitcnt vmcnt(0)
    v_cmp_ne_u32 vcc, s97, v120
    s_cbranch_vccnz POLL_267
POLLX_269:
    s_branch BACK_211
SPIN_214:
    s_mov_b32 s63, 0
    s_branch POLLB_271
POLL_270:
    s_sleep 2
    s_add_u32 s63, s63, 1
    s_cmp_gt_u32 s63, 400000
    s_cbranch_scc1 POLLX_272
POLLB_271:
    buffer_load_dword v120, v121, s[32:35], s67 offen sc1
    s_waitcnt vmcnt(0)
    v_cmp_ne_u32 vcc, s97, v120
    s_cbranch_vccnz POLL_270
POLLX_272:
    s_branch BACK_215
END:
    s_endpgm
.section .rodata,"a"
.p2align 6
.amdhsa_kernel interleave_layers__ssm_conv_h3__dense_activation_mish__prompt_kernel
  .amdhsa_next_free_vgpr 512
  .amdhsa_next_free_sgpr 102
  .amdhsa_accum_offset 256
  .amdhsa_group_segment_fixed_size 0
  .amdhsa_kernarg_size 104
  .amdhsa_user_sgpr_count 2
  .amdhsa_user_sgpr_kernarg_segment_ptr 1
  .amdhsa_system_sgpr_workgroup_id_x 1
  .amdhsa_float_denorm_mode_32 3
.end_amdhsa_kernel
```
